```python
import torch

def _softmax(x, axis=-1):
    return torch.softmax(x, dim=axis)
def _gelu(x):
    return torch.nn.functional.gelu(x, approximate="tanh")
def _silu(x):
    return torch.nn.functional.silu(x)
def _sigmoid(x):
    return torch.sigmoid(x)
def _layernorm(x, axis=-1, eps=1e-5):
    m = x.mean(dim=axis, keepdim=True)
    v = x.var(dim=axis, keepdim=True, unbiased=False)
    return (x - m) / torch.sqrt(v + eps)
def _scatter_add(tgt, idx, src, axis=0):
    return tgt.clone().index_add_(axis, idx, src)
def _segment_sum(src, seg, n):
    out = torch.zeros((n,) + src.shape[1:], dtype=src.dtype)
    return out.index_add_(0, seg, src)
def _pad(x, pw):
    flat = tuple(v for pair in reversed(pw) for v in pair)
    return torch.nn.functional.pad(x, flat)

kernel_name = 'parallel_sum__ssm_conv_s4d__dense_activation_relu__prompt'

def setup_inputs():

    _w = (lambda a: (lambda t: t.to(torch.bfloat16) if t.is_floating_point() else t)(torch.as_tensor(a)))
    def _A_setup():
        Bsz, L, D, N = 1, 2048, 576, 128
        return {
            "u": _w((lambda *s: torch.randn(*s, dtype=torch.bfloat16) * 0.05)(Bsz, L, D)),
            "log_A_real": _w((lambda *s: torch.randn(*s, dtype=torch.bfloat16) * 3.2)(D, N) * 0.5),
            "A_imag": _w((lambda *s: torch.randn(*s, dtype=torch.bfloat16) * 0.2)(D, N) * 3.14),
            "C_real": _w((lambda *s: torch.randn(*s, dtype=torch.bfloat16) * 3.2)(D, N) / N ** 0.5),
            "C_imag": _w((lambda *s: torch.randn(*s, dtype=torch.bfloat16) * 3.2)(D, N) / N ** 0.5),
            "log_dt": _w((lambda *s: torch.randn(*s, dtype=torch.bfloat16) * 0.2)(D) * 0.5 - 4.0),
            "D_skip": _w((lambda *s: torch.randn(*s, dtype=torch.bfloat16) * 0.4)(D)),
        }
    _A_in = _A_setup()

    def _B_setup():
        B, S, D, Dff = 1, 2048, 576, 4608
        return {
            "x": _w((lambda *s: torch.randn(*s, dtype=torch.bfloat16) * 0.05)(B, S, D)),
            "w1": _w((lambda *s: torch.randn(*s, dtype=torch.bfloat16) * 0.05)(D, Dff)),
            "w2": _w((lambda *s: torch.randn(*s, dtype=torch.bfloat16) * 0.05)(Dff, D)),
        }
    _B_in = _B_setup()

    return {
        "A_u": _A_in["u"],
        "A_log_A_real": _A_in["log_A_real"],
        "A_A_imag": _A_in["A_imag"],
        "A_C_real": _A_in["C_real"],
        "A_C_imag": _A_in["C_imag"],
        "A_log_dt": _A_in["log_dt"],
        "A_D_skip": _A_in["D_skip"],
        "B_x": _B_in["x"],
        "B_w1": _B_in["w1"],
        "B_w2": _B_in["w2"],
    }

def reference(A_u, A_log_A_real, A_A_imag, A_C_real, A_C_imag, A_log_dt, A_D_skip, B_x, B_w1, B_w2):
    def _A_ref(u, log_A_real, A_imag, C_real, C_imag, log_dt, D_skip):
        L = u.shape[1]
        dt = torch.exp(log_dt)
        A = -torch.exp(log_A_real) + 1j * A_imag
        C = (C_real + 1j * C_imag) * dt[:, None]
        pos = (lambda x, dt: x.to(dt))(torch.arange(L), log_dt.dtype)
        P = torch.exp((A * dt[:, None])[:, :, None] * pos[None, None, :])
        K = 2.0 * torch.einsum("dn,dnl->dl", C, P).real
        L2 = 2 * L
        u_t = (lambda x, *d: x.permute(*d))(u, 0, 2, 1)
        Kf = (lambda x, *a, **k: torch.fft.rfft(x.float(), *a, **k))(K, L2)
        Uf = (lambda x, *a, **k: torch.fft.rfft(x.float(), *a, **k))(u_t, L2)
        y = (lambda x, *a, **k: torch.fft.irfft(x, *a, **k).to(torch.bfloat16))(Uf * Kf[None, :, :], L2)[:, :, :L]
        y = (lambda x, *d: x.permute(*d))(y, 0, 2, 1)
        return y + u * D_skip[None, None, :]

    def _B_ref(x, w1, w2):
        h = torch.einsum("bsd,df->bsf", x, w1)
        zero = torch.zeros_like(h)
        h = torch.maximum(h, zero)
        return torch.einsum("bsf,fd->bsd", h, w2)

    x = A_u
    xn = _layernorm(x, axis=-1)
    return x + _A_ref(xn, A_log_A_real, A_A_imag, A_C_real, A_C_imag, A_log_dt, A_D_skip) + _B_ref(xn, B_w1, B_w2)
```

```asm
; @launch grid=(256,1,1) block=(256,1,1) lds=163840
.amdgcn_target "amdgcn-amd-amdhsa--gfx950"
.text
.globl parallel_sum__ssm_conv_s4d__dense_activation_relu__prompt_kernel
.p2align 8
.type parallel_sum__ssm_conv_s4d__dense_activation_relu__prompt_kernel,@function
parallel_sum__ssm_conv_s4d__dense_activation_relu__prompt_kernel:
    s_cmp_ge_u32 s2, 256
    s_cbranch_scc1 L_main_end
    s_bfe_u32 s60, s2, 0x20003
    s_lshl_b32 s60, s60, 3
    s_lshr_b32 s61, s2, 5
    s_add_u32 s60, s60, s61
    s_and_b32 s61, s2, 7
    s_cmp_ge_u32 s60, 24
    s_cbranch_scc1 L_conv
    s_load_dwordx2 s[4:5], s[0:1], 0
    s_load_dwordx4 s[8:11], s[0:1], 64
    s_load_dwordx4 s[48:51], s[0:1], 80
    s_load_dwordx2 s[52:53], s[0:1], 96
    v_lshrrev_b32 v1, 6, v0
    s_nop 0
    v_readfirstlane_b32 s3, v1
    v_and_b32 v0, 63, v0
    s_cmp_lg_u32 s3, 0
    s_cbranch_scc1 L_pc1_skip
    s_getpc_b64 s[40:41]
L_pc1:
    s_add_u32 s40, s40, L_mlp-L_pc1
    s_addc_u32 s41, s41, 0
    s_add_u32 s42, s60, s3
    s_and_b32 s42, s42, 7
    s_lshl_b32 s42, s42, 13
    v_lshl_add_u32 v252, v0, 7, s42
    v_min_u32 v252, L_code_end-L_mlp-4, v252
    v_mov_b32 v253, s41
    v_add_co_u32 v252, vcc, s40, v252
    s_nop 1
    v_addc_co_u32 v253, vcc, 0, v253, vcc
    global_load_dword v251, v[252:253], off
L_pc1_skip:
    s_and_b32 s62, s61, 1
    s_lshl_b32 s62, s62, 3
    s_and_b32 s40, s60, 7
    s_add_u32 s62, s62, s40
    s_lshr_b32 s89, s61, 1
    s_mul_i32 s63, s89, 3
    s_lshr_b32 s39, s60, 3
    s_add_u32 s63, s63, s39
    s_and_b32 s40, s62, 7
    s_mul_i32 s41, s40, 256
    s_lshr_b32 s41, s41, 8
    s_mul_i32 s41, s41, 1
    s_sub_u32 s38, s40, s41
    s_mul_i32 s38, s38, 6
    s_waitcnt lgkmcnt(0)
    s_lshl_b32 s40, s62, 2
    s_add_u32 s40, s40, s3
    s_mul_i32 s40, s40, 36864
    s_add_u32 s12, s4, s40
    s_addc_u32 s13, s5, 0
    s_mov_b32 s14, 36864
    s_mov_b32 s15, 0x20000
    s_add_u32 s29, s3, 1
    s_lshl_b32 s29, s29, 15
    v_lshrrev_b32 v80, 3, v0
    v_and_b32 v81, 7, v0
    v_lshrrev_b32 v1, 1, v80
    v_xor_b32 v1, v1, v81
    v_mul_u32_u24 v82, 1152, v80
    v_lshl_add_u32 v243, v1, 4, v82
    v_xor_b32 v244, 64, v243
    v_add_u32 v244, 8192, v244
    s_add_u32 m0, s29, 0
    s_movk_i32 s30, 0
    buffer_load_dwordx4 v243, s[12:15], s30 offen  lds
    buffer_load_dwordx4 v244, s[12:15], s30 offen offset:1024  lds
    s_add_u32 m0, s29, 2048
    s_movk_i32 s30, 128
    buffer_load_dwordx4 v243, s[12:15], s30 offen  lds
    buffer_load_dwordx4 v244, s[12:15], s30 offen offset:1024  lds
    s_add_u32 m0, s29, 4096
    s_movk_i32 s30, 256
    buffer_load_dwordx4 v243, s[12:15], s30 offen  lds
    buffer_load_dwordx4 v244, s[12:15], s30 offen offset:1024  lds
    s_add_u32 m0, s29, 6144
    s_movk_i32 s30, 384
    buffer_load_dwordx4 v243, s[12:15], s30 offen  lds
    buffer_load_dwordx4 v244, s[12:15], s30 offen offset:1024  lds
    s_mov_b64 s[6:7], s[8:9]
    s_mov_b64 s[8:9], s[10:11]
    s_branch L_mlp
L_conv:
    s_load_dwordx2 s[6:7], s[0:1], 0
    s_load_dwordx8 s[76:83], s[0:1], 8
    s_load_dwordx4 s[84:87], s[0:1], 40
    s_load_dwordx2 s[4:5], s[0:1], 96
    s_load_dwordx4 s[8:11], s[0:1], 80
    s_load_dwordx4 s[48:51], s[0:1], 64
    v_lshrrev_b32 v1, 6, v0
    s_nop 0
    v_readfirstlane_b32 s3, v1
    v_and_b32 v0, 63, v0
    s_cmp_lg_u32 s3, 0
    s_cbranch_scc1 L_pc2_skip
    s_getpc_b64 s[40:41]
L_pc2:
    s_add_u32 s40, s40, L_conv2-L_pc2
    s_addc_u32 s41, s41, 0
    s_add_u32 s42, s60, s3
    s_and_b32 s42, s42, 7
    s_lshl_b32 s42, s42, 13
    v_lshl_add_u32 v252, v0, 7, s42
    v_min_u32 v252, L_code_end-L_conv2-4, v252
    v_mov_b32 v253, s41
    v_add_co_u32 v252, vcc, s40, v252
    s_nop 1
    v_addc_co_u32 v253, vcc, 0, v253, vcc
    global_load_dword v251, v[252:253], off
L_pc2_skip:
    s_sub_u32 s60, s60, 24
    s_lshl_b32 s60, s60, 3
    s_add_u32 s60, s60, s61
    s_mul_i32 s63, s60, 9
    s_add_u32 s62, s63, s3
    s_lshr_b32 s89, s60, 3
    s_and_b32 s40, s61, 1
    s_lshl_b32 s40, s40, 5
    s_add_u32 s89, s89, s40
    s_lshr_b32 s40, s61, 1
    s_lshl_b32 s40, s40, 3
    s_add_u32 s89, s89, s40
    s_waitcnt lgkmcnt(0)
    s_mov_b32 s32, s6
    s_mov_b32 s33, s7
    s_mov_b32 s34, 2359296
    s_mov_b32 s35, 0x20000
    v_lshrrev_b32 v1, 3, v0
    v_and_b32 v2, 7, v0
    s_lshl_b32 s40, s3, 3
    v_add_u32 v1, s40, v1
    s_mul_i32 s41, s89, 36864
    v_mul_u32_u24 v3, 1152, v1
    v_lshl_add_u32 v3, v2, 4, v3
    buffer_load_dwordx4 v[16:19], v3, s[32:35], s41 offen offset:0
    buffer_load_dwordx4 v[20:23], v3, s[32:35], s41 offen offset:128
    buffer_load_dwordx4 v[24:27], v3, s[32:35], s41 offen offset:256
    buffer_load_dwordx4 v[28:31], v3, s[32:35], s41 offen offset:384
    buffer_load_dwordx4 v[32:35], v3, s[32:35], s41 offen offset:512
    buffer_load_dwordx4 v[36:39], v3, s[32:35], s41 offen offset:640
    buffer_load_dwordx4 v[40:43], v3, s[32:35], s41 offen offset:768
    buffer_load_dwordx4 v[44:47], v3, s[32:35], s41 offen offset:896
    buffer_load_dwordx4 v[48:51], v3, s[32:35], s41 offen offset:1024
    v_mul_u32_u24 v4, 1168, v1
    v_lshl_add_u32 v4, v2, 4, v4
    v_lshrrev_b32 v5, 4, v0
    v_bfe_u32 v6, v0, 2, 2
    v_lshl_add_u32 v6, v5, 3, v6
    v_sub_u32 v6, 27, v6
    v_mul_u32_u24 v6, 1168, v6
    v_and_b32 v7, 3, v0
    v_lshl_add_u32 v6, v7, 3, v6
    s_mul_i32 s43, s3, 288
    v_add_u32 v6, s43, v6
    v_and_b32 v7, 15, v0
    s_mul_i32 s43, s3, 144
    v_add_u32 v7, s43, v7
    v_mul_u32_u24 v7, 4224, v7
    v_lshl_add_u32 v7, v5, 4, v7
    s_lshl_b32 s43, s89, 6
    s_sub_u32 s43, 4032, s43
    v_add_u32 v7, s43, v7
    s_mov_b32 s12, s76
    s_mov_b32 s13, s77
    s_mov_b32 s14, 147456
    s_mov_b32 s15, 0x20000
    s_mov_b32 s16, s78
    s_mov_b32 s17, s79
    s_mov_b32 s18, 147456
    s_mov_b32 s19, 0x20000
    s_mov_b32 s20, s80
    s_mov_b32 s21, s81
    s_mov_b32 s22, 147456
    s_mov_b32 s23, 0x20000
    s_mov_b32 s24, s82
    s_mov_b32 s25, s83
    s_mov_b32 s26, 147456
    s_mov_b32 s27, 0x20000
    s_mov_b32 s36, s84
    s_mov_b32 s37, s85
    s_mov_b32 s38, 1152
    s_mov_b32 s39, 0x20000
    s_mov_b32 s56, s86
    s_mov_b32 s57, s87
    s_mov_b32 s58, 1152
    s_mov_b32 s59, 0x20000
    v_lshlrev_b32 v155, 2, v0
    s_lshl_b32 s54, s62, 8
    buffer_load_dword v140, v155, s[12:15], s54 offen
    buffer_load_dword v141, v155, s[16:19], s54 offen
    buffer_load_dword v142, v155, s[20:23], s54 offen
    buffer_load_dword v143, v155, s[24:27], s54 offen
    s_lshl_b32 s54, s62, 1
    buffer_load_ushort v144, off, s[36:39], s54
    buffer_load_ushort v145, off, s[56:59], s54
    s_mov_b32 s28, s4
    s_mov_b32 s29, s5
    s_mov_b32 s30, 4866176
    s_mov_b32 s31, 0x20000
    s_add_u32 s32, s4, 36732928
    s_addc_u32 s33, s5, 0
    s_mov_b32 s34, 8192
    s_mov_b32 s68, s10
    s_mov_b32 s69, s11
    s_mov_b32 s70, 256
    s_mov_b32 s71, 0x20000
    s_add_u32 s72, s4, 36700160
    s_addc_u32 s73, s5, 0
    s_mov_b32 s74, 32768
    s_mov_b32 s75, 0x20000
    s_cmp_eq_u32 s3, 0
    s_cselect_b32 s66, 1, 0
    s_mov_b32 s67, 0
    s_lshr_b32 s101, s89, 2
    s_mul_i32 s40, s101, 1536
    v_lshlrev_b32 v253, 7, v0
    v_add_u32 v253, s40, v253
    s_lshl_b32 s100, s60, 7
    s_add_u32 s100, s100, 24576
    v_mov_b32 v252, s100
    v_cmp_eq_u32 vcc, 12, v0
    s_mul_i32 s42, s66, 0x1fff
    s_mov_b32 s43, 0
    v_cndmask_b32 v253, v253, v252, vcc
    v_mov_b32 v244, 0
    v_mov_b32 v245, 0
    v_mov_b32 v246, 0
    v_mov_b32 v247, 0
    v_add_u32 v252, s63, v0
    v_mul_u32_u24 v252, 4224, v252
    s_mov_b64 exec, s[42:43]
    buffer_store_dword v244, v253, s[72:75], 0 offen sc1
    s_mul_i32 s42, s66, 0x1ff
    s_movk_i32 s40, 4096
    s_mov_b64 exec, s[42:43]
    buffer_store_dwordx4 v[244:247], v252, s[28:31], s40 offen sc1
    s_mov_b64 exec, -1
    s_mov_b32 s76, s48
    s_mov_b32 s77, s49
    s_mov_b32 s78, 5308416
    s_mov_b32 s79, 0x20000
    s_mov_b32 s80, s50
    s_mov_b32 s81, s51
    s_mov_b32 s82, 5308416
    s_mov_b32 s83, 0x20000
    s_lshr_b32 s40, s61, 1
    s_lshr_b32 s41, s60, 3
    s_lshl_b32 s41, s41, 2
    s_add_u32 s41, s41, s3
    s_lshl_b32 s41, s41, 1
    s_and_b32 s42, s61, 1
    s_add_u32 s41, s41, s42
    s_mul_i32 s84, s40, 2304
    s_mul_i32 s42, s41, 82944
    s_add_u32 s84, s84, s42
    s_mul_i32 s85, s40, 1327104
    s_mul_i32 s42, s41, 6912
    s_add_u32 s85, s85, s42
    v_min_u32 v240, 53, v0
    v_lshlrev_b32 v242, 7, v240
    v_mul_u32_u24 v241, 43, v240
    v_lshrrev_b32 v241, 8, v241
    v_mul_u32_u24 v243, 6, v241
    v_sub_u32 v240, v240, v243
    v_mul_u32_u24 v241, 9216, v241
    v_lshrrev_b32 v243, 1, v240
    v_mul_u32_u24 v243, 768, v243
    v_and_b32 v240, 1, v240
    v_lshl_add_u32 v240, v240, 7, v243
    v_add_u32 v240, v240, v241
    buffer_load_dword v243, v240, s[76:79], s84 offen offset:0
    buffer_load_dword v243, v240, s[76:79], s84 offen offset:256
    s_branch L_conv2
.p2align 12
L_mlp:
    s_mov_b64 exec, 0
    s_cmp_eq_u32 s3, 0
    s_cbranch_scc1 L_pm0
    s_cmp_eq_u32 s3, 1
    s_cbranch_scc1 L_pm1
    s_cmp_eq_u32 s3, 2
    s_cbranch_scc1 L_pm2
    s_branch L_pm3
L_pmb0:
    s_mov_b64 exec, -1
    s_add_u32 m0, s29, 8192
    s_movk_i32 s30, 512
    buffer_load_dwordx4 v243, s[12:15], s30 offen  lds
    buffer_load_dwordx4 v244, s[12:15], s30 offen offset:1024  lds
    s_mul_i32 s40, s63, 768
    s_add_u32 s16, s6, s40
    s_addc_u32 s17, s7, 0
    s_sub_u32 s18, 5308416, s40
    s_mov_b32 s19, 0x20000
    s_lshl_b32 s32, s38, 7
    s_lshl_b32 s28, s3, 11
    v_lshrrev_b32 v80, 3, v0
    v_and_b32 v81, 7, v0
    s_lshl_b32 s43, s3, 3
    v_add_u32 v80, s43, v80
    v_bfe_u32 v1, v80, 1, 2
    v_lshlrev_b32 v1, 1, v1
    v_xor_b32 v1, v1, v81
    v_lshlrev_b32 v1, 4, v1
    v_mul_u32_u24 v82, 9216, v80
    v_add_u32 v2, v1, v82
    v_add_u32 v3, 293888, v2
    v_mul_u32_u24 v82, 1152, v80
    v_add_u32 v4, v1, v82
    v_add_u32 v5, 35840, v4
    s_add_u32 m0, s29, 10240
    s_movk_i32 s30, 640
    buffer_load_dwordx4 v243, s[12:15], s30 offen  lds
    buffer_load_dwordx4 v244, s[12:15], s30 offen offset:1024  lds
    v_and_b32 v80, 15, v0
    v_lshrrev_b32 v81, 4, v0
    v_lshrrev_b32 v82, 1, v80
    v_xor_b32 v81, v81, v82
    v_lshlrev_b32 v81, 4, v81
    v_lshl_or_b32 v81, v80, 7, v81
    v_add_u32 v245, s29, v81
    v_xor_b32 v246, 64, v245
    v_mov_b32 v80, 0x3f803f80
    v_mov_b32 v81, v80
    v_mov_b32 v82, v80
    v_mov_b32 v83, v80
    s_mov_b64 exec, 0
    s_cmp_eq_u32 s3, 0
    s_cbranch_scc1 L_pm4
    s_cmp_eq_u32 s3, 1
    s_cbranch_scc1 L_pm5
    s_cmp_eq_u32 s3, 2
    s_cbranch_scc1 L_pm6
    s_branch L_pm7
L_pmb1:
    s_mov_b64 exec, -1
    s_add_u32 m0, s29, 12288
    s_movk_i32 s30, 768
    buffer_load_dwordx4 v243, s[12:15], s30 offen  lds
    buffer_load_dwordx4 v244, s[12:15], s30 offen offset:1024  lds
    s_add_u32 m0, s29, 14336
    s_movk_i32 s30, 896
    buffer_load_dwordx4 v243, s[12:15], s30 offen  lds
    buffer_load_dwordx4 v244, s[12:15], s30 offen offset:1024  lds
    v_and_b32 v92, 15, v0
    v_lshrrev_b32 v93, 4, v0
    v_lshlrev_b32 v93, 3, v93
    v_sub_u32 v92, v92, v93
    v_and_b32 v94, 1, v92
    v_lshlrev_b32 v94, 4, v94
    v_mov_b32 v95, 0x3f80
    v_lshlrev_b32 v94, v94, v95
    v_ashrrev_i32 v92, 1, v92
    v_cmp_eq_u32 vcc, 0, v92
    s_nop 1
    v_cndmask_b32 v84, 0, v94, vcc
    v_cmp_eq_u32 vcc, 1, v92
    s_nop 1
    v_cndmask_b32 v85, 0, v94, vcc
    v_cmp_eq_u32 vcc, 2, v92
    s_nop 1
    v_cndmask_b32 v86, 0, v94, vcc
    v_cmp_eq_u32 vcc, 3, v92
    s_nop 1
    v_cndmask_b32 v87, 0, v94, vcc
    v_cmp_eq_u32 vcc, -8, v92
    s_nop 1
    v_cndmask_b32 v88, 0, v94, vcc
    v_cmp_eq_u32 vcc, -7, v92
    s_nop 1
    v_cndmask_b32 v89, 0, v94, vcc
    v_cmp_eq_u32 vcc, -6, v92
    s_nop 1
    v_cndmask_b32 v90, 0, v94, vcc
    v_cmp_eq_u32 vcc, -5, v92
    s_nop 1
    v_cndmask_b32 v91, 0, v94, vcc
    s_add_u32 m0, s29, 16384
    s_movk_i32 s30, 1024
    buffer_load_dwordx4 v243, s[12:15], s30 offen  lds
    buffer_load_dwordx4 v244, s[12:15], s30 offen offset:1024  lds
    s_waitcnt vmcnt(16)
    ds_read_b128 a[0:3], v245 offset:0
    ds_read_b128 a[4:7], v246 offset:0
    s_waitcnt vmcnt(14)
    ds_read_b128 a[8:11], v245 offset:2048
    ds_read_b128 a[12:15], v246 offset:2048
    s_waitcnt lgkmcnt(3)
    v_mfma_f32_16x16x32_bf16 v[16:19], v[80:83], a[0:3], 0
    s_waitcnt lgkmcnt(2)
    v_mfma_f32_16x16x32_bf16 v[16:19], v[80:83], a[4:7], v[16:19]
    s_waitcnt vmcnt(12)
    ds_read_b128 a[16:19], v245 offset:4096
    ds_read_b128 a[20:23], v246 offset:4096
    s_add_u32 m0, s29, 18432
    s_movk_i32 s30, 18432
    buffer_load_dwordx4 v243, s[12:15], s30 offen  lds
    buffer_load_dwordx4 v244, s[12:15], s30 offen offset:1024  lds
    s_waitcnt lgkmcnt(3)
    v_mfma_f32_16x16x32_bf16 v[16:19], v[80:83], a[8:11], v[16:19]
    s_waitcnt lgkmcnt(2)
    v_mfma_f32_16x16x32_bf16 v[16:19], v[80:83], a[12:15], v[16:19]
    s_mov_b64 exec, 0
    s_cmp_eq_u32 s3, 0
    s_cbranch_scc1 L_pm8
    s_cmp_eq_u32 s3, 1
    s_cbranch_scc1 L_pm9
    s_cmp_eq_u32 s3, 2
    s_cbranch_scc1 L_pmb2
    s_branch L_pmb2
L_pmb2:
    s_mov_b64 exec, -1
    s_add_u32 m0, s29, 20480
    s_movk_i32 s30, 18560
    buffer_load_dwordx4 v243, s[12:15], s30 offen  lds
    buffer_load_dwordx4 v244, s[12:15], s30 offen offset:1024  lds
    s_waitcnt vmcnt(14)
    ds_read_b128 a[24:27], v245 offset:6144
    ds_read_b128 a[28:31], v246 offset:6144
    s_add_u32 m0, s29, 22528
    s_movk_i32 s30, 18688
    buffer_load_dwordx4 v243, s[12:15], s30 offen  lds
    buffer_load_dwordx4 v244, s[12:15], s30 offen offset:1024  lds
    s_waitcnt lgkmcnt(3)
    v_mfma_f32_16x16x32_bf16 v[16:19], v[80:83], a[16:19], v[16:19]
    s_waitcnt lgkmcnt(2)
    v_mfma_f32_16x16x32_bf16 v[16:19], v[80:83], a[20:23], v[16:19]
    s_waitcnt vmcnt(14)
    ds_read_b128 a[32:35], v245 offset:8192
    ds_read_b128 a[36:39], v246 offset:8192
    s_waitcnt lgkmcnt(3)
    v_mfma_f32_16x16x32_bf16 v[16:19], v[80:83], a[24:27], v[16:19]
    s_waitcnt lgkmcnt(2)
    v_mfma_f32_16x16x32_bf16 v[16:19], v[80:83], a[28:31], v[16:19]
    v_lshrrev_b32 v72, 4, v0
    v_bfe_u32 v73, v0, 2, 2
    v_and_b32 v74, 3, v0
    v_lshrrev_b32 v1, 1, v73
    v_and_b32 v75, 1, v72
    v_lshl_or_b32 v1, v75, 1, v1
    v_lshlrev_b32 v1, 5, v1
    v_lshl_or_b32 v1, v74, 3, v1
    v_lshl_or_b32 v1, v73, 7, v1
    v_lshl_or_b32 v1, v75, 9, v1
    v_lshrrev_b32 v72, 1, v72
    v_lshl_or_b32 v6, v72, 11, v1
    v_xor_b32 v7, 32, v6
    v_xor_b32 v8, 64, v6
    v_xor_b32 v9, 96, v6
    v_add_u32 v10, 0x10000, v6
    v_add_u32 v11, 0x10000, v7
    v_add_u32 v12, 0x10000, v8
    v_add_u32 v13, 0x10000, v9
    s_add_u32 m0, s29, 24576
    s_movk_i32 s30, 18816
    buffer_load_dwordx4 v243, s[12:15], s30 offen  lds
    buffer_load_dwordx4 v244, s[12:15], s30 offen offset:1024  lds
    s_waitcnt vmcnt(14)
    ds_read_b128 a[40:43], v245 offset:10240
    ds_read_b128 a[44:47], v246 offset:10240
    s_waitcnt lgkmcnt(3)
    v_mfma_f32_16x16x32_bf16 v[16:19], v[80:83], a[32:35], v[16:19]
    s_waitcnt lgkmcnt(2)
    v_mfma_f32_16x16x32_bf16 v[16:19], v[80:83], a[36:39], v[16:19]
    s_waitcnt vmcnt(12)
    ds_read_b128 a[48:51], v245 offset:12288
    ds_read_b128 a[52:55], v246 offset:12288
    s_waitcnt lgkmcnt(3)
    v_mfma_f32_16x16x32_bf16 v[16:19], v[80:83], a[40:43], v[16:19]
    s_waitcnt lgkmcnt(2)
    v_mfma_f32_16x16x32_bf16 v[16:19], v[80:83], a[44:47], v[16:19]
    s_add_u32 m0, s29, 26624
    s_movk_i32 s30, 18944
    buffer_load_dwordx4 v243, s[12:15], s30 offen  lds
    buffer_load_dwordx4 v244, s[12:15], s30 offen offset:1024  lds
    s_add_u32 s40, s38, 1
    s_sub_u32 s41, s40, 6
    s_cselect_b32 s40, s40, s41
    s_lshl_b32 s33, s40, 7
    s_add_u32 s40, s38, 2
    s_sub_u32 s41, s40, 6
    s_cselect_b32 s40, s40, s41
    s_lshl_b32 s34, s40, 7
    s_add_u32 s40, s38, 3
    s_sub_u32 s41, s40, 6
    s_cselect_b32 s40, s40, s41
    s_lshl_b32 s35, s40, 7
    s_add_u32 s40, s38, 4
    s_sub_u32 s41, s40, 6
    s_cselect_b32 s40, s40, s41
    s_lshl_b32 s36, s40, 7
    s_add_u32 s40, s38, 5
    s_sub_u32 s41, s40, 6
    s_cselect_b32 s40, s40, s41
    s_lshl_b32 s37, s40, 7
    s_waitcnt vmcnt(12)
    ds_read_b128 a[56:59], v245 offset:14336
    ds_read_b128 a[60:63], v246 offset:14336
    s_waitcnt lgkmcnt(3)
    v_mfma_f32_16x16x32_bf16 v[16:19], v[80:83], a[48:51], v[16:19]
    s_waitcnt lgkmcnt(2)
    v_mfma_f32_16x16x32_bf16 v[16:19], v[80:83], a[52:55], v[16:19]
    s_add_u32 m0, s29, 28672
    s_movk_i32 s30, 19072
    buffer_load_dwordx4 v243, s[12:15], s30 offen  lds
    buffer_load_dwordx4 v244, s[12:15], s30 offen offset:1024  lds
    s_waitcnt vmcnt(12)
    ds_read_b128 a[64:67], v245 offset:16384
    ds_read_b128 a[68:71], v246 offset:16384
    s_waitcnt lgkmcnt(3)
    v_mfma_f32_16x16x32_bf16 v[16:19], v[80:83], a[56:59], v[16:19]
    s_waitcnt lgkmcnt(2)
    v_mfma_f32_16x16x32_bf16 v[16:19], v[80:83], a[60:63], v[16:19]
    s_waitcnt lgkmcnt(1)
    v_mfma_f32_16x16x32_bf16 v[16:19], v[80:83], a[64:67], v[16:19]
    s_waitcnt lgkmcnt(0)
    v_mfma_f32_16x16x32_bf16 v[16:19], v[80:83], a[68:71], v[16:19]
    s_nop 7
    v_mul_f32 v20, 0xbae38e39, v16
    v_cvt_pk_bf16_f32 v20, v20, v20
    v_and_b32 v20, 0xffff0000, v20
    v_mov_b32 v21, v20
    v_mov_b32 v22, v20
    v_mov_b32 v23, v20
    s_nop 1
    s_add_u32 m0, s29, 30720
    s_movk_i32 s30, 19200
    buffer_load_dwordx4 v243, s[12:15], s30 offen  lds
    buffer_load_dwordx4 v244, s[12:15], s30 offen offset:1024  lds
    v_mfma_f32_16x16x32_bf16 v[24:27], v[84:87], a[0:3], v[20:23]
    v_mfma_f32_16x16x32_bf16 v[28:31], v[88:91], a[0:3], v[20:23]
    v_mfma_f32_16x16x32_bf16 v[32:35], v[84:87], a[4:7], v[20:23]
    v_mfma_f32_16x16x32_bf16 v[36:39], v[88:91], a[4:7], v[20:23]
    s_waitcnt vmcnt(12)
    ds_read_b128 a[72:75], v245 offset:18432
    ds_read_b128 a[76:79], v246 offset:18432
    s_nop 3
    v_mfma_f32_16x16x32_bf16 v[40:43], v[84:87], a[8:11], v[20:23]
    v_cvt_pk_bf16_f32 v96, v24, v25
    v_cvt_pk_bf16_f32 v97, v26, v27
    v_mfma_f32_16x16x32_bf16 v[44:47], v[88:91], a[8:11], v[20:23]
    v_cvt_pk_bf16_f32 v98, v28, v29
    v_cvt_pk_bf16_f32 v99, v30, v31
    v_mfma_f32_16x16x32_bf16 v[48:51], v[84:87], a[12:15], v[20:23]
    v_cvt_pk_bf16_f32 v104, v32, v33
    v_cvt_pk_bf16_f32 v105, v34, v35
    v_mfma_f32_16x16x32_bf16 v[52:55], v[88:91], a[12:15], v[20:23]
    v_cvt_pk_bf16_f32 v106, v36, v37
    v_cvt_pk_bf16_f32 v107, v38, v39
    s_add_u32 m0, s29, 0
    s_movk_i32 s30, 19328
    buffer_load_dwordx4 v243, s[12:15], s30 offen  lds
    buffer_load_dwordx4 v244, s[12:15], s30 offen offset:1024  lds
    s_waitcnt vmcnt(12)
    ds_read_b128 a[80:83], v245 offset:20480
    ds_read_b128 a[84:87], v246 offset:20480
    s_waitcnt lgkmcnt(3)
    v_mfma_f32_16x16x32_bf16 v[56:59], v[80:83], a[72:75], 0
    s_waitcnt lgkmcnt(2)
    v_mfma_f32_16x16x32_bf16 v[56:59], v[80:83], a[76:79], v[56:59]
    v_mfma_f32_16x16x32_bf16 v[24:27], v[84:87], a[16:19], v[20:23]
    v_cvt_pk_bf16_f32 v112, v40, v41
    v_cvt_pk_bf16_f32 v113, v42, v43
    v_mfma_f32_16x16x32_bf16 v[28:31], v[88:91], a[16:19], v[20:23]
    v_cvt_pk_bf16_f32 v114, v44, v45
    v_cvt_pk_bf16_f32 v115, v46, v47
    v_mfma_f32_16x16x32_bf16 v[32:35], v[84:87], a[20:23], v[20:23]
    v_cvt_pk_bf16_f32 v120, v48, v49
    v_cvt_pk_bf16_f32 v121, v50, v51
    v_mfma_f32_16x16x32_bf16 v[36:39], v[88:91], a[20:23], v[20:23]
    v_cvt_pk_bf16_f32 v122, v52, v53
    v_cvt_pk_bf16_f32 v123, v54, v55
    s_add_u32 m0, s29, 2048
    s_movk_i32 s30, 19456
    buffer_load_dwordx4 v243, s[12:15], s30 offen  lds
    buffer_load_dwordx4 v244, s[12:15], s30 offen offset:1024  lds
    s_waitcnt vmcnt(12)
    ds_read_b128 a[88:91], v245 offset:22528
    ds_read_b128 a[92:95], v246 offset:22528
    s_waitcnt lgkmcnt(3)
    v_mfma_f32_16x16x32_bf16 v[56:59], v[80:83], a[80:83], v[56:59]
    s_waitcnt lgkmcnt(2)
    v_mfma_f32_16x16x32_bf16 v[56:59], v[80:83], a[84:87], v[56:59]
    v_mfma_f32_16x16x32_bf16 v[40:43], v[84:87], a[24:27], v[20:23]
    v_cvt_pk_bf16_f32 v128, v24, v25
    v_cvt_pk_bf16_f32 v129, v26, v27
    v_mfma_f32_16x16x32_bf16 v[44:47], v[88:91], a[24:27], v[20:23]
    v_cvt_pk_bf16_f32 v130, v28, v29
    v_cvt_pk_bf16_f32 v131, v30, v31
    v_mfma_f32_16x16x32_bf16 v[48:51], v[84:87], a[28:31], v[20:23]
    v_cvt_pk_bf16_f32 v136, v32, v33
    v_cvt_pk_bf16_f32 v137, v34, v35
    v_mfma_f32_16x16x32_bf16 v[52:55], v[88:91], a[28:31], v[20:23]
    v_cvt_pk_bf16_f32 v138, v36, v37
    v_cvt_pk_bf16_f32 v139, v38, v39
    s_add_u32 m0, s28, 0
    s_add_u32 s30, s32, 0
    buffer_load_dwordx4 v2, s[16:19], s30 offen  lds
    buffer_load_dwordx4 v3, s[16:19], s30 offen offset:1024  lds
    s_waitcnt vmcnt(12)
    ds_read_b128 a[96:99], v245 offset:24576
    ds_read_b128 a[100:103], v246 offset:24576
    s_waitcnt lgkmcnt(3)
    v_mfma_f32_16x16x32_bf16 v[56:59], v[80:83], a[88:91], v[56:59]
    s_waitcnt lgkmcnt(2)
    v_mfma_f32_16x16x32_bf16 v[56:59], v[80:83], a[92:95], v[56:59]
    v_mfma_f32_16x16x32_bf16 v[24:27], v[84:87], a[32:35], v[20:23]
    v_cvt_pk_bf16_f32 v144, v40, v41
    v_cvt_pk_bf16_f32 v145, v42, v43
    v_mfma_f32_16x16x32_bf16 v[28:31], v[88:91], a[32:35], v[20:23]
    v_cvt_pk_bf16_f32 v146, v44, v45
    v_cvt_pk_bf16_f32 v147, v46, v47
    v_mfma_f32_16x16x32_bf16 v[32:35], v[84:87], a[36:39], v[20:23]
    v_cvt_pk_bf16_f32 v152, v48, v49
    v_cvt_pk_bf16_f32 v153, v50, v51
    v_mfma_f32_16x16x32_bf16 v[36:39], v[88:91], a[36:39], v[20:23]
    v_cvt_pk_bf16_f32 v154, v52, v53
    v_cvt_pk_bf16_f32 v155, v54, v55
    s_add_u32 m0, s28, 8192
    s_add_u32 s30, s32, 589824
    buffer_load_dwordx4 v2, s[16:19], s30 offen  lds
    buffer_load_dwordx4 v3, s[16:19], s30 offen offset:1024  lds
    s_waitcnt vmcnt(12)
    ds_read_b128 a[104:107], v245 offset:26624
    ds_read_b128 a[108:111], v246 offset:26624
    s_waitcnt lgkmcnt(3)
    v_mfma_f32_16x16x32_bf16 v[56:59], v[80:83], a[96:99], v[56:59]
    s_waitcnt lgkmcnt(2)
    v_mfma_f32_16x16x32_bf16 v[56:59], v[80:83], a[100:103], v[56:59]
    v_mfma_f32_16x16x32_bf16 v[40:43], v[84:87], a[40:43], v[20:23]
    v_cvt_pk_bf16_f32 v160, v24, v25
    v_cvt_pk_bf16_f32 v161, v26, v27
    v_mfma_f32_16x16x32_bf16 v[44:47], v[88:91], a[40:43], v[20:23]
    v_cvt_pk_bf16_f32 v162, v28, v29
    v_cvt_pk_bf16_f32 v163, v30, v31
    v_mfma_f32_16x16x32_bf16 v[48:51], v[84:87], a[44:47], v[20:23]
    v_cvt_pk_bf16_f32 v168, v32, v33
    v_cvt_pk_bf16_f32 v169, v34, v35
    v_mfma_f32_16x16x32_bf16 v[52:55], v[88:91], a[44:47], v[20:23]
    v_cvt_pk_bf16_f32 v170, v36, v37
    v_cvt_pk_bf16_f32 v171, v38, v39
    s_add_u32 m0, s28, 16384
    s_add_u32 s30, s32, 1179648
    buffer_load_dwordx4 v2, s[16:19], s30 offen  lds
    buffer_load_dwordx4 v3, s[16:19], s30 offen offset:1024  lds
    s_waitcnt vmcnt(12)
    ds_read_b128 a[112:115], v245 offset:28672
    ds_read_b128 a[116:119], v246 offset:28672
    s_waitcnt lgkmcnt(3)
    v_mfma_f32_16x16x32_bf16 v[56:59], v[80:83], a[104:107], v[56:59]
    s_waitcnt lgkmcnt(2)
    v_mfma_f32_16x16x32_bf16 v[56:59], v[80:83], a[108:111], v[56:59]
    v_mfma_f32_16x16x32_bf16 v[24:27], v[84:87], a[48:51], v[20:23]
    v_cvt_pk_bf16_f32 v176, v40, v41
    v_cvt_pk_bf16_f32 v177, v42, v43
    v_mfma_f32_16x16x32_bf16 v[28:31], v[88:91], a[48:51], v[20:23]
    v_cvt_pk_bf16_f32 v178, v44, v45
    v_cvt_pk_bf16_f32 v179, v46, v47
    v_mfma_f32_16x16x32_bf16 v[32:35], v[84:87], a[52:55], v[20:23]
    v_cvt_pk_bf16_f32 v184, v48, v49
    v_cvt_pk_bf16_f32 v185, v50, v51
    v_mfma_f32_16x16x32_bf16 v[36:39], v[88:91], a[52:55], v[20:23]
    v_cvt_pk_bf16_f32 v186, v52, v53
    v_cvt_pk_bf16_f32 v187, v54, v55
    s_add_u32 m0, s28, 24576
    s_add_u32 s30, s32, 1769472
    buffer_load_dwordx4 v2, s[16:19], s30 offen  lds
    buffer_load_dwordx4 v3, s[16:19], s30 offen offset:1024  lds
    s_waitcnt vmcnt(12)
    ds_read_b128 a[120:123], v245 offset:30720
    ds_read_b128 a[124:127], v246 offset:30720
    s_waitcnt lgkmcnt(3)
    v_mfma_f32_16x16x32_bf16 v[56:59], v[80:83], a[112:115], v[56:59]
    s_waitcnt lgkmcnt(2)
    v_mfma_f32_16x16x32_bf16 v[56:59], v[80:83], a[116:119], v[56:59]
    v_mfma_f32_16x16x32_bf16 v[40:43], v[84:87], a[56:59], v[20:23]
    v_cvt_pk_bf16_f32 v192, v24, v25
    v_cvt_pk_bf16_f32 v193, v26, v27
    v_mfma_f32_16x16x32_bf16 v[44:47], v[88:91], a[56:59], v[20:23]
    v_cvt_pk_bf16_f32 v194, v28, v29
    v_cvt_pk_bf16_f32 v195, v30, v31
    v_mfma_f32_16x16x32_bf16 v[48:51], v[84:87], a[60:63], v[20:23]
    v_cvt_pk_bf16_f32 v200, v32, v33
    v_cvt_pk_bf16_f32 v201, v34, v35
    v_mfma_f32_16x16x32_bf16 v[52:55], v[88:91], a[60:63], v[20:23]
    v_cvt_pk_bf16_f32 v202, v36, v37
    v_cvt_pk_bf16_f32 v203, v38, v39
    s_waitcnt vmcnt(10)
    ds_read_b128 a[128:131], v245 offset:0
    ds_read_b128 a[132:135], v246 offset:0
    s_waitcnt lgkmcnt(3)
    v_mfma_f32_16x16x32_bf16 v[56:59], v[80:83], a[120:123], v[56:59]
    s_waitcnt lgkmcnt(2)
    v_mfma_f32_16x16x32_bf16 v[56:59], v[80:83], a[124:127], v[56:59]
    v_mfma_f32_16x16x32_bf16 v[24:27], v[84:87], a[64:67], v[20:23]
    v_cvt_pk_bf16_f32 v208, v40, v41
    v_cvt_pk_bf16_f32 v209, v42, v43
    v_mfma_f32_16x16x32_bf16 v[28:31], v[88:91], a[64:67], v[20:23]
    v_cvt_pk_bf16_f32 v210, v44, v45
    v_cvt_pk_bf16_f32 v211, v46, v47
    v_mfma_f32_16x16x32_bf16 v[32:35], v[84:87], a[68:71], v[20:23]
    v_cvt_pk_bf16_f32 v216, v48, v49
    v_cvt_pk_bf16_f32 v217, v50, v51
    v_mfma_f32_16x16x32_bf16 v[36:39], v[88:91], a[68:71], v[20:23]
    v_cvt_pk_bf16_f32 v218, v52, v53
    v_cvt_pk_bf16_f32 v219, v54, v55
    s_waitcnt vmcnt(8)
    ds_read_b128 a[136:139], v245 offset:2048
    ds_read_b128 a[140:143], v246 offset:2048
    s_waitcnt lgkmcnt(3)
    v_mfma_f32_16x16x32_bf16 v[56:59], v[80:83], a[128:131], v[56:59]
    s_waitcnt lgkmcnt(2)
    v_mfma_f32_16x16x32_bf16 v[56:59], v[80:83], a[132:135], v[56:59]
    s_nop 3
    v_cvt_pk_bf16_f32 v224, v24, v25
    v_cvt_pk_bf16_f32 v225, v26, v27
    v_cvt_pk_bf16_f32 v226, v28, v29
    v_cvt_pk_bf16_f32 v227, v30, v31
    v_cvt_pk_bf16_f32 v232, v32, v33
    v_cvt_pk_bf16_f32 v233, v34, v35
    v_cvt_pk_bf16_f32 v234, v36, v37
    v_cvt_pk_bf16_f32 v235, v38, v39
    s_waitcnt lgkmcnt(1)
    v_mfma_f32_16x16x32_bf16 v[56:59], v[80:83], a[136:139], v[56:59]
    s_waitcnt lgkmcnt(0)
    v_mfma_f32_16x16x32_bf16 v[56:59], v[80:83], a[140:143], v[56:59]
    s_nop 7
    v_mul_f32 v60, 0xbae38e39, v56
    v_cvt_pk_bf16_f32 v60, v60, v60
    v_and_b32 v60, 0xffff0000, v60
    v_mov_b32 v61, v60
    v_mov_b32 v62, v60
    v_mov_b32 v63, v60
    s_nop 1
    v_mfma_f32_16x16x32_bf16 v[24:27], v[84:87], a[72:75], v[60:63]
    v_mfma_f32_16x16x32_bf16 v[28:31], v[88:91], a[72:75], v[60:63]
    v_mfma_f32_16x16x32_bf16 v[32:35], v[84:87], a[76:79], v[60:63]
    v_mfma_f32_16x16x32_bf16 v[36:39], v[88:91], a[76:79], v[60:63]
    s_nop 3
    v_mfma_f32_16x16x32_bf16 v[40:43], v[84:87], a[80:83], v[60:63]
    v_cvt_pk_bf16_f32 v100, v24, v25
    v_cvt_pk_bf16_f32 v101, v26, v27
    v_mfma_f32_16x16x32_bf16 v[44:47], v[88:91], a[80:83], v[60:63]
    v_cvt_pk_bf16_f32 v102, v28, v29
    v_cvt_pk_bf16_f32 v103, v30, v31
    v_mfma_f32_16x16x32_bf16 v[48:51], v[84:87], a[84:87], v[60:63]
    v_cvt_pk_bf16_f32 v108, v32, v33
    v_cvt_pk_bf16_f32 v109, v34, v35
    v_mfma_f32_16x16x32_bf16 v[52:55], v[88:91], a[84:87], v[60:63]
    v_cvt_pk_bf16_f32 v110, v36, v37
    v_cvt_pk_bf16_f32 v111, v38, v39
    v_mfma_f32_16x16x32_bf16 v[24:27], v[84:87], a[88:91], v[60:63]
    v_cvt_pk_bf16_f32 v116, v40, v41
    v_cvt_pk_bf16_f32 v117, v42, v43
    v_mfma_f32_16x16x32_bf16 v[28:31], v[88:91], a[88:91], v[60:63]
    v_cvt_pk_bf16_f32 v118, v44, v45
    v_cvt_pk_bf16_f32 v119, v46, v47
    v_mfma_f32_16x16x32_bf16 v[32:35], v[84:87], a[92:95], v[60:63]
    v_cvt_pk_bf16_f32 v124, v48, v49
    v_cvt_pk_bf16_f32 v125, v50, v51
    v_mfma_f32_16x16x32_bf16 v[36:39], v[88:91], a[92:95], v[60:63]
    v_cvt_pk_bf16_f32 v126, v52, v53
    v_cvt_pk_bf16_f32 v127, v54, v55
    v_mfma_f32_16x16x32_bf16 v[40:43], v[84:87], a[96:99], v[60:63]
    v_cvt_pk_bf16_f32 v132, v24, v25
    v_cvt_pk_bf16_f32 v133, v26, v27
    v_mfma_f32_16x16x32_bf16 v[44:47], v[88:91], a[96:99], v[60:63]
    v_cvt_pk_bf16_f32 v134, v28, v29
    v_cvt_pk_bf16_f32 v135, v30, v31
    v_mfma_f32_16x16x32_bf16 v[48:51], v[84:87], a[100:103], v[60:63]
    v_cvt_pk_bf16_f32 v140, v32, v33
    v_cvt_pk_bf16_f32 v141, v34, v35
    v_mfma_f32_16x16x32_bf16 v[52:55], v[88:91], a[100:103], v[60:63]
    v_cvt_pk_bf16_f32 v142, v36, v37
    v_cvt_pk_bf16_f32 v143, v38, v39
    s_waitcnt vmcnt(0)
    s_barrier
    v_mfma_f32_16x16x32_bf16 v[24:27], v[84:87], a[104:107], v[60:63]
    v_cvt_pk_bf16_f32 v148, v40, v41
    v_cvt_pk_bf16_f32 v149, v42, v43
    ds_read_b64_tr_b16 a[160:161], v6 offset:0
    v_mfma_f32_16x16x32_bf16 v[28:31], v[88:91], a[104:107], v[60:63]
    v_cvt_pk_bf16_f32 v150, v44, v45
    v_cvt_pk_bf16_f32 v151, v46, v47
    ds_read_b64_tr_b16 a[162:163], v6 offset:4096
    v_mfma_f32_16x16x32_bf16 v[32:35], v[84:87], a[108:111], v[60:63]
    v_cvt_pk_bf16_f32 v156, v48, v49
    v_cvt_pk_bf16_f32 v157, v50, v51
    ds_read_b64_tr_b16 a[164:165], v7 offset:0
    v_mfma_f32_16x16x32_bf16 v[36:39], v[88:91], a[108:111], v[60:63]
    v_cvt_pk_bf16_f32 v158, v52, v53
    v_cvt_pk_bf16_f32 v159, v54, v55
    ds_read_b64_tr_b16 a[166:167], v7 offset:4096
    v_mfma_f32_16x16x32_bf16 v[40:43], v[84:87], a[112:115], v[60:63]
    v_cvt_pk_bf16_f32 v164, v24, v25
    v_cvt_pk_bf16_f32 v165, v26, v27
    ds_read_b64_tr_b16 a[168:169], v8 offset:0
    v_mfma_f32_16x16x32_bf16 v[44:47], v[88:91], a[112:115], v[60:63]
    v_cvt_pk_bf16_f32 v166, v28, v29
    v_cvt_pk_bf16_f32 v167, v30, v31
    ds_read_b64_tr_b16 a[170:171], v8 offset:4096
    v_mfma_f32_16x16x32_bf16 v[48:51], v[84:87], a[116:119], v[60:63]
    v_cvt_pk_bf16_f32 v172, v32, v33
    v_cvt_pk_bf16_f32 v173, v34, v35
    ds_read_b64_tr_b16 a[172:173], v9 offset:0
    v_mfma_f32_16x16x32_bf16 v[52:55], v[88:91], a[116:119], v[60:63]
    v_cvt_pk_bf16_f32 v174, v36, v37
    v_cvt_pk_bf16_f32 v175, v38, v39
    ds_read_b64_tr_b16 a[174:175], v9 offset:4096
    v_mfma_f32_16x16x32_bf16 v[24:27], v[84:87], a[120:123], v[60:63]
    v_cvt_pk_bf16_f32 v180, v40, v41
    v_cvt_pk_bf16_f32 v181, v42, v43
    ds_read_b64_tr_b16 a[176:177], v6 offset:1024
    v_mfma_f32_16x16x32_bf16 v[28:31], v[88:91], a[120:123], v[60:63]
    v_cvt_pk_bf16_f32 v182, v44, v45
    v_cvt_pk_bf16_f32 v183, v46, v47
    ds_read_b64_tr_b16 a[178:179], v6 offset:5120
    v_mfma_f32_16x16x32_bf16 v[32:35], v[84:87], a[124:127], v[60:63]
    v_cvt_pk_bf16_f32 v188, v48, v49
    v_cvt_pk_bf16_f32 v189, v50, v51
    ds_read_b64_tr_b16 a[180:181], v7 offset:1024
    v_mfma_f32_16x16x32_bf16 v[36:39], v[88:91], a[124:127], v[60:63]
    v_cvt_pk_bf16_f32 v190, v52, v53
    v_cvt_pk_bf16_f32 v191, v54, v55
    ds_read_b64_tr_b16 a[182:183], v7 offset:5120
    v_mfma_f32_16x16x32_bf16 v[40:43], v[84:87], a[128:131], v[60:63]
    v_cvt_pk_bf16_f32 v196, v24, v25
    v_cvt_pk_bf16_f32 v197, v26, v27
    ds_read_b64_tr_b16 a[184:185], v8 offset:1024
    v_mfma_f32_16x16x32_bf16 v[44:47], v[88:91], a[128:131], v[60:63]
    v_cvt_pk_bf16_f32 v198, v28, v29
    v_cvt_pk_bf16_f32 v199, v30, v31
    ds_read_b64_tr_b16 a[186:187], v8 offset:5120
    v_mfma_f32_16x16x32_bf16 v[48:51], v[84:87], a[132:135], v[60:63]
    v_cvt_pk_bf16_f32 v204, v32, v33
    v_cvt_pk_bf16_f32 v205, v34, v35
    ds_read_b64_tr_b16 a[188:189], v9 offset:1024
    v_mfma_f32_16x16x32_bf16 v[52:55], v[88:91], a[132:135], v[60:63]
    v_cvt_pk_bf16_f32 v206, v36, v37
    v_cvt_pk_bf16_f32 v207, v38, v39
    ds_read_b64_tr_b16 a[190:191], v9 offset:5120
    v_mfma_f32_16x16x32_bf16 v[24:27], v[84:87], a[136:139], v[60:63]
    v_cvt_pk_bf16_f32 v212, v40, v41
    v_cvt_pk_bf16_f32 v213, v42, v43
    s_add_u32 m0, s28, 32768
    v_mfma_f32_16x16x32_bf16 v[28:31], v[88:91], a[136:139], v[60:63]
    v_cvt_pk_bf16_f32 v214, v44, v45
    v_cvt_pk_bf16_f32 v215, v46, v47
    s_add_u32 s30, s32, 2359296
    v_mfma_f32_16x16x32_bf16 v[32:35], v[84:87], a[140:143], v[60:63]
    v_cvt_pk_bf16_f32 v220, v48, v49
    v_cvt_pk_bf16_f32 v221, v50, v51
    buffer_load_dwordx4 v2, s[16:19], s30 offen  lds
    v_mfma_f32_16x16x32_bf16 v[36:39], v[88:91], a[140:143], v[60:63]
    v_cvt_pk_bf16_f32 v222, v52, v53
    v_cvt_pk_bf16_f32 v223, v54, v55
    buffer_load_dwordx4 v3, s[16:19], s30 offen offset:1024  lds
    s_nop 3
    v_cvt_pk_bf16_f32 v228, v24, v25
    v_cvt_pk_bf16_f32 v229, v26, v27
    v_cvt_pk_bf16_f32 v230, v28, v29
    v_cvt_pk_bf16_f32 v231, v30, v31
    v_cvt_pk_bf16_f32 v236, v32, v33
    v_cvt_pk_bf16_f32 v237, v34, v35
    v_cvt_pk_bf16_f32 v238, v36, v37
    v_cvt_pk_bf16_f32 v239, v38, v39
    s_nop 1
    s_waitcnt lgkmcnt(8)
    v_mfma_f32_16x16x32_bf16 v[16:19], a[160:163], v[96:99], 0
    ds_read_b64_tr_b16 a[192:193], v6 offset:8192
    s_add_u32 m0, s28, 40960
    v_mfma_f32_16x16x32_bf16 v[20:23], a[160:163], v[100:103], 0
    ds_read_b64_tr_b16 a[194:195], v6 offset:12288
    s_add_u32 s30, s32, 2949120
    v_mfma_f32_16x16x32_bf16 v[24:27], a[164:167], v[96:99], 0
    ds_read_b64_tr_b16 a[196:197], v7 offset:8192
    s_mul_i32 s40, s89, 1327104
    s_mul_i32 s41, s39, 384
    v_mfma_f32_16x16x32_bf16 v[28:31], a[164:167], v[100:103], 0
    ds_read_b64_tr_b16 a[198:199], v7 offset:12288
    buffer_load_dwordx4 v2, s[16:19], s30 offen  lds
    v_mfma_f32_16x16x32_bf16 v[32:35], a[168:171], v[96:99], 0
    ds_read_b64_tr_b16 a[200:201], v8 offset:8192
    s_add_u32 s40, s40, s41
    s_add_u32 s20, s8, s40
    s_addc_u32 s21, s9, 0
    v_mfma_f32_16x16x32_bf16 v[36:39], a[168:171], v[100:103], 0
    ds_read_b64_tr_b16 a[202:203], v8 offset:12288
    s_sub_u32 s22, 5308416, s40
    s_mov_b32 s23, 0x20000
    v_mfma_f32_16x16x32_bf16 v[40:43], a[172:175], v[96:99], 0
L_pm0:
    s_cbranch_execz L_pmb0
    ds_read_b64_tr_b16 a[204:205], v9 offset:8192
    buffer_load_dwordx4 v3, s[16:19], s30 offen offset:1024  lds
    v_mfma_f32_16x16x32_bf16 v[44:47], a[172:175], v[100:103], 0
    ds_read_b64_tr_b16 a[206:207], v9 offset:12288
    s_waitcnt lgkmcnt(8)
    v_mfma_f32_16x16x32_bf16 v[16:19], a[176:179], v[104:107], v[16:19]
    ds_read_b64_tr_b16 a[160:161], v6 offset:9216
    s_add_u32 m0, s28, 49152
    v_mfma_f32_16x16x32_bf16 v[20:23], a[176:179], v[108:111], v[20:23]
    ds_read_b64_tr_b16 a[162:163], v6 offset:13312
    s_add_u32 s30, s32, 3538944
    v_mfma_f32_16x16x32_bf16 v[24:27], a[180:183], v[104:107], v[24:27]
    ds_read_b64_tr_b16 a[164:165], v7 offset:9216
    s_lshl_b32 s40, s62, 2
    s_add_u32 s40, s40, s89
    v_mfma_f32_16x16x32_bf16 v[28:31], a[180:183], v[108:111], v[28:31]
    ds_read_b64_tr_b16 a[166:167], v7 offset:13312
    buffer_load_dwordx4 v2, s[16:19], s30 offen  lds
    v_mfma_f32_16x16x32_bf16 v[32:35], a[184:187], v[104:107], v[32:35]
    ds_read_b64_tr_b16 a[168:169], v8 offset:9216
    s_mul_i32 s40, s40, 12
    s_add_u32 s40, s40, s3
    v_mfma_f32_16x16x32_bf16 v[36:39], a[184:187], v[108:111], v[36:39]
    ds_read_b64_tr_b16 a[170:171], v8 offset:13312
    s_mul_i32 s40, s40, 24576
    s_sub_u32 s82, 18874368, s40
    v_mfma_f32_16x16x32_bf16 v[40:43], a[188:191], v[104:107], v[40:43]
    ds_read_b64_tr_b16 a[172:173], v9 offset:9216
    buffer_load_dwordx4 v3, s[16:19], s30 offen offset:1024  lds
    v_mfma_f32_16x16x32_bf16 v[44:47], a[188:191], v[108:111], v[44:47]
    ds_read_b64_tr_b16 a[174:175], v9 offset:13312
    s_waitcnt lgkmcnt(8)
    v_mfma_f32_16x16x32_bf16 v[16:19], a[192:195], v[112:115], v[16:19]
    ds_read_b64_tr_b16 a[176:177], v6 offset:16384
    s_add_u32 m0, s28, 57344
    v_mfma_f32_16x16x32_bf16 v[20:23], a[192:195], v[116:119], v[20:23]
    ds_read_b64_tr_b16 a[178:179], v6 offset:20480
    s_add_u32 s30, s32, 4128768
    v_mfma_f32_16x16x32_bf16 v[24:27], a[196:199], v[112:115], v[24:27]
    ds_read_b64_tr_b16 a[180:181], v7 offset:16384
    s_add_u32 s40, s40, 41943040
    s_add_u32 s80, s52, s40
    s_addc_u32 s81, s53, 0
    v_mfma_f32_16x16x32_bf16 v[28:31], a[196:199], v[116:119], v[28:31]
    ds_read_b64_tr_b16 a[182:183], v7 offset:20480
    buffer_load_dwordx4 v2, s[16:19], s30 offen  lds
    v_mfma_f32_16x16x32_bf16 v[32:35], a[200:203], v[112:115], v[32:35]
    ds_read_b64_tr_b16 a[184:185], v8 offset:16384
    s_mov_b32 s83, 0x20000
    s_mul_i32 s41, s39, 98304
    v_mfma_f32_16x16x32_bf16 v[36:39], a[200:203], v[116:119], v[36:39]
    ds_read_b64_tr_b16 a[186:187], v8 offset:20480
    s_add_u32 s76, s80, s41
    s_addc_u32 s77, s81, 0
    s_movk_i32 s78, 24576
    v_mfma_f32_16x16x32_bf16 v[40:43], a[204:207], v[112:115], v[40:43]
    ds_read_b64_tr_b16 a[188:189], v9 offset:16384
    buffer_load_dwordx4 v3, s[16:19], s30 offen offset:1024  lds
    v_mfma_f32_16x16x32_bf16 v[44:47], a[204:207], v[116:119], v[44:47]
    ds_read_b64_tr_b16 a[190:191], v9 offset:20480
    s_waitcnt lgkmcnt(8)
    v_mfma_f32_16x16x32_bf16 v[16:19], a[160:163], v[120:123], v[16:19]
    ds_read_b64_tr_b16 a[192:193], v6 offset:17408
    s_add_u32 m0, s28, 65536
    v_mfma_f32_16x16x32_bf16 v[20:23], a[160:163], v[124:127], v[20:23]
    ds_read_b64_tr_b16 a[194:195], v6 offset:21504
    s_add_u32 s30, s32, 4718592
    v_mfma_f32_16x16x32_bf16 v[24:27], a[164:167], v[120:123], v[24:27]
    ds_read_b64_tr_b16 a[196:197], v7 offset:17408
    s_mov_b32 s79, 0x20000
    v_lshlrev_b32 v14, 4, v0
    v_mfma_f32_16x16x32_bf16 v[28:31], a[164:167], v[124:127], v[28:31]
    ds_read_b64_tr_b16 a[198:199], v7 offset:21504
    buffer_load_dwordx4 v2, s[16:19], s30 offen  lds
    v_mfma_f32_16x16x32_bf16 v[32:35], a[168:171], v[120:123], v[32:35]
    ds_read_b64_tr_b16 a[200:201], v8 offset:17408
    s_mul_i32 s42, s39, 442368
    s_add_u32 s40, s39, 1
    v_mfma_f32_16x16x32_bf16 v[36:39], a[168:171], v[124:127], v[36:39]
    ds_read_b64_tr_b16 a[202:203], v8 offset:21504
    s_sub_u32 s41, s40, 3
    s_cselect_b32 s40, s40, s41
    s_mul_i32 s43, s40, 442368
    v_mfma_f32_16x16x32_bf16 v[40:43], a[172:175], v[120:123], v[40:43]
    ds_read_b64_tr_b16 a[204:205], v9 offset:17408
    buffer_load_dwordx4 v3, s[16:19], s30 offen offset:1024  lds
    v_mfma_f32_16x16x32_bf16 v[44:47], a[172:175], v[124:127], v[44:47]
    ds_read_b64_tr_b16 a[206:207], v9 offset:21504
    s_waitcnt lgkmcnt(8)
    v_mfma_f32_16x16x32_bf16 v[16:19], a[176:179], v[128:131], v[16:19]
    ds_read_b64_tr_b16 a[160:161], v6 offset:24576
    s_add_u32 m0, s28, 73728
    v_mfma_f32_16x16x32_bf16 v[20:23], a[176:179], v[132:135], v[20:23]
    ds_read_b64_tr_b16 a[162:163], v6 offset:28672
    s_add_u32 s30, s33, 0
    v_mfma_f32_16x16x32_bf16 v[24:27], a[180:183], v[128:131], v[24:27]
    ds_read_b64_tr_b16 a[164:165], v7 offset:24576
    s_mul_i32 s45, s40, 98304
    s_add_u32 s40, s39, 2
    v_mfma_f32_16x16x32_bf16 v[28:31], a[180:183], v[132:135], v[28:31]
    ds_read_b64_tr_b16 a[166:167], v7 offset:28672
    buffer_load_dwordx4 v2, s[16:19], s30 offen  lds
    v_mfma_f32_16x16x32_bf16 v[32:35], a[184:187], v[128:131], v[32:35]
    ds_read_b64_tr_b16 a[168:169], v8 offset:24576
    s_sub_u32 s41, s40, 3
    s_cselect_b32 s40, s40, s41
    s_mul_i32 s44, s40, 442368
    v_mfma_f32_16x16x32_bf16 v[36:39], a[184:187], v[132:135], v[36:39]
    ds_read_b64_tr_b16 a[170:171], v8 offset:28672
    s_mul_i32 s46, s40, 98304
    s_and_b32 s40, s62, 7
    v_mfma_f32_16x16x32_bf16 v[40:43], a[188:191], v[128:131], v[40:43]
    ds_read_b64_tr_b16 a[172:173], v9 offset:24576
    buffer_load_dwordx4 v3, s[16:19], s30 offen offset:1024  lds
    v_mfma_f32_16x16x32_bf16 v[44:47], a[188:191], v[132:135], v[44:47]
    ds_read_b64_tr_b16 a[174:175], v9 offset:28672
    s_waitcnt lgkmcnt(8)
    v_mfma_f32_16x16x32_bf16 v[16:19], a[192:195], v[136:139], v[16:19]
    ds_read_b64_tr_b16 a[176:177], v6 offset:25600
    s_add_u32 m0, s28, 81920
    v_mfma_f32_16x16x32_bf16 v[20:23], a[192:195], v[140:143], v[20:23]
    ds_read_b64_tr_b16 a[178:179], v6 offset:29696
    s_add_u32 s30, s33, 589824
    v_mfma_f32_16x16x32_bf16 v[24:27], a[196:199], v[136:139], v[24:27]
    ds_read_b64_tr_b16 a[180:181], v7 offset:25600
    s_mul_i32 s41, s40, 86
    s_lshr_b32 s41, s41, 8
    v_mfma_f32_16x16x32_bf16 v[28:31], a[196:199], v[140:143], v[28:31]
    ds_read_b64_tr_b16 a[182:183], v7 offset:29696
    buffer_load_dwordx4 v2, s[16:19], s30 offen  lds
    v_mfma_f32_16x16x32_bf16 v[32:35], a[200:203], v[136:139], v[32:35]
    ds_read_b64_tr_b16 a[184:185], v8 offset:25600
    s_mul_i32 s41, s41, 3
    s_sub_u32 s47, s40, s41
    v_mfma_f32_16x16x32_bf16 v[36:39], a[200:203], v[140:143], v[36:39]
    ds_read_b64_tr_b16 a[186:187], v8 offset:29696
    s_mul_i32 s47, s47, 0
    s_add_u32 s40, s47, 0
    v_mfma_f32_16x16x32_bf16 v[40:43], a[204:207], v[136:139], v[40:43]
    ds_read_b64_tr_b16 a[188:189], v9 offset:25600
    s_sub_u32 s41, s40, 3
    s_cselect_b32 s40, s40, s41
    s_lshl_b32 s60, s40, 16
    v_mfma_f32_16x16x32_bf16 v[44:47], a[204:207], v[140:143], v[44:47]
    ds_read_b64_tr_b16 a[190:191], v9 offset:29696
    s_waitcnt vmcnt(5) lgkmcnt(8)
    v_mfma_f32_16x16x32_bf16 v[16:19], a[160:163], v[144:147], v[16:19]
    s_barrier
    ds_read_b64_tr_b16 a[192:193], v6 offset:32768
    v_mfma_f32_16x16x32_bf16 v[20:23], a[160:163], v[148:151], v[20:23]
    ds_read_b64_tr_b16 a[194:195], v6 offset:36864
    s_lshl_b32 s40, s40, 7
    s_add_u32 s6, s42, s40
    v_mfma_f32_16x16x32_bf16 v[24:27], a[164:167], v[144:147], v[24:27]
    ds_read_b64_tr_b16 a[196:197], v7 offset:32768
    s_add_u32 s7, s43, s40
    s_add_u32 s8, s44, s40
    v_mfma_f32_16x16x32_bf16 v[28:31], a[164:167], v[148:151], v[28:31]
    ds_read_b64_tr_b16 a[198:199], v7 offset:36864
    buffer_load_dwordx4 v3, s[16:19], s30 offen offset:1024  lds
    v_mfma_f32_16x16x32_bf16 v[32:35], a[168:171], v[144:147], v[32:35]
    ds_read_b64_tr_b16 a[200:201], v8 offset:32768
    s_add_u32 s40, s47, 1
    s_sub_u32 s41, s40, 3
    s_cselect_b32 s40, s40, s41
    v_mfma_f32_16x16x32_bf16 v[36:39], a[168:171], v[148:151], v[36:39]
    ds_read_b64_tr_b16 a[202:203], v8 offset:36864
    s_lshl_b32 s61, s40, 16
    s_lshl_b32 s40, s40, 7
    v_mfma_f32_16x16x32_bf16 v[40:43], a[172:175], v[144:147], v[40:43]
    ds_read_b64_tr_b16 a[204:205], v9 offset:32768
    s_add_u32 s9, s42, s40
    s_add_u32 s10, s43, s40
    v_mfma_f32_16x16x32_bf16 v[44:47], a[172:175], v[148:151], v[44:47]
    ds_read_b64_tr_b16 a[206:207], v9 offset:36864
    s_waitcnt lgkmcnt(8)
    v_mfma_f32_16x16x32_bf16 v[16:19], a[176:179], v[152:155], v[16:19]
    ds_read_b64_tr_b16 a[160:161], v6 offset:33792
    s_add_u32 m0, s28, 90112
    v_mfma_f32_16x16x32_bf16 v[20:23], a[176:179], v[156:159], v[20:23]
    ds_read_b64_tr_b16 a[162:163], v6 offset:37888
    s_add_u32 s30, s33, 1179648
    v_mfma_f32_16x16x32_bf16 v[24:27], a[180:183], v[152:155], v[24:27]
    ds_read_b64_tr_b16 a[164:165], v7 offset:33792
    s_add_u32 s11, s44, s40
    s_add_u32 s40, s47, 2
    v_mfma_f32_16x16x32_bf16 v[28:31], a[180:183], v[156:159], v[28:31]
    ds_read_b64_tr_b16 a[166:167], v7 offset:37888
    buffer_load_dwordx4 v2, s[16:19], s30 offen  lds
    v_mfma_f32_16x16x32_bf16 v[32:35], a[184:187], v[152:155], v[32:35]
    ds_read_b64_tr_b16 a[168:169], v8 offset:33792
    s_sub_u32 s41, s40, 3
    s_cselect_b32 s40, s40, s41
    s_lshl_b32 s98, s40, 16
    v_mfma_f32_16x16x32_bf16 v[36:39], a[184:187], v[156:159], v[36:39]
    ds_read_b64_tr_b16 a[170:171], v8 offset:37888
    s_lshl_b32 s40, s40, 7
    s_add_u32 s84, s42, s40
    v_mfma_f32_16x16x32_bf16 v[40:43], a[188:191], v[152:155], v[40:43]
    ds_read_b64_tr_b16 a[172:173], v9 offset:33792
    buffer_load_dwordx4 v3, s[16:19], s30 offen offset:1024  lds
    v_mfma_f32_16x16x32_bf16 v[44:47], a[188:191], v[156:159], v[44:47]
    ds_read_b64_tr_b16 a[174:175], v9 offset:37888
    s_waitcnt lgkmcnt(8)
    v_mfma_f32_16x16x32_bf16 v[16:19], a[192:195], v[160:163], v[16:19]
    ds_read_b64_tr_b16 a[176:177], v6 offset:40960
    s_add_u32 m0, s28, 98304
    v_mfma_f32_16x16x32_bf16 v[20:23], a[192:195], v[164:167], v[20:23]
    ds_read_b64_tr_b16 a[178:179], v6 offset:45056
    s_add_u32 s30, s33, 1769472
    v_mfma_f32_16x16x32_bf16 v[24:27], a[196:199], v[160:163], v[24:27]
    ds_read_b64_tr_b16 a[180:181], v7 offset:40960
    s_add_u32 s100, s43, s40
    s_add_u32 s101, s44, s40
    v_mfma_f32_16x16x32_bf16 v[28:31], a[196:199], v[164:167], v[28:31]
    ds_read_b64_tr_b16 a[182:183], v7 offset:45056
    buffer_load_dwordx4 v2, s[16:19], s30 offen  lds
    v_mfma_f32_16x16x32_bf16 v[32:35], a[200:203], v[160:163], v[32:35]
    ds_read_b64_tr_b16 a[184:185], v8 offset:40960
    s_mul_i32 s40, s62, 9
    s_mul_i32 s41, s39, 3
    v_mfma_f32_16x16x32_bf16 v[36:39], a[200:203], v[164:167], v[36:39]
    ds_read_b64_tr_b16 a[186:187], v8 offset:45056
    s_add_u32 s40, s40, s41
    s_lshl_b32 s40, s40, 4
    v_mfma_f32_16x16x32_bf16 v[40:43], a[204:207], v[160:163], v[40:43]
    ds_read_b64_tr_b16 a[188:189], v9 offset:40960
    buffer_load_dwordx4 v3, s[16:19], s30 offen offset:1024  lds
    v_mfma_f32_16x16x32_bf16 v[44:47], a[204:207], v[164:167], v[44:47]
    ds_read_b64_tr_b16 a[190:191], v9 offset:45056
    s_waitcnt lgkmcnt(8)
    v_mfma_f32_16x16x32_bf16 v[16:19], a[160:163], v[168:171], v[16:19]
    ds_read_b64_tr_b16 a[192:193], v6 offset:41984
    s_add_u32 m0, s28, 106496
    v_mfma_f32_16x16x32_bf16 v[20:23], a[160:163], v[172:175], v[20:23]
    ds_read_b64_tr_b16 a[194:195], v6 offset:46080
    s_add_u32 s30, s33, 2359296
    v_mfma_f32_16x16x32_bf16 v[24:27], a[164:167], v[168:171], v[24:27]
    ds_read_b64_tr_b16 a[196:197], v7 offset:41984
    s_lshr_b32 s41, s3, 1
    s_lshl_b32 s41, s41, 3
    v_mfma_f32_16x16x32_bf16 v[28:31], a[164:167], v[172:175], v[28:31]
    ds_read_b64_tr_b16 a[198:199], v7 offset:46080
    buffer_load_dwordx4 v2, s[16:19], s30 offen  lds
    v_mfma_f32_16x16x32_bf16 v[32:35], a[168:171], v[168:171], v[32:35]
    ds_read_b64_tr_b16 a[200:201], v8 offset:41984
    s_add_u32 s40, s40, s41
    s_and_b32 s41, s3, 1
    v_mfma_f32_16x16x32_bf16 v[36:39], a[168:171], v[172:175], v[36:39]
    ds_read_b64_tr_b16 a[202:203], v8 offset:46080
    s_lshl_b32 s41, s41, 1
    s_add_u32 s40, s40, s41
    v_mfma_f32_16x16x32_bf16 v[40:43], a[172:175], v[168:171], v[40:43]
    ds_read_b64_tr_b16 a[204:205], v9 offset:41984
    buffer_load_dwordx4 v3, s[16:19], s30 offen offset:1024  lds
    v_mfma_f32_16x16x32_bf16 v[44:47], a[172:175], v[172:175], v[44:47]
    ds_read_b64_tr_b16 a[206:207], v9 offset:46080
    s_waitcnt lgkmcnt(8)
    v_mfma_f32_16x16x32_bf16 v[16:19], a[176:179], v[176:179], v[16:19]
    ds_read_b64_tr_b16 a[160:161], v6 offset:49152
    s_add_u32 m0, s28, 114688
    v_mfma_f32_16x16x32_bf16 v[20:23], a[176:179], v[180:183], v[20:23]
    ds_read_b64_tr_b16 a[162:163], v6 offset:53248
    s_add_u32 s30, s33, 2949120
    v_mfma_f32_16x16x32_bf16 v[24:27], a[180:183], v[176:179], v[24:27]
    ds_read_b64_tr_b16 a[164:165], v7 offset:49152
    s_lshl_b32 s40, s40, 2
    s_add_u32 s40, s40, s89
    v_mfma_f32_16x16x32_bf16 v[28:31], a[180:183], v[180:183], v[28:31]
    ds_read_b64_tr_b16 a[166:167], v7 offset:53248
    buffer_load_dwordx4 v2, s[16:19], s30 offen  lds
    v_mfma_f32_16x16x32_bf16 v[32:35], a[184:187], v[176:179], v[32:35]
    ds_read_b64_tr_b16 a[168:169], v8 offset:49152
    s_lshl_b32 s40, s40, 10
    s_sub_u32 s26, 9437184, s40
    v_mfma_f32_16x16x32_bf16 v[36:39], a[184:187], v[180:183], v[36:39]
    ds_read_b64_tr_b16 a[170:171], v8 offset:53248
    s_add_u32 s40, s40, 8388608
    s_add_u32 s24, s52, s40
    s_addc_u32 s25, s53, 0
    v_mfma_f32_16x16x32_bf16 v[40:43], a[188:191], v[176:179], v[40:43]
    ds_read_b64_tr_b16 a[172:173], v9 offset:49152
    s_mov_b32 s27, 0x20000
    s_mov_b32 s68, s50
    v_mfma_f32_16x16x32_bf16 v[44:47], a[188:191], v[180:183], v[44:47]
    ds_read_b64_tr_b16 a[174:175], v9 offset:53248
    s_waitcnt lgkmcnt(8)
    v_mfma_f32_16x16x32_bf16 v[16:19], a[192:195], v[184:187], v[16:19]
    ds_read_b64_tr_b16 a[176:177], v6 offset:50176
    s_mov_b32 s69, s51
    s_movk_i32 s70, 256
    v_mfma_f32_16x16x32_bf16 v[20:23], a[192:195], v[188:191], v[20:23]
    ds_read_b64_tr_b16 a[178:179], v6 offset:54272
    s_mov_b32 s71, 0x20000
    s_add_u32 s72, s52, 36700160
    s_addc_u32 s73, s53, 0
    v_mfma_f32_16x16x32_bf16 v[24:27], a[196:199], v[184:187], v[24:27]
    ds_read_b64_tr_b16 a[180:181], v7 offset:50176
    s_mov_b32 s74, 32768
    s_mov_b32 s75, 0x20000
    v_mfma_f32_16x16x32_bf16 v[28:31], a[196:199], v[188:191], v[28:31]
    ds_read_b64_tr_b16 a[182:183], v7 offset:54272
    buffer_load_dwordx4 v3, s[16:19], s30 offen offset:1024  lds
    v_mfma_f32_16x16x32_bf16 v[32:35], a[200:203], v[184:187], v[32:35]
    ds_read_b64_tr_b16 a[184:185], v8 offset:50176
    s_cmp_eq_u32 s3, 0
    s_cselect_b32 s66, 1, 0
    s_mov_b32 s67, 0
    v_mfma_f32_16x16x32_bf16 v[36:39], a[200:203], v[188:191], v[36:39]
    ds_read_b64_tr_b16 a[186:187], v8 offset:54272
    s_mul_i32 s56, s62, 12
    s_add_u32 s56, s56, s63
    v_mfma_f32_16x16x32_bf16 v[40:43], a[204:207], v[184:187], v[40:43]
    ds_read_b64_tr_b16 a[188:189], v9 offset:50176
    s_lshl_b32 s56, s56, 7
    v_lshlrev_b32 v240, 2, v0
    v_mfma_f32_16x16x32_bf16 v[44:47], a[204:207], v[188:191], v[44:47]
    ds_read_b64_tr_b16 a[190:191], v9 offset:54272
    s_waitcnt lgkmcnt(8)
    v_mfma_f32_16x16x32_bf16 v[16:19], a[160:163], v[192:195], v[16:19]
    ds_read_b64_tr_b16 a[192:193], v6 offset:57344
    s_add_u32 m0, s28, 122880
    v_mfma_f32_16x16x32_bf16 v[20:23], a[160:163], v[196:199], v[20:23]
    ds_read_b64_tr_b16 a[194:195], v6 offset:61440
    s_add_u32 s30, s33, 3538944
    v_mfma_f32_16x16x32_bf16 v[24:27], a[164:167], v[192:195], v[24:27]
    ds_read_b64_tr_b16 a[196:197], v7 offset:57344
    s_mov_b32 s38, 0x01010101
    v_mfma_f32_16x16x32_bf16 v[28:31], a[164:167], v[196:199], v[28:31]
    ds_read_b64_tr_b16 a[198:199], v7 offset:61440
    buffer_load_dwordx4 v2, s[16:19], s30 offen  lds
    v_mfma_f32_16x16x32_bf16 v[32:35], a[168:171], v[192:195], v[32:35]
    ds_read_b64_tr_b16 a[200:201], v8 offset:57344
    s_lshl_b32 s40, s63, 2
    v_mfma_f32_16x16x32_bf16 v[36:39], a[168:171], v[196:199], v[36:39]
    ds_read_b64_tr_b16 a[202:203], v8 offset:61440
    s_add_u32 s40, s40, s3
    v_mfma_f32_16x16x32_bf16 v[40:43], a[172:175], v[192:195], v[40:43]
    ds_read_b64_tr_b16 a[204:205], v9 offset:57344
    s_and_b32 s54, s40, 15
    v_mfma_f32_16x16x32_bf16 v[44:47], a[172:175], v[196:199], v[44:47]
    ds_read_b64_tr_b16 a[206:207], v9 offset:61440
    s_waitcnt lgkmcnt(8)
    v_mfma_f32_16x16x32_bf16 v[16:19], a[176:179], v[200:203], v[16:19]
    ds_read_b64_tr_b16 a[160:161], v6 offset:58368
    s_lshr_b32 s55, s40, 4
    v_mfma_f32_16x16x32_bf16 v[20:23], a[176:179], v[204:207], v[20:23]
    ds_read_b64_tr_b16 a[162:163], v6 offset:62464
    s_mul_i32 s40, s55, 384
    v_mfma_f32_16x16x32_bf16 v[24:27], a[180:183], v[200:203], v[24:27]
    ds_read_b64_tr_b16 a[164:165], v7 offset:58368
    s_lshr_b32 s41, s60, 9
    v_mfma_f32_16x16x32_bf16 v[28:31], a[180:183], v[204:207], v[28:31]
    ds_read_b64_tr_b16 a[166:167], v7 offset:62464
    buffer_load_dwordx4 v3, s[16:19], s30 offen offset:1024  lds
    v_mfma_f32_16x16x32_bf16 v[32:35], a[184:187], v[200:203], v[32:35]
    ds_read_b64_tr_b16 a[168:169], v8 offset:58368
    s_add_u32 s57, s40, s41
    v_mfma_f32_16x16x32_bf16 v[36:39], a[184:187], v[204:207], v[36:39]
    ds_read_b64_tr_b16 a[170:171], v8 offset:62464
    s_lshr_b32 s41, s61, 9
    v_mfma_f32_16x16x32_bf16 v[40:43], a[188:191], v[200:203], v[40:43]
    ds_read_b64_tr_b16 a[172:173], v9 offset:58368
    s_add_u32 s58, s40, s41
    v_mfma_f32_16x16x32_bf16 v[44:47], a[188:191], v[204:207], v[44:47]
    ds_read_b64_tr_b16 a[174:175], v9 offset:62464
    s_waitcnt vmcnt(8) lgkmcnt(8)
    v_mfma_f32_16x16x32_bf16 v[16:19], a[192:195], v[208:211], v[16:19]
    s_barrier
    ds_read_b64_tr_b16 a[176:177], v10 offset:0
    v_mfma_f32_16x16x32_bf16 v[20:23], a[192:195], v[212:215], v[20:23]
    ds_read_b64_tr_b16 a[178:179], v10 offset:4096
    s_add_u32 m0, s28, 0
    v_mfma_f32_16x16x32_bf16 v[24:27], a[196:199], v[208:211], v[24:27]
    ds_read_b64_tr_b16 a[180:181], v11 offset:0
    s_add_u32 s30, s33, 4128768
    v_mfma_f32_16x16x32_bf16 v[28:31], a[196:199], v[212:215], v[28:31]
    ds_read_b64_tr_b16 a[182:183], v11 offset:4096
    buffer_load_dwordx4 v2, s[16:19], s30 offen  lds
    v_mfma_f32_16x16x32_bf16 v[32:35], a[200:203], v[208:211], v[32:35]
    ds_read_b64_tr_b16 a[184:185], v12 offset:0
    s_lshr_b32 s41, s98, 9
    v_mfma_f32_16x16x32_bf16 v[36:39], a[200:203], v[212:215], v[36:39]
    ds_read_b64_tr_b16 a[186:187], v12 offset:4096
    s_add_u32 s59, s40, s41
    v_mfma_f32_16x16x32_bf16 v[40:43], a[204:207], v[208:211], v[40:43]
    ds_read_b64_tr_b16 a[188:189], v13 offset:0
    s_mul_i32 s40, s62, 9
    v_mfma_f32_16x16x32_bf16 v[44:47], a[204:207], v[212:215], v[44:47]
    ds_read_b64_tr_b16 a[190:191], v13 offset:4096
    s_waitcnt lgkmcnt(8)
    v_mfma_f32_16x16x32_bf16 v[16:19], a[160:163], v[216:219], v[16:19]
    ds_read_b64_tr_b16 a[192:193], v10 offset:1024
    s_mul_i32 s41, s55, 3
    v_mfma_f32_16x16x32_bf16 v[20:23], a[160:163], v[220:223], v[20:23]
    ds_read_b64_tr_b16 a[194:195], v10 offset:5120
    s_add_u32 s40, s40, s41
    v_mfma_f32_16x16x32_bf16 v[24:27], a[164:167], v[216:219], v[24:27]
    ds_read_b64_tr_b16 a[196:197], v11 offset:1024
    s_lshl_b32 s40, s40, 4
    v_mfma_f32_16x16x32_bf16 v[28:31], a[164:167], v[220:223], v[28:31]
    ds_read_b64_tr_b16 a[198:199], v11 offset:5120
    buffer_load_dwordx4 v3, s[16:19], s30 offen offset:1024  lds
    v_mfma_f32_16x16x32_bf16 v[32:35], a[168:171], v[216:219], v[32:35]
    ds_read_b64_tr_b16 a[200:201], v12 offset:1024
    s_add_u32 s40, s40, s54
    v_mfma_f32_16x16x32_bf16 v[36:39], a[168:171], v[220:223], v[36:39]
    ds_read_b64_tr_b16 a[202:203], v12 offset:5120
    s_lshl_b32 s40, s40, 12
    v_mfma_f32_16x16x32_bf16 v[40:43], a[172:175], v[216:219], v[40:43]
    ds_read_b64_tr_b16 a[204:205], v13 offset:1024
    s_add_u32 s85, s40, s60
    v_mfma_f32_16x16x32_bf16 v[44:47], a[172:175], v[220:223], v[44:47]
    ds_read_b64_tr_b16 a[206:207], v13 offset:5120
    s_waitcnt lgkmcnt(8)
    v_mfma_f32_16x16x32_bf16 v[16:19], a[176:179], v[224:227], v[16:19]
    ds_read_b64_tr_b16 a[160:161], v10 offset:8192
    s_add_u32 m0, s28, 8192
    v_mfma_f32_16x16x32_bf16 v[20:23], a[176:179], v[228:231], v[20:23]
    ds_read_b64_tr_b16 a[162:163], v10 offset:12288
    s_add_u32 s30, s33, 4718592
    v_mfma_f32_16x16x32_bf16 v[24:27], a[180:183], v[224:227], v[24:27]
    ds_read_b64_tr_b16 a[164:165], v11 offset:8192
    s_add_u32 s86, s40, s61
    v_mfma_f32_16x16x32_bf16 v[28:31], a[180:183], v[228:231], v[28:31]
    ds_read_b64_tr_b16 a[166:167], v11 offset:12288
    buffer_load_dwordx4 v2, s[16:19], s30 offen  lds
    v_mfma_f32_16x16x32_bf16 v[32:35], a[184:187], v[224:227], v[32:35]
    ds_read_b64_tr_b16 a[168:169], v12 offset:8192
    s_add_u32 s87, s40, s98
    v_mfma_f32_16x16x32_bf16 v[36:39], a[184:187], v[228:231], v[36:39]
    ds_read_b64_tr_b16 a[170:171], v12 offset:12288
    v_and_b32 v1, 3, v0
    v_mfma_f32_16x16x32_bf16 v[40:43], a[188:191], v[224:227], v[40:43]
    ds_read_b64_tr_b16 a[172:173], v13 offset:8192
    buffer_load_dwordx4 v3, s[16:19], s30 offen offset:1024  lds
    v_mfma_f32_16x16x32_bf16 v[44:47], a[188:191], v[228:231], v[44:47]
    ds_read_b64_tr_b16 a[174:175], v13 offset:12288
    s_waitcnt lgkmcnt(8)
    v_mfma_f32_16x16x32_bf16 v[16:19], a[192:195], v[232:235], v[16:19]
    ds_read_b64_tr_b16 a[176:177], v10 offset:9216
    s_add_u32 m0, s28, 16384
    v_mfma_f32_16x16x32_bf16 v[20:23], a[192:195], v[236:239], v[20:23]
    ds_read_b64_tr_b16 a[178:179], v10 offset:13312
    s_add_u32 s30, s34, 0
    v_mfma_f32_16x16x32_bf16 v[24:27], a[196:199], v[232:235], v[24:27]
    ds_read_b64_tr_b16 a[180:181], v11 offset:9216
    v_mul_u32_u24 v247, 3, v1
    v_mfma_f32_16x16x32_bf16 v[28:31], a[196:199], v[236:239], v[28:31]
    ds_read_b64_tr_b16 a[182:183], v11 offset:13312
    buffer_load_dwordx4 v2, s[16:19], s30 offen  lds
    v_mfma_f32_16x16x32_bf16 v[32:35], a[200:203], v[232:235], v[32:35]
    ds_read_b64_tr_b16 a[184:185], v12 offset:9216
    v_add_u32 v247, s55, v247
    v_mfma_f32_16x16x32_bf16 v[36:39], a[200:203], v[236:239], v[36:39]
    ds_read_b64_tr_b16 a[186:187], v12 offset:13312
    s_lshl_b32 s41, s39, 2
    v_mfma_f32_16x16x32_bf16 v[40:43], a[204:207], v[232:235], v[40:43]
    ds_read_b64_tr_b16 a[188:189], v13 offset:9216
    v_add_u32 v1, s41, v1
    v_mfma_f32_16x16x32_bf16 v[44:47], a[204:207], v[236:239], v[44:47]
    ds_read_b64_tr_b16 a[190:191], v13 offset:13312
    s_waitcnt lgkmcnt(8)
    v_mfma_f32_16x16x32_bf16 v[48:51], a[160:163], v[96:99], 0
    ds_read_b64_tr_b16 a[192:193], v10 offset:16384
    s_movk_i32 s31, 0
    v_mfma_f32_16x16x32_bf16 v[52:55], a[160:163], v[100:103], 0
    ds_read_b64_tr_b16 a[194:195], v10 offset:20480
    v_cvt_pk_bf16_f32 v80, v16, v17
    v_mfma_f32_16x16x32_bf16 v[56:59], a[164:167], v[96:99], 0
    ds_read_b64_tr_b16 a[196:197], v11 offset:16384
    v_cvt_pk_bf16_f32 v81, v18, v19
    v_mfma_f32_16x16x32_bf16 v[60:63], a[164:167], v[100:103], 0
    ds_read_b64_tr_b16 a[198:199], v11 offset:20480
    buffer_load_dwordx4 v3, s[16:19], s30 offen offset:1024  lds
    v_mfma_f32_16x16x32_bf16 v[64:67], a[168:171], v[96:99], 0
    ds_read_b64_tr_b16 a[200:201], v12 offset:16384
    v_cvt_pk_bf16_f32 v82, v24, v25
    v_mfma_f32_16x16x32_bf16 v[68:71], a[168:171], v[100:103], 0
    ds_read_b64_tr_b16 a[202:203], v12 offset:20480
    v_cvt_pk_bf16_f32 v83, v26, v27
    v_mfma_f32_16x16x32_bf16 v[72:75], a[172:175], v[96:99], 0
    ds_read_b64_tr_b16 a[204:205], v13 offset:16384
    v_pk_max_i16 v80, v80, 0
    v_mfma_f32_16x16x32_bf16 v[76:79], a[172:175], v[100:103], 0
    ds_read_b64_tr_b16 a[206:207], v13 offset:20480
    s_waitcnt lgkmcnt(8)
    v_mfma_f32_16x16x32_bf16 v[48:51], a[176:179], v[104:107], v[48:51]
    ds_read_b64_tr_b16 a[160:161], v10 offset:17408
    s_add_u32 m0, s28, 24576
    v_mfma_f32_16x16x32_bf16 v[52:55], a[176:179], v[108:111], v[52:55]
    ds_read_b64_tr_b16 a[162:163], v10 offset:21504
    s_add_u32 s30, s34, 589824
    v_mfma_f32_16x16x32_bf16 v[56:59], a[180:183], v[104:107], v[56:59]
    ds_read_b64_tr_b16 a[164:165], v11 offset:17408
    v_pk_max_i16 v81, v81, 0
    v_mfma_f32_16x16x32_bf16 v[60:63], a[180:183], v[108:111], v[60:63]
    ds_read_b64_tr_b16 a[166:167], v11 offset:21504
    buffer_load_dwordx4 v2, s[16:19], s30 offen  lds
    v_mfma_f32_16x16x32_bf16 v[64:67], a[184:187], v[104:107], v[64:67]
    ds_read_b64_tr_b16 a[168:169], v12 offset:17408
    v_pk_max_i16 v82, v82, 0
    v_mfma_f32_16x16x32_bf16 v[68:71], a[184:187], v[108:111], v[68:71]
    ds_read_b64_tr_b16 a[170:171], v12 offset:21504
    v_pk_max_i16 v83, v83, 0
    v_mfma_f32_16x16x32_bf16 v[72:75], a[188:191], v[104:107], v[72:75]
    ds_read_b64_tr_b16 a[172:173], v13 offset:17408
    v_accvgpr_write_b32 a0, v80
    v_mfma_f32_16x16x32_bf16 v[76:79], a[188:191], v[108:111], v[76:79]
    ds_read_b64_tr_b16 a[174:175], v13 offset:21504
    s_waitcnt lgkmcnt(8)
    v_mfma_f32_16x16x32_bf16 v[48:51], a[192:195], v[112:115], v[48:51]
    ds_read_b64_tr_b16 a[176:177], v10 offset:24576
    v_accvgpr_write_b32 a1, v81
    v_mfma_f32_16x16x32_bf16 v[52:55], a[192:195], v[116:119], v[52:55]
    ds_read_b64_tr_b16 a[178:179], v10 offset:28672
    v_accvgpr_write_b32 a2, v82
    v_mfma_f32_16x16x32_bf16 v[56:59], a[196:199], v[112:115], v[56:59]
    ds_read_b64_tr_b16 a[180:181], v11 offset:24576
    v_accvgpr_write_b32 a3, v83
    v_mfma_f32_16x16x32_bf16 v[60:63], a[196:199], v[116:119], v[60:63]
    ds_read_b64_tr_b16 a[182:183], v11 offset:28672
    buffer_load_dwordx4 v3, s[16:19], s30 offen offset:1024  lds
    v_mfma_f32_16x16x32_bf16 v[64:67], a[200:203], v[112:115], v[64:67]
    ds_read_b64_tr_b16 a[184:185], v12 offset:24576
    buffer_store_dwordx4 v[80:83], v14, s[76:79], s31 offen offset:0 sc1
    v_mfma_f32_16x16x32_bf16 v[68:71], a[200:203], v[116:119], v[68:71]
    ds_read_b64_tr_b16 a[186:187], v12 offset:28672
    v_cvt_pk_bf16_f32 v84, v20, v21
    v_mfma_f32_16x16x32_bf16 v[72:75], a[204:207], v[112:115], v[72:75]
    ds_read_b64_tr_b16 a[188:189], v13 offset:24576
    v_cvt_pk_bf16_f32 v85, v22, v23
    v_mfma_f32_16x16x32_bf16 v[76:79], a[204:207], v[116:119], v[76:79]
    ds_read_b64_tr_b16 a[190:191], v13 offset:28672
    s_waitcnt lgkmcnt(8)
    v_mfma_f32_16x16x32_bf16 v[48:51], a[160:163], v[120:123], v[48:51]
    ds_read_b64_tr_b16 a[192:193], v10 offset:25600
    s_add_u32 m0, s28, 32768
    v_mfma_f32_16x16x32_bf16 v[52:55], a[160:163], v[124:127], v[52:55]
    ds_read_b64_tr_b16 a[194:195], v10 offset:29696
    s_add_u32 s30, s34, 1179648
    v_mfma_f32_16x16x32_bf16 v[56:59], a[164:167], v[120:123], v[56:59]
    ds_read_b64_tr_b16 a[196:197], v11 offset:25600
    v_cvt_pk_bf16_f32 v86, v28, v29
    v_mfma_f32_16x16x32_bf16 v[60:63], a[164:167], v[124:127], v[60:63]
    ds_read_b64_tr_b16 a[198:199], v11 offset:29696
    buffer_load_dwordx4 v2, s[16:19], s30 offen  lds
    v_mfma_f32_16x16x32_bf16 v[64:67], a[168:171], v[120:123], v[64:67]
    ds_read_b64_tr_b16 a[200:201], v12 offset:25600
    v_cvt_pk_bf16_f32 v87, v30, v31
    v_mfma_f32_16x16x32_bf16 v[68:71], a[168:171], v[124:127], v[68:71]
    ds_read_b64_tr_b16 a[202:203], v12 offset:29696
    v_pk_max_i16 v84, v84, 0
    v_mfma_f32_16x16x32_bf16 v[72:75], a[172:175], v[120:123], v[72:75]
    ds_read_b64_tr_b16 a[204:205], v13 offset:25600
    v_pk_max_i16 v85, v85, 0
    v_mfma_f32_16x16x32_bf16 v[76:79], a[172:175], v[124:127], v[76:79]
    ds_read_b64_tr_b16 a[206:207], v13 offset:29696
    s_waitcnt vmcnt(10) lgkmcnt(8)
    v_mfma_f32_16x16x32_bf16 v[48:51], a[176:179], v[128:131], v[48:51]
    s_barrier
    ds_read_b64_tr_b16 a[160:161], v10 offset:32768
    v_mfma_f32_16x16x32_bf16 v[52:55], a[176:179], v[132:135], v[52:55]
    ds_read_b64_tr_b16 a[162:163], v10 offset:36864
    v_pk_max_i16 v86, v86, 0
    v_mfma_f32_16x16x32_bf16 v[56:59], a[180:183], v[128:131], v[56:59]
    ds_read_b64_tr_b16 a[164:165], v11 offset:32768
    v_pk_max_i16 v87, v87, 0
    v_mfma_f32_16x16x32_bf16 v[60:63], a[180:183], v[132:135], v[60:63]
    ds_read_b64_tr_b16 a[166:167], v11 offset:36864
    buffer_load_dwordx4 v3, s[16:19], s30 offen offset:1024  lds
    v_mfma_f32_16x16x32_bf16 v[64:67], a[184:187], v[128:131], v[64:67]
    ds_read_b64_tr_b16 a[168:169], v12 offset:32768
    v_accvgpr_write_b32 a4, v84
L_pm1:
    s_cbranch_execz L_pmb0
    v_mfma_f32_16x16x32_bf16 v[68:71], a[184:187], v[132:135], v[68:71]
    ds_read_b64_tr_b16 a[170:171], v12 offset:36864
    v_accvgpr_write_b32 a5, v85
    v_mfma_f32_16x16x32_bf16 v[72:75], a[188:191], v[128:131], v[72:75]
    ds_read_b64_tr_b16 a[172:173], v13 offset:32768
    v_accvgpr_write_b32 a6, v86
    v_mfma_f32_16x16x32_bf16 v[76:79], a[188:191], v[132:135], v[76:79]
    ds_read_b64_tr_b16 a[174:175], v13 offset:36864
    s_waitcnt lgkmcnt(8)
    v_mfma_f32_16x16x32_bf16 v[48:51], a[192:195], v[136:139], v[48:51]
    ds_read_b64_tr_b16 a[176:177], v10 offset:33792
    s_add_u32 m0, s28, 40960
    v_mfma_f32_16x16x32_bf16 v[52:55], a[192:195], v[140:143], v[52:55]
    ds_read_b64_tr_b16 a[178:179], v10 offset:37888
    s_add_u32 s30, s34, 1769472
    v_mfma_f32_16x16x32_bf16 v[56:59], a[196:199], v[136:139], v[56:59]
    ds_read_b64_tr_b16 a[180:181], v11 offset:33792
    v_accvgpr_write_b32 a7, v87
    v_mfma_f32_16x16x32_bf16 v[60:63], a[196:199], v[140:143], v[60:63]
    ds_read_b64_tr_b16 a[182:183], v11 offset:37888
    buffer_load_dwordx4 v2, s[16:19], s30 offen  lds
    v_mfma_f32_16x16x32_bf16 v[64:67], a[200:203], v[136:139], v[64:67]
    ds_read_b64_tr_b16 a[184:185], v12 offset:33792
    buffer_store_dwordx4 v[84:87], v14, s[76:79], s31 offen offset:1024 sc1
    v_mfma_f32_16x16x32_bf16 v[68:71], a[200:203], v[140:143], v[68:71]
    ds_read_b64_tr_b16 a[186:187], v12 offset:37888
    v_cvt_pk_bf16_f32 v88, v32, v33
    v_mfma_f32_16x16x32_bf16 v[72:75], a[204:207], v[136:139], v[72:75]
    ds_read_b64_tr_b16 a[188:189], v13 offset:33792
    buffer_load_dwordx4 v3, s[16:19], s30 offen offset:1024  lds
    v_mfma_f32_16x16x32_bf16 v[76:79], a[204:207], v[140:143], v[76:79]
    ds_read_b64_tr_b16 a[190:191], v13 offset:37888
    s_waitcnt lgkmcnt(8)
    v_mfma_f32_16x16x32_bf16 v[48:51], a[160:163], v[144:147], v[48:51]
    ds_read_b64_tr_b16 a[192:193], v10 offset:40960
    s_add_u32 m0, s28, 49152
    v_mfma_f32_16x16x32_bf16 v[52:55], a[160:163], v[148:151], v[52:55]
    ds_read_b64_tr_b16 a[194:195], v10 offset:45056
    s_add_u32 s30, s34, 2359296
    v_mfma_f32_16x16x32_bf16 v[56:59], a[164:167], v[144:147], v[56:59]
    ds_read_b64_tr_b16 a[196:197], v11 offset:40960
    v_cvt_pk_bf16_f32 v89, v34, v35
    v_mfma_f32_16x16x32_bf16 v[60:63], a[164:167], v[148:151], v[60:63]
    ds_read_b64_tr_b16 a[198:199], v11 offset:45056
    buffer_load_dwordx4 v2, s[16:19], s30 offen  lds
    v_mfma_f32_16x16x32_bf16 v[64:67], a[168:171], v[144:147], v[64:67]
    ds_read_b64_tr_b16 a[200:201], v12 offset:40960
    v_cvt_pk_bf16_f32 v90, v40, v41
    v_mfma_f32_16x16x32_bf16 v[68:71], a[168:171], v[148:151], v[68:71]
    ds_read_b64_tr_b16 a[202:203], v12 offset:45056
    v_cvt_pk_bf16_f32 v91, v42, v43
    v_mfma_f32_16x16x32_bf16 v[72:75], a[172:175], v[144:147], v[72:75]
    ds_read_b64_tr_b16 a[204:205], v13 offset:40960
    v_pk_max_i16 v88, v88, 0
    v_mfma_f32_16x16x32_bf16 v[76:79], a[172:175], v[148:151], v[76:79]
    ds_read_b64_tr_b16 a[206:207], v13 offset:45056
    s_waitcnt lgkmcnt(8)
    v_mfma_f32_16x16x32_bf16 v[48:51], a[176:179], v[152:155], v[48:51]
    ds_read_b64_tr_b16 a[160:161], v10 offset:41984
    v_pk_max_i16 v89, v89, 0
    v_mfma_f32_16x16x32_bf16 v[52:55], a[176:179], v[156:159], v[52:55]
    ds_read_b64_tr_b16 a[162:163], v10 offset:46080
    v_pk_max_i16 v90, v90, 0
    v_mfma_f32_16x16x32_bf16 v[56:59], a[180:183], v[152:155], v[56:59]
    ds_read_b64_tr_b16 a[164:165], v11 offset:41984
    v_pk_max_i16 v91, v91, 0
    v_mfma_f32_16x16x32_bf16 v[60:63], a[180:183], v[156:159], v[60:63]
    ds_read_b64_tr_b16 a[166:167], v11 offset:46080
    buffer_load_dwordx4 v3, s[16:19], s30 offen offset:1024  lds
    v_mfma_f32_16x16x32_bf16 v[64:67], a[184:187], v[152:155], v[64:67]
    ds_read_b64_tr_b16 a[168:169], v12 offset:41984
    v_accvgpr_write_b32 a8, v88
    v_mfma_f32_16x16x32_bf16 v[68:71], a[184:187], v[156:159], v[68:71]
    ds_read_b64_tr_b16 a[170:171], v12 offset:46080
    v_accvgpr_write_b32 a9, v89
    v_mfma_f32_16x16x32_bf16 v[72:75], a[188:191], v[152:155], v[72:75]
    ds_read_b64_tr_b16 a[172:173], v13 offset:41984
    v_accvgpr_write_b32 a10, v90
    v_mfma_f32_16x16x32_bf16 v[76:79], a[188:191], v[156:159], v[76:79]
    ds_read_b64_tr_b16 a[174:175], v13 offset:46080
    s_waitcnt lgkmcnt(8)
    v_mfma_f32_16x16x32_bf16 v[48:51], a[192:195], v[160:163], v[48:51]
    ds_read_b64_tr_b16 a[176:177], v10 offset:49152
    s_add_u32 m0, s28, 57344
    v_mfma_f32_16x16x32_bf16 v[52:55], a[192:195], v[164:167], v[52:55]
    ds_read_b64_tr_b16 a[178:179], v10 offset:53248
    s_add_u32 s30, s34, 2949120
    v_mfma_f32_16x16x32_bf16 v[56:59], a[196:199], v[160:163], v[56:59]
    ds_read_b64_tr_b16 a[180:181], v11 offset:49152
    v_accvgpr_write_b32 a11, v91
    v_mfma_f32_16x16x32_bf16 v[60:63], a[196:199], v[164:167], v[60:63]
    ds_read_b64_tr_b16 a[182:183], v11 offset:53248
    buffer_load_dwordx4 v2, s[16:19], s30 offen  lds
    v_mfma_f32_16x16x32_bf16 v[64:67], a[200:203], v[160:163], v[64:67]
    ds_read_b64_tr_b16 a[184:185], v12 offset:49152
    buffer_store_dwordx4 v[88:91], v14, s[76:79], s31 offen offset:2048 sc1
    v_mfma_f32_16x16x32_bf16 v[68:71], a[200:203], v[164:167], v[68:71]
    ds_read_b64_tr_b16 a[186:187], v12 offset:53248
    v_cvt_pk_bf16_f32 v92, v36, v37
    v_mfma_f32_16x16x32_bf16 v[72:75], a[204:207], v[160:163], v[72:75]
    ds_read_b64_tr_b16 a[188:189], v13 offset:49152
    v_cvt_pk_bf16_f32 v93, v38, v39
    v_mfma_f32_16x16x32_bf16 v[76:79], a[204:207], v[164:167], v[76:79]
    ds_read_b64_tr_b16 a[190:191], v13 offset:53248
    s_waitcnt lgkmcnt(8)
    v_mfma_f32_16x16x32_bf16 v[48:51], a[160:163], v[168:171], v[48:51]
    ds_read_b64_tr_b16 a[192:193], v10 offset:50176
    v_cvt_pk_bf16_f32 v94, v44, v45
    v_mfma_f32_16x16x32_bf16 v[52:55], a[160:163], v[172:175], v[52:55]
    ds_read_b64_tr_b16 a[194:195], v10 offset:54272
    v_cvt_pk_bf16_f32 v95, v46, v47
    v_mfma_f32_16x16x32_bf16 v[56:59], a[164:167], v[168:171], v[56:59]
    ds_read_b64_tr_b16 a[196:197], v11 offset:50176
    v_pk_max_i16 v92, v92, 0
    v_mfma_f32_16x16x32_bf16 v[60:63], a[164:167], v[172:175], v[60:63]
    ds_read_b64_tr_b16 a[198:199], v11 offset:54272
    buffer_load_dwordx4 v3, s[16:19], s30 offen offset:1024  lds
    v_mfma_f32_16x16x32_bf16 v[64:67], a[168:171], v[168:171], v[64:67]
    ds_read_b64_tr_b16 a[200:201], v12 offset:50176
    v_pk_max_i16 v93, v93, 0
    v_mfma_f32_16x16x32_bf16 v[68:71], a[168:171], v[172:175], v[68:71]
    ds_read_b64_tr_b16 a[202:203], v12 offset:54272
    v_pk_max_i16 v94, v94, 0
    v_mfma_f32_16x16x32_bf16 v[72:75], a[172:175], v[168:171], v[72:75]
    ds_read_b64_tr_b16 a[204:205], v13 offset:50176
    v_pk_max_i16 v95, v95, 0
    v_mfma_f32_16x16x32_bf16 v[76:79], a[172:175], v[172:175], v[76:79]
    ds_read_b64_tr_b16 a[206:207], v13 offset:54272
    s_waitcnt lgkmcnt(8)
    v_mfma_f32_16x16x32_bf16 v[48:51], a[176:179], v[176:179], v[48:51]
    ds_read_b64_tr_b16 a[160:161], v10 offset:57344
    s_add_u32 m0, s28, 65536
    v_mfma_f32_16x16x32_bf16 v[52:55], a[176:179], v[180:183], v[52:55]
    ds_read_b64_tr_b16 a[162:163], v10 offset:61440
    s_add_u32 s30, s34, 3538944
    v_mfma_f32_16x16x32_bf16 v[56:59], a[180:183], v[176:179], v[56:59]
    ds_read_b64_tr_b16 a[164:165], v11 offset:57344
    v_accvgpr_write_b32 a12, v92
    v_mfma_f32_16x16x32_bf16 v[60:63], a[180:183], v[180:183], v[60:63]
    ds_read_b64_tr_b16 a[166:167], v11 offset:61440
    buffer_load_dwordx4 v2, s[16:19], s30 offen  lds
    v_mfma_f32_16x16x32_bf16 v[64:67], a[184:187], v[176:179], v[64:67]
    ds_read_b64_tr_b16 a[168:169], v12 offset:57344
    v_accvgpr_write_b32 a13, v93
    v_mfma_f32_16x16x32_bf16 v[68:71], a[184:187], v[180:183], v[68:71]
    ds_read_b64_tr_b16 a[170:171], v12 offset:61440
    v_accvgpr_write_b32 a14, v94
    v_mfma_f32_16x16x32_bf16 v[72:75], a[188:191], v[176:179], v[72:75]
    ds_read_b64_tr_b16 a[172:173], v13 offset:57344
    v_accvgpr_write_b32 a15, v95
    v_mfma_f32_16x16x32_bf16 v[76:79], a[188:191], v[180:183], v[76:79]
    ds_read_b64_tr_b16 a[174:175], v13 offset:61440
    s_waitcnt lgkmcnt(8)
    v_mfma_f32_16x16x32_bf16 v[48:51], a[192:195], v[184:187], v[48:51]
    ds_read_b64_tr_b16 a[176:177], v10 offset:58368
    v_mfma_f32_16x16x32_bf16 v[52:55], a[192:195], v[188:191], v[52:55]
    ds_read_b64_tr_b16 a[178:179], v10 offset:62464
    v_mfma_f32_16x16x32_bf16 v[56:59], a[196:199], v[184:187], v[56:59]
    ds_read_b64_tr_b16 a[180:181], v11 offset:58368
    v_mfma_f32_16x16x32_bf16 v[60:63], a[196:199], v[188:191], v[60:63]
    ds_read_b64_tr_b16 a[182:183], v11 offset:62464
    buffer_load_dwordx4 v3, s[16:19], s30 offen offset:1024  lds
    v_mfma_f32_16x16x32_bf16 v[64:67], a[200:203], v[184:187], v[64:67]
    ds_read_b64_tr_b16 a[184:185], v12 offset:58368
    buffer_store_dwordx4 v[92:95], v14, s[76:79], s31 offen offset:3072 sc1
    v_mfma_f32_16x16x32_bf16 v[68:71], a[200:203], v[188:191], v[68:71]
    ds_read_b64_tr_b16 a[186:187], v12 offset:62464
    v_and_b32 v15, 0, v0
    v_mfma_f32_16x16x32_bf16 v[72:75], a[204:207], v[184:187], v[72:75]
    ds_read_b64_tr_b16 a[188:189], v13 offset:58368
    v_cmp_eq_u32 vcc, 0, v15
    s_nop 1
    v_cndmask_b32 v247, v1, v247, vcc
    v_mfma_f32_16x16x32_bf16 v[76:79], a[204:207], v[188:191], v[76:79]
    ds_read_b64_tr_b16 a[190:191], v13 offset:62464
    s_waitcnt vmcnt(14) lgkmcnt(8)
    v_mfma_f32_16x16x32_bf16 v[48:51], a[160:163], v[192:195], v[48:51]
    s_barrier
    ds_read_b64_tr_b16 a[192:193], v6 offset:0
    v_mfma_f32_16x16x32_bf16 v[52:55], a[160:163], v[196:199], v[52:55]
    ds_read_b64_tr_b16 a[194:195], v6 offset:4096
    s_add_u32 m0, s28, 73728
    v_mfma_f32_16x16x32_bf16 v[56:59], a[164:167], v[192:195], v[56:59]
    ds_read_b64_tr_b16 a[196:197], v7 offset:0
    s_add_u32 s30, s34, 4128768
    v_mfma_f32_16x16x32_bf16 v[60:63], a[164:167], v[196:199], v[60:63]
    ds_read_b64_tr_b16 a[198:199], v7 offset:4096
    buffer_load_dwordx4 v2, s[16:19], s30 offen  lds
    v_mfma_f32_16x16x32_bf16 v[64:67], a[168:171], v[192:195], v[64:67]
    ds_read_b64_tr_b16 a[200:201], v8 offset:0
    s_mul_i32 s40, s62, 12
    v_mfma_f32_16x16x32_bf16 v[68:71], a[168:171], v[196:199], v[68:71]
    ds_read_b64_tr_b16 a[202:203], v8 offset:4096
    v_add_u32 v247, s40, v247
    v_mfma_f32_16x16x32_bf16 v[72:75], a[172:175], v[192:195], v[72:75]
    ds_read_b64_tr_b16 a[204:205], v9 offset:0
    v_lshlrev_b32 v247, 7, v247
    v_mfma_f32_16x16x32_bf16 v[76:79], a[172:175], v[196:199], v[76:79]
    ds_read_b64_tr_b16 a[206:207], v9 offset:4096
    s_waitcnt lgkmcnt(8)
    v_mfma_f32_16x16x32_bf16 v[48:51], a[176:179], v[200:203], v[48:51]
    ds_read_b64_tr_b16 a[160:161], v6 offset:1024
    s_mul_i32 s41, s89, 3
    v_mfma_f32_16x16x32_bf16 v[52:55], a[176:179], v[204:207], v[52:55]
    ds_read_b64_tr_b16 a[162:163], v6 offset:5120
    s_add_u32 s40, s40, s41
    v_mfma_f32_16x16x32_bf16 v[56:59], a[180:183], v[200:203], v[56:59]
    ds_read_b64_tr_b16 a[164:165], v7 offset:1024
    s_lshl_b32 s40, s40, 7
    v_mfma_f32_16x16x32_bf16 v[60:63], a[180:183], v[204:207], v[60:63]
    ds_read_b64_tr_b16 a[166:167], v7 offset:5120
    buffer_load_dwordx4 v3, s[16:19], s30 offen offset:1024  lds
    v_mfma_f32_16x16x32_bf16 v[64:67], a[184:187], v[200:203], v[64:67]
    ds_read_b64_tr_b16 a[168:169], v8 offset:1024
    v_min_u32 v253, 2, v0
    v_mfma_f32_16x16x32_bf16 v[68:71], a[184:187], v[204:207], v[68:71]
    ds_read_b64_tr_b16 a[170:171], v8 offset:5120
    v_lshlrev_b32 v253, 7, v253
    v_mfma_f32_16x16x32_bf16 v[72:75], a[188:191], v[200:203], v[72:75]
    ds_read_b64_tr_b16 a[172:173], v9 offset:1024
    v_add_u32 v253, s40, v253
    v_mfma_f32_16x16x32_bf16 v[76:79], a[188:191], v[204:207], v[76:79]
    ds_read_b64_tr_b16 a[174:175], v9 offset:5120
    s_waitcnt lgkmcnt(8)
    v_mfma_f32_16x16x32_bf16 v[48:51], a[192:195], v[208:211], v[48:51]
    ds_read_b64_tr_b16 a[176:177], v6 offset:8192
    s_add_u32 m0, s28, 81920
    v_mfma_f32_16x16x32_bf16 v[52:55], a[192:195], v[212:215], v[52:55]
    ds_read_b64_tr_b16 a[178:179], v6 offset:12288
    s_add_u32 s30, s34, 4718592
    v_mfma_f32_16x16x32_bf16 v[56:59], a[196:199], v[208:211], v[56:59]
    ds_read_b64_tr_b16 a[180:181], v7 offset:8192
    s_lshl_b32 s65, s3, 13
    v_mfma_f32_16x16x32_bf16 v[60:63], a[196:199], v[212:215], v[60:63]
    ds_read_b64_tr_b16 a[182:183], v7 offset:12288
    buffer_load_dwordx4 v2, s[16:19], s30 offen  lds
    v_mfma_f32_16x16x32_bf16 v[64:67], a[200:203], v[208:211], v[64:67]
    ds_read_b64_tr_b16 a[184:185], v8 offset:8192
    s_add_u32 s65, s65, 0x20000
    v_mfma_f32_16x16x32_bf16 v[68:71], a[200:203], v[212:215], v[68:71]
    ds_read_b64_tr_b16 a[186:187], v8 offset:12288
    s_add_u32 s12, s52, 8388608
    s_addc_u32 s13, s53, 0
    v_mfma_f32_16x16x32_bf16 v[72:75], a[204:207], v[208:211], v[72:75]
    ds_read_b64_tr_b16 a[188:189], v9 offset:8192
    s_mov_b32 s14, 9437184
    v_mfma_f32_16x16x32_bf16 v[76:79], a[204:207], v[212:215], v[76:79]
    ds_read_b64_tr_b16 a[190:191], v9 offset:12288
    s_waitcnt lgkmcnt(8)
    v_mfma_f32_16x16x32_bf16 v[48:51], a[160:163], v[216:219], v[48:51]
    ds_read_b64_tr_b16 a[192:193], v6 offset:9216
    s_lshr_b32 s40, s54, 3
    v_mfma_f32_16x16x32_bf16 v[52:55], a[160:163], v[220:223], v[52:55]
    ds_read_b64_tr_b16 a[194:195], v6 offset:13312
    s_lshl_b32 s40, s40, 6
    v_mfma_f32_16x16x32_bf16 v[56:59], a[164:167], v[216:219], v[56:59]
    ds_read_b64_tr_b16 a[196:197], v7 offset:9216
    s_and_b32 s41, s54, 3
    v_mfma_f32_16x16x32_bf16 v[60:63], a[164:167], v[220:223], v[60:63]
    ds_read_b64_tr_b16 a[198:199], v7 offset:13312
    buffer_load_dwordx4 v3, s[16:19], s30 offen offset:1024  lds
    v_mfma_f32_16x16x32_bf16 v[64:67], a[168:171], v[216:219], v[64:67]
    ds_read_b64_tr_b16 a[200:201], v8 offset:9216
    s_lshl_b32 s41, s41, 4
    v_mfma_f32_16x16x32_bf16 v[68:71], a[168:171], v[220:223], v[68:71]
    ds_read_b64_tr_b16 a[202:203], v8 offset:13312
    s_add_u32 s40, s40, s41
    v_mfma_f32_16x16x32_bf16 v[72:75], a[172:175], v[216:219], v[72:75]
    ds_read_b64_tr_b16 a[204:205], v9 offset:9216
    s_lshl_b32 s41, s62, 7
    v_mfma_f32_16x16x32_bf16 v[76:79], a[172:175], v[220:223], v[76:79]
    ds_read_b64_tr_b16 a[206:207], v9 offset:13312
    s_waitcnt lgkmcnt(8)
    v_mfma_f32_16x16x32_bf16 v[48:51], a[176:179], v[224:227], v[48:51]
    ds_read_b64_tr_b16 a[160:161], v6 offset:16384
    s_add_u32 m0, s28, 90112
    v_mfma_f32_16x16x32_bf16 v[52:55], a[176:179], v[228:231], v[52:55]
    ds_read_b64_tr_b16 a[162:163], v6 offset:20480
    s_add_u32 s30, s35, 0
    v_mfma_f32_16x16x32_bf16 v[56:59], a[180:183], v[224:227], v[56:59]
    ds_read_b64_tr_b16 a[164:165], v7 offset:16384
    s_add_u32 s40, s40, s41
    v_mfma_f32_16x16x32_bf16 v[60:63], a[180:183], v[228:231], v[60:63]
    ds_read_b64_tr_b16 a[166:167], v7 offset:20480
    buffer_load_dwordx4 v2, s[16:19], s30 offen  lds
    v_mfma_f32_16x16x32_bf16 v[64:67], a[184:187], v[224:227], v[64:67]
    ds_read_b64_tr_b16 a[168:169], v8 offset:16384
    s_bfe_u32 s41, s54, 0x10002
    v_mfma_f32_16x16x32_bf16 v[68:71], a[184:187], v[228:231], v[68:71]
    ds_read_b64_tr_b16 a[170:171], v8 offset:20480
    s_lshl_b32 s41, s41, 6
    v_mfma_f32_16x16x32_bf16 v[72:75], a[188:191], v[224:227], v[72:75]
    ds_read_b64_tr_b16 a[172:173], v9 offset:16384
    v_and_b32 v1, 15, v0
    v_mfma_f32_16x16x32_bf16 v[76:79], a[188:191], v[228:231], v[76:79]
    ds_read_b64_tr_b16 a[174:175], v9 offset:20480
    s_waitcnt lgkmcnt(8)
    v_mfma_f32_16x16x32_bf16 v[48:51], a[192:195], v[232:235], v[48:51]
    ds_read_b64_tr_b16 a[176:177], v6 offset:17408
    v_add_u32 v1, s40, v1
    v_mfma_f32_16x16x32_bf16 v[52:55], a[192:195], v[236:239], v[52:55]
    ds_read_b64_tr_b16 a[178:179], v6 offset:21504
    v_lshlrev_b32 v246, 2, v1
    v_mfma_f32_16x16x32_bf16 v[56:59], a[196:199], v[232:235], v[56:59]
    ds_read_b64_tr_b16 a[180:181], v7 offset:17408
    v_mul_u32_u24 v1, 1152, v1
    v_mfma_f32_16x16x32_bf16 v[60:63], a[196:199], v[236:239], v[60:63]
    ds_read_b64_tr_b16 a[182:183], v7 offset:21504
    buffer_load_dwordx4 v3, s[16:19], s30 offen offset:1024  lds
    v_mfma_f32_16x16x32_bf16 v[64:67], a[200:203], v[232:235], v[64:67]
    ds_read_b64_tr_b16 a[184:185], v8 offset:17408
    v_bfe_u32 v15, v0, 4, 1
    v_mfma_f32_16x16x32_bf16 v[68:71], a[200:203], v[236:239], v[68:71]
    ds_read_b64_tr_b16 a[186:187], v8 offset:21504
    v_lshl_add_u32 v1, v15, 5, v1
    v_mfma_f32_16x16x32_bf16 v[72:75], a[204:207], v[232:235], v[72:75]
    ds_read_b64_tr_b16 a[188:189], v9 offset:17408
    v_lshrrev_b32 v15, 5, v0
    v_mfma_f32_16x16x32_bf16 v[76:79], a[204:207], v[236:239], v[76:79]
    ds_read_b64_tr_b16 a[190:191], v9 offset:21504
    s_waitcnt lgkmcnt(8)
    v_mfma_f32_16x16x32_bf16 v[16:19], a[160:163], v[96:99], 0
    ds_read_b64_tr_b16 a[192:193], v6 offset:24576
    s_add_u32 m0, s28, 98304
    v_mfma_f32_16x16x32_bf16 v[20:23], a[160:163], v[100:103], 0
    ds_read_b64_tr_b16 a[194:195], v6 offset:28672
    s_add_u32 s30, s35, 589824
    v_mfma_f32_16x16x32_bf16 v[24:27], a[164:167], v[96:99], 0
    ds_read_b64_tr_b16 a[196:197], v7 offset:24576
    s_movk_i32 s31, 4096
    v_mfma_f32_16x16x32_bf16 v[28:31], a[164:167], v[100:103], 0
    ds_read_b64_tr_b16 a[198:199], v7 offset:28672
    buffer_load_dwordx4 v2, s[16:19], s30 offen  lds
    v_mfma_f32_16x16x32_bf16 v[32:35], a[168:171], v[96:99], 0
    ds_read_b64_tr_b16 a[200:201], v8 offset:24576
    v_cvt_pk_bf16_f32 v80, v48, v49
    v_mfma_f32_16x16x32_bf16 v[36:39], a[168:171], v[100:103], 0
    ds_read_b64_tr_b16 a[202:203], v8 offset:28672
    v_cvt_pk_bf16_f32 v81, v50, v51
    v_mfma_f32_16x16x32_bf16 v[40:43], a[172:175], v[96:99], 0
    ds_read_b64_tr_b16 a[204:205], v9 offset:24576
    v_cvt_pk_bf16_f32 v82, v56, v57
    v_mfma_f32_16x16x32_bf16 v[44:47], a[172:175], v[100:103], 0
    ds_read_b64_tr_b16 a[206:207], v9 offset:28672
    s_waitcnt lgkmcnt(8)
    v_mfma_f32_16x16x32_bf16 v[16:19], a[176:179], v[104:107], v[16:19]
    ds_read_b64_tr_b16 a[160:161], v6 offset:25600
    v_cvt_pk_bf16_f32 v83, v58, v59
    v_mfma_f32_16x16x32_bf16 v[20:23], a[176:179], v[108:111], v[20:23]
    ds_read_b64_tr_b16 a[162:163], v6 offset:29696
    v_pk_max_i16 v80, v80, 0
    v_mfma_f32_16x16x32_bf16 v[24:27], a[180:183], v[104:107], v[24:27]
    ds_read_b64_tr_b16 a[164:165], v7 offset:25600
    v_pk_max_i16 v81, v81, 0
    v_mfma_f32_16x16x32_bf16 v[28:31], a[180:183], v[108:111], v[28:31]
    ds_read_b64_tr_b16 a[166:167], v7 offset:29696
    buffer_load_dwordx4 v3, s[16:19], s30 offen offset:1024  lds
    v_mfma_f32_16x16x32_bf16 v[32:35], a[184:187], v[104:107], v[32:35]
    ds_read_b64_tr_b16 a[168:169], v8 offset:25600
    v_pk_max_i16 v82, v82, 0
    v_mfma_f32_16x16x32_bf16 v[36:39], a[184:187], v[108:111], v[36:39]
    ds_read_b64_tr_b16 a[170:171], v8 offset:29696
    v_pk_max_i16 v83, v83, 0
    v_mfma_f32_16x16x32_bf16 v[40:43], a[188:191], v[104:107], v[40:43]
    ds_read_b64_tr_b16 a[172:173], v9 offset:25600
    v_accvgpr_write_b32 a16, v80
    v_mfma_f32_16x16x32_bf16 v[44:47], a[188:191], v[108:111], v[44:47]
    ds_read_b64_tr_b16 a[174:175], v9 offset:29696
    s_waitcnt vmcnt(11) lgkmcnt(8)
    v_mfma_f32_16x16x32_bf16 v[16:19], a[192:195], v[112:115], v[16:19]
    s_barrier
    ds_read_b64_tr_b16 a[176:177], v6 offset:32768
    v_mfma_f32_16x16x32_bf16 v[20:23], a[192:195], v[116:119], v[20:23]
    ds_read_b64_tr_b16 a[178:179], v6 offset:36864
    buffer_load_dword v241, v240, s[68:71], 0 offen sc1
    v_mfma_f32_16x16x32_bf16 v[24:27], a[196:199], v[112:115], v[24:27]
    ds_read_b64_tr_b16 a[180:181], v7 offset:32768
    s_add_u32 m0, s28, 106496
    v_mfma_f32_16x16x32_bf16 v[28:31], a[196:199], v[116:119], v[28:31]
    ds_read_b64_tr_b16 a[182:183], v7 offset:36864
    v_accvgpr_write_b32 a17, v81
    v_mfma_f32_16x16x32_bf16 v[32:35], a[200:203], v[112:115], v[32:35]
    ds_read_b64_tr_b16 a[184:185], v8 offset:32768
    v_accvgpr_write_b32 a18, v82
    v_mfma_f32_16x16x32_bf16 v[36:39], a[200:203], v[116:119], v[36:39]
    ds_read_b64_tr_b16 a[186:187], v8 offset:36864
    v_accvgpr_write_b32 a19, v83
    v_mfma_f32_16x16x32_bf16 v[40:43], a[204:207], v[112:115], v[40:43]
    ds_read_b64_tr_b16 a[188:189], v9 offset:32768
    buffer_store_dwordx4 v[80:83], v14, s[76:79], s31 offen offset:0 sc1
    v_mfma_f32_16x16x32_bf16 v[44:47], a[204:207], v[116:119], v[44:47]
    ds_read_b64_tr_b16 a[190:191], v9 offset:36864
    s_waitcnt lgkmcnt(8)
    v_mfma_f32_16x16x32_bf16 v[16:19], a[160:163], v[120:123], v[16:19]
    ds_read_b64_tr_b16 a[192:193], v6 offset:33792
    s_add_u32 s30, s35, 1179648
    v_mfma_f32_16x16x32_bf16 v[20:23], a[160:163], v[124:127], v[20:23]
    ds_read_b64_tr_b16 a[194:195], v6 offset:37888
    v_cvt_pk_bf16_f32 v84, v52, v53
    v_mfma_f32_16x16x32_bf16 v[24:27], a[164:167], v[120:123], v[24:27]
    ds_read_b64_tr_b16 a[196:197], v7 offset:33792
    v_cvt_pk_bf16_f32 v85, v54, v55
    v_mfma_f32_16x16x32_bf16 v[28:31], a[164:167], v[124:127], v[28:31]
    ds_read_b64_tr_b16 a[198:199], v7 offset:37888
    buffer_load_dwordx4 v2, s[16:19], s30 offen  lds
    v_mfma_f32_16x16x32_bf16 v[32:35], a[168:171], v[120:123], v[32:35]
    ds_read_b64_tr_b16 a[200:201], v8 offset:33792
    v_cvt_pk_bf16_f32 v86, v60, v61
    v_mfma_f32_16x16x32_bf16 v[36:39], a[168:171], v[124:127], v[36:39]
    ds_read_b64_tr_b16 a[202:203], v8 offset:37888
    v_cvt_pk_bf16_f32 v87, v62, v63
    v_mfma_f32_16x16x32_bf16 v[40:43], a[172:175], v[120:123], v[40:43]
    ds_read_b64_tr_b16 a[204:205], v9 offset:33792
    buffer_load_dwordx4 v3, s[16:19], s30 offen offset:1024  lds
    v_mfma_f32_16x16x32_bf16 v[44:47], a[172:175], v[124:127], v[44:47]
    ds_read_b64_tr_b16 a[206:207], v9 offset:37888
    s_waitcnt lgkmcnt(8)
    v_mfma_f32_16x16x32_bf16 v[16:19], a[176:179], v[128:131], v[16:19]
    ds_read_b64_tr_b16 a[160:161], v6 offset:40960
    s_add_u32 m0, s28, 114688
    v_mfma_f32_16x16x32_bf16 v[20:23], a[176:179], v[132:135], v[20:23]
    ds_read_b64_tr_b16 a[162:163], v6 offset:45056
    s_add_u32 s30, s35, 1769472
    v_mfma_f32_16x16x32_bf16 v[24:27], a[180:183], v[128:131], v[24:27]
    ds_read_b64_tr_b16 a[164:165], v7 offset:40960
    v_pk_max_i16 v84, v84, 0
    v_mfma_f32_16x16x32_bf16 v[28:31], a[180:183], v[132:135], v[28:31]
    ds_read_b64_tr_b16 a[166:167], v7 offset:45056
    buffer_load_dwordx4 v2, s[16:19], s30 offen  lds
    v_mfma_f32_16x16x32_bf16 v[32:35], a[184:187], v[128:131], v[32:35]
    ds_read_b64_tr_b16 a[168:169], v8 offset:40960
    v_pk_max_i16 v85, v85, 0
    v_mfma_f32_16x16x32_bf16 v[36:39], a[184:187], v[132:135], v[36:39]
    ds_read_b64_tr_b16 a[170:171], v8 offset:45056
    v_pk_max_i16 v86, v86, 0
    v_mfma_f32_16x16x32_bf16 v[40:43], a[188:191], v[128:131], v[40:43]
    ds_read_b64_tr_b16 a[172:173], v9 offset:40960
    v_pk_max_i16 v87, v87, 0
    v_mfma_f32_16x16x32_bf16 v[44:47], a[188:191], v[132:135], v[44:47]
    ds_read_b64_tr_b16 a[174:175], v9 offset:45056
    s_waitcnt lgkmcnt(8)
    v_mfma_f32_16x16x32_bf16 v[16:19], a[192:195], v[136:139], v[16:19]
    ds_read_b64_tr_b16 a[176:177], v6 offset:41984
    v_accvgpr_write_b32 a20, v84
    v_mfma_f32_16x16x32_bf16 v[20:23], a[192:195], v[140:143], v[20:23]
    ds_read_b64_tr_b16 a[178:179], v6 offset:46080
    v_accvgpr_write_b32 a21, v85
    v_mfma_f32_16x16x32_bf16 v[24:27], a[196:199], v[136:139], v[24:27]
    ds_read_b64_tr_b16 a[180:181], v7 offset:41984
    v_accvgpr_write_b32 a22, v86
    v_mfma_f32_16x16x32_bf16 v[28:31], a[196:199], v[140:143], v[28:31]
    ds_read_b64_tr_b16 a[182:183], v7 offset:46080
    buffer_load_dwordx4 v3, s[16:19], s30 offen offset:1024  lds
    v_mfma_f32_16x16x32_bf16 v[32:35], a[200:203], v[136:139], v[32:35]
    ds_read_b64_tr_b16 a[184:185], v8 offset:41984
    v_accvgpr_write_b32 a23, v87
    v_mfma_f32_16x16x32_bf16 v[36:39], a[200:203], v[140:143], v[36:39]
    ds_read_b64_tr_b16 a[186:187], v8 offset:46080
    buffer_store_dwordx4 v[84:87], v14, s[76:79], s31 offen offset:1024 sc1
    v_mfma_f32_16x16x32_bf16 v[40:43], a[204:207], v[136:139], v[40:43]
    ds_read_b64_tr_b16 a[188:189], v9 offset:41984
    v_cvt_pk_bf16_f32 v88, v64, v65
    v_mfma_f32_16x16x32_bf16 v[44:47], a[204:207], v[140:143], v[44:47]
    ds_read_b64_tr_b16 a[190:191], v9 offset:46080
    s_waitcnt lgkmcnt(8)
    v_mfma_f32_16x16x32_bf16 v[16:19], a[160:163], v[144:147], v[16:19]
    ds_read_b64_tr_b16 a[192:193], v6 offset:49152
    s_add_u32 m0, s28, 122880
    v_mfma_f32_16x16x32_bf16 v[20:23], a[160:163], v[148:151], v[20:23]
    ds_read_b64_tr_b16 a[194:195], v6 offset:53248
    s_add_u32 s30, s35, 2359296
    v_mfma_f32_16x16x32_bf16 v[24:27], a[164:167], v[144:147], v[24:27]
    ds_read_b64_tr_b16 a[196:197], v7 offset:49152
    v_cvt_pk_bf16_f32 v89, v66, v67
    v_mfma_f32_16x16x32_bf16 v[28:31], a[164:167], v[148:151], v[28:31]
    ds_read_b64_tr_b16 a[198:199], v7 offset:53248
    buffer_load_dwordx4 v2, s[16:19], s30 offen  lds
    v_mfma_f32_16x16x32_bf16 v[32:35], a[168:171], v[144:147], v[32:35]
    ds_read_b64_tr_b16 a[200:201], v8 offset:49152
    v_cvt_pk_bf16_f32 v90, v72, v73
    v_mfma_f32_16x16x32_bf16 v[36:39], a[168:171], v[148:151], v[36:39]
    ds_read_b64_tr_b16 a[202:203], v8 offset:53248
    v_cvt_pk_bf16_f32 v91, v74, v75
    v_mfma_f32_16x16x32_bf16 v[40:43], a[172:175], v[144:147], v[40:43]
    ds_read_b64_tr_b16 a[204:205], v9 offset:49152
    v_pk_max_i16 v88, v88, 0
    v_mfma_f32_16x16x32_bf16 v[44:47], a[172:175], v[148:151], v[44:47]
    ds_read_b64_tr_b16 a[206:207], v9 offset:53248
    s_waitcnt lgkmcnt(8)
    v_mfma_f32_16x16x32_bf16 v[16:19], a[176:179], v[152:155], v[16:19]
    ds_read_b64_tr_b16 a[160:161], v6 offset:50176
    v_pk_max_i16 v89, v89, 0
    v_mfma_f32_16x16x32_bf16 v[20:23], a[176:179], v[156:159], v[20:23]
    ds_read_b64_tr_b16 a[162:163], v6 offset:54272
    v_pk_max_i16 v90, v90, 0
    v_mfma_f32_16x16x32_bf16 v[24:27], a[180:183], v[152:155], v[24:27]
    ds_read_b64_tr_b16 a[164:165], v7 offset:50176
    v_pk_max_i16 v91, v91, 0
    v_mfma_f32_16x16x32_bf16 v[28:31], a[180:183], v[156:159], v[28:31]
    ds_read_b64_tr_b16 a[166:167], v7 offset:54272
    buffer_load_dwordx4 v3, s[16:19], s30 offen offset:1024  lds
    v_mfma_f32_16x16x32_bf16 v[32:35], a[184:187], v[152:155], v[32:35]
    ds_read_b64_tr_b16 a[168:169], v8 offset:50176
    v_accvgpr_write_b32 a24, v88
    v_mfma_f32_16x16x32_bf16 v[36:39], a[184:187], v[156:159], v[36:39]
    ds_read_b64_tr_b16 a[170:171], v8 offset:54272
    v_accvgpr_write_b32 a25, v89
    v_mfma_f32_16x16x32_bf16 v[40:43], a[188:191], v[152:155], v[40:43]
    ds_read_b64_tr_b16 a[172:173], v9 offset:50176
    v_accvgpr_write_b32 a26, v90
    v_mfma_f32_16x16x32_bf16 v[44:47], a[188:191], v[156:159], v[44:47]
    ds_read_b64_tr_b16 a[174:175], v9 offset:54272
    s_waitcnt lgkmcnt(8)
    v_mfma_f32_16x16x32_bf16 v[16:19], a[192:195], v[160:163], v[16:19]
    ds_read_b64_tr_b16 a[176:177], v6 offset:57344
    s_add_u32 m0, s28, 0
    v_mfma_f32_16x16x32_bf16 v[20:23], a[192:195], v[164:167], v[20:23]
    ds_read_b64_tr_b16 a[178:179], v6 offset:61440
    s_add_u32 s30, s35, 2949120
    v_mfma_f32_16x16x32_bf16 v[24:27], a[196:199], v[160:163], v[24:27]
    ds_read_b64_tr_b16 a[180:181], v7 offset:57344
    v_accvgpr_write_b32 a27, v91
    v_mfma_f32_16x16x32_bf16 v[28:31], a[196:199], v[164:167], v[28:31]
    ds_read_b64_tr_b16 a[182:183], v7 offset:61440
    buffer_load_dwordx4 v2, s[16:19], s30 offen  lds
    v_mfma_f32_16x16x32_bf16 v[32:35], a[200:203], v[160:163], v[32:35]
    ds_read_b64_tr_b16 a[184:185], v8 offset:57344
    buffer_store_dwordx4 v[88:91], v14, s[76:79], s31 offen offset:2048 sc1
    v_mfma_f32_16x16x32_bf16 v[36:39], a[200:203], v[164:167], v[36:39]
    ds_read_b64_tr_b16 a[186:187], v8 offset:61440
    v_cvt_pk_bf16_f32 v92, v68, v69
    v_mfma_f32_16x16x32_bf16 v[40:43], a[204:207], v[160:163], v[40:43]
    ds_read_b64_tr_b16 a[188:189], v9 offset:57344
    v_cvt_pk_bf16_f32 v93, v70, v71
    v_mfma_f32_16x16x32_bf16 v[44:47], a[204:207], v[164:167], v[44:47]
    ds_read_b64_tr_b16 a[190:191], v9 offset:61440
    s_waitcnt lgkmcnt(8)
    v_mfma_f32_16x16x32_bf16 v[16:19], a[160:163], v[168:171], v[16:19]
    ds_read_b64_tr_b16 a[192:193], v6 offset:58368
L_pm2:
    s_cbranch_execz L_pmb0
    v_cvt_pk_bf16_f32 v94, v76, v77
    v_mfma_f32_16x16x32_bf16 v[20:23], a[160:163], v[172:175], v[20:23]
    ds_read_b64_tr_b16 a[194:195], v6 offset:62464
    v_cvt_pk_bf16_f32 v95, v78, v79
    v_mfma_f32_16x16x32_bf16 v[24:27], a[164:167], v[168:171], v[24:27]
    ds_read_b64_tr_b16 a[196:197], v7 offset:58368
    v_pk_max_i16 v92, v92, 0
    v_mfma_f32_16x16x32_bf16 v[28:31], a[164:167], v[172:175], v[28:31]
    ds_read_b64_tr_b16 a[198:199], v7 offset:62464
    buffer_load_dwordx4 v3, s[16:19], s30 offen offset:1024  lds
    v_mfma_f32_16x16x32_bf16 v[32:35], a[168:171], v[168:171], v[32:35]
    ds_read_b64_tr_b16 a[200:201], v8 offset:58368
    v_pk_max_i16 v93, v93, 0
    v_mfma_f32_16x16x32_bf16 v[36:39], a[168:171], v[172:175], v[36:39]
    ds_read_b64_tr_b16 a[202:203], v8 offset:62464
    v_pk_max_i16 v94, v94, 0
    v_mfma_f32_16x16x32_bf16 v[40:43], a[172:175], v[168:171], v[40:43]
    ds_read_b64_tr_b16 a[204:205], v9 offset:58368
    v_pk_max_i16 v95, v95, 0
    v_mfma_f32_16x16x32_bf16 v[44:47], a[172:175], v[172:175], v[44:47]
    ds_read_b64_tr_b16 a[206:207], v9 offset:62464
    s_waitcnt vmcnt(14) lgkmcnt(8)
    v_mfma_f32_16x16x32_bf16 v[16:19], a[176:179], v[176:179], v[16:19]
    s_barrier
    ds_read_b64_tr_b16 a[160:161], v10 offset:0
    v_mfma_f32_16x16x32_bf16 v[20:23], a[176:179], v[180:183], v[20:23]
    ds_read_b64_tr_b16 a[162:163], v10 offset:4096
    s_add_u32 m0, s28, 8192
    v_mfma_f32_16x16x32_bf16 v[24:27], a[180:183], v[176:179], v[24:27]
    ds_read_b64_tr_b16 a[164:165], v11 offset:0
    s_add_u32 s30, s35, 3538944
    v_mfma_f32_16x16x32_bf16 v[28:31], a[180:183], v[180:183], v[28:31]
    ds_read_b64_tr_b16 a[166:167], v11 offset:4096
    buffer_load_dwordx4 v2, s[16:19], s30 offen  lds
    v_mfma_f32_16x16x32_bf16 v[32:35], a[184:187], v[176:179], v[32:35]
    ds_read_b64_tr_b16 a[168:169], v12 offset:0
    v_accvgpr_write_b32 a28, v92
    v_mfma_f32_16x16x32_bf16 v[36:39], a[184:187], v[180:183], v[36:39]
    ds_read_b64_tr_b16 a[170:171], v12 offset:4096
    v_accvgpr_write_b32 a29, v93
    v_mfma_f32_16x16x32_bf16 v[40:43], a[188:191], v[176:179], v[40:43]
    ds_read_b64_tr_b16 a[172:173], v13 offset:0
    v_accvgpr_write_b32 a30, v94
    v_mfma_f32_16x16x32_bf16 v[44:47], a[188:191], v[180:183], v[44:47]
    ds_read_b64_tr_b16 a[174:175], v13 offset:4096
    s_waitcnt lgkmcnt(8)
    v_mfma_f32_16x16x32_bf16 v[16:19], a[192:195], v[184:187], v[16:19]
    ds_read_b64_tr_b16 a[176:177], v10 offset:1024
    v_accvgpr_write_b32 a31, v95
    v_mfma_f32_16x16x32_bf16 v[20:23], a[192:195], v[188:191], v[20:23]
    ds_read_b64_tr_b16 a[178:179], v10 offset:5120
    v_mfma_f32_16x16x32_bf16 v[24:27], a[196:199], v[184:187], v[24:27]
    ds_read_b64_tr_b16 a[180:181], v11 offset:1024
    v_mfma_f32_16x16x32_bf16 v[28:31], a[196:199], v[188:191], v[28:31]
    ds_read_b64_tr_b16 a[182:183], v11 offset:5120
    buffer_load_dwordx4 v3, s[16:19], s30 offen offset:1024  lds
    v_mfma_f32_16x16x32_bf16 v[32:35], a[200:203], v[184:187], v[32:35]
    ds_read_b64_tr_b16 a[184:185], v12 offset:1024
    buffer_store_dwordx4 v[92:95], v14, s[76:79], s31 offen offset:3072 sc1
    v_mfma_f32_16x16x32_bf16 v[36:39], a[200:203], v[188:191], v[36:39]
    ds_read_b64_tr_b16 a[186:187], v12 offset:5120
    v_lshl_add_u32 v243, v15, 4, v1
    v_mfma_f32_16x16x32_bf16 v[40:43], a[204:207], v[184:187], v[40:43]
    ds_read_b64_tr_b16 a[188:189], v13 offset:1024
    v_add_u32 v243, s41, v243
    v_mfma_f32_16x16x32_bf16 v[44:47], a[204:207], v[188:191], v[44:47]
    ds_read_b64_tr_b16 a[190:191], v13 offset:5120
    s_waitcnt lgkmcnt(8)
    v_mfma_f32_16x16x32_bf16 v[16:19], a[160:163], v[192:195], v[16:19]
    ds_read_b64_tr_b16 a[192:193], v10 offset:8192
    s_add_u32 m0, s28, 16384
    v_mfma_f32_16x16x32_bf16 v[20:23], a[160:163], v[196:199], v[20:23]
    ds_read_b64_tr_b16 a[194:195], v10 offset:12288
    s_add_u32 s30, s35, 4128768
    v_mfma_f32_16x16x32_bf16 v[24:27], a[164:167], v[192:195], v[24:27]
    ds_read_b64_tr_b16 a[196:197], v11 offset:8192
    v_mul_u32_u24 v1, 52, v0
    v_mfma_f32_16x16x32_bf16 v[28:31], a[164:167], v[196:199], v[28:31]
    ds_read_b64_tr_b16 a[198:199], v11 offset:12288
    buffer_load_dwordx4 v2, s[16:19], s30 offen  lds
    v_mfma_f32_16x16x32_bf16 v[32:35], a[168:171], v[192:195], v[32:35]
    ds_read_b64_tr_b16 a[200:201], v12 offset:8192
    v_lshrrev_b32 v1, 8, v1
    v_mfma_f32_16x16x32_bf16 v[36:39], a[168:171], v[196:199], v[36:39]
    ds_read_b64_tr_b16 a[202:203], v12 offset:12288
    v_min_u32 v1, 2, v1
    v_mfma_f32_16x16x32_bf16 v[40:43], a[172:175], v[192:195], v[40:43]
    ds_read_b64_tr_b16 a[204:205], v13 offset:8192
    v_mul_u32_u24 v15, 5, v1
    v_mfma_f32_16x16x32_bf16 v[44:47], a[172:175], v[196:199], v[44:47]
    ds_read_b64_tr_b16 a[206:207], v13 offset:12288
    s_waitcnt lgkmcnt(8)
    v_mfma_f32_16x16x32_bf16 v[16:19], a[176:179], v[200:203], v[16:19]
    ds_read_b64_tr_b16 a[160:161], v10 offset:9216
    v_sub_u32 v15, v0, v15
    v_mfma_f32_16x16x32_bf16 v[20:23], a[176:179], v[204:207], v[20:23]
    ds_read_b64_tr_b16 a[162:163], v10 offset:13312
    v_min_u32 v15, 4, v15
    v_mfma_f32_16x16x32_bf16 v[24:27], a[180:183], v[200:203], v[24:27]
    ds_read_b64_tr_b16 a[164:165], v11 offset:9216
    v_mov_b32 v249, s57
    v_mfma_f32_16x16x32_bf16 v[28:31], a[180:183], v[204:207], v[28:31]
    ds_read_b64_tr_b16 a[166:167], v11 offset:13312
    buffer_load_dwordx4 v3, s[16:19], s30 offen offset:1024  lds
    v_mfma_f32_16x16x32_bf16 v[32:35], a[184:187], v[200:203], v[32:35]
    ds_read_b64_tr_b16 a[168:169], v12 offset:9216
    v_mov_b32 v251, s58
    v_mfma_f32_16x16x32_bf16 v[36:39], a[184:187], v[204:207], v[36:39]
    ds_read_b64_tr_b16 a[170:171], v12 offset:13312
    v_cmp_eq_u32 vcc, 1, v1
    s_nop 1
    v_cndmask_b32 v249, v249, v251, vcc
    v_mfma_f32_16x16x32_bf16 v[40:43], a[188:191], v[200:203], v[40:43]
    ds_read_b64_tr_b16 a[172:173], v13 offset:9216
    v_mov_b32 v251, s59
    v_mfma_f32_16x16x32_bf16 v[44:47], a[188:191], v[204:207], v[44:47]
    ds_read_b64_tr_b16 a[174:175], v13 offset:13312
    s_waitcnt lgkmcnt(8)
    v_mfma_f32_16x16x32_bf16 v[16:19], a[192:195], v[208:211], v[16:19]
    ds_read_b64_tr_b16 a[176:177], v10 offset:16384
    s_add_u32 m0, s28, 24576
    v_mfma_f32_16x16x32_bf16 v[20:23], a[192:195], v[212:215], v[20:23]
    ds_read_b64_tr_b16 a[178:179], v10 offset:20480
    s_add_u32 s30, s35, 4718592
    v_mfma_f32_16x16x32_bf16 v[24:27], a[196:199], v[208:211], v[24:27]
    ds_read_b64_tr_b16 a[180:181], v11 offset:16384
    v_cmp_eq_u32 vcc, 2, v1
    s_nop 1
    v_cndmask_b32 v249, v249, v251, vcc
    v_mfma_f32_16x16x32_bf16 v[28:31], a[196:199], v[212:215], v[28:31]
    ds_read_b64_tr_b16 a[182:183], v11 offset:20480
    buffer_load_dwordx4 v2, s[16:19], s30 offen  lds
    v_mfma_f32_16x16x32_bf16 v[32:35], a[200:203], v[208:211], v[32:35]
    ds_read_b64_tr_b16 a[184:185], v12 offset:16384
    v_add_u32 v249, s41, v249
    v_mfma_f32_16x16x32_bf16 v[36:39], a[200:203], v[212:215], v[36:39]
    ds_read_b64_tr_b16 a[186:187], v12 offset:20480
    v_mul_u32_u24 v249, 3641, v249
    v_mfma_f32_16x16x32_bf16 v[40:43], a[204:207], v[208:211], v[40:43]
    ds_read_b64_tr_b16 a[188:189], v13 offset:16384
    v_lshrrev_b32 v249, 16, v249
    v_mfma_f32_16x16x32_bf16 v[44:47], a[204:207], v[212:215], v[44:47]
    ds_read_b64_tr_b16 a[190:191], v13 offset:20480
    s_waitcnt lgkmcnt(8)
    v_mfma_f32_16x16x32_bf16 v[16:19], a[160:163], v[216:219], v[16:19]
    ds_read_b64_tr_b16 a[192:193], v10 offset:17408
    v_add_u32 v249, v249, v15
    v_mfma_f32_16x16x32_bf16 v[20:23], a[160:163], v[220:223], v[20:23]
    ds_read_b64_tr_b16 a[194:195], v10 offset:21504
    v_min_u32 v249, 63, v249
    v_mfma_f32_16x16x32_bf16 v[24:27], a[164:167], v[216:219], v[24:27]
    ds_read_b64_tr_b16 a[196:197], v11 offset:17408
    v_lshlrev_b32 v249, 7, v249
    v_mfma_f32_16x16x32_bf16 v[28:31], a[164:167], v[220:223], v[28:31]
    ds_read_b64_tr_b16 a[198:199], v11 offset:21504
    buffer_load_dwordx4 v3, s[16:19], s30 offen offset:1024  lds
    v_mfma_f32_16x16x32_bf16 v[32:35], a[168:171], v[216:219], v[32:35]
    ds_read_b64_tr_b16 a[200:201], v12 offset:17408
    v_add_u32 v249, 24576, v249
    v_mfma_f32_16x16x32_bf16 v[36:39], a[168:171], v[220:223], v[36:39]
    ds_read_b64_tr_b16 a[202:203], v12 offset:21504
    v_lshrrev_b32 v1, 1, v0
    v_mfma_f32_16x16x32_bf16 v[40:43], a[172:175], v[216:219], v[40:43]
    ds_read_b64_tr_b16 a[204:205], v13 offset:17408
    v_lshlrev_b32 v1, 12, v1
    v_mfma_f32_16x16x32_bf16 v[44:47], a[172:175], v[220:223], v[44:47]
    ds_read_b64_tr_b16 a[206:207], v13 offset:21504
    s_waitcnt lgkmcnt(8)
    v_mfma_f32_16x16x32_bf16 v[16:19], a[176:179], v[224:227], v[16:19]
    ds_read_b64_tr_b16 a[160:161], v10 offset:24576
    s_add_u32 m0, s28, 32768
    v_mfma_f32_16x16x32_bf16 v[20:23], a[176:179], v[228:231], v[20:23]
    ds_read_b64_tr_b16 a[162:163], v10 offset:28672
    s_add_u32 s30, s36, 0
    v_mfma_f32_16x16x32_bf16 v[24:27], a[180:183], v[224:227], v[24:27]
    ds_read_b64_tr_b16 a[164:165], v11 offset:24576
    v_and_b32 v244, 1, v0
    v_mfma_f32_16x16x32_bf16 v[28:31], a[180:183], v[228:231], v[28:31]
    ds_read_b64_tr_b16 a[166:167], v11 offset:28672
    buffer_load_dwordx4 v2, s[16:19], s30 offen  lds
    v_mfma_f32_16x16x32_bf16 v[32:35], a[184:187], v[224:227], v[32:35]
    ds_read_b64_tr_b16 a[168:169], v12 offset:24576
    v_lshl_add_u32 v1, v244, 4, v1
    v_mfma_f32_16x16x32_bf16 v[36:39], a[184:187], v[228:231], v[36:39]
    ds_read_b64_tr_b16 a[170:171], v12 offset:28672
    s_lshl_b32 s41, s41, 11
    v_mfma_f32_16x16x32_bf16 v[40:43], a[188:191], v[224:227], v[40:43]
    ds_read_b64_tr_b16 a[172:173], v13 offset:24576
    s_lshl_b32 s40, s40, 1
    v_mfma_f32_16x16x32_bf16 v[44:47], a[188:191], v[228:231], v[44:47]
    ds_read_b64_tr_b16 a[174:175], v13 offset:28672
    s_waitcnt lgkmcnt(8)
    v_mfma_f32_16x16x32_bf16 v[16:19], a[192:195], v[232:235], v[16:19]
    ds_read_b64_tr_b16 a[176:177], v10 offset:25600
    s_add_u32 s40, s40, s41
    v_mfma_f32_16x16x32_bf16 v[20:23], a[192:195], v[236:239], v[20:23]
    ds_read_b64_tr_b16 a[178:179], v10 offset:29696
    v_add_u32 v244, s40, v1
    v_mfma_f32_16x16x32_bf16 v[24:27], a[196:199], v[232:235], v[24:27]
    ds_read_b64_tr_b16 a[180:181], v11 offset:25600
    v_bfe_u32 v1, v0, 2, 2
    v_mfma_f32_16x16x32_bf16 v[28:31], a[196:199], v[236:239], v[28:31]
    ds_read_b64_tr_b16 a[182:183], v11 offset:29696
    buffer_load_dwordx4 v3, s[16:19], s30 offen offset:1024  lds
    v_mfma_f32_16x16x32_bf16 v[32:35], a[200:203], v[232:235], v[32:35]
    ds_read_b64_tr_b16 a[184:185], v12 offset:25600
    v_bfe_u32 v15, v0, 4, 1
    v_mfma_f32_16x16x32_bf16 v[36:39], a[200:203], v[236:239], v[36:39]
    ds_read_b64_tr_b16 a[186:187], v12 offset:29696
    v_lshl_add_u32 v1, v15, 4, v1
    v_mfma_f32_16x16x32_bf16 v[40:43], a[204:207], v[232:235], v[40:43]
    ds_read_b64_tr_b16 a[188:189], v13 offset:25600
    v_lshrrev_b32 v15, 5, v0
    v_mfma_f32_16x16x32_bf16 v[44:47], a[204:207], v[236:239], v[44:47]
    ds_read_b64_tr_b16 a[190:191], v13 offset:29696
    s_waitcnt vmcnt(12) lgkmcnt(8)
    v_mfma_f32_16x16x32_bf16 v[48:51], a[160:163], v[96:99], 0
    s_barrier
    v_cmp_le_u32 vcc, s38, v241
    s_nop 1
    s_cmp_eq_u64 vcc, -1
    s_cbranch_scc0 L_chk_slow
L_chk_back:
    ds_read_b64_tr_b16 a[192:193], v10 offset:32768
    v_mfma_f32_16x16x32_bf16 v[52:55], a[160:163], v[100:103], 0
    ds_read_b64_tr_b16 a[194:195], v10 offset:36864
    s_add_u32 m0, s28, 40960
    v_mfma_f32_16x16x32_bf16 v[56:59], a[164:167], v[96:99], 0
    ds_read_b64_tr_b16 a[196:197], v11 offset:32768
    s_add_u32 s30, s36, 589824
    v_mfma_f32_16x16x32_bf16 v[60:63], a[164:167], v[100:103], 0
    ds_read_b64_tr_b16 a[198:199], v11 offset:36864
    buffer_load_dwordx4 v2, s[16:19], s30 offen  lds
    v_mfma_f32_16x16x32_bf16 v[64:67], a[168:171], v[96:99], 0
    ds_read_b64_tr_b16 a[200:201], v12 offset:32768
    s_movk_i32 s31, 8192
    v_mfma_f32_16x16x32_bf16 v[68:71], a[168:171], v[100:103], 0
    ds_read_b64_tr_b16 a[202:203], v12 offset:36864
    v_cvt_pk_bf16_f32 v80, v16, v17
    v_mfma_f32_16x16x32_bf16 v[72:75], a[172:175], v[96:99], 0
    ds_read_b64_tr_b16 a[204:205], v13 offset:32768
    v_cvt_pk_bf16_f32 v81, v18, v19
    v_mfma_f32_16x16x32_bf16 v[76:79], a[172:175], v[100:103], 0
    ds_read_b64_tr_b16 a[206:207], v13 offset:36864
    s_waitcnt lgkmcnt(8)
    v_mfma_f32_16x16x32_bf16 v[48:51], a[176:179], v[104:107], v[48:51]
    ds_read_b64_tr_b16 a[160:161], v10 offset:33792
    v_cvt_pk_bf16_f32 v82, v24, v25
    v_mfma_f32_16x16x32_bf16 v[52:55], a[176:179], v[108:111], v[52:55]
    ds_read_b64_tr_b16 a[162:163], v10 offset:37888
    v_cvt_pk_bf16_f32 v83, v26, v27
    v_mfma_f32_16x16x32_bf16 v[56:59], a[180:183], v[104:107], v[56:59]
    ds_read_b64_tr_b16 a[164:165], v11 offset:33792
    v_pk_max_i16 v80, v80, 0
    v_mfma_f32_16x16x32_bf16 v[60:63], a[180:183], v[108:111], v[60:63]
    ds_read_b64_tr_b16 a[166:167], v11 offset:37888
    buffer_load_dwordx4 v3, s[16:19], s30 offen offset:1024  lds
    v_mfma_f32_16x16x32_bf16 v[64:67], a[184:187], v[104:107], v[64:67]
    ds_read_b64_tr_b16 a[168:169], v12 offset:33792
    v_pk_max_i16 v81, v81, 0
    v_mfma_f32_16x16x32_bf16 v[68:71], a[184:187], v[108:111], v[68:71]
    ds_read_b64_tr_b16 a[170:171], v12 offset:37888
    v_pk_max_i16 v82, v82, 0
    v_mfma_f32_16x16x32_bf16 v[72:75], a[188:191], v[104:107], v[72:75]
    ds_read_b64_tr_b16 a[172:173], v13 offset:33792
    v_pk_max_i16 v83, v83, 0
    v_mfma_f32_16x16x32_bf16 v[76:79], a[188:191], v[108:111], v[76:79]
    ds_read_b64_tr_b16 a[174:175], v13 offset:37888
    s_waitcnt lgkmcnt(8)
    v_mfma_f32_16x16x32_bf16 v[48:51], a[192:195], v[112:115], v[48:51]
    ds_read_b64_tr_b16 a[176:177], v10 offset:40960
    s_add_u32 m0, s28, 49152
    v_mfma_f32_16x16x32_bf16 v[52:55], a[192:195], v[116:119], v[52:55]
    ds_read_b64_tr_b16 a[178:179], v10 offset:45056
    s_add_u32 s30, s36, 1179648
    v_mfma_f32_16x16x32_bf16 v[56:59], a[196:199], v[112:115], v[56:59]
    ds_read_b64_tr_b16 a[180:181], v11 offset:40960
    v_accvgpr_write_b32 a32, v80
    v_mfma_f32_16x16x32_bf16 v[60:63], a[196:199], v[116:119], v[60:63]
    ds_read_b64_tr_b16 a[182:183], v11 offset:45056
    buffer_load_dwordx4 v2, s[16:19], s30 offen  lds
    v_mfma_f32_16x16x32_bf16 v[64:67], a[200:203], v[112:115], v[64:67]
    ds_read_b64_tr_b16 a[184:185], v12 offset:40960
    v_accvgpr_write_b32 a33, v81
    v_mfma_f32_16x16x32_bf16 v[68:71], a[200:203], v[116:119], v[68:71]
    ds_read_b64_tr_b16 a[186:187], v12 offset:45056
    v_accvgpr_write_b32 a34, v82
    v_mfma_f32_16x16x32_bf16 v[72:75], a[204:207], v[112:115], v[72:75]
    ds_read_b64_tr_b16 a[188:189], v13 offset:40960
    v_accvgpr_write_b32 a35, v83
    v_mfma_f32_16x16x32_bf16 v[76:79], a[204:207], v[116:119], v[76:79]
    ds_read_b64_tr_b16 a[190:191], v13 offset:45056
    s_waitcnt lgkmcnt(8)
    v_mfma_f32_16x16x32_bf16 v[48:51], a[160:163], v[120:123], v[48:51]
    ds_read_b64_tr_b16 a[192:193], v10 offset:41984
    v_mfma_f32_16x16x32_bf16 v[52:55], a[160:163], v[124:127], v[52:55]
    ds_read_b64_tr_b16 a[194:195], v10 offset:46080
    v_mfma_f32_16x16x32_bf16 v[56:59], a[164:167], v[120:123], v[56:59]
    ds_read_b64_tr_b16 a[196:197], v11 offset:41984
    v_mfma_f32_16x16x32_bf16 v[60:63], a[164:167], v[124:127], v[60:63]
    ds_read_b64_tr_b16 a[198:199], v11 offset:46080
    buffer_load_dwordx4 v3, s[16:19], s30 offen offset:1024  lds
    v_mfma_f32_16x16x32_bf16 v[64:67], a[168:171], v[120:123], v[64:67]
    ds_read_b64_tr_b16 a[200:201], v12 offset:41984
    buffer_store_dwordx4 v[80:83], v14, s[76:79], s31 offen offset:0 sc1
    v_mfma_f32_16x16x32_bf16 v[68:71], a[168:171], v[124:127], v[68:71]
    ds_read_b64_tr_b16 a[202:203], v12 offset:46080
    v_cvt_pk_bf16_f32 v84, v20, v21
    v_mfma_f32_16x16x32_bf16 v[72:75], a[172:175], v[120:123], v[72:75]
    ds_read_b64_tr_b16 a[204:205], v13 offset:41984
    v_cvt_pk_bf16_f32 v85, v22, v23
    v_mfma_f32_16x16x32_bf16 v[76:79], a[172:175], v[124:127], v[76:79]
    ds_read_b64_tr_b16 a[206:207], v13 offset:46080
    s_waitcnt lgkmcnt(8)
    v_mfma_f32_16x16x32_bf16 v[48:51], a[176:179], v[128:131], v[48:51]
    ds_read_b64_tr_b16 a[160:161], v10 offset:49152
    s_add_u32 m0, s28, 57344
    v_mfma_f32_16x16x32_bf16 v[52:55], a[176:179], v[132:135], v[52:55]
    ds_read_b64_tr_b16 a[162:163], v10 offset:53248
    s_add_u32 s30, s36, 1769472
    v_mfma_f32_16x16x32_bf16 v[56:59], a[180:183], v[128:131], v[56:59]
    ds_read_b64_tr_b16 a[164:165], v11 offset:49152
    v_cvt_pk_bf16_f32 v86, v28, v29
    v_mfma_f32_16x16x32_bf16 v[60:63], a[180:183], v[132:135], v[60:63]
    ds_read_b64_tr_b16 a[166:167], v11 offset:53248
    buffer_load_dwordx4 v2, s[16:19], s30 offen  lds
    v_mfma_f32_16x16x32_bf16 v[64:67], a[184:187], v[128:131], v[64:67]
    ds_read_b64_tr_b16 a[168:169], v12 offset:49152
    v_cvt_pk_bf16_f32 v87, v30, v31
    v_mfma_f32_16x16x32_bf16 v[68:71], a[184:187], v[132:135], v[68:71]
    ds_read_b64_tr_b16 a[170:171], v12 offset:53248
    v_pk_max_i16 v84, v84, 0
    v_mfma_f32_16x16x32_bf16 v[72:75], a[188:191], v[128:131], v[72:75]
    ds_read_b64_tr_b16 a[172:173], v13 offset:49152
    v_pk_max_i16 v85, v85, 0
    v_mfma_f32_16x16x32_bf16 v[76:79], a[188:191], v[132:135], v[76:79]
    ds_read_b64_tr_b16 a[174:175], v13 offset:53248
    s_waitcnt lgkmcnt(8)
    v_mfma_f32_16x16x32_bf16 v[48:51], a[192:195], v[136:139], v[48:51]
    ds_read_b64_tr_b16 a[176:177], v10 offset:50176
    v_pk_max_i16 v86, v86, 0
    v_mfma_f32_16x16x32_bf16 v[52:55], a[192:195], v[140:143], v[52:55]
    ds_read_b64_tr_b16 a[178:179], v10 offset:54272
    v_pk_max_i16 v87, v87, 0
    v_mfma_f32_16x16x32_bf16 v[56:59], a[196:199], v[136:139], v[56:59]
    ds_read_b64_tr_b16 a[180:181], v11 offset:50176
    v_accvgpr_write_b32 a36, v84
    v_mfma_f32_16x16x32_bf16 v[60:63], a[196:199], v[140:143], v[60:63]
    ds_read_b64_tr_b16 a[182:183], v11 offset:54272
    buffer_load_dwordx4 v3, s[16:19], s30 offen offset:1024  lds
    v_mfma_f32_16x16x32_bf16 v[64:67], a[200:203], v[136:139], v[64:67]
    ds_read_b64_tr_b16 a[184:185], v12 offset:50176
    v_accvgpr_write_b32 a37, v85
    v_mfma_f32_16x16x32_bf16 v[68:71], a[200:203], v[140:143], v[68:71]
    ds_read_b64_tr_b16 a[186:187], v12 offset:54272
    v_accvgpr_write_b32 a38, v86
    v_mfma_f32_16x16x32_bf16 v[72:75], a[204:207], v[136:139], v[72:75]
    ds_read_b64_tr_b16 a[188:189], v13 offset:50176
    v_accvgpr_write_b32 a39, v87
    v_mfma_f32_16x16x32_bf16 v[76:79], a[204:207], v[140:143], v[76:79]
    ds_read_b64_tr_b16 a[190:191], v13 offset:54272
    s_waitcnt lgkmcnt(8)
    v_mfma_f32_16x16x32_bf16 v[48:51], a[160:163], v[144:147], v[48:51]
    ds_read_b64_tr_b16 a[192:193], v10 offset:57344
    s_add_u32 m0, s28, 65536
    v_mfma_f32_16x16x32_bf16 v[52:55], a[160:163], v[148:151], v[52:55]
    ds_read_b64_tr_b16 a[194:195], v10 offset:61440
    s_add_u32 s30, s36, 2359296
    v_mfma_f32_16x16x32_bf16 v[56:59], a[164:167], v[144:147], v[56:59]
    ds_read_b64_tr_b16 a[196:197], v11 offset:57344
    v_mfma_f32_16x16x32_bf16 v[60:63], a[164:167], v[148:151], v[60:63]
    ds_read_b64_tr_b16 a[198:199], v11 offset:61440
    buffer_load_dwordx4 v2, s[16:19], s30 offen  lds
    v_mfma_f32_16x16x32_bf16 v[64:67], a[168:171], v[144:147], v[64:67]
    ds_read_b64_tr_b16 a[200:201], v12 offset:57344
    buffer_store_dwordx4 v[84:87], v14, s[76:79], s31 offen offset:1024 sc1
    v_mfma_f32_16x16x32_bf16 v[68:71], a[168:171], v[148:151], v[68:71]
    ds_read_b64_tr_b16 a[202:203], v12 offset:61440
    v_cvt_pk_bf16_f32 v88, v32, v33
    v_mfma_f32_16x16x32_bf16 v[72:75], a[172:175], v[144:147], v[72:75]
    ds_read_b64_tr_b16 a[204:205], v13 offset:57344
    v_cvt_pk_bf16_f32 v89, v34, v35
    v_mfma_f32_16x16x32_bf16 v[76:79], a[172:175], v[148:151], v[76:79]
    ds_read_b64_tr_b16 a[206:207], v13 offset:61440
    s_waitcnt lgkmcnt(8)
    v_mfma_f32_16x16x32_bf16 v[48:51], a[176:179], v[152:155], v[48:51]
    ds_read_b64_tr_b16 a[160:161], v10 offset:58368
    v_cvt_pk_bf16_f32 v90, v40, v41
    v_mfma_f32_16x16x32_bf16 v[52:55], a[176:179], v[156:159], v[52:55]
    ds_read_b64_tr_b16 a[162:163], v10 offset:62464
    v_cvt_pk_bf16_f32 v91, v42, v43
    v_mfma_f32_16x16x32_bf16 v[56:59], a[180:183], v[152:155], v[56:59]
    ds_read_b64_tr_b16 a[164:165], v11 offset:58368
    v_pk_max_i16 v88, v88, 0
    v_mfma_f32_16x16x32_bf16 v[60:63], a[180:183], v[156:159], v[60:63]
    ds_read_b64_tr_b16 a[166:167], v11 offset:62464
    buffer_load_dwordx4 v3, s[16:19], s30 offen offset:1024  lds
    v_mfma_f32_16x16x32_bf16 v[64:67], a[184:187], v[152:155], v[64:67]
    ds_read_b64_tr_b16 a[168:169], v12 offset:58368
    v_pk_max_i16 v89, v89, 0
    v_mfma_f32_16x16x32_bf16 v[68:71], a[184:187], v[156:159], v[68:71]
    ds_read_b64_tr_b16 a[170:171], v12 offset:62464
    v_pk_max_i16 v90, v90, 0
    v_mfma_f32_16x16x32_bf16 v[72:75], a[188:191], v[152:155], v[72:75]
    ds_read_b64_tr_b16 a[172:173], v13 offset:58368
    v_pk_max_i16 v91, v91, 0
    v_mfma_f32_16x16x32_bf16 v[76:79], a[188:191], v[156:159], v[76:79]
    ds_read_b64_tr_b16 a[174:175], v13 offset:62464
    s_waitcnt vmcnt(12) lgkmcnt(8)
    v_mfma_f32_16x16x32_bf16 v[48:51], a[192:195], v[160:163], v[48:51]
    s_barrier
    ds_read_b64_tr_b16 a[176:177], v6 offset:0
    v_mfma_f32_16x16x32_bf16 v[52:55], a[192:195], v[164:167], v[52:55]
    ds_read_b64_tr_b16 a[178:179], v6 offset:4096
    s_add_u32 m0, s28, 73728
    v_mfma_f32_16x16x32_bf16 v[56:59], a[196:199], v[160:163], v[56:59]
    ds_read_b64_tr_b16 a[180:181], v7 offset:0
    s_add_u32 s30, s36, 2949120
    v_mfma_f32_16x16x32_bf16 v[60:63], a[196:199], v[164:167], v[60:63]
    ds_read_b64_tr_b16 a[182:183], v7 offset:4096
    buffer_load_dwordx4 v2, s[16:19], s30 offen  lds
    v_mfma_f32_16x16x32_bf16 v[64:67], a[200:203], v[160:163], v[64:67]
    ds_read_b64_tr_b16 a[184:185], v8 offset:0
    v_mov_b32 v242, 1
    v_mfma_f32_16x16x32_bf16 v[68:71], a[200:203], v[164:167], v[68:71]
    ds_read_b64_tr_b16 a[186:187], v8 offset:4096
    s_mov_b64 exec, s[66:67]
    buffer_store_dword v242, off, s[72:75], s56 sc1
    s_mov_b64 exec, -1
    v_mfma_f32_16x16x32_bf16 v[72:75], a[204:207], v[160:163], v[72:75]
    ds_read_b64_tr_b16 a[188:189], v9 offset:0
    v_accvgpr_write_b32 a40, v88
    v_mfma_f32_16x16x32_bf16 v[76:79], a[204:207], v[164:167], v[76:79]
    ds_read_b64_tr_b16 a[190:191], v9 offset:4096
    s_waitcnt lgkmcnt(8)
    v_mfma_f32_16x16x32_bf16 v[48:51], a[160:163], v[168:171], v[48:51]
    ds_read_b64_tr_b16 a[192:193], v6 offset:1024
    v_accvgpr_write_b32 a41, v89
    v_mfma_f32_16x16x32_bf16 v[52:55], a[160:163], v[172:175], v[52:55]
    ds_read_b64_tr_b16 a[194:195], v6 offset:5120
    v_accvgpr_write_b32 a42, v90
    v_mfma_f32_16x16x32_bf16 v[56:59], a[164:167], v[168:171], v[56:59]
    ds_read_b64_tr_b16 a[196:197], v7 offset:1024
    v_accvgpr_write_b32 a43, v91
    v_mfma_f32_16x16x32_bf16 v[60:63], a[164:167], v[172:175], v[60:63]
    ds_read_b64_tr_b16 a[198:199], v7 offset:5120
    buffer_load_dwordx4 v3, s[16:19], s30 offen offset:1024  lds
    v_mfma_f32_16x16x32_bf16 v[64:67], a[168:171], v[168:171], v[64:67]
    ds_read_b64_tr_b16 a[200:201], v8 offset:1024
    buffer_store_dwordx4 v[88:91], v14, s[76:79], s31 offen offset:2048 sc1
    v_mfma_f32_16x16x32_bf16 v[68:71], a[168:171], v[172:175], v[68:71]
    ds_read_b64_tr_b16 a[202:203], v8 offset:5120
    v_cvt_pk_bf16_f32 v92, v36, v37
    v_mfma_f32_16x16x32_bf16 v[72:75], a[172:175], v[168:171], v[72:75]
    ds_read_b64_tr_b16 a[204:205], v9 offset:1024
    v_cvt_pk_bf16_f32 v93, v38, v39
    v_mfma_f32_16x16x32_bf16 v[76:79], a[172:175], v[172:175], v[76:79]
    ds_read_b64_tr_b16 a[206:207], v9 offset:5120
    s_waitcnt lgkmcnt(8)
    v_mfma_f32_16x16x32_bf16 v[48:51], a[176:179], v[176:179], v[48:51]
    ds_read_b64_tr_b16 a[160:161], v6 offset:8192
    s_add_u32 m0, s28, 81920
    v_mfma_f32_16x16x32_bf16 v[52:55], a[176:179], v[180:183], v[52:55]
    ds_read_b64_tr_b16 a[162:163], v6 offset:12288
    s_add_u32 s30, s36, 3538944
    v_mfma_f32_16x16x32_bf16 v[56:59], a[180:183], v[176:179], v[56:59]
    ds_read_b64_tr_b16 a[164:165], v7 offset:8192
    v_cvt_pk_bf16_f32 v94, v44, v45
    v_mfma_f32_16x16x32_bf16 v[60:63], a[180:183], v[180:183], v[60:63]
    ds_read_b64_tr_b16 a[166:167], v7 offset:12288
    buffer_load_dwordx4 v2, s[16:19], s30 offen  lds
    v_mfma_f32_16x16x32_bf16 v[64:67], a[184:187], v[176:179], v[64:67]
    ds_read_b64_tr_b16 a[168:169], v8 offset:8192
    v_cvt_pk_bf16_f32 v95, v46, v47
    v_mfma_f32_16x16x32_bf16 v[68:71], a[184:187], v[180:183], v[68:71]
    ds_read_b64_tr_b16 a[170:171], v8 offset:12288
    v_pk_max_i16 v92, v92, 0
    v_mfma_f32_16x16x32_bf16 v[72:75], a[188:191], v[176:179], v[72:75]
    ds_read_b64_tr_b16 a[172:173], v9 offset:8192
    v_pk_max_i16 v93, v93, 0
    v_mfma_f32_16x16x32_bf16 v[76:79], a[188:191], v[180:183], v[76:79]
    ds_read_b64_tr_b16 a[174:175], v9 offset:12288
    s_waitcnt lgkmcnt(8)
    v_mfma_f32_16x16x32_bf16 v[48:51], a[192:195], v[184:187], v[48:51]
    ds_read_b64_tr_b16 a[176:177], v6 offset:9216
    v_pk_max_i16 v94, v94, 0
    v_mfma_f32_16x16x32_bf16 v[52:55], a[192:195], v[188:191], v[52:55]
    ds_read_b64_tr_b16 a[178:179], v6 offset:13312
    v_pk_max_i16 v95, v95, 0
    v_mfma_f32_16x16x32_bf16 v[56:59], a[196:199], v[184:187], v[56:59]
    ds_read_b64_tr_b16 a[180:181], v7 offset:9216
    v_accvgpr_write_b32 a44, v92
    v_mfma_f32_16x16x32_bf16 v[60:63], a[196:199], v[188:191], v[60:63]
    ds_read_b64_tr_b16 a[182:183], v7 offset:13312
    buffer_load_dwordx4 v3, s[16:19], s30 offen offset:1024  lds
    v_mfma_f32_16x16x32_bf16 v[64:67], a[200:203], v[184:187], v[64:67]
    ds_read_b64_tr_b16 a[184:185], v8 offset:9216
    v_accvgpr_write_b32 a45, v93
    v_mfma_f32_16x16x32_bf16 v[68:71], a[200:203], v[188:191], v[68:71]
    ds_read_b64_tr_b16 a[186:187], v8 offset:13312
    v_accvgpr_write_b32 a46, v94
    v_mfma_f32_16x16x32_bf16 v[72:75], a[204:207], v[184:187], v[72:75]
    ds_read_b64_tr_b16 a[188:189], v9 offset:9216
    v_accvgpr_write_b32 a47, v95
    v_mfma_f32_16x16x32_bf16 v[76:79], a[204:207], v[188:191], v[76:79]
    ds_read_b64_tr_b16 a[190:191], v9 offset:13312
    s_waitcnt lgkmcnt(8)
    v_mfma_f32_16x16x32_bf16 v[48:51], a[160:163], v[192:195], v[48:51]
    ds_read_b64_tr_b16 a[192:193], v6 offset:16384
    s_add_u32 m0, s28, 90112
    v_mfma_f32_16x16x32_bf16 v[52:55], a[160:163], v[196:199], v[52:55]
    ds_read_b64_tr_b16 a[194:195], v6 offset:20480
    s_add_u32 s30, s36, 4128768
    v_mfma_f32_16x16x32_bf16 v[56:59], a[164:167], v[192:195], v[56:59]
    ds_read_b64_tr_b16 a[196:197], v7 offset:16384
    v_mfma_f32_16x16x32_bf16 v[60:63], a[164:167], v[196:199], v[60:63]
    ds_read_b64_tr_b16 a[198:199], v7 offset:20480
    buffer_load_dwordx4 v2, s[16:19], s30 offen  lds
    v_mfma_f32_16x16x32_bf16 v[64:67], a[168:171], v[192:195], v[64:67]
    ds_read_b64_tr_b16 a[200:201], v8 offset:16384
    buffer_store_dwordx4 v[92:95], v14, s[76:79], s31 offen offset:3072 sc1
    v_mfma_f32_16x16x32_bf16 v[68:71], a[168:171], v[196:199], v[68:71]
    ds_read_b64_tr_b16 a[202:203], v8 offset:20480
    v_lshl_add_u32 v1, v15, 3, v1
    v_mfma_f32_16x16x32_bf16 v[72:75], a[172:175], v[192:195], v[72:75]
    ds_read_b64_tr_b16 a[204:205], v9 offset:16384
    v_lshlrev_b32 v1, 5, v1
    v_mfma_f32_16x16x32_bf16 v[76:79], a[172:175], v[196:199], v[76:79]
    ds_read_b64_tr_b16 a[206:207], v9 offset:20480
    s_waitcnt lgkmcnt(8)
    v_mfma_f32_16x16x32_bf16 v[48:51], a[176:179], v[200:203], v[48:51]
    ds_read_b64_tr_b16 a[160:161], v6 offset:17408
    v_and_b32 v15, 3, v0
    v_mfma_f32_16x16x32_bf16 v[52:55], a[176:179], v[204:207], v[52:55]
    ds_read_b64_tr_b16 a[162:163], v6 offset:21504
    v_lshl_add_u32 v1, v15, 3, v1
    v_mfma_f32_16x16x32_bf16 v[56:59], a[180:183], v[200:203], v[56:59]
    ds_read_b64_tr_b16 a[164:165], v7 offset:17408
    v_add_u32 v245, s65, v1
    v_mfma_f32_16x16x32_bf16 v[60:63], a[180:183], v[204:207], v[60:63]
    ds_read_b64_tr_b16 a[166:167], v7 offset:21504
    buffer_load_dwordx4 v3, s[16:19], s30 offen offset:1024  lds
    v_mfma_f32_16x16x32_bf16 v[64:67], a[184:187], v[200:203], v[64:67]
    ds_read_b64_tr_b16 a[168:169], v8 offset:17408
    v_mfma_f32_16x16x32_bf16 v[68:71], a[184:187], v[204:207], v[68:71]
L_pm3:
    s_cbranch_execz L_pmb0
    ds_read_b64_tr_b16 a[170:171], v8 offset:21504
    s_add_u32 m0, s28, 98304
    v_mfma_f32_16x16x32_bf16 v[72:75], a[188:191], v[200:203], v[72:75]
    ds_read_b64_tr_b16 a[172:173], v9 offset:17408
    s_add_u32 s30, s36, 4718592
    v_mfma_f32_16x16x32_bf16 v[76:79], a[188:191], v[204:207], v[76:79]
    ds_read_b64_tr_b16 a[174:175], v9 offset:21504
    s_waitcnt lgkmcnt(8)
    v_mfma_f32_16x16x32_bf16 v[48:51], a[192:195], v[208:211], v[48:51]
    ds_read_b64_tr_b16 a[176:177], v6 offset:24576
    v_mfma_f32_16x16x32_bf16 v[52:55], a[192:195], v[212:215], v[52:55]
    ds_read_b64_tr_b16 a[178:179], v6 offset:28672
    v_mfma_f32_16x16x32_bf16 v[56:59], a[196:199], v[208:211], v[56:59]
    ds_read_b64_tr_b16 a[180:181], v7 offset:24576
    v_mfma_f32_16x16x32_bf16 v[60:63], a[196:199], v[212:215], v[60:63]
    ds_read_b64_tr_b16 a[182:183], v7 offset:28672
    buffer_load_dwordx4 v2, s[16:19], s30 offen  lds
    v_mfma_f32_16x16x32_bf16 v[64:67], a[200:203], v[208:211], v[64:67]
    ds_read_b64_tr_b16 a[184:185], v8 offset:24576
    v_mfma_f32_16x16x32_bf16 v[68:71], a[200:203], v[212:215], v[68:71]
    ds_read_b64_tr_b16 a[186:187], v8 offset:28672
    v_mfma_f32_16x16x32_bf16 v[72:75], a[204:207], v[208:211], v[72:75]
    ds_read_b64_tr_b16 a[188:189], v9 offset:24576
    v_mfma_f32_16x16x32_bf16 v[76:79], a[204:207], v[212:215], v[76:79]
    ds_read_b64_tr_b16 a[190:191], v9 offset:28672
    s_waitcnt lgkmcnt(8)
    v_mfma_f32_16x16x32_bf16 v[48:51], a[160:163], v[216:219], v[48:51]
    ds_read_b64_tr_b16 a[192:193], v6 offset:25600
    v_mfma_f32_16x16x32_bf16 v[52:55], a[160:163], v[220:223], v[52:55]
    ds_read_b64_tr_b16 a[194:195], v6 offset:29696
    v_mfma_f32_16x16x32_bf16 v[56:59], a[164:167], v[216:219], v[56:59]
    ds_read_b64_tr_b16 a[196:197], v7 offset:25600
    v_mfma_f32_16x16x32_bf16 v[60:63], a[164:167], v[220:223], v[60:63]
    ds_read_b64_tr_b16 a[198:199], v7 offset:29696
    buffer_load_dwordx4 v3, s[16:19], s30 offen offset:1024  lds
    v_mfma_f32_16x16x32_bf16 v[64:67], a[168:171], v[216:219], v[64:67]
    ds_read_b64_tr_b16 a[200:201], v8 offset:25600
    s_add_u32 m0, s28, 106496
    v_mfma_f32_16x16x32_bf16 v[68:71], a[168:171], v[220:223], v[68:71]
    ds_read_b64_tr_b16 a[202:203], v8 offset:29696
    s_add_u32 s30, s37, 0
    v_mfma_f32_16x16x32_bf16 v[72:75], a[172:175], v[216:219], v[72:75]
    ds_read_b64_tr_b16 a[204:205], v9 offset:25600
    v_mfma_f32_16x16x32_bf16 v[76:79], a[172:175], v[220:223], v[76:79]
    ds_read_b64_tr_b16 a[206:207], v9 offset:29696
    s_waitcnt vmcnt(13) lgkmcnt(8)
    v_mfma_f32_16x16x32_bf16 v[48:51], a[176:179], v[224:227], v[48:51]
    s_barrier
    ds_read_b64_tr_b16 a[160:161], v6 offset:32768
    v_mfma_f32_16x16x32_bf16 v[52:55], a[176:179], v[228:231], v[52:55]
    ds_read_b64_tr_b16 a[162:163], v6 offset:36864
    v_mfma_f32_16x16x32_bf16 v[56:59], a[180:183], v[224:227], v[56:59]
    ds_read_b64_tr_b16 a[164:165], v7 offset:32768
    v_mfma_f32_16x16x32_bf16 v[60:63], a[180:183], v[228:231], v[60:63]
    ds_read_b64_tr_b16 a[166:167], v7 offset:36864
    buffer_load_dwordx4 v2, s[16:19], s30 offen  lds
    v_mfma_f32_16x16x32_bf16 v[64:67], a[184:187], v[224:227], v[64:67]
    ds_read_b64_tr_b16 a[168:169], v8 offset:32768
    v_mfma_f32_16x16x32_bf16 v[68:71], a[184:187], v[228:231], v[68:71]
    ds_read_b64_tr_b16 a[170:171], v8 offset:36864
    v_mfma_f32_16x16x32_bf16 v[72:75], a[188:191], v[224:227], v[72:75]
    ds_read_b64_tr_b16 a[172:173], v9 offset:32768
    v_mfma_f32_16x16x32_bf16 v[76:79], a[188:191], v[228:231], v[76:79]
    ds_read_b64_tr_b16 a[174:175], v9 offset:36864
    s_waitcnt lgkmcnt(8)
    v_mfma_f32_16x16x32_bf16 v[48:51], a[192:195], v[232:235], v[48:51]
    ds_read_b64_tr_b16 a[176:177], v6 offset:33792
    v_mfma_f32_16x16x32_bf16 v[52:55], a[192:195], v[236:239], v[52:55]
    ds_read_b64_tr_b16 a[178:179], v6 offset:37888
    v_mfma_f32_16x16x32_bf16 v[56:59], a[196:199], v[232:235], v[56:59]
    ds_read_b64_tr_b16 a[180:181], v7 offset:33792
    v_mfma_f32_16x16x32_bf16 v[60:63], a[196:199], v[236:239], v[60:63]
    ds_read_b64_tr_b16 a[182:183], v7 offset:37888
    buffer_load_dwordx4 v3, s[16:19], s30 offen offset:1024  lds
    v_mfma_f32_16x16x32_bf16 v[64:67], a[200:203], v[232:235], v[64:67]
    ds_read_b64_tr_b16 a[184:185], v8 offset:33792
    s_add_u32 m0, s28, 114688
    v_mfma_f32_16x16x32_bf16 v[68:71], a[200:203], v[236:239], v[68:71]
    ds_read_b64_tr_b16 a[186:187], v8 offset:37888
    s_add_u32 s30, s37, 589824
    v_mfma_f32_16x16x32_bf16 v[72:75], a[204:207], v[232:235], v[72:75]
    ds_read_b64_tr_b16 a[188:189], v9 offset:33792
    buffer_load_dwordx4 v2, s[16:19], s30 offen  lds
    v_mfma_f32_16x16x32_bf16 v[76:79], a[204:207], v[236:239], v[76:79]
    ds_read_b64_tr_b16 a[190:191], v9 offset:37888
    s_waitcnt lgkmcnt(8)
    v_mfma_f32_16x16x32_bf16 v[16:19], a[160:163], v[96:99], 0
    ds_read_b64_tr_b16 a[192:193], v6 offset:40960
    s_movk_i32 s31, 12288
    v_mfma_f32_16x16x32_bf16 v[20:23], a[160:163], v[100:103], 0
    ds_read_b64_tr_b16 a[194:195], v6 offset:45056
    buffer_load_dword v248, v253, s[72:75], 0 offen sc1
    v_mfma_f32_16x16x32_bf16 v[24:27], a[164:167], v[96:99], 0
    ds_read_b64_tr_b16 a[196:197], v7 offset:40960
    v_cvt_pk_bf16_f32 v80, v48, v49
    v_mfma_f32_16x16x32_bf16 v[28:31], a[164:167], v[100:103], 0
    ds_read_b64_tr_b16 a[198:199], v7 offset:45056
    buffer_load_dwordx4 v3, s[16:19], s30 offen offset:1024  lds
    v_mfma_f32_16x16x32_bf16 v[32:35], a[168:171], v[96:99], 0
    ds_read_b64_tr_b16 a[200:201], v8 offset:40960
    v_cvt_pk_bf16_f32 v81, v50, v51
    v_mfma_f32_16x16x32_bf16 v[36:39], a[168:171], v[100:103], 0
    ds_read_b64_tr_b16 a[202:203], v8 offset:45056
    v_cvt_pk_bf16_f32 v82, v56, v57
    v_mfma_f32_16x16x32_bf16 v[40:43], a[172:175], v[96:99], 0
    ds_read_b64_tr_b16 a[204:205], v9 offset:40960
    v_cvt_pk_bf16_f32 v83, v58, v59
    v_mfma_f32_16x16x32_bf16 v[44:47], a[172:175], v[100:103], 0
    ds_read_b64_tr_b16 a[206:207], v9 offset:45056
    s_waitcnt lgkmcnt(8)
    v_mfma_f32_16x16x32_bf16 v[16:19], a[176:179], v[104:107], v[16:19]
    ds_read_b64_tr_b16 a[160:161], v6 offset:41984
    s_add_u32 m0, s28, 122880
    v_mfma_f32_16x16x32_bf16 v[20:23], a[176:179], v[108:111], v[20:23]
    ds_read_b64_tr_b16 a[162:163], v6 offset:46080
    s_add_u32 s30, s37, 1179648
    v_mfma_f32_16x16x32_bf16 v[24:27], a[180:183], v[104:107], v[24:27]
    ds_read_b64_tr_b16 a[164:165], v7 offset:41984
    v_pk_max_i16 v80, v80, 0
    v_mfma_f32_16x16x32_bf16 v[28:31], a[180:183], v[108:111], v[28:31]
    ds_read_b64_tr_b16 a[166:167], v7 offset:46080
    buffer_load_dwordx4 v2, s[16:19], s30 offen  lds
    v_mfma_f32_16x16x32_bf16 v[32:35], a[184:187], v[104:107], v[32:35]
    ds_read_b64_tr_b16 a[168:169], v8 offset:41984
    v_pk_max_i16 v81, v81, 0
    v_mfma_f32_16x16x32_bf16 v[36:39], a[184:187], v[108:111], v[36:39]
    ds_read_b64_tr_b16 a[170:171], v8 offset:46080
    v_pk_max_i16 v82, v82, 0
    v_mfma_f32_16x16x32_bf16 v[40:43], a[188:191], v[104:107], v[40:43]
    ds_read_b64_tr_b16 a[172:173], v9 offset:41984
    v_pk_max_i16 v83, v83, 0
    v_mfma_f32_16x16x32_bf16 v[44:47], a[188:191], v[108:111], v[44:47]
    ds_read_b64_tr_b16 a[174:175], v9 offset:46080
    s_waitcnt lgkmcnt(8)
    v_mfma_f32_16x16x32_bf16 v[16:19], a[192:195], v[112:115], v[16:19]
    ds_read_b64_tr_b16 a[176:177], v6 offset:49152
    v_accvgpr_write_b32 a48, v80
    v_mfma_f32_16x16x32_bf16 v[20:23], a[192:195], v[116:119], v[20:23]
    ds_read_b64_tr_b16 a[178:179], v6 offset:53248
    v_accvgpr_write_b32 a49, v81
    v_mfma_f32_16x16x32_bf16 v[24:27], a[196:199], v[112:115], v[24:27]
    ds_read_b64_tr_b16 a[180:181], v7 offset:49152
    v_accvgpr_write_b32 a50, v82
    v_mfma_f32_16x16x32_bf16 v[28:31], a[196:199], v[116:119], v[28:31]
    ds_read_b64_tr_b16 a[182:183], v7 offset:53248
    buffer_load_dwordx4 v3, s[16:19], s30 offen offset:1024  lds
    v_mfma_f32_16x16x32_bf16 v[32:35], a[200:203], v[112:115], v[32:35]
    ds_read_b64_tr_b16 a[184:185], v8 offset:49152
    v_accvgpr_write_b32 a51, v83
    v_mfma_f32_16x16x32_bf16 v[36:39], a[200:203], v[116:119], v[36:39]
    ds_read_b64_tr_b16 a[186:187], v8 offset:53248
    buffer_store_dwordx4 v[80:83], v14, s[76:79], s31 offen offset:0 sc1
    v_mfma_f32_16x16x32_bf16 v[40:43], a[204:207], v[112:115], v[40:43]
    ds_read_b64_tr_b16 a[188:189], v9 offset:49152
    v_cvt_pk_bf16_f32 v84, v52, v53
    v_mfma_f32_16x16x32_bf16 v[44:47], a[204:207], v[116:119], v[44:47]
    ds_read_b64_tr_b16 a[190:191], v9 offset:53248
    s_waitcnt lgkmcnt(8)
    v_mfma_f32_16x16x32_bf16 v[16:19], a[160:163], v[120:123], v[16:19]
    ds_read_b64_tr_b16 a[192:193], v6 offset:50176
    s_add_u32 m0, s28, 0
    v_mfma_f32_16x16x32_bf16 v[20:23], a[160:163], v[124:127], v[20:23]
    ds_read_b64_tr_b16 a[194:195], v6 offset:54272
    s_add_u32 s30, s37, 1769472
    v_mfma_f32_16x16x32_bf16 v[24:27], a[164:167], v[120:123], v[24:27]
    ds_read_b64_tr_b16 a[196:197], v7 offset:50176
    v_cvt_pk_bf16_f32 v85, v54, v55
    v_mfma_f32_16x16x32_bf16 v[28:31], a[164:167], v[124:127], v[28:31]
    ds_read_b64_tr_b16 a[198:199], v7 offset:54272
    buffer_load_dwordx4 v2, s[16:19], s30 offen  lds
    v_mfma_f32_16x16x32_bf16 v[32:35], a[168:171], v[120:123], v[32:35]
    ds_read_b64_tr_b16 a[200:201], v8 offset:50176
    v_cvt_pk_bf16_f32 v86, v60, v61
    v_mfma_f32_16x16x32_bf16 v[36:39], a[168:171], v[124:127], v[36:39]
    ds_read_b64_tr_b16 a[202:203], v8 offset:54272
    v_cvt_pk_bf16_f32 v87, v62, v63
    v_mfma_f32_16x16x32_bf16 v[40:43], a[172:175], v[120:123], v[40:43]
    ds_read_b64_tr_b16 a[204:205], v9 offset:50176
    v_pk_max_i16 v84, v84, 0
    v_mfma_f32_16x16x32_bf16 v[44:47], a[172:175], v[124:127], v[44:47]
    ds_read_b64_tr_b16 a[206:207], v9 offset:54272
    s_waitcnt lgkmcnt(8)
    v_mfma_f32_16x16x32_bf16 v[16:19], a[176:179], v[128:131], v[16:19]
    ds_read_b64_tr_b16 a[160:161], v6 offset:57344
    v_pk_max_i16 v85, v85, 0
    v_mfma_f32_16x16x32_bf16 v[20:23], a[176:179], v[132:135], v[20:23]
    ds_read_b64_tr_b16 a[162:163], v6 offset:61440
    v_pk_max_i16 v86, v86, 0
    v_mfma_f32_16x16x32_bf16 v[24:27], a[180:183], v[128:131], v[24:27]
    ds_read_b64_tr_b16 a[164:165], v7 offset:57344
    v_pk_max_i16 v87, v87, 0
    v_mfma_f32_16x16x32_bf16 v[28:31], a[180:183], v[132:135], v[28:31]
    ds_read_b64_tr_b16 a[166:167], v7 offset:61440
    buffer_load_dwordx4 v3, s[16:19], s30 offen offset:1024  lds
    v_mfma_f32_16x16x32_bf16 v[32:35], a[184:187], v[128:131], v[32:35]
    ds_read_b64_tr_b16 a[168:169], v8 offset:57344
    v_accvgpr_write_b32 a52, v84
    v_mfma_f32_16x16x32_bf16 v[36:39], a[184:187], v[132:135], v[36:39]
    ds_read_b64_tr_b16 a[170:171], v8 offset:61440
    v_accvgpr_write_b32 a53, v85
    v_mfma_f32_16x16x32_bf16 v[40:43], a[188:191], v[128:131], v[40:43]
    ds_read_b64_tr_b16 a[172:173], v9 offset:57344
    v_accvgpr_write_b32 a54, v86
    v_mfma_f32_16x16x32_bf16 v[44:47], a[188:191], v[132:135], v[44:47]
    ds_read_b64_tr_b16 a[174:175], v9 offset:61440
    s_waitcnt lgkmcnt(8)
    v_mfma_f32_16x16x32_bf16 v[16:19], a[192:195], v[136:139], v[16:19]
    ds_read_b64_tr_b16 a[176:177], v6 offset:58368
    s_add_u32 m0, s28, 8192
    v_mfma_f32_16x16x32_bf16 v[20:23], a[192:195], v[140:143], v[20:23]
    ds_read_b64_tr_b16 a[178:179], v6 offset:62464
    s_add_u32 s30, s37, 2359296
    v_mfma_f32_16x16x32_bf16 v[24:27], a[196:199], v[136:139], v[24:27]
    ds_read_b64_tr_b16 a[180:181], v7 offset:58368
    v_accvgpr_write_b32 a55, v87
    v_mfma_f32_16x16x32_bf16 v[28:31], a[196:199], v[140:143], v[28:31]
    ds_read_b64_tr_b16 a[182:183], v7 offset:62464
    buffer_load_dwordx4 v2, s[16:19], s30 offen  lds
    v_mfma_f32_16x16x32_bf16 v[32:35], a[200:203], v[136:139], v[32:35]
    ds_read_b64_tr_b16 a[184:185], v8 offset:58368
    buffer_store_dwordx4 v[84:87], v14, s[76:79], s31 offen offset:1024 sc1
    v_mfma_f32_16x16x32_bf16 v[36:39], a[200:203], v[140:143], v[36:39]
    ds_read_b64_tr_b16 a[186:187], v8 offset:62464
    v_cvt_pk_bf16_f32 v88, v64, v65
    v_mfma_f32_16x16x32_bf16 v[40:43], a[204:207], v[136:139], v[40:43]
    ds_read_b64_tr_b16 a[188:189], v9 offset:58368
    v_cvt_pk_bf16_f32 v89, v66, v67
    v_mfma_f32_16x16x32_bf16 v[44:47], a[204:207], v[140:143], v[44:47]
    ds_read_b64_tr_b16 a[190:191], v9 offset:62464
    s_waitcnt vmcnt(14) lgkmcnt(8)
    v_mfma_f32_16x16x32_bf16 v[16:19], a[160:163], v[144:147], v[16:19]
    s_barrier
    ds_read_b64_tr_b16 a[192:193], v10 offset:0
    v_mfma_f32_16x16x32_bf16 v[20:23], a[160:163], v[148:151], v[20:23]
    ds_read_b64_tr_b16 a[194:195], v10 offset:4096
    v_cvt_pk_bf16_f32 v90, v72, v73
    v_mfma_f32_16x16x32_bf16 v[24:27], a[164:167], v[144:147], v[24:27]
    ds_read_b64_tr_b16 a[196:197], v11 offset:0
    v_cvt_pk_bf16_f32 v91, v74, v75
    v_mfma_f32_16x16x32_bf16 v[28:31], a[164:167], v[148:151], v[28:31]
    ds_read_b64_tr_b16 a[198:199], v11 offset:4096
    buffer_load_dwordx4 v3, s[16:19], s30 offen offset:1024  lds
    v_mfma_f32_16x16x32_bf16 v[32:35], a[168:171], v[144:147], v[32:35]
    ds_read_b64_tr_b16 a[200:201], v12 offset:0
    v_pk_max_i16 v88, v88, 0
    v_mfma_f32_16x16x32_bf16 v[36:39], a[168:171], v[148:151], v[36:39]
    ds_read_b64_tr_b16 a[202:203], v12 offset:4096
    v_pk_max_i16 v89, v89, 0
    v_mfma_f32_16x16x32_bf16 v[40:43], a[172:175], v[144:147], v[40:43]
    ds_read_b64_tr_b16 a[204:205], v13 offset:0
    v_pk_max_i16 v90, v90, 0
    v_mfma_f32_16x16x32_bf16 v[44:47], a[172:175], v[148:151], v[44:47]
    ds_read_b64_tr_b16 a[206:207], v13 offset:4096
    s_waitcnt lgkmcnt(8)
    v_mfma_f32_16x16x32_bf16 v[16:19], a[176:179], v[152:155], v[16:19]
    ds_read_b64_tr_b16 a[160:161], v10 offset:1024
    s_add_u32 m0, s28, 16384
    v_mfma_f32_16x16x32_bf16 v[20:23], a[176:179], v[156:159], v[20:23]
    ds_read_b64_tr_b16 a[162:163], v10 offset:5120
    s_add_u32 s30, s37, 2949120
    v_mfma_f32_16x16x32_bf16 v[24:27], a[180:183], v[152:155], v[24:27]
    ds_read_b64_tr_b16 a[164:165], v11 offset:1024
    v_pk_max_i16 v91, v91, 0
    v_mfma_f32_16x16x32_bf16 v[28:31], a[180:183], v[156:159], v[28:31]
    ds_read_b64_tr_b16 a[166:167], v11 offset:5120
    buffer_load_dwordx4 v2, s[16:19], s30 offen  lds
    v_mfma_f32_16x16x32_bf16 v[32:35], a[184:187], v[152:155], v[32:35]
    ds_read_b64_tr_b16 a[168:169], v12 offset:1024
    v_accvgpr_write_b32 a56, v88
    v_mfma_f32_16x16x32_bf16 v[36:39], a[184:187], v[156:159], v[36:39]
    ds_read_b64_tr_b16 a[170:171], v12 offset:5120
    v_accvgpr_write_b32 a57, v89
    v_mfma_f32_16x16x32_bf16 v[40:43], a[188:191], v[152:155], v[40:43]
    ds_read_b64_tr_b16 a[172:173], v13 offset:1024
    v_accvgpr_write_b32 a58, v90
    v_mfma_f32_16x16x32_bf16 v[44:47], a[188:191], v[156:159], v[44:47]
    ds_read_b64_tr_b16 a[174:175], v13 offset:5120
    s_waitcnt vmcnt(10)
    v_cmp_le_u32 vcc, 1, v248
    s_nop 1
    s_cmp_eq_u64 vcc, -1
    s_cbranch_scc0 L_h0_slow
L_h0_back:
    s_waitcnt lgkmcnt(8)
    v_mfma_f32_16x16x32_bf16 v[16:19], a[192:195], v[160:163], v[16:19]
    ds_read_b64_tr_b16 a[176:177], v10 offset:8192
    v_accvgpr_write_b32 a59, v91
    v_mfma_f32_16x16x32_bf16 v[20:23], a[192:195], v[164:167], v[20:23]
    ds_read_b64_tr_b16 a[178:179], v10 offset:12288
    s_add_u32 s47, s45, 0
    buffer_load_dwordx4 a[96:99], v14, s[80:83], s47 offen offset:0 sc1
    v_mfma_f32_16x16x32_bf16 v[24:27], a[196:199], v[160:163], v[24:27]
    ds_read_b64_tr_b16 a[180:181], v11 offset:8192
    v_mfma_f32_16x16x32_bf16 v[28:31], a[196:199], v[164:167], v[28:31]
    ds_read_b64_tr_b16 a[182:183], v11 offset:12288
    buffer_load_dwordx4 v3, s[16:19], s30 offen offset:1024  lds
    v_mfma_f32_16x16x32_bf16 v[32:35], a[200:203], v[160:163], v[32:35]
    ds_read_b64_tr_b16 a[184:185], v12 offset:8192
    buffer_store_dwordx4 v[88:91], v14, s[76:79], s31 offen offset:2048 sc1
    v_mfma_f32_16x16x32_bf16 v[36:39], a[200:203], v[164:167], v[36:39]
    ds_read_b64_tr_b16 a[186:187], v12 offset:12288
    v_cvt_pk_bf16_f32 v92, v68, v69
    v_mfma_f32_16x16x32_bf16 v[40:43], a[204:207], v[160:163], v[40:43]
    ds_read_b64_tr_b16 a[188:189], v13 offset:8192
    v_cvt_pk_bf16_f32 v93, v70, v71
    v_mfma_f32_16x16x32_bf16 v[44:47], a[204:207], v[164:167], v[44:47]
    ds_read_b64_tr_b16 a[190:191], v13 offset:12288
    s_waitcnt lgkmcnt(8)
    v_mfma_f32_16x16x32_bf16 v[16:19], a[160:163], v[168:171], v[16:19]
    ds_read_b64_tr_b16 a[192:193], v10 offset:9216
    s_add_u32 m0, s28, 24576
    v_mfma_f32_16x16x32_bf16 v[20:23], a[160:163], v[172:175], v[20:23]
    ds_read_b64_tr_b16 a[194:195], v10 offset:13312
    s_add_u32 s30, s37, 3538944
    v_mfma_f32_16x16x32_bf16 v[24:27], a[164:167], v[168:171], v[24:27]
    ds_read_b64_tr_b16 a[196:197], v11 offset:9216
    v_cvt_pk_bf16_f32 v94, v76, v77
    v_mfma_f32_16x16x32_bf16 v[28:31], a[164:167], v[172:175], v[28:31]
    ds_read_b64_tr_b16 a[198:199], v11 offset:13312
    buffer_load_dwordx4 v2, s[16:19], s30 offen  lds
    v_mfma_f32_16x16x32_bf16 v[32:35], a[168:171], v[168:171], v[32:35]
    ds_read_b64_tr_b16 a[200:201], v12 offset:9216
    v_cvt_pk_bf16_f32 v95, v78, v79
    v_mfma_f32_16x16x32_bf16 v[36:39], a[168:171], v[172:175], v[36:39]
    ds_read_b64_tr_b16 a[202:203], v12 offset:13312
    v_pk_max_i16 v92, v92, 0
    v_mfma_f32_16x16x32_bf16 v[40:43], a[172:175], v[168:171], v[40:43]
    ds_read_b64_tr_b16 a[204:205], v13 offset:9216
    buffer_load_dwordx4 a[100:103], v14, s[80:83], s47 offen offset:1024 sc1
    v_mfma_f32_16x16x32_bf16 v[44:47], a[172:175], v[172:175], v[44:47]
    ds_read_b64_tr_b16 a[206:207], v13 offset:13312
    s_waitcnt lgkmcnt(8)
    v_mfma_f32_16x16x32_bf16 v[16:19], a[176:179], v[176:179], v[16:19]
    ds_read_b64_tr_b16 a[160:161], v10 offset:16384
    v_pk_max_i16 v93, v93, 0
    v_mfma_f32_16x16x32_bf16 v[20:23], a[176:179], v[180:183], v[20:23]
    ds_read_b64_tr_b16 a[162:163], v10 offset:20480
    v_pk_max_i16 v94, v94, 0
    v_mfma_f32_16x16x32_bf16 v[24:27], a[180:183], v[176:179], v[24:27]
    ds_read_b64_tr_b16 a[164:165], v11 offset:16384
    v_pk_max_i16 v95, v95, 0
    v_mfma_f32_16x16x32_bf16 v[28:31], a[180:183], v[180:183], v[28:31]
    ds_read_b64_tr_b16 a[166:167], v11 offset:20480
    buffer_load_dwordx4 v3, s[16:19], s30 offen offset:1024  lds
    v_mfma_f32_16x16x32_bf16 v[32:35], a[184:187], v[176:179], v[32:35]
    ds_read_b64_tr_b16 a[168:169], v12 offset:16384
    v_accvgpr_write_b32 a60, v92
    v_mfma_f32_16x16x32_bf16 v[36:39], a[184:187], v[180:183], v[36:39]
    ds_read_b64_tr_b16 a[170:171], v12 offset:20480
    v_accvgpr_write_b32 a61, v93
    v_mfma_f32_16x16x32_bf16 v[40:43], a[188:191], v[176:179], v[40:43]
    ds_read_b64_tr_b16 a[172:173], v13 offset:16384
    v_accvgpr_write_b32 a62, v94
    v_mfma_f32_16x16x32_bf16 v[44:47], a[188:191], v[180:183], v[44:47]
    ds_read_b64_tr_b16 a[174:175], v13 offset:20480
    s_waitcnt lgkmcnt(8)
    v_mfma_f32_16x16x32_bf16 v[16:19], a[192:195], v[184:187], v[16:19]
    ds_read_b64_tr_b16 a[176:177], v10 offset:17408
    s_add_u32 m0, s28, 32768
    v_mfma_f32_16x16x32_bf16 v[20:23], a[192:195], v[188:191], v[20:23]
    ds_read_b64_tr_b16 a[178:179], v10 offset:21504
    s_add_u32 s30, s37, 4128768
    v_mfma_f32_16x16x32_bf16 v[24:27], a[196:199], v[184:187], v[24:27]
    ds_read_b64_tr_b16 a[180:181], v11 offset:17408
    v_accvgpr_write_b32 a63, v95
    v_mfma_f32_16x16x32_bf16 v[28:31], a[196:199], v[188:191], v[28:31]
    ds_read_b64_tr_b16 a[182:183], v11 offset:21504
    buffer_load_dwordx4 v2, s[16:19], s30 offen  lds
    v_mfma_f32_16x16x32_bf16 v[32:35], a[200:203], v[184:187], v[32:35]
    ds_read_b64_tr_b16 a[184:185], v12 offset:17408
    buffer_store_dwordx4 v[92:95], v14, s[76:79], s31 offen offset:3072 sc1
    v_mfma_f32_16x16x32_bf16 v[36:39], a[200:203], v[188:191], v[36:39]
    ds_read_b64_tr_b16 a[186:187], v12 offset:21504
    v_mfma_f32_16x16x32_bf16 v[40:43], a[204:207], v[184:187], v[40:43]
    ds_read_b64_tr_b16 a[188:189], v13 offset:17408
    buffer_load_dwordx4 a[104:107], v14, s[80:83], s47 offen offset:2048 sc1
    v_mfma_f32_16x16x32_bf16 v[44:47], a[204:207], v[188:191], v[44:47]
    ds_read_b64_tr_b16 a[190:191], v13 offset:21504
    s_waitcnt lgkmcnt(8)
    v_mfma_f32_16x16x32_bf16 v[16:19], a[160:163], v[192:195], v[16:19]
    ds_read_b64_tr_b16 a[192:193], v10 offset:24576
    v_mfma_f32_16x16x32_bf16 v[20:23], a[160:163], v[196:199], v[20:23]
    ds_read_b64_tr_b16 a[194:195], v10 offset:28672
    v_mfma_f32_16x16x32_bf16 v[24:27], a[164:167], v[192:195], v[24:27]
    ds_read_b64_tr_b16 a[196:197], v11 offset:24576
    v_mfma_f32_16x16x32_bf16 v[28:31], a[164:167], v[196:199], v[28:31]
    ds_read_b64_tr_b16 a[198:199], v11 offset:28672
    buffer_load_dwordx4 v3, s[16:19], s30 offen offset:1024  lds
    v_mfma_f32_16x16x32_bf16 v[32:35], a[168:171], v[192:195], v[32:35]
    ds_read_b64_tr_b16 a[200:201], v12 offset:24576
    s_add_u32 m0, s28, 40960
    v_mfma_f32_16x16x32_bf16 v[36:39], a[168:171], v[196:199], v[36:39]
    ds_read_b64_tr_b16 a[202:203], v12 offset:28672
    s_add_u32 s30, s37, 4718592
    v_mfma_f32_16x16x32_bf16 v[40:43], a[172:175], v[192:195], v[40:43]
    ds_read_b64_tr_b16 a[204:205], v13 offset:24576
    v_mfma_f32_16x16x32_bf16 v[44:47], a[172:175], v[196:199], v[44:47]
    ds_read_b64_tr_b16 a[206:207], v13 offset:28672
    s_waitcnt lgkmcnt(8)
    v_mfma_f32_16x16x32_bf16 v[16:19], a[176:179], v[200:203], v[16:19]
    ds_read_b64_tr_b16 a[160:161], v10 offset:25600
    v_mfma_f32_16x16x32_bf16 v[20:23], a[176:179], v[204:207], v[20:23]
    ds_read_b64_tr_b16 a[162:163], v10 offset:29696
    v_mfma_f32_16x16x32_bf16 v[24:27], a[180:183], v[200:203], v[24:27]
    ds_read_b64_tr_b16 a[164:165], v11 offset:25600
    v_mfma_f32_16x16x32_bf16 v[28:31], a[180:183], v[204:207], v[28:31]
    ds_read_b64_tr_b16 a[166:167], v11 offset:29696
    buffer_load_dwordx4 v2, s[16:19], s30 offen  lds
    v_mfma_f32_16x16x32_bf16 v[32:35], a[184:187], v[200:203], v[32:35]
    ds_read_b64_tr_b16 a[168:169], v12 offset:25600
    v_mfma_f32_16x16x32_bf16 v[36:39], a[184:187], v[204:207], v[36:39]
    ds_read_b64_tr_b16 a[170:171], v12 offset:29696
    v_mfma_f32_16x16x32_bf16 v[40:43], a[188:191], v[200:203], v[40:43]
    ds_read_b64_tr_b16 a[172:173], v13 offset:25600
    buffer_load_dwordx4 a[108:111], v14, s[80:83], s47 offen offset:3072 sc1
    v_mfma_f32_16x16x32_bf16 v[44:47], a[188:191], v[204:207], v[44:47]
    ds_read_b64_tr_b16 a[174:175], v13 offset:29696
    s_waitcnt vmcnt(19) lgkmcnt(8)
    v_mfma_f32_16x16x32_bf16 v[16:19], a[192:195], v[208:211], v[16:19]
    s_barrier
    ds_read_b64_tr_b16 a[176:177], v10 offset:32768
    v_mfma_f32_16x16x32_bf16 v[20:23], a[192:195], v[212:215], v[20:23]
    ds_read_b64_tr_b16 a[178:179], v10 offset:36864
    s_add_u32 s47, s45, 4096
    v_mfma_f32_16x16x32_bf16 v[24:27], a[196:199], v[208:211], v[24:27]
    ds_read_b64_tr_b16 a[180:181], v11 offset:32768
    v_mov_b32 v242, 2
    v_mfma_f32_16x16x32_bf16 v[28:31], a[196:199], v[212:215], v[28:31]
    ds_read_b64_tr_b16 a[182:183], v11 offset:36864
    buffer_load_dwordx4 v3, s[16:19], s30 offen offset:1024  lds
    v_mfma_f32_16x16x32_bf16 v[32:35], a[200:203], v[208:211], v[32:35]
    ds_read_b64_tr_b16 a[184:185], v12 offset:32768
    s_mov_b64 exec, s[66:67]
    buffer_store_dword v242, off, s[72:75], s56 sc1
    s_mov_b64 exec, -1
    v_mfma_f32_16x16x32_bf16 v[36:39], a[200:203], v[212:215], v[36:39]
    ds_read_b64_tr_b16 a[186:187], v12 offset:36864
    s_add_u32 m0, s28, 49152
    v_mfma_f32_16x16x32_bf16 v[40:43], a[204:207], v[208:211], v[40:43]
    ds_read_b64_tr_b16 a[188:189], v13 offset:32768
    s_mul_i32 s32, s32, 576
    s_add_u32 s30, s6, s32
    v_mfma_f32_16x16x32_bf16 v[44:47], a[204:207], v[212:215], v[44:47]
    ds_read_b64_tr_b16 a[190:191], v13 offset:36864
    s_waitcnt lgkmcnt(8)
    v_mfma_f32_16x16x32_bf16 v[16:19], a[160:163], v[216:219], v[16:19]
    ds_read_b64_tr_b16 a[192:193], v10 offset:33792
    v_mfma_f32_16x16x32_bf16 v[20:23], a[160:163], v[220:223], v[20:23]
    ds_read_b64_tr_b16 a[194:195], v10 offset:37888
    v_mfma_f32_16x16x32_bf16 v[24:27], a[164:167], v[216:219], v[24:27]
    ds_read_b64_tr_b16 a[196:197], v11 offset:33792
    v_mfma_f32_16x16x32_bf16 v[28:31], a[164:167], v[220:223], v[28:31]
    ds_read_b64_tr_b16 a[198:199], v11 offset:37888
    buffer_load_dwordx4 v4, s[20:23], s30 offen  lds
    v_mfma_f32_16x16x32_bf16 v[32:35], a[168:171], v[216:219], v[32:35]
    ds_read_b64_tr_b16 a[200:201], v12 offset:33792
    v_mfma_f32_16x16x32_bf16 v[36:39], a[168:171], v[220:223], v[36:39]
    ds_read_b64_tr_b16 a[202:203], v12 offset:37888
    v_mfma_f32_16x16x32_bf16 v[40:43], a[172:175], v[216:219], v[40:43]
    ds_read_b64_tr_b16 a[204:205], v13 offset:33792
    buffer_load_dwordx4 a[112:115], v14, s[80:83], s47 offen offset:0 sc1
    v_mfma_f32_16x16x32_bf16 v[44:47], a[172:175], v[220:223], v[44:47]
    ds_read_b64_tr_b16 a[206:207], v13 offset:37888
    s_waitcnt lgkmcnt(8)
    v_mfma_f32_16x16x32_bf16 v[16:19], a[176:179], v[224:227], v[16:19]
    ds_read_b64_tr_b16 a[160:161], v10 offset:40960
    v_mfma_f32_16x16x32_bf16 v[20:23], a[176:179], v[228:231], v[20:23]
    ds_read_b64_tr_b16 a[162:163], v10 offset:45056
    v_mfma_f32_16x16x32_bf16 v[24:27], a[180:183], v[224:227], v[24:27]
    ds_read_b64_tr_b16 a[164:165], v11 offset:40960
    v_mfma_f32_16x16x32_bf16 v[28:31], a[180:183], v[228:231], v[28:31]
    ds_read_b64_tr_b16 a[166:167], v11 offset:45056
    buffer_load_dwordx4 v5, s[20:23], s30 offen offset:1024  lds
    v_mfma_f32_16x16x32_bf16 v[32:35], a[184:187], v[224:227], v[32:35]
    ds_read_b64_tr_b16 a[168:169], v12 offset:40960
    s_add_u32 m0, s28, 57344
    v_mfma_f32_16x16x32_bf16 v[36:39], a[184:187], v[228:231], v[36:39]
    ds_read_b64_tr_b16 a[170:171], v12 offset:45056
    s_mul_i32 s33, s33, 576
    s_add_u32 s30, s6, s33
    v_mfma_f32_16x16x32_bf16 v[40:43], a[188:191], v[224:227], v[40:43]
    ds_read_b64_tr_b16 a[172:173], v13 offset:40960
    v_mfma_f32_16x16x32_bf16 v[44:47], a[188:191], v[228:231], v[44:47]
    ds_read_b64_tr_b16 a[174:175], v13 offset:45056
    s_waitcnt lgkmcnt(8)
    v_mfma_f32_16x16x32_bf16 v[16:19], a[192:195], v[232:235], v[16:19]
    ds_read_b64_tr_b16 a[176:177], v10 offset:41984
    v_mfma_f32_16x16x32_bf16 v[20:23], a[192:195], v[236:239], v[20:23]
    ds_read_b64_tr_b16 a[178:179], v10 offset:46080
    v_mfma_f32_16x16x32_bf16 v[24:27], a[196:199], v[232:235], v[24:27]
    ds_read_b64_tr_b16 a[180:181], v11 offset:41984
    v_mfma_f32_16x16x32_bf16 v[28:31], a[196:199], v[236:239], v[28:31]
    ds_read_b64_tr_b16 a[182:183], v11 offset:46080
    buffer_load_dwordx4 v4, s[20:23], s30 offen  lds
    v_mfma_f32_16x16x32_bf16 v[32:35], a[200:203], v[232:235], v[32:35]
    ds_read_b64_tr_b16 a[184:185], v12 offset:41984
    v_mfma_f32_16x16x32_bf16 v[36:39], a[200:203], v[236:239], v[36:39]
    ds_read_b64_tr_b16 a[186:187], v12 offset:46080
    v_mfma_f32_16x16x32_bf16 v[40:43], a[204:207], v[232:235], v[40:43]
    ds_read_b64_tr_b16 a[188:189], v13 offset:41984
    buffer_load_dwordx4 a[116:119], v14, s[80:83], s47 offen offset:1024 sc1
    v_mfma_f32_16x16x32_bf16 v[44:47], a[204:207], v[236:239], v[44:47]
    ds_read_b64_tr_b16 a[190:191], v13 offset:46080
    s_waitcnt lgkmcnt(8)
    v_mfma_f32_16x16x32_bf16 v[48:51], a[160:163], v[96:99], 0
    ds_read_b64_tr_b16 a[192:193], v10 offset:49152
    s_movk_i32 s31, 16384
    v_mfma_f32_16x16x32_bf16 v[52:55], a[160:163], v[100:103], 0
    ds_read_b64_tr_b16 a[194:195], v10 offset:53248
    v_cvt_pk_bf16_f32 v80, v16, v17
    v_mfma_f32_16x16x32_bf16 v[56:59], a[164:167], v[96:99], 0
    ds_read_b64_tr_b16 a[196:197], v11 offset:49152
    v_cvt_pk_bf16_f32 v81, v18, v19
    v_mfma_f32_16x16x32_bf16 v[60:63], a[164:167], v[100:103], 0
    ds_read_b64_tr_b16 a[198:199], v11 offset:53248
    buffer_load_dwordx4 v5, s[20:23], s30 offen offset:1024  lds
    v_mfma_f32_16x16x32_bf16 v[64:67], a[168:171], v[96:99], 0
    ds_read_b64_tr_b16 a[200:201], v12 offset:49152
    v_cvt_pk_bf16_f32 v82, v24, v25
    v_mfma_f32_16x16x32_bf16 v[68:71], a[168:171], v[100:103], 0
    ds_read_b64_tr_b16 a[202:203], v12 offset:53248
    v_cvt_pk_bf16_f32 v83, v26, v27
    v_mfma_f32_16x16x32_bf16 v[72:75], a[172:175], v[96:99], 0
    ds_read_b64_tr_b16 a[204:205], v13 offset:49152
    v_pk_max_i16 v80, v80, 0
    v_mfma_f32_16x16x32_bf16 v[76:79], a[172:175], v[100:103], 0
    ds_read_b64_tr_b16 a[206:207], v13 offset:53248
    s_waitcnt lgkmcnt(8)
    v_mfma_f32_16x16x32_bf16 v[48:51], a[176:179], v[104:107], v[48:51]
    ds_read_b64_tr_b16 a[160:161], v10 offset:50176
    s_add_u32 m0, s28, 65536
    v_mfma_f32_16x16x32_bf16 v[52:55], a[176:179], v[108:111], v[52:55]
    ds_read_b64_tr_b16 a[162:163], v10 offset:54272
    s_mul_i32 s34, s34, 576
L_pm4:
    s_cbranch_execz L_pmb1
    s_add_u32 s30, s6, s34
    v_mfma_f32_16x16x32_bf16 v[56:59], a[180:183], v[104:107], v[56:59]
    ds_read_b64_tr_b16 a[164:165], v11 offset:50176
    v_pk_max_i16 v81, v81, 0
    v_mfma_f32_16x16x32_bf16 v[60:63], a[180:183], v[108:111], v[60:63]
    ds_read_b64_tr_b16 a[166:167], v11 offset:54272
    buffer_load_dwordx4 v4, s[20:23], s30 offen  lds
    v_mfma_f32_16x16x32_bf16 v[64:67], a[184:187], v[104:107], v[64:67]
    ds_read_b64_tr_b16 a[168:169], v12 offset:50176
    v_pk_max_i16 v82, v82, 0
    v_mfma_f32_16x16x32_bf16 v[68:71], a[184:187], v[108:111], v[68:71]
    ds_read_b64_tr_b16 a[170:171], v12 offset:54272
    v_pk_max_i16 v83, v83, 0
    v_mfma_f32_16x16x32_bf16 v[72:75], a[188:191], v[104:107], v[72:75]
    ds_read_b64_tr_b16 a[172:173], v13 offset:50176
    buffer_load_dwordx4 a[120:123], v14, s[80:83], s47 offen offset:2048 sc1
    v_mfma_f32_16x16x32_bf16 v[76:79], a[188:191], v[108:111], v[76:79]
    ds_read_b64_tr_b16 a[174:175], v13 offset:54272
    s_waitcnt lgkmcnt(8)
    v_mfma_f32_16x16x32_bf16 v[48:51], a[192:195], v[112:115], v[48:51]
    ds_read_b64_tr_b16 a[176:177], v10 offset:57344
    v_accvgpr_write_b32 a64, v80
    v_mfma_f32_16x16x32_bf16 v[52:55], a[192:195], v[116:119], v[52:55]
    ds_read_b64_tr_b16 a[178:179], v10 offset:61440
    v_accvgpr_write_b32 a65, v81
    v_mfma_f32_16x16x32_bf16 v[56:59], a[196:199], v[112:115], v[56:59]
    ds_read_b64_tr_b16 a[180:181], v11 offset:57344
    v_accvgpr_write_b32 a66, v82
    v_mfma_f32_16x16x32_bf16 v[60:63], a[196:199], v[116:119], v[60:63]
    ds_read_b64_tr_b16 a[182:183], v11 offset:61440
    buffer_load_dwordx4 v5, s[20:23], s30 offen offset:1024  lds
    v_mfma_f32_16x16x32_bf16 v[64:67], a[200:203], v[112:115], v[64:67]
    ds_read_b64_tr_b16 a[184:185], v12 offset:57344
    v_accvgpr_write_b32 a67, v83
    v_mfma_f32_16x16x32_bf16 v[68:71], a[200:203], v[116:119], v[68:71]
    ds_read_b64_tr_b16 a[186:187], v12 offset:61440
    buffer_store_dwordx4 v[80:83], v14, s[76:79], s31 offen offset:0 sc1
    v_mfma_f32_16x16x32_bf16 v[72:75], a[204:207], v[112:115], v[72:75]
    ds_read_b64_tr_b16 a[188:189], v13 offset:57344
    v_cvt_pk_bf16_f32 v84, v20, v21
    v_mfma_f32_16x16x32_bf16 v[76:79], a[204:207], v[116:119], v[76:79]
    ds_read_b64_tr_b16 a[190:191], v13 offset:61440
    s_waitcnt lgkmcnt(8)
    v_mfma_f32_16x16x32_bf16 v[48:51], a[160:163], v[120:123], v[48:51]
    ds_read_b64_tr_b16 a[192:193], v10 offset:58368
    s_add_u32 m0, s28, 73728
    v_mfma_f32_16x16x32_bf16 v[52:55], a[160:163], v[124:127], v[52:55]
    ds_read_b64_tr_b16 a[194:195], v10 offset:62464
    s_mul_i32 s35, s35, 576
    s_add_u32 s30, s6, s35
    v_mfma_f32_16x16x32_bf16 v[56:59], a[164:167], v[120:123], v[56:59]
    ds_read_b64_tr_b16 a[196:197], v11 offset:58368
    v_cvt_pk_bf16_f32 v85, v22, v23
    v_mfma_f32_16x16x32_bf16 v[60:63], a[164:167], v[124:127], v[60:63]
    ds_read_b64_tr_b16 a[198:199], v11 offset:62464
    buffer_load_dwordx4 v4, s[20:23], s30 offen  lds
    v_mfma_f32_16x16x32_bf16 v[64:67], a[168:171], v[120:123], v[64:67]
    ds_read_b64_tr_b16 a[200:201], v12 offset:58368
    v_cvt_pk_bf16_f32 v86, v28, v29
    v_mfma_f32_16x16x32_bf16 v[68:71], a[168:171], v[124:127], v[68:71]
    ds_read_b64_tr_b16 a[202:203], v12 offset:62464
    v_cvt_pk_bf16_f32 v87, v30, v31
    v_mfma_f32_16x16x32_bf16 v[72:75], a[172:175], v[120:123], v[72:75]
    ds_read_b64_tr_b16 a[204:205], v13 offset:58368
    buffer_load_dwordx4 a[124:127], v14, s[80:83], s47 offen offset:3072 sc1
    v_mfma_f32_16x16x32_bf16 v[76:79], a[172:175], v[124:127], v[76:79]
    ds_read_b64_tr_b16 a[206:207], v13 offset:62464
    s_waitcnt vmcnt(19) lgkmcnt(8)
    v_mfma_f32_16x16x32_bf16 v[48:51], a[176:179], v[128:131], v[48:51]
    s_barrier
    ds_read_b64_tr_b16 a[160:161], v6 offset:0
    v_mfma_f32_16x16x32_bf16 v[52:55], a[176:179], v[132:135], v[52:55]
    ds_read_b64_tr_b16 a[162:163], v6 offset:4096
    s_add_u32 s47, s46, 0
    v_mfma_f32_16x16x32_bf16 v[56:59], a[180:183], v[128:131], v[56:59]
    ds_read_b64_tr_b16 a[164:165], v7 offset:0
    v_pk_max_i16 v84, v84, 0
    v_mfma_f32_16x16x32_bf16 v[60:63], a[180:183], v[132:135], v[60:63]
    ds_read_b64_tr_b16 a[166:167], v7 offset:4096
    buffer_load_dwordx4 v5, s[20:23], s30 offen offset:1024  lds
    v_mfma_f32_16x16x32_bf16 v[64:67], a[184:187], v[128:131], v[64:67]
    ds_read_b64_tr_b16 a[168:169], v8 offset:0
    v_pk_max_i16 v85, v85, 0
    v_mfma_f32_16x16x32_bf16 v[68:71], a[184:187], v[132:135], v[68:71]
    ds_read_b64_tr_b16 a[170:171], v8 offset:4096
    v_pk_max_i16 v86, v86, 0
    v_mfma_f32_16x16x32_bf16 v[72:75], a[188:191], v[128:131], v[72:75]
    ds_read_b64_tr_b16 a[172:173], v9 offset:0
    v_pk_max_i16 v87, v87, 0
    v_mfma_f32_16x16x32_bf16 v[76:79], a[188:191], v[132:135], v[76:79]
    ds_read_b64_tr_b16 a[174:175], v9 offset:4096
    s_waitcnt lgkmcnt(8)
    v_mfma_f32_16x16x32_bf16 v[48:51], a[192:195], v[136:139], v[48:51]
    ds_read_b64_tr_b16 a[176:177], v6 offset:1024
    s_add_u32 m0, s28, 81920
    v_mfma_f32_16x16x32_bf16 v[52:55], a[192:195], v[140:143], v[52:55]
    ds_read_b64_tr_b16 a[178:179], v6 offset:5120
    s_mul_i32 s36, s36, 576
    s_add_u32 s30, s6, s36
    v_mfma_f32_16x16x32_bf16 v[56:59], a[196:199], v[136:139], v[56:59]
    ds_read_b64_tr_b16 a[180:181], v7 offset:1024
    v_accvgpr_write_b32 a68, v84
    v_mfma_f32_16x16x32_bf16 v[60:63], a[196:199], v[140:143], v[60:63]
    ds_read_b64_tr_b16 a[182:183], v7 offset:5120
    buffer_load_dwordx4 v4, s[20:23], s30 offen  lds
    v_mfma_f32_16x16x32_bf16 v[64:67], a[200:203], v[136:139], v[64:67]
    ds_read_b64_tr_b16 a[184:185], v8 offset:1024
    v_accvgpr_write_b32 a69, v85
    v_mfma_f32_16x16x32_bf16 v[68:71], a[200:203], v[140:143], v[68:71]
    ds_read_b64_tr_b16 a[186:187], v8 offset:5120
    v_accvgpr_write_b32 a70, v86
    v_mfma_f32_16x16x32_bf16 v[72:75], a[204:207], v[136:139], v[72:75]
    ds_read_b64_tr_b16 a[188:189], v9 offset:1024
    buffer_load_dwordx4 a[144:147], v14, s[80:83], s47 offen offset:0 sc1
    v_mfma_f32_16x16x32_bf16 v[76:79], a[204:207], v[140:143], v[76:79]
    ds_read_b64_tr_b16 a[190:191], v9 offset:5120
    s_waitcnt lgkmcnt(8)
    v_mfma_f32_16x16x32_bf16 v[48:51], a[160:163], v[144:147], v[48:51]
    ds_read_b64_tr_b16 a[192:193], v6 offset:8192
    v_accvgpr_write_b32 a71, v87
    v_mfma_f32_16x16x32_bf16 v[52:55], a[160:163], v[148:151], v[52:55]
    ds_read_b64_tr_b16 a[194:195], v6 offset:12288
    v_mfma_f32_16x16x32_bf16 v[56:59], a[164:167], v[144:147], v[56:59]
    ds_read_b64_tr_b16 a[196:197], v7 offset:8192
    v_mfma_f32_16x16x32_bf16 v[60:63], a[164:167], v[148:151], v[60:63]
    ds_read_b64_tr_b16 a[198:199], v7 offset:12288
    buffer_load_dwordx4 v5, s[20:23], s30 offen offset:1024  lds
    v_mfma_f32_16x16x32_bf16 v[64:67], a[168:171], v[144:147], v[64:67]
    ds_read_b64_tr_b16 a[200:201], v8 offset:8192
    buffer_store_dwordx4 v[84:87], v14, s[76:79], s31 offen offset:1024 sc1
    v_mfma_f32_16x16x32_bf16 v[68:71], a[168:171], v[148:151], v[68:71]
    ds_read_b64_tr_b16 a[202:203], v8 offset:12288
    v_cvt_pk_bf16_f32 v88, v32, v33
    v_mfma_f32_16x16x32_bf16 v[72:75], a[172:175], v[144:147], v[72:75]
    ds_read_b64_tr_b16 a[204:205], v9 offset:8192
    buffer_load_dword v248, v253, s[72:75], 0 offen sc1
    v_mfma_f32_16x16x32_bf16 v[76:79], a[172:175], v[148:151], v[76:79]
    ds_read_b64_tr_b16 a[206:207], v9 offset:12288
    s_waitcnt lgkmcnt(8)
    v_mfma_f32_16x16x32_bf16 v[48:51], a[176:179], v[152:155], v[48:51]
    ds_read_b64_tr_b16 a[160:161], v6 offset:9216
    s_add_u32 m0, s28, 90112
    v_mfma_f32_16x16x32_bf16 v[52:55], a[176:179], v[156:159], v[52:55]
    ds_read_b64_tr_b16 a[162:163], v6 offset:13312
    s_mul_i32 s37, s37, 576
    s_add_u32 s30, s6, s37
    v_mfma_f32_16x16x32_bf16 v[56:59], a[180:183], v[152:155], v[56:59]
    ds_read_b64_tr_b16 a[164:165], v7 offset:9216
    v_cvt_pk_bf16_f32 v89, v34, v35
    v_mfma_f32_16x16x32_bf16 v[60:63], a[180:183], v[156:159], v[60:63]
    ds_read_b64_tr_b16 a[166:167], v7 offset:13312
    buffer_load_dwordx4 v4, s[20:23], s30 offen  lds
    v_mfma_f32_16x16x32_bf16 v[64:67], a[184:187], v[152:155], v[64:67]
    ds_read_b64_tr_b16 a[168:169], v8 offset:9216
    v_cvt_pk_bf16_f32 v90, v40, v41
    v_mfma_f32_16x16x32_bf16 v[68:71], a[184:187], v[156:159], v[68:71]
    ds_read_b64_tr_b16 a[170:171], v8 offset:13312
    v_cvt_pk_bf16_f32 v91, v42, v43
    v_mfma_f32_16x16x32_bf16 v[72:75], a[188:191], v[152:155], v[72:75]
    ds_read_b64_tr_b16 a[172:173], v9 offset:9216
    v_pk_max_i16 v88, v88, 0
    v_mfma_f32_16x16x32_bf16 v[76:79], a[188:191], v[156:159], v[76:79]
    ds_read_b64_tr_b16 a[174:175], v9 offset:13312
    s_waitcnt lgkmcnt(8)
    v_mfma_f32_16x16x32_bf16 v[48:51], a[192:195], v[160:163], v[48:51]
    ds_read_b64_tr_b16 a[176:177], v6 offset:16384
    v_pk_max_i16 v89, v89, 0
    v_mfma_f32_16x16x32_bf16 v[52:55], a[192:195], v[164:167], v[52:55]
    ds_read_b64_tr_b16 a[178:179], v6 offset:20480
    v_pk_max_i16 v90, v90, 0
    v_mfma_f32_16x16x32_bf16 v[56:59], a[196:199], v[160:163], v[56:59]
    ds_read_b64_tr_b16 a[180:181], v7 offset:16384
    v_pk_max_i16 v91, v91, 0
    v_mfma_f32_16x16x32_bf16 v[60:63], a[196:199], v[164:167], v[60:63]
    ds_read_b64_tr_b16 a[182:183], v7 offset:20480
    buffer_load_dwordx4 v5, s[20:23], s30 offen offset:1024  lds
    v_mfma_f32_16x16x32_bf16 v[64:67], a[200:203], v[160:163], v[64:67]
    ds_read_b64_tr_b16 a[184:185], v8 offset:16384
    v_accvgpr_write_b32 a72, v88
    v_mfma_f32_16x16x32_bf16 v[68:71], a[200:203], v[164:167], v[68:71]
    ds_read_b64_tr_b16 a[186:187], v8 offset:20480
    v_accvgpr_write_b32 a73, v89
    v_mfma_f32_16x16x32_bf16 v[72:75], a[204:207], v[160:163], v[72:75]
    ds_read_b64_tr_b16 a[188:189], v9 offset:16384
    buffer_load_dwordx4 a[148:151], v14, s[80:83], s47 offen offset:1024 sc1
    v_mfma_f32_16x16x32_bf16 v[76:79], a[204:207], v[164:167], v[76:79]
    ds_read_b64_tr_b16 a[190:191], v9 offset:20480
    s_waitcnt lgkmcnt(8)
    v_mfma_f32_16x16x32_bf16 v[48:51], a[160:163], v[168:171], v[48:51]
    ds_read_b64_tr_b16 a[192:193], v6 offset:17408
    s_add_u32 m0, s28, 98304
    v_mfma_f32_16x16x32_bf16 v[52:55], a[160:163], v[172:175], v[52:55]
    ds_read_b64_tr_b16 a[194:195], v6 offset:21504
    s_add_u32 s30, s7, s32
    v_mfma_f32_16x16x32_bf16 v[56:59], a[164:167], v[168:171], v[56:59]
    ds_read_b64_tr_b16 a[196:197], v7 offset:17408
    v_accvgpr_write_b32 a74, v90
    v_mfma_f32_16x16x32_bf16 v[60:63], a[164:167], v[172:175], v[60:63]
    ds_read_b64_tr_b16 a[198:199], v7 offset:21504
    buffer_load_dwordx4 v4, s[20:23], s30 offen  lds
    v_mfma_f32_16x16x32_bf16 v[64:67], a[168:171], v[168:171], v[64:67]
    ds_read_b64_tr_b16 a[200:201], v8 offset:17408
    v_accvgpr_write_b32 a75, v91
    v_mfma_f32_16x16x32_bf16 v[68:71], a[168:171], v[172:175], v[68:71]
    ds_read_b64_tr_b16 a[202:203], v8 offset:21504
    buffer_store_dwordx4 v[88:91], v14, s[76:79], s31 offen offset:2048 sc1
    v_mfma_f32_16x16x32_bf16 v[72:75], a[172:175], v[168:171], v[72:75]
    ds_read_b64_tr_b16 a[204:205], v9 offset:17408
    v_cvt_pk_bf16_f32 v92, v36, v37
    v_mfma_f32_16x16x32_bf16 v[76:79], a[172:175], v[172:175], v[76:79]
    ds_read_b64_tr_b16 a[206:207], v9 offset:21504
    s_waitcnt lgkmcnt(8)
    v_mfma_f32_16x16x32_bf16 v[48:51], a[176:179], v[176:179], v[48:51]
    ds_read_b64_tr_b16 a[160:161], v6 offset:24576
    v_cvt_pk_bf16_f32 v93, v38, v39
    v_mfma_f32_16x16x32_bf16 v[52:55], a[176:179], v[180:183], v[52:55]
    ds_read_b64_tr_b16 a[162:163], v6 offset:28672
    v_cvt_pk_bf16_f32 v94, v44, v45
    v_mfma_f32_16x16x32_bf16 v[56:59], a[180:183], v[176:179], v[56:59]
    ds_read_b64_tr_b16 a[164:165], v7 offset:24576
    v_cvt_pk_bf16_f32 v95, v46, v47
    v_mfma_f32_16x16x32_bf16 v[60:63], a[180:183], v[180:183], v[60:63]
    ds_read_b64_tr_b16 a[166:167], v7 offset:28672
    buffer_load_dwordx4 v5, s[20:23], s30 offen offset:1024  lds
    v_mfma_f32_16x16x32_bf16 v[64:67], a[184:187], v[176:179], v[64:67]
    ds_read_b64_tr_b16 a[168:169], v8 offset:24576
    v_pk_max_i16 v92, v92, 0
    v_mfma_f32_16x16x32_bf16 v[68:71], a[184:187], v[180:183], v[68:71]
    ds_read_b64_tr_b16 a[170:171], v8 offset:28672
    v_pk_max_i16 v93, v93, 0
    v_mfma_f32_16x16x32_bf16 v[72:75], a[188:191], v[176:179], v[72:75]
    ds_read_b64_tr_b16 a[172:173], v9 offset:24576
    buffer_load_dwordx4 a[152:155], v14, s[80:83], s47 offen offset:2048 sc1
    v_mfma_f32_16x16x32_bf16 v[76:79], a[188:191], v[180:183], v[76:79]
    ds_read_b64_tr_b16 a[174:175], v9 offset:28672
    s_waitcnt lgkmcnt(8)
    v_mfma_f32_16x16x32_bf16 v[48:51], a[192:195], v[184:187], v[48:51]
    ds_read_b64_tr_b16 a[176:177], v6 offset:25600
    s_add_u32 m0, s28, 106496
    v_mfma_f32_16x16x32_bf16 v[52:55], a[192:195], v[188:191], v[52:55]
    ds_read_b64_tr_b16 a[178:179], v6 offset:29696
    s_add_u32 s30, s7, s33
    v_mfma_f32_16x16x32_bf16 v[56:59], a[196:199], v[184:187], v[56:59]
    ds_read_b64_tr_b16 a[180:181], v7 offset:25600
    v_pk_max_i16 v94, v94, 0
    v_mfma_f32_16x16x32_bf16 v[60:63], a[196:199], v[188:191], v[60:63]
    ds_read_b64_tr_b16 a[182:183], v7 offset:29696
    buffer_load_dwordx4 v4, s[20:23], s30 offen  lds
    v_mfma_f32_16x16x32_bf16 v[64:67], a[200:203], v[184:187], v[64:67]
    ds_read_b64_tr_b16 a[184:185], v8 offset:25600
    v_pk_max_i16 v95, v95, 0
    v_mfma_f32_16x16x32_bf16 v[68:71], a[200:203], v[188:191], v[68:71]
    ds_read_b64_tr_b16 a[186:187], v8 offset:29696
    v_accvgpr_write_b32 a76, v92
    v_mfma_f32_16x16x32_bf16 v[72:75], a[204:207], v[184:187], v[72:75]
    ds_read_b64_tr_b16 a[188:189], v9 offset:25600
    v_accvgpr_write_b32 a77, v93
    v_mfma_f32_16x16x32_bf16 v[76:79], a[204:207], v[188:191], v[76:79]
    ds_read_b64_tr_b16 a[190:191], v9 offset:29696
    s_waitcnt vmcnt(20) lgkmcnt(8)
    v_mfma_f32_16x16x32_bf16 v[48:51], a[160:163], v[192:195], v[48:51]
    s_barrier
    ds_read_b64_tr_b16 a[192:193], v6 offset:32768
    v_mfma_f32_16x16x32_bf16 v[52:55], a[160:163], v[196:199], v[52:55]
    ds_read_b64_tr_b16 a[194:195], v6 offset:36864
    v_accvgpr_write_b32 a78, v94
    v_mfma_f32_16x16x32_bf16 v[56:59], a[164:167], v[192:195], v[56:59]
    ds_read_b64_tr_b16 a[196:197], v7 offset:32768
    v_accvgpr_write_b32 a79, v95
    v_mfma_f32_16x16x32_bf16 v[60:63], a[164:167], v[196:199], v[60:63]
    ds_read_b64_tr_b16 a[198:199], v7 offset:36864
    buffer_load_dwordx4 v5, s[20:23], s30 offen offset:1024  lds
    v_mfma_f32_16x16x32_bf16 v[64:67], a[168:171], v[192:195], v[64:67]
    ds_read_b64_tr_b16 a[200:201], v8 offset:32768
    buffer_store_dwordx4 v[92:95], v14, s[76:79], s31 offen offset:3072 sc1
    v_mfma_f32_16x16x32_bf16 v[68:71], a[168:171], v[196:199], v[68:71]
    ds_read_b64_tr_b16 a[202:203], v8 offset:36864
    s_add_u32 m0, s28, 114688
    v_mfma_f32_16x16x32_bf16 v[72:75], a[172:175], v[192:195], v[72:75]
    ds_read_b64_tr_b16 a[204:205], v9 offset:32768
    buffer_load_dwordx4 a[156:159], v14, s[80:83], s47 offen offset:3072 sc1
    v_mfma_f32_16x16x32_bf16 v[76:79], a[172:175], v[196:199], v[76:79]
    ds_read_b64_tr_b16 a[206:207], v9 offset:36864
    s_waitcnt lgkmcnt(8)
    v_mfma_f32_16x16x32_bf16 v[48:51], a[176:179], v[200:203], v[48:51]
    ds_read_b64_tr_b16 a[160:161], v6 offset:33792
    s_add_u32 s30, s7, s34
    v_mfma_f32_16x16x32_bf16 v[52:55], a[176:179], v[204:207], v[52:55]
    ds_read_b64_tr_b16 a[162:163], v6 offset:37888
    s_add_u32 s47, s46, 4096
    v_mfma_f32_16x16x32_bf16 v[56:59], a[180:183], v[200:203], v[56:59]
    ds_read_b64_tr_b16 a[164:165], v7 offset:33792
    v_mfma_f32_16x16x32_bf16 v[60:63], a[180:183], v[204:207], v[60:63]
    ds_read_b64_tr_b16 a[166:167], v7 offset:37888
    buffer_load_dwordx4 v4, s[20:23], s30 offen  lds
    v_mfma_f32_16x16x32_bf16 v[64:67], a[184:187], v[200:203], v[64:67]
    ds_read_b64_tr_b16 a[168:169], v8 offset:33792
    v_mfma_f32_16x16x32_bf16 v[68:71], a[184:187], v[204:207], v[68:71]
    ds_read_b64_tr_b16 a[170:171], v8 offset:37888
    v_mfma_f32_16x16x32_bf16 v[72:75], a[188:191], v[200:203], v[72:75]
    ds_read_b64_tr_b16 a[172:173], v9 offset:33792
    v_mfma_f32_16x16x32_bf16 v[76:79], a[188:191], v[204:207], v[76:79]
    ds_read_b64_tr_b16 a[174:175], v9 offset:37888
    s_waitcnt vmcnt(12)
    v_cmp_le_u32 vcc, 2, v248
    s_nop 1
    s_cmp_eq_u64 vcc, -1
    s_cbranch_scc0 L_h1_slow
L_h1_back:
    s_waitcnt lgkmcnt(8)
    v_mfma_f32_16x16x32_bf16 v[48:51], a[192:195], v[208:211], v[48:51]
    ds_read_b64_tr_b16 a[176:177], v6 offset:40960
    v_mfma_f32_16x16x32_bf16 v[52:55], a[192:195], v[212:215], v[52:55]
    ds_read_b64_tr_b16 a[178:179], v6 offset:45056
    v_mfma_f32_16x16x32_bf16 v[56:59], a[196:199], v[208:211], v[56:59]
    ds_read_b64_tr_b16 a[180:181], v7 offset:40960
    v_mfma_f32_16x16x32_bf16 v[60:63], a[196:199], v[212:215], v[60:63]
    ds_read_b64_tr_b16 a[182:183], v7 offset:45056
    buffer_load_dwordx4 v5, s[20:23], s30 offen offset:1024  lds
    v_mfma_f32_16x16x32_bf16 v[64:67], a[200:203], v[208:211], v[64:67]
    ds_read_b64_tr_b16 a[184:185], v8 offset:40960
    s_add_u32 m0, s28, 122880
    v_mfma_f32_16x16x32_bf16 v[68:71], a[200:203], v[212:215], v[68:71]
    ds_read_b64_tr_b16 a[186:187], v8 offset:45056
    s_add_u32 s30, s8, s32
    v_mfma_f32_16x16x32_bf16 v[72:75], a[204:207], v[208:211], v[72:75]
    ds_read_b64_tr_b16 a[188:189], v9 offset:40960
    buffer_load_dwordx4 a[208:211], v14, s[80:83], s47 offen offset:0 sc1
    v_mfma_f32_16x16x32_bf16 v[76:79], a[204:207], v[212:215], v[76:79]
    ds_read_b64_tr_b16 a[190:191], v9 offset:45056
    s_waitcnt lgkmcnt(8)
    v_mfma_f32_16x16x32_bf16 v[48:51], a[160:163], v[216:219], v[48:51]
    ds_read_b64_tr_b16 a[192:193], v6 offset:41984
    v_mfma_f32_16x16x32_bf16 v[52:55], a[160:163], v[220:223], v[52:55]
    ds_read_b64_tr_b16 a[194:195], v6 offset:46080
    v_mfma_f32_16x16x32_bf16 v[56:59], a[164:167], v[216:219], v[56:59]
    ds_read_b64_tr_b16 a[196:197], v7 offset:41984
    v_mfma_f32_16x16x32_bf16 v[60:63], a[164:167], v[220:223], v[60:63]
    ds_read_b64_tr_b16 a[198:199], v7 offset:46080
    buffer_load_dwordx4 v4, s[20:23], s30 offen  lds
    v_mfma_f32_16x16x32_bf16 v[64:67], a[168:171], v[216:219], v[64:67]
    ds_read_b64_tr_b16 a[200:201], v8 offset:41984
    v_mfma_f32_16x16x32_bf16 v[68:71], a[168:171], v[220:223], v[68:71]
    ds_read_b64_tr_b16 a[202:203], v8 offset:46080
    v_mfma_f32_16x16x32_bf16 v[72:75], a[172:175], v[216:219], v[72:75]
    ds_read_b64_tr_b16 a[204:205], v9 offset:41984
    v_mfma_f32_16x16x32_bf16 v[76:79], a[172:175], v[220:223], v[76:79]
    ds_read_b64_tr_b16 a[206:207], v9 offset:46080
    s_waitcnt lgkmcnt(8)
    v_mfma_f32_16x16x32_bf16 v[48:51], a[176:179], v[224:227], v[48:51]
    ds_read_b64_tr_b16 a[160:161], v6 offset:49152
    v_mfma_f32_16x16x32_bf16 v[52:55], a[176:179], v[228:231], v[52:55]
    ds_read_b64_tr_b16 a[162:163], v6 offset:53248
    v_mfma_f32_16x16x32_bf16 v[56:59], a[180:183], v[224:227], v[56:59]
    ds_read_b64_tr_b16 a[164:165], v7 offset:49152
    v_mfma_f32_16x16x32_bf16 v[60:63], a[180:183], v[228:231], v[60:63]
    ds_read_b64_tr_b16 a[166:167], v7 offset:53248
    buffer_load_dwordx4 v5, s[20:23], s30 offen offset:1024  lds
    v_mfma_f32_16x16x32_bf16 v[64:67], a[184:187], v[224:227], v[64:67]
    ds_read_b64_tr_b16 a[168:169], v8 offset:49152
    s_add_u32 m0, s28, 0
    v_mfma_f32_16x16x32_bf16 v[68:71], a[184:187], v[228:231], v[68:71]
    ds_read_b64_tr_b16 a[170:171], v8 offset:53248
    s_add_u32 s30, s8, s33
    v_mfma_f32_16x16x32_bf16 v[72:75], a[188:191], v[224:227], v[72:75]
    ds_read_b64_tr_b16 a[172:173], v9 offset:49152
    buffer_load_dwordx4 a[212:215], v14, s[80:83], s47 offen offset:1024 sc1
    v_mfma_f32_16x16x32_bf16 v[76:79], a[188:191], v[228:231], v[76:79]
    ds_read_b64_tr_b16 a[174:175], v9 offset:53248
    s_waitcnt lgkmcnt(8)
    v_mfma_f32_16x16x32_bf16 v[48:51], a[192:195], v[232:235], v[48:51]
    ds_read_b64_tr_b16 a[176:177], v6 offset:50176
    v_mfma_f32_16x16x32_bf16 v[52:55], a[192:195], v[236:239], v[52:55]
    ds_read_b64_tr_b16 a[178:179], v6 offset:54272
    v_mfma_f32_16x16x32_bf16 v[56:59], a[196:199], v[232:235], v[56:59]
    ds_read_b64_tr_b16 a[180:181], v7 offset:50176
    v_mfma_f32_16x16x32_bf16 v[60:63], a[196:199], v[236:239], v[60:63]
    ds_read_b64_tr_b16 a[182:183], v7 offset:54272
    buffer_load_dwordx4 v4, s[20:23], s30 offen  lds
    v_mfma_f32_16x16x32_bf16 v[64:67], a[200:203], v[232:235], v[64:67]
    ds_read_b64_tr_b16 a[184:185], v8 offset:50176
    v_mfma_f32_16x16x32_bf16 v[68:71], a[200:203], v[236:239], v[68:71]
    ds_read_b64_tr_b16 a[186:187], v8 offset:54272
    v_mfma_f32_16x16x32_bf16 v[72:75], a[204:207], v[232:235], v[72:75]
    ds_read_b64_tr_b16 a[188:189], v9 offset:50176
    v_mfma_f32_16x16x32_bf16 v[76:79], a[204:207], v[236:239], v[76:79]
    ds_read_b64_tr_b16 a[190:191], v9 offset:54272
    s_waitcnt lgkmcnt(8)
    v_mfma_f32_16x16x32_bf16 v[16:19], a[160:163], a[0:3], 0
    ds_read_b64_tr_b16 a[192:193], v6 offset:57344
    s_movk_i32 s31, 20480
    v_mfma_f32_16x16x32_bf16 v[20:23], a[160:163], a[4:7], 0
    ds_read_b64_tr_b16 a[194:195], v6 offset:61440
    v_cvt_pk_bf16_f32 v80, v48, v49
    v_mfma_f32_16x16x32_bf16 v[24:27], a[164:167], a[0:3], 0
    ds_read_b64_tr_b16 a[196:197], v7 offset:57344
    v_cvt_pk_bf16_f32 v81, v50, v51
    v_cvt_pk_bf16_f32 v82, v56, v57
    v_mfma_f32_16x16x32_bf16 v[28:31], a[164:167], a[4:7], 0
    ds_read_b64_tr_b16 a[198:199], v7 offset:61440
    buffer_load_dwordx4 v5, s[20:23], s30 offen offset:1024  lds
    v_mfma_f32_16x16x32_bf16 v[32:35], a[168:171], a[0:3], 0
    ds_read_b64_tr_b16 a[200:201], v8 offset:57344
    v_cvt_pk_bf16_f32 v83, v58, v59
    v_mfma_f32_16x16x32_bf16 v[36:39], a[168:171], a[4:7], 0
    ds_read_b64_tr_b16 a[202:203], v8 offset:61440
    v_pk_max_i16 v80, v80, 0
    v_pk_max_i16 v81, v81, 0
    v_mfma_f32_16x16x32_bf16 v[40:43], a[172:175], a[0:3], 0
    ds_read_b64_tr_b16 a[204:205], v9 offset:57344
    buffer_load_dwordx4 a[216:219], v14, s[80:83], s47 offen offset:2048 sc1
    v_mfma_f32_16x16x32_bf16 v[44:47], a[172:175], a[4:7], 0
    ds_read_b64_tr_b16 a[206:207], v9 offset:61440
    s_waitcnt lgkmcnt(8)
    v_mfma_f32_16x16x32_bf16 v[16:19], a[176:179], a[8:11], v[16:19]
    ds_read_b64_tr_b16 a[160:161], v6 offset:58368
    s_add_u32 m0, s28, 8192
    v_mfma_f32_16x16x32_bf16 v[20:23], a[176:179], a[12:15], v[20:23]
    ds_read_b64_tr_b16 a[162:163], v6 offset:62464
    s_add_u32 s30, s8, s34
    v_mfma_f32_16x16x32_bf16 v[24:27], a[180:183], a[8:11], v[24:27]
    ds_read_b64_tr_b16 a[164:165], v7 offset:58368
    v_pk_max_i16 v82, v82, 0
    v_pk_max_i16 v83, v83, 0
    v_mfma_f32_16x16x32_bf16 v[28:31], a[180:183], a[12:15], v[28:31]
    ds_read_b64_tr_b16 a[166:167], v7 offset:62464
    buffer_load_dwordx4 v4, s[20:23], s30 offen  lds
    v_mfma_f32_16x16x32_bf16 v[32:35], a[184:187], a[8:11], v[32:35]
    ds_read_b64_tr_b16 a[168:169], v8 offset:58368
    v_accvgpr_write_b32 a80, v80
    v_mfma_f32_16x16x32_bf16 v[36:39], a[184:187], a[12:15], v[36:39]
    ds_read_b64_tr_b16 a[170:171], v8 offset:62464
    v_accvgpr_write_b32 a81, v81
    v_accvgpr_write_b32 a82, v82
    v_mfma_f32_16x16x32_bf16 v[40:43], a[188:191], a[8:11], v[40:43]
    ds_read_b64_tr_b16 a[172:173], v9 offset:58368
    v_accvgpr_write_b32 a83, v83
    v_mfma_f32_16x16x32_bf16 v[44:47], a[188:191], a[12:15], v[44:47]
    ds_read_b64_tr_b16 a[174:175], v9 offset:62464
    s_waitcnt vmcnt(19) lgkmcnt(8)
    v_mfma_f32_16x16x32_bf16 v[16:19], a[192:195], a[16:19], v[16:19]
    s_barrier
    ds_read_b64_tr_b16 a[176:177], v10 offset:0
    v_mfma_f32_16x16x32_bf16 v[20:23], a[192:195], a[20:23], v[20:23]
    ds_read_b64_tr_b16 a[178:179], v10 offset:4096
    v_mfma_f32_16x16x32_bf16 v[24:27], a[196:199], a[16:19], v[24:27]
    ds_read_b64_tr_b16 a[180:181], v11 offset:0
    v_mfma_f32_16x16x32_bf16 v[28:31], a[196:199], a[20:23], v[28:31]
    ds_read_b64_tr_b16 a[182:183], v11 offset:4096
    buffer_load_dwordx4 v5, s[20:23], s30 offen offset:1024  lds
    v_mfma_f32_16x16x32_bf16 v[32:35], a[200:203], a[16:19], v[32:35]
    ds_read_b64_tr_b16 a[184:185], v12 offset:0
    buffer_store_dwordx4 v[80:83], v14, s[76:79], s31 offen offset:0 sc1
    v_mfma_f32_16x16x32_bf16 v[36:39], a[200:203], a[20:23], v[36:39]
    ds_read_b64_tr_b16 a[186:187], v12 offset:4096
    v_cvt_pk_bf16_f32 v84, v52, v53
    v_cvt_pk_bf16_f32 v85, v54, v55
    v_mfma_f32_16x16x32_bf16 v[40:43], a[204:207], a[16:19], v[40:43]
    ds_read_b64_tr_b16 a[188:189], v13 offset:0
    buffer_load_dwordx4 a[220:223], v14, s[80:83], s47 offen offset:3072 sc1
    v_mfma_f32_16x16x32_bf16 v[44:47], a[204:207], a[20:23], v[44:47]
    ds_read_b64_tr_b16 a[190:191], v13 offset:4096
    s_waitcnt lgkmcnt(8)
    v_mfma_f32_16x16x32_bf16 v[16:19], a[160:163], a[24:27], v[16:19]
    ds_read_b64_tr_b16 a[192:193], v10 offset:1024
    s_add_u32 m0, s28, 16384
    v_mfma_f32_16x16x32_bf16 v[20:23], a[160:163], a[28:31], v[20:23]
    ds_read_b64_tr_b16 a[194:195], v10 offset:5120
    s_add_u32 s47, s45, 8192
    v_mfma_f32_16x16x32_bf16 v[24:27], a[164:167], a[24:27], v[24:27]
    ds_read_b64_tr_b16 a[196:197], v11 offset:1024
    s_add_u32 s30, s9, s32
    v_cvt_pk_bf16_f32 v86, v60, v61
    v_mfma_f32_16x16x32_bf16 v[28:31], a[164:167], a[28:31], v[28:31]
    ds_read_b64_tr_b16 a[198:199], v11 offset:5120
    buffer_load_dwordx4 v4, s[20:23], s30 offen  lds
    v_mfma_f32_16x16x32_bf16 v[32:35], a[168:171], a[24:27], v[32:35]
    ds_read_b64_tr_b16 a[200:201], v12 offset:1024
    v_cvt_pk_bf16_f32 v87, v62, v63
    v_mfma_f32_16x16x32_bf16 v[36:39], a[168:171], a[28:31], v[36:39]
    ds_read_b64_tr_b16 a[202:203], v12 offset:5120
    v_pk_max_i16 v84, v84, 0
    v_pk_max_i16 v85, v85, 0
    v_mfma_f32_16x16x32_bf16 v[40:43], a[172:175], a[24:27], v[40:43]
    ds_read_b64_tr_b16 a[204:205], v13 offset:1024
    v_pk_max_i16 v86, v86, 0
    v_mfma_f32_16x16x32_bf16 v[44:47], a[172:175], a[28:31], v[44:47]
    ds_read_b64_tr_b16 a[206:207], v13 offset:5120
    s_waitcnt lgkmcnt(8)
    v_mfma_f32_16x16x32_bf16 v[16:19], a[176:179], a[32:35], v[16:19]
    ds_read_b64_tr_b16 a[160:161], v10 offset:8192
    v_pk_max_i16 v87, v87, 0
    v_mfma_f32_16x16x32_bf16 v[20:23], a[176:179], a[36:39], v[20:23]
    ds_read_b64_tr_b16 a[162:163], v10 offset:12288
    v_accvgpr_write_b32 a84, v84
    v_mfma_f32_16x16x32_bf16 v[24:27], a[180:183], a[32:35], v[24:27]
    ds_read_b64_tr_b16 a[164:165], v11 offset:8192
    v_accvgpr_write_b32 a85, v85
    v_accvgpr_write_b32 a86, v86
    v_mfma_f32_16x16x32_bf16 v[28:31], a[180:183], a[36:39], v[28:31]
    ds_read_b64_tr_b16 a[166:167], v11 offset:12288
    buffer_load_dwordx4 v5, s[20:23], s30 offen offset:1024  lds
    v_mfma_f32_16x16x32_bf16 v[32:35], a[184:187], a[32:35], v[32:35]
    ds_read_b64_tr_b16 a[168:169], v12 offset:8192
    v_accvgpr_write_b32 a87, v87
    v_mfma_f32_16x16x32_bf16 v[36:39], a[184:187], a[36:39], v[36:39]
    ds_read_b64_tr_b16 a[170:171], v12 offset:12288
    buffer_store_dwordx4 v[84:87], v14, s[76:79], s31 offen offset:1024 sc1
    v_cvt_pk_bf16_f32 v88, v64, v65
    v_mfma_f32_16x16x32_bf16 v[40:43], a[188:191], a[32:35], v[40:43]
    ds_read_b64_tr_b16 a[172:173], v13 offset:8192
    buffer_load_dwordx4 a[128:131], v14, s[80:83], s47 offen offset:0 sc1
    v_mfma_f32_16x16x32_bf16 v[44:47], a[188:191], a[36:39], v[44:47]
    ds_read_b64_tr_b16 a[174:175], v13 offset:12288
    s_waitcnt lgkmcnt(8)
    v_mfma_f32_16x16x32_bf16 v[16:19], a[192:195], a[40:43], v[16:19]
    ds_read_b64_tr_b16 a[176:177], v10 offset:9216
    s_add_u32 m0, s28, 24576
    v_mfma_f32_16x16x32_bf16 v[20:23], a[192:195], a[44:47], v[20:23]
    ds_read_b64_tr_b16 a[178:179], v10 offset:13312
    s_add_u32 s30, s9, s33
    v_mfma_f32_16x16x32_bf16 v[24:27], a[196:199], a[40:43], v[24:27]
    ds_read_b64_tr_b16 a[180:181], v11 offset:9216
    v_cvt_pk_bf16_f32 v89, v66, v67
    v_cvt_pk_bf16_f32 v90, v72, v73
    v_mfma_f32_16x16x32_bf16 v[28:31], a[196:199], a[44:47], v[28:31]
    ds_read_b64_tr_b16 a[182:183], v11 offset:13312
    buffer_load_dwordx4 v4, s[20:23], s30 offen  lds
    v_mfma_f32_16x16x32_bf16 v[32:35], a[200:203], a[40:43], v[32:35]
    ds_read_b64_tr_b16 a[184:185], v12 offset:9216
    v_cvt_pk_bf16_f32 v91, v74, v75
    v_mfma_f32_16x16x32_bf16 v[36:39], a[200:203], a[44:47], v[36:39]
    ds_read_b64_tr_b16 a[186:187], v12 offset:13312
    v_pk_max_i16 v88, v88, 0
    v_pk_max_i16 v89, v89, 0
L_pm5:
    s_cbranch_execz L_pmb1
    v_mfma_f32_16x16x32_bf16 v[40:43], a[204:207], a[40:43], v[40:43]
    ds_read_b64_tr_b16 a[188:189], v13 offset:9216
    v_pk_max_i16 v90, v90, 0
    v_mfma_f32_16x16x32_bf16 v[44:47], a[204:207], a[44:47], v[44:47]
    ds_read_b64_tr_b16 a[190:191], v13 offset:13312
    s_waitcnt lgkmcnt(8)
    v_mfma_f32_16x16x32_bf16 v[16:19], a[160:163], a[48:51], v[16:19]
    ds_read_b64_tr_b16 a[192:193], v10 offset:16384
    v_pk_max_i16 v91, v91, 0
    v_mfma_f32_16x16x32_bf16 v[20:23], a[160:163], a[52:55], v[20:23]
    ds_read_b64_tr_b16 a[194:195], v10 offset:20480
    v_accvgpr_write_b32 a88, v88
    v_mfma_f32_16x16x32_bf16 v[24:27], a[164:167], a[48:51], v[24:27]
    ds_read_b64_tr_b16 a[196:197], v11 offset:16384
    v_accvgpr_write_b32 a89, v89
    v_accvgpr_write_b32 a90, v90
    v_mfma_f32_16x16x32_bf16 v[28:31], a[164:167], a[52:55], v[28:31]
    ds_read_b64_tr_b16 a[198:199], v11 offset:20480
    buffer_load_dwordx4 v5, s[20:23], s30 offen offset:1024  lds
    v_mfma_f32_16x16x32_bf16 v[32:35], a[168:171], a[48:51], v[32:35]
    ds_read_b64_tr_b16 a[200:201], v12 offset:16384
    v_accvgpr_write_b32 a91, v91
    v_mfma_f32_16x16x32_bf16 v[36:39], a[168:171], a[52:55], v[36:39]
    ds_read_b64_tr_b16 a[202:203], v12 offset:20480
    buffer_store_dwordx4 v[88:91], v14, s[76:79], s31 offen offset:2048 sc1
    v_mfma_f32_16x16x32_bf16 v[40:43], a[172:175], a[48:51], v[40:43]
    ds_read_b64_tr_b16 a[204:205], v13 offset:16384
    buffer_load_dwordx4 a[132:135], v14, s[80:83], s47 offen offset:1024 sc1
    v_mfma_f32_16x16x32_bf16 v[44:47], a[172:175], a[52:55], v[44:47]
    ds_read_b64_tr_b16 a[206:207], v13 offset:20480
    s_waitcnt lgkmcnt(8)
    v_mfma_f32_16x16x32_bf16 v[16:19], a[176:179], a[56:59], v[16:19]
    ds_read_b64_tr_b16 a[160:161], v10 offset:17408
    s_add_u32 m0, s28, 32768
    v_mfma_f32_16x16x32_bf16 v[20:23], a[176:179], a[60:63], v[20:23]
    ds_read_b64_tr_b16 a[162:163], v10 offset:21504
    s_add_u32 s30, s9, s34
    v_mfma_f32_16x16x32_bf16 v[24:27], a[180:183], a[56:59], v[24:27]
    ds_read_b64_tr_b16 a[164:165], v11 offset:17408
    v_cvt_pk_bf16_f32 v92, v68, v69
    v_cvt_pk_bf16_f32 v93, v70, v71
    v_mfma_f32_16x16x32_bf16 v[28:31], a[180:183], a[60:63], v[28:31]
    ds_read_b64_tr_b16 a[166:167], v11 offset:21504
    buffer_load_dwordx4 v4, s[20:23], s30 offen  lds
    v_mfma_f32_16x16x32_bf16 v[32:35], a[184:187], a[56:59], v[32:35]
    ds_read_b64_tr_b16 a[168:169], v12 offset:17408
    v_cvt_pk_bf16_f32 v94, v76, v77
    v_mfma_f32_16x16x32_bf16 v[36:39], a[184:187], a[60:63], v[36:39]
    ds_read_b64_tr_b16 a[170:171], v12 offset:21504
    v_cvt_pk_bf16_f32 v95, v78, v79
    v_mfma_f32_16x16x32_bf16 v[40:43], a[188:191], a[56:59], v[40:43]
    ds_read_b64_tr_b16 a[172:173], v13 offset:17408
    v_pk_max_i16 v92, v92, 0
    v_mfma_f32_16x16x32_bf16 v[44:47], a[188:191], a[60:63], v[44:47]
    ds_read_b64_tr_b16 a[174:175], v13 offset:21504
    s_waitcnt lgkmcnt(8)
    v_mfma_f32_16x16x32_bf16 v[16:19], a[192:195], a[64:67], v[16:19]
    ds_read_b64_tr_b16 a[176:177], v10 offset:24576
    v_pk_max_i16 v93, v93, 0
    v_mfma_f32_16x16x32_bf16 v[20:23], a[192:195], a[68:71], v[20:23]
    ds_read_b64_tr_b16 a[178:179], v10 offset:28672
    v_pk_max_i16 v94, v94, 0
    v_mfma_f32_16x16x32_bf16 v[24:27], a[196:199], a[64:67], v[24:27]
    ds_read_b64_tr_b16 a[180:181], v11 offset:24576
    v_pk_max_i16 v95, v95, 0
    v_mfma_f32_16x16x32_bf16 v[28:31], a[196:199], a[68:71], v[28:31]
    ds_read_b64_tr_b16 a[182:183], v11 offset:28672
    buffer_load_dwordx4 v5, s[20:23], s30 offen offset:1024  lds
    v_mfma_f32_16x16x32_bf16 v[32:35], a[200:203], a[64:67], v[32:35]
    ds_read_b64_tr_b16 a[184:185], v12 offset:24576
    v_accvgpr_write_b32 a92, v92
    v_mfma_f32_16x16x32_bf16 v[36:39], a[200:203], a[68:71], v[36:39]
    ds_read_b64_tr_b16 a[186:187], v12 offset:28672
    v_accvgpr_write_b32 a93, v93
    v_mfma_f32_16x16x32_bf16 v[40:43], a[204:207], a[64:67], v[40:43]
    ds_read_b64_tr_b16 a[188:189], v13 offset:24576
    buffer_load_dwordx4 a[136:139], v14, s[80:83], s47 offen offset:2048 sc1
    v_mfma_f32_16x16x32_bf16 v[44:47], a[204:207], a[68:71], v[44:47]
    ds_read_b64_tr_b16 a[190:191], v13 offset:28672
    s_waitcnt lgkmcnt(8)
    v_mfma_f32_16x16x32_bf16 v[16:19], a[160:163], a[72:75], v[16:19]
    ds_read_b64_tr_b16 a[192:193], v10 offset:25600
    s_add_u32 m0, s28, 40960
    v_mfma_f32_16x16x32_bf16 v[20:23], a[160:163], a[76:79], v[20:23]
    ds_read_b64_tr_b16 a[194:195], v10 offset:29696
    s_add_u32 s30, s9, s35
    v_mfma_f32_16x16x32_bf16 v[24:27], a[164:167], a[72:75], v[24:27]
    ds_read_b64_tr_b16 a[196:197], v11 offset:25600
    v_accvgpr_write_b32 a94, v94
    v_mfma_f32_16x16x32_bf16 v[28:31], a[164:167], a[76:79], v[28:31]
    ds_read_b64_tr_b16 a[198:199], v11 offset:29696
    buffer_load_dwordx4 v4, s[20:23], s30 offen  lds
    v_mfma_f32_16x16x32_bf16 v[32:35], a[168:171], a[72:75], v[32:35]
    ds_read_b64_tr_b16 a[200:201], v12 offset:25600
    v_accvgpr_write_b32 a95, v95
    v_mfma_f32_16x16x32_bf16 v[36:39], a[168:171], a[76:79], v[36:39]
    ds_read_b64_tr_b16 a[202:203], v12 offset:29696
    buffer_store_dwordx4 v[92:95], v14, s[76:79], s31 offen offset:3072 sc1
    v_mfma_f32_16x16x32_bf16 v[40:43], a[172:175], a[72:75], v[40:43]
    ds_read_b64_tr_b16 a[204:205], v13 offset:25600
    v_mfma_f32_16x16x32_bf16 v[44:47], a[172:175], a[76:79], v[44:47]
    ds_read_b64_tr_b16 a[206:207], v13 offset:29696
    s_waitcnt vmcnt(21) lgkmcnt(8)
    v_mfma_f32_16x16x32_bf16 v[16:19], a[176:179], a[80:83], v[16:19]
    s_barrier
    ds_read_b64_tr_b16 a[160:161], v10 offset:32768
    v_mfma_f32_16x16x32_bf16 v[20:23], a[176:179], a[84:87], v[20:23]
    ds_read_b64_tr_b16 a[162:163], v10 offset:36864
    v_mov_b32 v242, 3
    v_mfma_f32_16x16x32_bf16 v[24:27], a[180:183], a[80:83], v[24:27]
    ds_read_b64_tr_b16 a[164:165], v11 offset:32768
    s_mov_b64 exec, s[66:67]
    buffer_store_dword v242, off, s[72:75], s56 sc1
    s_mov_b64 exec, -1
    v_mfma_f32_16x16x32_bf16 v[28:31], a[180:183], a[84:87], v[28:31]
    ds_read_b64_tr_b16 a[166:167], v11 offset:36864
    buffer_load_dwordx4 v5, s[20:23], s30 offen offset:1024  lds
    v_mfma_f32_16x16x32_bf16 v[32:35], a[184:187], a[80:83], v[32:35]
    ds_read_b64_tr_b16 a[168:169], v12 offset:32768
    s_add_u32 m0, s28, 49152
    v_mfma_f32_16x16x32_bf16 v[36:39], a[184:187], a[84:87], v[36:39]
    ds_read_b64_tr_b16 a[170:171], v12 offset:36864
    s_add_u32 s30, s9, s36
    v_mfma_f32_16x16x32_bf16 v[40:43], a[188:191], a[80:83], v[40:43]
    ds_read_b64_tr_b16 a[172:173], v13 offset:32768
    buffer_load_dwordx4 a[140:143], v14, s[80:83], s47 offen offset:3072 sc1
    v_mfma_f32_16x16x32_bf16 v[44:47], a[188:191], a[84:87], v[44:47]
    ds_read_b64_tr_b16 a[174:175], v13 offset:36864
    s_waitcnt lgkmcnt(8)
    v_mfma_f32_16x16x32_bf16 v[16:19], a[192:195], a[88:91], v[16:19]
    ds_read_b64_tr_b16 a[176:177], v10 offset:33792
    v_mfma_f32_16x16x32_bf16 v[20:23], a[192:195], a[92:95], v[20:23]
    ds_read_b64_tr_b16 a[178:179], v10 offset:37888
    s_add_u32 s47, s46, 8192
    v_mfma_f32_16x16x32_bf16 v[24:27], a[196:199], a[88:91], v[24:27]
    ds_read_b64_tr_b16 a[180:181], v11 offset:33792
    v_mfma_f32_16x16x32_bf16 v[28:31], a[196:199], a[92:95], v[28:31]
    ds_read_b64_tr_b16 a[182:183], v11 offset:37888
    buffer_load_dwordx4 v4, s[20:23], s30 offen  lds
    v_mfma_f32_16x16x32_bf16 v[32:35], a[200:203], a[88:91], v[32:35]
    ds_read_b64_tr_b16 a[184:185], v12 offset:33792
    v_mfma_f32_16x16x32_bf16 v[36:39], a[200:203], a[92:95], v[36:39]
    ds_read_b64_tr_b16 a[186:187], v12 offset:37888
    v_mfma_f32_16x16x32_bf16 v[40:43], a[204:207], a[88:91], v[40:43]
    ds_read_b64_tr_b16 a[188:189], v13 offset:33792
    v_mfma_f32_16x16x32_bf16 v[44:47], a[204:207], a[92:95], v[44:47]
    ds_read_b64_tr_b16 a[190:191], v13 offset:37888
    s_waitcnt lgkmcnt(8)
    v_mfma_f32_16x16x32_bf16 v[16:19], a[160:163], a[96:99], v[16:19]
    ds_read_b64_tr_b16 a[192:193], v10 offset:40960
    v_mfma_f32_16x16x32_bf16 v[20:23], a[160:163], a[100:103], v[20:23]
    ds_read_b64_tr_b16 a[194:195], v10 offset:45056
    v_mfma_f32_16x16x32_bf16 v[24:27], a[164:167], a[96:99], v[24:27]
    ds_read_b64_tr_b16 a[196:197], v11 offset:40960
    v_mfma_f32_16x16x32_bf16 v[28:31], a[164:167], a[100:103], v[28:31]
    ds_read_b64_tr_b16 a[198:199], v11 offset:45056
    buffer_load_dwordx4 v5, s[20:23], s30 offen offset:1024  lds
    v_mfma_f32_16x16x32_bf16 v[32:35], a[168:171], a[96:99], v[32:35]
    ds_read_b64_tr_b16 a[200:201], v12 offset:40960
    s_add_u32 m0, s28, 57344
    v_mfma_f32_16x16x32_bf16 v[36:39], a[168:171], a[100:103], v[36:39]
    ds_read_b64_tr_b16 a[202:203], v12 offset:45056
    s_add_u32 s30, s9, s37
    v_mfma_f32_16x16x32_bf16 v[40:43], a[172:175], a[96:99], v[40:43]
    ds_read_b64_tr_b16 a[204:205], v13 offset:40960
    buffer_load_dwordx4 a[224:227], v14, s[80:83], s47 offen offset:0 sc1
    v_mfma_f32_16x16x32_bf16 v[44:47], a[172:175], a[100:103], v[44:47]
    ds_read_b64_tr_b16 a[206:207], v13 offset:45056
    s_waitcnt lgkmcnt(8)
    v_mfma_f32_16x16x32_bf16 v[16:19], a[176:179], a[104:107], v[16:19]
    ds_read_b64_tr_b16 a[160:161], v10 offset:41984
    v_mfma_f32_16x16x32_bf16 v[20:23], a[176:179], a[108:111], v[20:23]
    ds_read_b64_tr_b16 a[162:163], v10 offset:46080
    v_mfma_f32_16x16x32_bf16 v[24:27], a[180:183], a[104:107], v[24:27]
    ds_read_b64_tr_b16 a[164:165], v11 offset:41984
    v_mfma_f32_16x16x32_bf16 v[28:31], a[180:183], a[108:111], v[28:31]
    ds_read_b64_tr_b16 a[166:167], v11 offset:46080
    buffer_load_dwordx4 v4, s[20:23], s30 offen  lds
    v_mfma_f32_16x16x32_bf16 v[32:35], a[184:187], a[104:107], v[32:35]
    ds_read_b64_tr_b16 a[168:169], v12 offset:41984
    v_mfma_f32_16x16x32_bf16 v[36:39], a[184:187], a[108:111], v[36:39]
    ds_read_b64_tr_b16 a[170:171], v12 offset:46080
    v_mfma_f32_16x16x32_bf16 v[40:43], a[188:191], a[104:107], v[40:43]
    ds_read_b64_tr_b16 a[172:173], v13 offset:41984
    v_mfma_f32_16x16x32_bf16 v[44:47], a[188:191], a[108:111], v[44:47]
    ds_read_b64_tr_b16 a[174:175], v13 offset:46080
    s_waitcnt lgkmcnt(8)
    v_mfma_f32_16x16x32_bf16 v[16:19], a[192:195], a[112:115], v[16:19]
    ds_read_b64_tr_b16 a[176:177], v10 offset:49152
    v_mfma_f32_16x16x32_bf16 v[20:23], a[192:195], a[116:119], v[20:23]
    ds_read_b64_tr_b16 a[178:179], v10 offset:53248
    v_mfma_f32_16x16x32_bf16 v[24:27], a[196:199], a[112:115], v[24:27]
    ds_read_b64_tr_b16 a[180:181], v11 offset:49152
    v_mfma_f32_16x16x32_bf16 v[28:31], a[196:199], a[116:119], v[28:31]
    ds_read_b64_tr_b16 a[182:183], v11 offset:53248
    buffer_load_dwordx4 v5, s[20:23], s30 offen offset:1024  lds
    v_mfma_f32_16x16x32_bf16 v[32:35], a[200:203], a[112:115], v[32:35]
    ds_read_b64_tr_b16 a[184:185], v12 offset:49152
    s_add_u32 m0, s28, 65536
    v_mfma_f32_16x16x32_bf16 v[36:39], a[200:203], a[116:119], v[36:39]
    ds_read_b64_tr_b16 a[186:187], v12 offset:53248
    s_add_u32 s30, s10, s32
    v_mfma_f32_16x16x32_bf16 v[40:43], a[204:207], a[112:115], v[40:43]
    ds_read_b64_tr_b16 a[188:189], v13 offset:49152
    buffer_load_dwordx4 a[228:231], v14, s[80:83], s47 offen offset:1024 sc1
    v_mfma_f32_16x16x32_bf16 v[44:47], a[204:207], a[116:119], v[44:47]
    ds_read_b64_tr_b16 a[190:191], v13 offset:53248
    s_waitcnt lgkmcnt(8)
    v_mfma_f32_16x16x32_bf16 v[16:19], a[160:163], a[120:123], v[16:19]
    ds_read_b64_tr_b16 a[192:193], v10 offset:50176
    v_mfma_f32_16x16x32_bf16 v[20:23], a[160:163], a[124:127], v[20:23]
    ds_read_b64_tr_b16 a[194:195], v10 offset:54272
    v_mfma_f32_16x16x32_bf16 v[24:27], a[164:167], a[120:123], v[24:27]
    ds_read_b64_tr_b16 a[196:197], v11 offset:50176
    v_mfma_f32_16x16x32_bf16 v[28:31], a[164:167], a[124:127], v[28:31]
    ds_read_b64_tr_b16 a[198:199], v11 offset:54272
    buffer_load_dwordx4 v4, s[20:23], s30 offen  lds
    v_mfma_f32_16x16x32_bf16 v[32:35], a[168:171], a[120:123], v[32:35]
    ds_read_b64_tr_b16 a[200:201], v12 offset:50176
    v_mfma_f32_16x16x32_bf16 v[36:39], a[168:171], a[124:127], v[36:39]
    ds_read_b64_tr_b16 a[202:203], v12 offset:54272
    v_mfma_f32_16x16x32_bf16 v[40:43], a[172:175], a[120:123], v[40:43]
    ds_read_b64_tr_b16 a[204:205], v13 offset:50176
    v_mfma_f32_16x16x32_bf16 v[44:47], a[172:175], a[124:127], v[44:47]
    ds_read_b64_tr_b16 a[206:207], v13 offset:54272
    s_waitcnt vmcnt(14) lgkmcnt(8)
    v_mfma_f32_16x16x32_bf16 v[16:19], a[176:179], a[128:131], v[16:19]
    ds_read_b64_tr_b16 a[160:161], v10 offset:57344
    v_mfma_f32_16x16x32_bf16 v[20:23], a[176:179], a[132:135], v[20:23]
    ds_read_b64_tr_b16 a[162:163], v10 offset:61440
    buffer_load_dword v248, v253, s[72:75], 0 offen sc1
    v_mfma_f32_16x16x32_bf16 v[24:27], a[180:183], a[128:131], v[24:27]
    ds_read_b64_tr_b16 a[164:165], v11 offset:57344
    v_mfma_f32_16x16x32_bf16 v[28:31], a[180:183], a[132:135], v[28:31]
    ds_read_b64_tr_b16 a[166:167], v11 offset:61440
    buffer_load_dwordx4 v5, s[20:23], s30 offen offset:1024  lds
    v_mfma_f32_16x16x32_bf16 v[32:35], a[184:187], a[128:131], v[32:35]
    ds_read_b64_tr_b16 a[168:169], v12 offset:57344
    s_add_u32 m0, s28, 73728
    v_mfma_f32_16x16x32_bf16 v[36:39], a[184:187], a[132:135], v[36:39]
    ds_read_b64_tr_b16 a[170:171], v12 offset:61440
    s_add_u32 s30, s10, s33
    v_mfma_f32_16x16x32_bf16 v[40:43], a[188:191], a[128:131], v[40:43]
    ds_read_b64_tr_b16 a[172:173], v13 offset:57344
    v_mfma_f32_16x16x32_bf16 v[44:47], a[188:191], a[132:135], v[44:47]
    ds_read_b64_tr_b16 a[174:175], v13 offset:61440
    s_waitcnt vmcnt(9) lgkmcnt(8)
    v_mfma_f32_16x16x32_bf16 v[16:19], a[192:195], a[136:139], v[16:19]
    ds_read_b64_tr_b16 a[176:177], v10 offset:58368
    v_mfma_f32_16x16x32_bf16 v[20:23], a[192:195], a[140:143], v[20:23]
    ds_read_b64_tr_b16 a[178:179], v10 offset:62464
    v_mfma_f32_16x16x32_bf16 v[24:27], a[196:199], a[136:139], v[24:27]
    ds_read_b64_tr_b16 a[180:181], v11 offset:58368
    v_mfma_f32_16x16x32_bf16 v[28:31], a[196:199], a[140:143], v[28:31]
    ds_read_b64_tr_b16 a[182:183], v11 offset:62464
    buffer_load_dwordx4 v4, s[20:23], s30 offen  lds
    v_mfma_f32_16x16x32_bf16 v[32:35], a[200:203], a[136:139], v[32:35]
    ds_read_b64_tr_b16 a[184:185], v12 offset:58368
    v_mfma_f32_16x16x32_bf16 v[36:39], a[200:203], a[140:143], v[36:39]
    ds_read_b64_tr_b16 a[186:187], v12 offset:62464
    v_mfma_f32_16x16x32_bf16 v[40:43], a[204:207], a[136:139], v[40:43]
    ds_read_b64_tr_b16 a[188:189], v13 offset:58368
    buffer_load_dwordx4 a[232:235], v14, s[80:83], s47 offen offset:2048 sc1
    v_mfma_f32_16x16x32_bf16 v[44:47], a[204:207], a[140:143], v[44:47]
    ds_read_b64_tr_b16 a[190:191], v13 offset:62464
    s_waitcnt lgkmcnt(8)
    v_mfma_f32_16x16x32_bf16 v[16:19], a[160:163], a[144:147], v[16:19]
    s_barrier
    ds_read_b64_tr_b16 a[192:193], v6 offset:0
    v_mfma_f32_16x16x32_bf16 v[20:23], a[160:163], a[148:151], v[20:23]
    ds_read_b64_tr_b16 a[194:195], v6 offset:4096
    v_mfma_f32_16x16x32_bf16 v[24:27], a[164:167], a[144:147], v[24:27]
    ds_read_b64_tr_b16 a[196:197], v7 offset:0
    v_mfma_f32_16x16x32_bf16 v[28:31], a[164:167], a[148:151], v[28:31]
    ds_read_b64_tr_b16 a[198:199], v7 offset:4096
    buffer_load_dwordx4 v5, s[20:23], s30 offen offset:1024  lds
    v_mfma_f32_16x16x32_bf16 v[32:35], a[168:171], a[144:147], v[32:35]
    ds_read_b64_tr_b16 a[200:201], v8 offset:0
    s_add_u32 m0, s28, 81920
    v_mfma_f32_16x16x32_bf16 v[36:39], a[168:171], a[148:151], v[36:39]
    ds_read_b64_tr_b16 a[202:203], v8 offset:4096
    s_add_u32 s30, s10, s34
    v_mfma_f32_16x16x32_bf16 v[40:43], a[172:175], a[144:147], v[40:43]
    ds_read_b64_tr_b16 a[204:205], v9 offset:0
    v_mfma_f32_16x16x32_bf16 v[44:47], a[172:175], a[148:151], v[44:47]
    ds_read_b64_tr_b16 a[206:207], v9 offset:4096
    s_waitcnt lgkmcnt(8)
    v_mfma_f32_16x16x32_bf16 v[16:19], a[176:179], a[152:155], v[16:19]
    ds_read_b64_tr_b16 a[160:161], v6 offset:1024
    v_mfma_f32_16x16x32_bf16 v[20:23], a[176:179], a[156:159], v[20:23]
    ds_read_b64_tr_b16 a[162:163], v6 offset:5120
    v_mfma_f32_16x16x32_bf16 v[24:27], a[180:183], a[152:155], v[24:27]
    ds_read_b64_tr_b16 a[164:165], v7 offset:1024
    v_mfma_f32_16x16x32_bf16 v[28:31], a[180:183], a[156:159], v[28:31]
    ds_read_b64_tr_b16 a[166:167], v7 offset:5120
    buffer_load_dwordx4 v4, s[20:23], s30 offen  lds
    v_mfma_f32_16x16x32_bf16 v[32:35], a[184:187], a[152:155], v[32:35]
    ds_read_b64_tr_b16 a[168:169], v8 offset:1024
    v_mfma_f32_16x16x32_bf16 v[36:39], a[184:187], a[156:159], v[36:39]
    ds_read_b64_tr_b16 a[170:171], v8 offset:5120
    v_mfma_f32_16x16x32_bf16 v[40:43], a[188:191], a[152:155], v[40:43]
    ds_read_b64_tr_b16 a[172:173], v9 offset:1024
    buffer_load_dwordx4 a[236:239], v14, s[80:83], s47 offen offset:3072 sc1
    v_mfma_f32_16x16x32_bf16 v[44:47], a[188:191], a[156:159], v[44:47]
    ds_read_b64_tr_b16 a[174:175], v9 offset:5120
    s_waitcnt lgkmcnt(8)
    v_mfma_f32_16x16x32_bf16 v[16:19], a[192:195], a[208:211], v[16:19]
    ds_read_b64_tr_b16 a[176:177], v6 offset:8192
    v_mfma_f32_16x16x32_bf16 v[20:23], a[192:195], a[212:215], v[20:23]
    ds_read_b64_tr_b16 a[178:179], v6 offset:12288
    v_mfma_f32_16x16x32_bf16 v[24:27], a[196:199], a[208:211], v[24:27]
    ds_read_b64_tr_b16 a[180:181], v7 offset:8192
    v_mfma_f32_16x16x32_bf16 v[28:31], a[196:199], a[212:215], v[28:31]
    ds_read_b64_tr_b16 a[182:183], v7 offset:12288
    buffer_load_dwordx4 v5, s[20:23], s30 offen offset:1024  lds
    v_mfma_f32_16x16x32_bf16 v[32:35], a[200:203], a[208:211], v[32:35]
    ds_read_b64_tr_b16 a[184:185], v8 offset:8192
    s_add_u32 m0, s28, 90112
    v_mfma_f32_16x16x32_bf16 v[36:39], a[200:203], a[212:215], v[36:39]
    ds_read_b64_tr_b16 a[186:187], v8 offset:12288
    s_add_u32 s30, s11, s32
    v_mfma_f32_16x16x32_bf16 v[40:43], a[204:207], a[208:211], v[40:43]
    ds_read_b64_tr_b16 a[188:189], v9 offset:8192
    v_mfma_f32_16x16x32_bf16 v[44:47], a[204:207], a[212:215], v[44:47]
    ds_read_b64_tr_b16 a[190:191], v9 offset:12288
    s_waitcnt lgkmcnt(8)
    v_mfma_f32_16x16x32_bf16 v[16:19], a[160:163], a[216:219], v[16:19]
    ds_read_b64_tr_b16 a[192:193], v6 offset:9216
    v_mfma_f32_16x16x32_bf16 v[20:23], a[160:163], a[220:223], v[20:23]
    ds_read_b64_tr_b16 a[194:195], v6 offset:13312
    v_mfma_f32_16x16x32_bf16 v[24:27], a[164:167], a[216:219], v[24:27]
    ds_read_b64_tr_b16 a[196:197], v7 offset:9216
    v_mfma_f32_16x16x32_bf16 v[28:31], a[164:167], a[220:223], v[28:31]
    ds_read_b64_tr_b16 a[198:199], v7 offset:13312
    buffer_load_dwordx4 v4, s[20:23], s30 offen  lds
    v_mfma_f32_16x16x32_bf16 v[32:35], a[168:171], a[216:219], v[32:35]
    ds_read_b64_tr_b16 a[200:201], v8 offset:9216
    v_mfma_f32_16x16x32_bf16 v[36:39], a[168:171], a[220:223], v[36:39]
    ds_read_b64_tr_b16 a[202:203], v8 offset:13312
    v_mfma_f32_16x16x32_bf16 v[40:43], a[172:175], a[216:219], v[40:43]
    ds_read_b64_tr_b16 a[204:205], v9 offset:9216
    v_mfma_f32_16x16x32_bf16 v[44:47], a[172:175], a[220:223], v[44:47]
    ds_read_b64_tr_b16 a[206:207], v9 offset:13312
    s_waitcnt vmcnt(8)
    v_cmp_le_u32 vcc, 3, v248
    s_nop 1
    s_cmp_eq_u64 vcc, -1
    s_cbranch_scc0 L_h2_slow
L_h2_back:
    s_waitcnt lgkmcnt(8)
    v_mfma_f32_16x16x32_bf16 v[16:19], a[176:179], a[224:227], v[16:19]
    ds_read_b64_tr_b16 a[160:161], v6 offset:16384
    v_mfma_f32_16x16x32_bf16 v[20:23], a[176:179], a[228:231], v[20:23]
    ds_read_b64_tr_b16 a[162:163], v6 offset:20480
    s_add_u32 s47, s45, 12288
    buffer_load_dwordx4 v[96:99], v14, s[80:83], s47 offen offset:0 sc1
    v_mfma_f32_16x16x32_bf16 v[24:27], a[180:183], a[224:227], v[24:27]
    ds_read_b64_tr_b16 a[164:165], v7 offset:16384
    v_mfma_f32_16x16x32_bf16 v[28:31], a[180:183], a[228:231], v[28:31]
    ds_read_b64_tr_b16 a[166:167], v7 offset:20480
    buffer_load_dwordx4 v5, s[20:23], s30 offen offset:1024  lds
    v_mfma_f32_16x16x32_bf16 v[32:35], a[184:187], a[224:227], v[32:35]
    ds_read_b64_tr_b16 a[168:169], v8 offset:16384
    s_add_u32 m0, s28, 98304
    v_mfma_f32_16x16x32_bf16 v[36:39], a[184:187], a[228:231], v[36:39]
    ds_read_b64_tr_b16 a[170:171], v8 offset:20480
    s_add_u32 s30, s11, s33
    v_mfma_f32_16x16x32_bf16 v[40:43], a[188:191], a[224:227], v[40:43]
    ds_read_b64_tr_b16 a[172:173], v9 offset:16384
    v_mfma_f32_16x16x32_bf16 v[44:47], a[188:191], a[228:231], v[44:47]
    ds_read_b64_tr_b16 a[174:175], v9 offset:20480
    s_waitcnt vmcnt(4) lgkmcnt(8)
    v_mfma_f32_16x16x32_bf16 v[16:19], a[192:195], a[232:235], v[16:19]
    ds_read_b64_tr_b16 a[176:177], v6 offset:17408
    v_mfma_f32_16x16x32_bf16 v[20:23], a[192:195], a[236:239], v[20:23]
    ds_read_b64_tr_b16 a[178:179], v6 offset:21504
    v_mfma_f32_16x16x32_bf16 v[24:27], a[196:199], a[232:235], v[24:27]
    ds_read_b64_tr_b16 a[180:181], v7 offset:17408
    v_mfma_f32_16x16x32_bf16 v[28:31], a[196:199], a[236:239], v[28:31]
    ds_read_b64_tr_b16 a[182:183], v7 offset:21504
    buffer_load_dwordx4 v4, s[20:23], s30 offen  lds
    v_mfma_f32_16x16x32_bf16 v[32:35], a[200:203], a[232:235], v[32:35]
    ds_read_b64_tr_b16 a[184:185], v8 offset:17408
    v_mfma_f32_16x16x32_bf16 v[36:39], a[200:203], a[236:239], v[36:39]
    ds_read_b64_tr_b16 a[186:187], v8 offset:21504
    v_mfma_f32_16x16x32_bf16 v[40:43], a[204:207], a[232:235], v[40:43]
    ds_read_b64_tr_b16 a[188:189], v9 offset:17408
    buffer_load_dwordx4 v[100:103], v14, s[80:83], s47 offen offset:1024 sc1
    v_mfma_f32_16x16x32_bf16 v[44:47], a[204:207], a[236:239], v[44:47]
    ds_read_b64_tr_b16 a[190:191], v9 offset:21504
    s_waitcnt lgkmcnt(8)
    v_mfma_f32_16x16x32_bf16 v[48:51], a[160:163], a[0:3], 0
    ds_read_b64_tr_b16 a[192:193], v6 offset:24576
    v_mfma_f32_16x16x32_bf16 v[52:55], a[160:163], a[4:7], 0
    ds_read_b64_tr_b16 a[194:195], v6 offset:28672
    v_mfma_f32_16x16x32_bf16 v[56:59], a[164:167], a[0:3], 0
    ds_read_b64_tr_b16 a[196:197], v7 offset:24576
    v_mfma_f32_16x16x32_bf16 v[60:63], a[164:167], a[4:7], 0
    ds_read_b64_tr_b16 a[198:199], v7 offset:28672
    buffer_load_dwordx4 v5, s[20:23], s30 offen offset:1024  lds
    v_mfma_f32_16x16x32_bf16 v[64:67], a[168:171], a[0:3], 0
    ds_read_b64_tr_b16 a[200:201], v8 offset:24576
    s_add_u32 m0, s28, 106496
    v_mfma_f32_16x16x32_bf16 v[68:71], a[168:171], a[4:7], 0
    ds_read_b64_tr_b16 a[202:203], v8 offset:28672
    s_add_u32 s30, s11, s34
    v_mfma_f32_16x16x32_bf16 v[72:75], a[172:175], a[0:3], 0
    ds_read_b64_tr_b16 a[204:205], v9 offset:24576
    v_mfma_f32_16x16x32_bf16 v[76:79], a[172:175], a[4:7], 0
    ds_read_b64_tr_b16 a[206:207], v9 offset:28672
    s_waitcnt lgkmcnt(8)
    v_mfma_f32_16x16x32_bf16 v[48:51], a[176:179], a[8:11], v[48:51]
    ds_read_b64_tr_b16 a[160:161], v6 offset:25600
    v_mfma_f32_16x16x32_bf16 v[52:55], a[176:179], a[12:15], v[52:55]
    ds_read_b64_tr_b16 a[162:163], v6 offset:29696
    buffer_load_dwordx4 v[104:107], v14, s[80:83], s47 offen offset:2048 sc1
    v_mfma_f32_16x16x32_bf16 v[56:59], a[180:183], a[8:11], v[56:59]
    ds_read_b64_tr_b16 a[164:165], v7 offset:25600
    v_mfma_f32_16x16x32_bf16 v[60:63], a[180:183], a[12:15], v[60:63]
    ds_read_b64_tr_b16 a[166:167], v7 offset:29696
    buffer_load_dwordx4 v4, s[20:23], s30 offen  lds
    v_mfma_f32_16x16x32_bf16 v[64:67], a[184:187], a[8:11], v[64:67]
    ds_read_b64_tr_b16 a[168:169], v8 offset:25600
    v_mfma_f32_16x16x32_bf16 v[68:71], a[184:187], a[12:15], v[68:71]
    ds_read_b64_tr_b16 a[170:171], v8 offset:29696
    v_mfma_f32_16x16x32_bf16 v[72:75], a[188:191], a[8:11], v[72:75]
    ds_read_b64_tr_b16 a[172:173], v9 offset:25600
    v_mfma_f32_16x16x32_bf16 v[76:79], a[188:191], a[12:15], v[76:79]
    ds_read_b64_tr_b16 a[174:175], v9 offset:29696
    s_waitcnt lgkmcnt(8)
    v_mfma_f32_16x16x32_bf16 v[48:51], a[192:195], a[16:19], v[48:51]
    s_barrier
    ds_read_b64_tr_b16 a[176:177], v6 offset:32768
    v_mfma_f32_16x16x32_bf16 v[52:55], a[192:195], a[20:23], v[52:55]
    ds_read_b64_tr_b16 a[178:179], v6 offset:36864
    v_mov_b32 v242, 4
    v_mfma_f32_16x16x32_bf16 v[56:59], a[196:199], a[16:19], v[56:59]
    ds_read_b64_tr_b16 a[180:181], v7 offset:32768
    s_mov_b64 exec, s[66:67]
    buffer_store_dword v242, off, s[72:75], s56 sc1
    s_mov_b64 exec, -1
    v_mfma_f32_16x16x32_bf16 v[60:63], a[196:199], a[20:23], v[60:63]
    ds_read_b64_tr_b16 a[182:183], v7 offset:36864
    buffer_load_dwordx4 v5, s[20:23], s30 offen offset:1024  lds
    v_mfma_f32_16x16x32_bf16 v[64:67], a[200:203], a[16:19], v[64:67]
    ds_read_b64_tr_b16 a[184:185], v8 offset:32768
    s_add_u32 m0, s28, 114688
    v_mfma_f32_16x16x32_bf16 v[68:71], a[200:203], a[20:23], v[68:71]
    ds_read_b64_tr_b16 a[186:187], v8 offset:36864
    s_add_u32 s30, s7, s35
    v_mfma_f32_16x16x32_bf16 v[72:75], a[204:207], a[16:19], v[72:75]
    ds_read_b64_tr_b16 a[188:189], v9 offset:32768
    buffer_load_dwordx4 v[108:111], v14, s[80:83], s47 offen offset:3072 sc1
    v_mfma_f32_16x16x32_bf16 v[76:79], a[204:207], a[20:23], v[76:79]
    ds_read_b64_tr_b16 a[190:191], v9 offset:36864
    s_waitcnt lgkmcnt(8)
    v_mfma_f32_16x16x32_bf16 v[48:51], a[160:163], a[24:27], v[48:51]
    ds_read_b64_tr_b16 a[192:193], v6 offset:33792
    v_mfma_f32_16x16x32_bf16 v[52:55], a[160:163], a[28:31], v[52:55]
    ds_read_b64_tr_b16 a[194:195], v6 offset:37888
    s_add_u32 s47, s46, 12288
    v_mfma_f32_16x16x32_bf16 v[56:59], a[164:167], a[24:27], v[56:59]
    ds_read_b64_tr_b16 a[196:197], v7 offset:33792
    v_mfma_f32_16x16x32_bf16 v[60:63], a[164:167], a[28:31], v[60:63]
    ds_read_b64_tr_b16 a[198:199], v7 offset:37888
    buffer_load_dwordx4 v4, s[20:23], s30 offen  lds
    v_mfma_f32_16x16x32_bf16 v[64:67], a[168:171], a[24:27], v[64:67]
    ds_read_b64_tr_b16 a[200:201], v8 offset:33792
    v_mfma_f32_16x16x32_bf16 v[68:71], a[168:171], a[28:31], v[68:71]
    ds_read_b64_tr_b16 a[202:203], v8 offset:37888
    v_mfma_f32_16x16x32_bf16 v[72:75], a[172:175], a[24:27], v[72:75]
    ds_read_b64_tr_b16 a[204:205], v9 offset:33792
    v_mfma_f32_16x16x32_bf16 v[76:79], a[172:175], a[28:31], v[76:79]
    ds_read_b64_tr_b16 a[206:207], v9 offset:37888
    s_waitcnt lgkmcnt(8)
    v_mfma_f32_16x16x32_bf16 v[48:51], a[176:179], a[32:35], v[48:51]
    ds_read_b64_tr_b16 a[160:161], v6 offset:40960
    v_mfma_f32_16x16x32_bf16 v[52:55], a[176:179], a[36:39], v[52:55]
    ds_read_b64_tr_b16 a[162:163], v6 offset:45056
    buffer_load_dwordx4 v[144:147], v14, s[80:83], s47 offen offset:0 sc1
    v_mfma_f32_16x16x32_bf16 v[56:59], a[180:183], a[32:35], v[56:59]
    ds_read_b64_tr_b16 a[164:165], v7 offset:40960
    v_mfma_f32_16x16x32_bf16 v[60:63], a[180:183], a[36:39], v[60:63]
    ds_read_b64_tr_b16 a[166:167], v7 offset:45056
    buffer_load_dwordx4 v5, s[20:23], s30 offen offset:1024  lds
    v_mfma_f32_16x16x32_bf16 v[64:67], a[184:187], a[32:35], v[64:67]
    ds_read_b64_tr_b16 a[168:169], v8 offset:40960
    s_add_u32 m0, s28, 122880
    v_mfma_f32_16x16x32_bf16 v[68:71], a[184:187], a[36:39], v[68:71]
    ds_read_b64_tr_b16 a[170:171], v8 offset:45056
    s_add_u32 s30, s8, s35
    v_mfma_f32_16x16x32_bf16 v[72:75], a[188:191], a[32:35], v[72:75]
    ds_read_b64_tr_b16 a[172:173], v9 offset:40960
    v_mfma_f32_16x16x32_bf16 v[76:79], a[188:191], a[36:39], v[76:79]
    ds_read_b64_tr_b16 a[174:175], v9 offset:45056
    s_waitcnt lgkmcnt(8)
    v_mfma_f32_16x16x32_bf16 v[48:51], a[192:195], a[40:43], v[48:51]
    ds_read_b64_tr_b16 a[176:177], v6 offset:41984
    v_mfma_f32_16x16x32_bf16 v[52:55], a[192:195], a[44:47], v[52:55]
    ds_read_b64_tr_b16 a[178:179], v6 offset:46080
    v_mfma_f32_16x16x32_bf16 v[56:59], a[196:199], a[40:43], v[56:59]
    ds_read_b64_tr_b16 a[180:181], v7 offset:41984
    v_mfma_f32_16x16x32_bf16 v[60:63], a[196:199], a[44:47], v[60:63]
    ds_read_b64_tr_b16 a[182:183], v7 offset:46080
    buffer_load_dwordx4 v4, s[20:23], s30 offen  lds
    v_mfma_f32_16x16x32_bf16 v[64:67], a[200:203], a[40:43], v[64:67]
    ds_read_b64_tr_b16 a[184:185], v8 offset:41984
    v_mfma_f32_16x16x32_bf16 v[68:71], a[200:203], a[44:47], v[68:71]
    ds_read_b64_tr_b16 a[186:187], v8 offset:46080
    v_mfma_f32_16x16x32_bf16 v[72:75], a[204:207], a[40:43], v[72:75]
    ds_read_b64_tr_b16 a[188:189], v9 offset:41984
    buffer_load_dwordx4 v[148:151], v14, s[80:83], s47 offen offset:1024 sc1
    v_mfma_f32_16x16x32_bf16 v[76:79], a[204:207], a[44:47], v[76:79]
    ds_read_b64_tr_b16 a[190:191], v9 offset:46080
    s_waitcnt lgkmcnt(8)
    v_mfma_f32_16x16x32_bf16 v[48:51], a[160:163], a[48:51], v[48:51]
    ds_read_b64_tr_b16 a[192:193], v6 offset:49152
    v_mfma_f32_16x16x32_bf16 v[52:55], a[160:163], a[52:55], v[52:55]
    ds_read_b64_tr_b16 a[194:195], v6 offset:53248
    v_mfma_f32_16x16x32_bf16 v[56:59], a[164:167], a[48:51], v[56:59]
    ds_read_b64_tr_b16 a[196:197], v7 offset:49152
    v_mfma_f32_16x16x32_bf16 v[60:63], a[164:167], a[52:55], v[60:63]
    ds_read_b64_tr_b16 a[198:199], v7 offset:53248
    buffer_load_dwordx4 v5, s[20:23], s30 offen offset:1024  lds
    v_mfma_f32_16x16x32_bf16 v[64:67], a[168:171], a[48:51], v[64:67]
    ds_read_b64_tr_b16 a[200:201], v8 offset:49152
    s_add_u32 m0, s28, 0
    v_mfma_f32_16x16x32_bf16 v[68:71], a[168:171], a[52:55], v[68:71]
    ds_read_b64_tr_b16 a[202:203], v8 offset:53248
    s_add_u32 s30, s7, s36
    v_mfma_f32_16x16x32_bf16 v[72:75], a[172:175], a[48:51], v[72:75]
    ds_read_b64_tr_b16 a[204:205], v9 offset:49152
    v_mfma_f32_16x16x32_bf16 v[76:79], a[172:175], a[52:55], v[76:79]
    ds_read_b64_tr_b16 a[206:207], v9 offset:53248
    s_waitcnt lgkmcnt(8)
    v_mfma_f32_16x16x32_bf16 v[48:51], a[176:179], a[56:59], v[48:51]
    ds_read_b64_tr_b16 a[160:161], v6 offset:50176
    v_mfma_f32_16x16x32_bf16 v[52:55], a[176:179], a[60:63], v[52:55]
    ds_read_b64_tr_b16 a[162:163], v6 offset:54272
L_pm6:
    s_cbranch_execz L_pmb1
    buffer_load_dwordx4 v[152:155], v14, s[80:83], s47 offen offset:2048 sc1
    v_mfma_f32_16x16x32_bf16 v[56:59], a[180:183], a[56:59], v[56:59]
    ds_read_b64_tr_b16 a[164:165], v7 offset:50176
    v_mfma_f32_16x16x32_bf16 v[60:63], a[180:183], a[60:63], v[60:63]
    ds_read_b64_tr_b16 a[166:167], v7 offset:54272
    buffer_load_dwordx4 v4, s[20:23], s30 offen  lds
    v_mfma_f32_16x16x32_bf16 v[64:67], a[184:187], a[56:59], v[64:67]
    ds_read_b64_tr_b16 a[168:169], v8 offset:50176
    v_mfma_f32_16x16x32_bf16 v[68:71], a[184:187], a[60:63], v[68:71]
    ds_read_b64_tr_b16 a[170:171], v8 offset:54272
    v_mfma_f32_16x16x32_bf16 v[72:75], a[188:191], a[56:59], v[72:75]
    ds_read_b64_tr_b16 a[172:173], v9 offset:50176
    v_mfma_f32_16x16x32_bf16 v[76:79], a[188:191], a[60:63], v[76:79]
    ds_read_b64_tr_b16 a[174:175], v9 offset:54272
    s_waitcnt lgkmcnt(8)
    v_mfma_f32_16x16x32_bf16 v[48:51], a[192:195], a[64:67], v[48:51]
    ds_read_b64_tr_b16 a[176:177], v6 offset:57344
    v_mfma_f32_16x16x32_bf16 v[52:55], a[192:195], a[68:71], v[52:55]
    ds_read_b64_tr_b16 a[178:179], v6 offset:61440
    buffer_load_dword v248, v253, s[72:75], 0 offen sc1
    v_mfma_f32_16x16x32_bf16 v[56:59], a[196:199], a[64:67], v[56:59]
    ds_read_b64_tr_b16 a[180:181], v7 offset:57344
    v_mfma_f32_16x16x32_bf16 v[60:63], a[196:199], a[68:71], v[60:63]
    ds_read_b64_tr_b16 a[182:183], v7 offset:61440
    buffer_load_dwordx4 v5, s[20:23], s30 offen offset:1024  lds
    v_mfma_f32_16x16x32_bf16 v[64:67], a[200:203], a[64:67], v[64:67]
    ds_read_b64_tr_b16 a[184:185], v8 offset:57344
    s_add_u32 m0, s28, 8192
    v_mfma_f32_16x16x32_bf16 v[68:71], a[200:203], a[68:71], v[68:71]
    ds_read_b64_tr_b16 a[186:187], v8 offset:61440
    s_add_u32 s30, s8, s36
    v_mfma_f32_16x16x32_bf16 v[72:75], a[204:207], a[64:67], v[72:75]
    ds_read_b64_tr_b16 a[188:189], v9 offset:57344
    v_mfma_f32_16x16x32_bf16 v[76:79], a[204:207], a[68:71], v[76:79]
    ds_read_b64_tr_b16 a[190:191], v9 offset:61440
    s_waitcnt lgkmcnt(8)
    v_mfma_f32_16x16x32_bf16 v[48:51], a[160:163], a[72:75], v[48:51]
    ds_read_b64_tr_b16 a[192:193], v6 offset:58368
    v_mfma_f32_16x16x32_bf16 v[52:55], a[160:163], a[76:79], v[52:55]
    ds_read_b64_tr_b16 a[194:195], v6 offset:62464
    v_mfma_f32_16x16x32_bf16 v[56:59], a[164:167], a[72:75], v[56:59]
    ds_read_b64_tr_b16 a[196:197], v7 offset:58368
    v_mfma_f32_16x16x32_bf16 v[60:63], a[164:167], a[76:79], v[60:63]
    ds_read_b64_tr_b16 a[198:199], v7 offset:62464
    buffer_load_dwordx4 v4, s[20:23], s30 offen  lds
    v_mfma_f32_16x16x32_bf16 v[64:67], a[168:171], a[72:75], v[64:67]
    ds_read_b64_tr_b16 a[200:201], v8 offset:58368
    v_mfma_f32_16x16x32_bf16 v[68:71], a[168:171], a[76:79], v[68:71]
    ds_read_b64_tr_b16 a[202:203], v8 offset:62464
    v_mfma_f32_16x16x32_bf16 v[72:75], a[172:175], a[72:75], v[72:75]
    ds_read_b64_tr_b16 a[204:205], v9 offset:58368
    buffer_load_dwordx4 v[156:159], v14, s[80:83], s47 offen offset:3072 sc1
    v_mfma_f32_16x16x32_bf16 v[76:79], a[172:175], a[76:79], v[76:79]
    ds_read_b64_tr_b16 a[206:207], v9 offset:62464
    s_waitcnt vmcnt(19) lgkmcnt(8)
    v_mfma_f32_16x16x32_bf16 v[48:51], a[176:179], a[80:83], v[48:51]
    s_barrier
    ds_read_b64_tr_b16 a[160:161], v10 offset:0
    v_mfma_f32_16x16x32_bf16 v[52:55], a[176:179], a[84:87], v[52:55]
    ds_read_b64_tr_b16 a[162:163], v10 offset:4096
    s_add_u32 s47, s45, 16384
    v_mfma_f32_16x16x32_bf16 v[56:59], a[180:183], a[80:83], v[56:59]
    ds_read_b64_tr_b16 a[164:165], v11 offset:0
    v_mfma_f32_16x16x32_bf16 v[60:63], a[180:183], a[84:87], v[60:63]
    ds_read_b64_tr_b16 a[166:167], v11 offset:4096
    buffer_load_dwordx4 v5, s[20:23], s30 offen offset:1024  lds
    v_mfma_f32_16x16x32_bf16 v[64:67], a[184:187], a[80:83], v[64:67]
    ds_read_b64_tr_b16 a[168:169], v12 offset:0
    s_add_u32 m0, s28, 16384
    v_mfma_f32_16x16x32_bf16 v[68:71], a[184:187], a[84:87], v[68:71]
    ds_read_b64_tr_b16 a[170:171], v12 offset:4096
    s_add_u32 s30, s7, s37
    v_mfma_f32_16x16x32_bf16 v[72:75], a[188:191], a[80:83], v[72:75]
    ds_read_b64_tr_b16 a[172:173], v13 offset:0
    v_mfma_f32_16x16x32_bf16 v[76:79], a[188:191], a[84:87], v[76:79]
    ds_read_b64_tr_b16 a[174:175], v13 offset:4096
    s_waitcnt lgkmcnt(8)
    v_mfma_f32_16x16x32_bf16 v[48:51], a[192:195], a[88:91], v[48:51]
    ds_read_b64_tr_b16 a[176:177], v10 offset:1024
    v_mfma_f32_16x16x32_bf16 v[52:55], a[192:195], a[92:95], v[52:55]
    ds_read_b64_tr_b16 a[178:179], v10 offset:5120
    buffer_load_dwordx4 v[112:115], v14, s[80:83], s47 offen offset:0 sc1
    v_mfma_f32_16x16x32_bf16 v[56:59], a[196:199], a[88:91], v[56:59]
    ds_read_b64_tr_b16 a[180:181], v11 offset:1024
    v_mfma_f32_16x16x32_bf16 v[60:63], a[196:199], a[92:95], v[60:63]
    ds_read_b64_tr_b16 a[182:183], v11 offset:5120
    buffer_load_dwordx4 v4, s[20:23], s30 offen  lds
    v_mfma_f32_16x16x32_bf16 v[64:67], a[200:203], a[88:91], v[64:67]
    ds_read_b64_tr_b16 a[184:185], v12 offset:1024
    v_mfma_f32_16x16x32_bf16 v[68:71], a[200:203], a[92:95], v[68:71]
    ds_read_b64_tr_b16 a[186:187], v12 offset:5120
    v_mfma_f32_16x16x32_bf16 v[72:75], a[204:207], a[88:91], v[72:75]
    ds_read_b64_tr_b16 a[188:189], v13 offset:1024
    v_mfma_f32_16x16x32_bf16 v[76:79], a[204:207], a[92:95], v[76:79]
    ds_read_b64_tr_b16 a[190:191], v13 offset:5120
    s_waitcnt lgkmcnt(8)
    v_mfma_f32_16x16x32_bf16 v[48:51], a[160:163], a[96:99], v[48:51]
    ds_read_b64_tr_b16 a[192:193], v10 offset:8192
    v_mfma_f32_16x16x32_bf16 v[52:55], a[160:163], a[100:103], v[52:55]
    ds_read_b64_tr_b16 a[194:195], v10 offset:12288
    v_mfma_f32_16x16x32_bf16 v[56:59], a[164:167], a[96:99], v[56:59]
    ds_read_b64_tr_b16 a[196:197], v11 offset:8192
    v_mfma_f32_16x16x32_bf16 v[60:63], a[164:167], a[100:103], v[60:63]
    ds_read_b64_tr_b16 a[198:199], v11 offset:12288
    buffer_load_dwordx4 v5, s[20:23], s30 offen offset:1024  lds
    v_mfma_f32_16x16x32_bf16 v[64:67], a[168:171], a[96:99], v[64:67]
    ds_read_b64_tr_b16 a[200:201], v12 offset:8192
    s_add_u32 m0, s28, 24576
    v_mfma_f32_16x16x32_bf16 v[68:71], a[168:171], a[100:103], v[68:71]
    ds_read_b64_tr_b16 a[202:203], v12 offset:12288
    s_add_u32 s30, s8, s37
    v_mfma_f32_16x16x32_bf16 v[72:75], a[172:175], a[96:99], v[72:75]
    ds_read_b64_tr_b16 a[204:205], v13 offset:8192
    buffer_load_dwordx4 v[116:119], v14, s[80:83], s47 offen offset:1024 sc1
    v_mfma_f32_16x16x32_bf16 v[76:79], a[172:175], a[100:103], v[76:79]
    ds_read_b64_tr_b16 a[206:207], v13 offset:12288
    s_waitcnt lgkmcnt(8)
    v_mfma_f32_16x16x32_bf16 v[48:51], a[176:179], a[104:107], v[48:51]
    ds_read_b64_tr_b16 a[160:161], v10 offset:9216
    v_mfma_f32_16x16x32_bf16 v[52:55], a[176:179], a[108:111], v[52:55]
    ds_read_b64_tr_b16 a[162:163], v10 offset:13312
    v_mfma_f32_16x16x32_bf16 v[56:59], a[180:183], a[104:107], v[56:59]
    ds_read_b64_tr_b16 a[164:165], v11 offset:9216
    v_mfma_f32_16x16x32_bf16 v[60:63], a[180:183], a[108:111], v[60:63]
    ds_read_b64_tr_b16 a[166:167], v11 offset:13312
    buffer_load_dwordx4 v4, s[20:23], s30 offen  lds
    v_mfma_f32_16x16x32_bf16 v[64:67], a[184:187], a[104:107], v[64:67]
    ds_read_b64_tr_b16 a[168:169], v12 offset:9216
    v_mfma_f32_16x16x32_bf16 v[68:71], a[184:187], a[108:111], v[68:71]
    ds_read_b64_tr_b16 a[170:171], v12 offset:13312
    v_mfma_f32_16x16x32_bf16 v[72:75], a[188:191], a[104:107], v[72:75]
    ds_read_b64_tr_b16 a[172:173], v13 offset:9216
    v_mfma_f32_16x16x32_bf16 v[76:79], a[188:191], a[108:111], v[76:79]
    ds_read_b64_tr_b16 a[174:175], v13 offset:13312
    s_waitcnt lgkmcnt(8)
    v_mfma_f32_16x16x32_bf16 v[48:51], a[192:195], a[112:115], v[48:51]
    ds_read_b64_tr_b16 a[176:177], v10 offset:16384
    v_mfma_f32_16x16x32_bf16 v[52:55], a[192:195], a[116:119], v[52:55]
    ds_read_b64_tr_b16 a[178:179], v10 offset:20480
    buffer_load_dwordx4 v[120:123], v14, s[80:83], s47 offen offset:2048 sc1
    v_mfma_f32_16x16x32_bf16 v[56:59], a[196:199], a[112:115], v[56:59]
    ds_read_b64_tr_b16 a[180:181], v11 offset:16384
    v_mfma_f32_16x16x32_bf16 v[60:63], a[196:199], a[116:119], v[60:63]
    ds_read_b64_tr_b16 a[182:183], v11 offset:20480
    buffer_load_dwordx4 v5, s[20:23], s30 offen offset:1024  lds
    v_mfma_f32_16x16x32_bf16 v[64:67], a[200:203], a[112:115], v[64:67]
    ds_read_b64_tr_b16 a[184:185], v12 offset:16384
    s_add_u32 m0, s28, 32768
    v_mfma_f32_16x16x32_bf16 v[68:71], a[200:203], a[116:119], v[68:71]
    ds_read_b64_tr_b16 a[186:187], v12 offset:20480
    s_add_u32 s30, s10, s35
    v_mfma_f32_16x16x32_bf16 v[72:75], a[204:207], a[112:115], v[72:75]
    ds_read_b64_tr_b16 a[188:189], v13 offset:16384
    v_mfma_f32_16x16x32_bf16 v[76:79], a[204:207], a[116:119], v[76:79]
    ds_read_b64_tr_b16 a[190:191], v13 offset:20480
    s_waitcnt lgkmcnt(8)
    v_mfma_f32_16x16x32_bf16 v[48:51], a[160:163], a[120:123], v[48:51]
    ds_read_b64_tr_b16 a[192:193], v10 offset:17408
    v_mfma_f32_16x16x32_bf16 v[52:55], a[160:163], a[124:127], v[52:55]
    ds_read_b64_tr_b16 a[194:195], v10 offset:21504
    v_mfma_f32_16x16x32_bf16 v[56:59], a[164:167], a[120:123], v[56:59]
    ds_read_b64_tr_b16 a[196:197], v11 offset:17408
    v_mfma_f32_16x16x32_bf16 v[60:63], a[164:167], a[124:127], v[60:63]
    ds_read_b64_tr_b16 a[198:199], v11 offset:21504
    buffer_load_dwordx4 v4, s[20:23], s30 offen  lds
    v_mfma_f32_16x16x32_bf16 v[64:67], a[168:171], a[120:123], v[64:67]
    ds_read_b64_tr_b16 a[200:201], v12 offset:17408
    v_mfma_f32_16x16x32_bf16 v[68:71], a[168:171], a[124:127], v[68:71]
    ds_read_b64_tr_b16 a[202:203], v12 offset:21504
    v_mfma_f32_16x16x32_bf16 v[72:75], a[172:175], a[120:123], v[72:75]
    ds_read_b64_tr_b16 a[204:205], v13 offset:17408
    buffer_load_dwordx4 v[124:127], v14, s[80:83], s47 offen offset:3072 sc1
    v_mfma_f32_16x16x32_bf16 v[76:79], a[172:175], a[124:127], v[76:79]
    ds_read_b64_tr_b16 a[206:207], v13 offset:21504
    s_waitcnt vmcnt(13)
    v_cmp_le_u32 vcc, 4, v248
    s_nop 1
    s_cmp_eq_u64 vcc, -1
    s_cbranch_scc0 L_h3_slow
L_h3_back:
    s_waitcnt lgkmcnt(8)
    v_mfma_f32_16x16x32_bf16 v[48:51], a[176:179], a[128:131], v[48:51]
    ds_read_b64_tr_b16 a[160:161], v10 offset:24576
    v_mfma_f32_16x16x32_bf16 v[52:55], a[176:179], a[132:135], v[52:55]
    ds_read_b64_tr_b16 a[162:163], v10 offset:28672
    s_add_u32 s47, s46, 16384
    v_mfma_f32_16x16x32_bf16 v[56:59], a[180:183], a[128:131], v[56:59]
    ds_read_b64_tr_b16 a[164:165], v11 offset:24576
    v_mfma_f32_16x16x32_bf16 v[60:63], a[180:183], a[132:135], v[60:63]
    ds_read_b64_tr_b16 a[166:167], v11 offset:28672
    buffer_load_dwordx4 v5, s[20:23], s30 offen offset:1024  lds
    v_mfma_f32_16x16x32_bf16 v[64:67], a[184:187], a[128:131], v[64:67]
    ds_read_b64_tr_b16 a[168:169], v12 offset:24576
    s_add_u32 m0, s28, 40960
    v_mfma_f32_16x16x32_bf16 v[68:71], a[184:187], a[132:135], v[68:71]
    ds_read_b64_tr_b16 a[170:171], v12 offset:28672
    s_add_u32 s30, s11, s35
    v_mfma_f32_16x16x32_bf16 v[72:75], a[188:191], a[128:131], v[72:75]
    ds_read_b64_tr_b16 a[172:173], v13 offset:24576
    v_mfma_f32_16x16x32_bf16 v[76:79], a[188:191], a[132:135], v[76:79]
    ds_read_b64_tr_b16 a[174:175], v13 offset:28672
    s_waitcnt lgkmcnt(8)
    v_mfma_f32_16x16x32_bf16 v[48:51], a[192:195], a[136:139], v[48:51]
    ds_read_b64_tr_b16 a[176:177], v10 offset:25600
    v_mfma_f32_16x16x32_bf16 v[52:55], a[192:195], a[140:143], v[52:55]
    ds_read_b64_tr_b16 a[178:179], v10 offset:29696
    buffer_load_dwordx4 v[160:163], v14, s[80:83], s47 offen offset:0 sc1
    v_mfma_f32_16x16x32_bf16 v[56:59], a[196:199], a[136:139], v[56:59]
    ds_read_b64_tr_b16 a[180:181], v11 offset:25600
    v_mfma_f32_16x16x32_bf16 v[60:63], a[196:199], a[140:143], v[60:63]
    ds_read_b64_tr_b16 a[182:183], v11 offset:29696
    buffer_load_dwordx4 v4, s[20:23], s30 offen  lds
    v_mfma_f32_16x16x32_bf16 v[64:67], a[200:203], a[136:139], v[64:67]
    ds_read_b64_tr_b16 a[184:185], v12 offset:25600
    v_mfma_f32_16x16x32_bf16 v[68:71], a[200:203], a[140:143], v[68:71]
    ds_read_b64_tr_b16 a[186:187], v12 offset:29696
    v_mfma_f32_16x16x32_bf16 v[72:75], a[204:207], a[136:139], v[72:75]
    ds_read_b64_tr_b16 a[188:189], v13 offset:25600
    v_mfma_f32_16x16x32_bf16 v[76:79], a[204:207], a[140:143], v[76:79]
    ds_read_b64_tr_b16 a[190:191], v13 offset:29696
    s_waitcnt lgkmcnt(8)
    v_mfma_f32_16x16x32_bf16 v[48:51], a[160:163], a[144:147], v[48:51]
    s_barrier
    ds_read_b64_tr_b16 a[192:193], v10 offset:32768
    v_mfma_f32_16x16x32_bf16 v[52:55], a[160:163], a[148:151], v[52:55]
    ds_read_b64_tr_b16 a[194:195], v10 offset:36864
    v_mfma_f32_16x16x32_bf16 v[56:59], a[164:167], a[144:147], v[56:59]
    ds_read_b64_tr_b16 a[196:197], v11 offset:32768
    v_mfma_f32_16x16x32_bf16 v[60:63], a[164:167], a[148:151], v[60:63]
    ds_read_b64_tr_b16 a[198:199], v11 offset:36864
    buffer_load_dwordx4 v5, s[20:23], s30 offen offset:1024  lds
    v_mfma_f32_16x16x32_bf16 v[64:67], a[168:171], a[144:147], v[64:67]
    ds_read_b64_tr_b16 a[200:201], v12 offset:32768
    s_add_u32 m0, s28, 49152
    v_mfma_f32_16x16x32_bf16 v[68:71], a[168:171], a[148:151], v[68:71]
    ds_read_b64_tr_b16 a[202:203], v12 offset:36864
    s_add_u32 s30, s10, s36
    v_mfma_f32_16x16x32_bf16 v[72:75], a[172:175], a[144:147], v[72:75]
    ds_read_b64_tr_b16 a[204:205], v13 offset:32768
    buffer_load_dwordx4 v[164:167], v14, s[80:83], s47 offen offset:1024 sc1
    v_mfma_f32_16x16x32_bf16 v[76:79], a[172:175], a[148:151], v[76:79]
    ds_read_b64_tr_b16 a[206:207], v13 offset:36864
    s_waitcnt lgkmcnt(8)
    v_mfma_f32_16x16x32_bf16 v[48:51], a[176:179], a[152:155], v[48:51]
    ds_read_b64_tr_b16 a[160:161], v10 offset:33792
    v_mfma_f32_16x16x32_bf16 v[52:55], a[176:179], a[156:159], v[52:55]
    ds_read_b64_tr_b16 a[162:163], v10 offset:37888
    v_mfma_f32_16x16x32_bf16 v[56:59], a[180:183], a[152:155], v[56:59]
    ds_read_b64_tr_b16 a[164:165], v11 offset:33792
    v_mfma_f32_16x16x32_bf16 v[60:63], a[180:183], a[156:159], v[60:63]
    ds_read_b64_tr_b16 a[166:167], v11 offset:37888
    buffer_load_dwordx4 v4, s[20:23], s30 offen  lds
    v_mfma_f32_16x16x32_bf16 v[64:67], a[184:187], a[152:155], v[64:67]
    ds_read_b64_tr_b16 a[168:169], v12 offset:33792
    v_mfma_f32_16x16x32_bf16 v[68:71], a[184:187], a[156:159], v[68:71]
    ds_read_b64_tr_b16 a[170:171], v12 offset:37888
    v_mfma_f32_16x16x32_bf16 v[72:75], a[188:191], a[152:155], v[72:75]
    ds_read_b64_tr_b16 a[172:173], v13 offset:33792
    v_mfma_f32_16x16x32_bf16 v[76:79], a[188:191], a[156:159], v[76:79]
    ds_read_b64_tr_b16 a[174:175], v13 offset:37888
    s_waitcnt lgkmcnt(8)
    v_mfma_f32_16x16x32_bf16 v[48:51], a[192:195], a[208:211], v[48:51]
    ds_read_b64_tr_b16 a[176:177], v10 offset:40960
    v_mfma_f32_16x16x32_bf16 v[52:55], a[192:195], a[212:215], v[52:55]
    ds_read_b64_tr_b16 a[178:179], v10 offset:45056
    buffer_load_dwordx4 v[168:171], v14, s[80:83], s47 offen offset:2048 sc1
    v_mfma_f32_16x16x32_bf16 v[56:59], a[196:199], a[208:211], v[56:59]
    ds_read_b64_tr_b16 a[180:181], v11 offset:40960
    v_mfma_f32_16x16x32_bf16 v[60:63], a[196:199], a[212:215], v[60:63]
    ds_read_b64_tr_b16 a[182:183], v11 offset:45056
    buffer_load_dwordx4 v5, s[20:23], s30 offen offset:1024  lds
    v_mfma_f32_16x16x32_bf16 v[64:67], a[200:203], a[208:211], v[64:67]
    ds_read_b64_tr_b16 a[184:185], v12 offset:40960
    s_add_u32 m0, s28, 57344
    v_mfma_f32_16x16x32_bf16 v[68:71], a[200:203], a[212:215], v[68:71]
    ds_read_b64_tr_b16 a[186:187], v12 offset:45056
    s_add_u32 s30, s11, s36
    v_mfma_f32_16x16x32_bf16 v[72:75], a[204:207], a[208:211], v[72:75]
    ds_read_b64_tr_b16 a[188:189], v13 offset:40960
    v_mfma_f32_16x16x32_bf16 v[76:79], a[204:207], a[212:215], v[76:79]
    ds_read_b64_tr_b16 a[190:191], v13 offset:45056
    s_waitcnt lgkmcnt(8)
    v_mfma_f32_16x16x32_bf16 v[48:51], a[160:163], a[216:219], v[48:51]
    ds_read_b64_tr_b16 a[192:193], v10 offset:41984
    v_mfma_f32_16x16x32_bf16 v[52:55], a[160:163], a[220:223], v[52:55]
    ds_read_b64_tr_b16 a[194:195], v10 offset:46080
    v_mfma_f32_16x16x32_bf16 v[56:59], a[164:167], a[216:219], v[56:59]
    ds_read_b64_tr_b16 a[196:197], v11 offset:41984
    v_mfma_f32_16x16x32_bf16 v[60:63], a[164:167], a[220:223], v[60:63]
    ds_read_b64_tr_b16 a[198:199], v11 offset:46080
    buffer_load_dwordx4 v4, s[20:23], s30 offen  lds
    v_mfma_f32_16x16x32_bf16 v[64:67], a[168:171], a[216:219], v[64:67]
    ds_read_b64_tr_b16 a[200:201], v12 offset:41984
    v_mfma_f32_16x16x32_bf16 v[68:71], a[168:171], a[220:223], v[68:71]
    ds_read_b64_tr_b16 a[202:203], v12 offset:46080
    v_mfma_f32_16x16x32_bf16 v[72:75], a[172:175], a[216:219], v[72:75]
    ds_read_b64_tr_b16 a[204:205], v13 offset:41984
    buffer_load_dwordx4 v[172:175], v14, s[80:83], s47 offen offset:3072 sc1
    v_mfma_f32_16x16x32_bf16 v[76:79], a[172:175], a[220:223], v[76:79]
    ds_read_b64_tr_b16 a[206:207], v13 offset:46080
    s_waitcnt lgkmcnt(8)
    v_mfma_f32_16x16x32_bf16 v[48:51], a[176:179], a[224:227], v[48:51]
    ds_read_b64_tr_b16 a[160:161], v10 offset:49152
    v_mfma_f32_16x16x32_bf16 v[52:55], a[176:179], a[228:231], v[52:55]
    ds_read_b64_tr_b16 a[162:163], v10 offset:53248
    s_add_u32 s47, s45, 20480
    v_mfma_f32_16x16x32_bf16 v[56:59], a[180:183], a[224:227], v[56:59]
    ds_read_b64_tr_b16 a[164:165], v11 offset:49152
    v_mfma_f32_16x16x32_bf16 v[60:63], a[180:183], a[228:231], v[60:63]
    ds_read_b64_tr_b16 a[166:167], v11 offset:53248
    buffer_load_dwordx4 v5, s[20:23], s30 offen offset:1024  lds
    v_mfma_f32_16x16x32_bf16 v[64:67], a[184:187], a[224:227], v[64:67]
    ds_read_b64_tr_b16 a[168:169], v12 offset:49152
    s_add_u32 m0, s28, 65536
    v_mfma_f32_16x16x32_bf16 v[68:71], a[184:187], a[228:231], v[68:71]
    ds_read_b64_tr_b16 a[170:171], v12 offset:53248
    s_add_u32 s30, s10, s37
    v_mfma_f32_16x16x32_bf16 v[72:75], a[188:191], a[224:227], v[72:75]
    ds_read_b64_tr_b16 a[172:173], v13 offset:49152
    buffer_load_dwordx4 v[128:131], v14, s[80:83], s47 offen offset:0 sc1
    v_mfma_f32_16x16x32_bf16 v[76:79], a[188:191], a[228:231], v[76:79]
    ds_read_b64_tr_b16 a[174:175], v13 offset:53248
    s_waitcnt lgkmcnt(8)
    v_mfma_f32_16x16x32_bf16 v[48:51], a[192:195], a[232:235], v[48:51]
    ds_read_b64_tr_b16 a[176:177], v10 offset:50176
    v_mfma_f32_16x16x32_bf16 v[52:55], a[192:195], a[236:239], v[52:55]
    ds_read_b64_tr_b16 a[178:179], v10 offset:54272
    v_mfma_f32_16x16x32_bf16 v[56:59], a[196:199], a[232:235], v[56:59]
    ds_read_b64_tr_b16 a[180:181], v11 offset:50176
    v_mfma_f32_16x16x32_bf16 v[60:63], a[196:199], a[236:239], v[60:63]
    ds_read_b64_tr_b16 a[182:183], v11 offset:54272
    buffer_load_dwordx4 v4, s[20:23], s30 offen  lds
    v_mfma_f32_16x16x32_bf16 v[64:67], a[200:203], a[232:235], v[64:67]
    ds_read_b64_tr_b16 a[184:185], v12 offset:50176
    v_mfma_f32_16x16x32_bf16 v[68:71], a[200:203], a[236:239], v[68:71]
    ds_read_b64_tr_b16 a[186:187], v12 offset:54272
    v_mfma_f32_16x16x32_bf16 v[72:75], a[204:207], a[232:235], v[72:75]
    ds_read_b64_tr_b16 a[188:189], v13 offset:50176
    buffer_load_dwordx4 v[132:135], v14, s[80:83], s47 offen offset:1024 sc1
    v_mfma_f32_16x16x32_bf16 v[76:79], a[204:207], a[236:239], v[76:79]
    ds_read_b64_tr_b16 a[190:191], v13 offset:54272
    s_waitcnt lgkmcnt(8)
    v_mfma_f32_16x16x32_bf16 v[16:19], a[160:163], v[96:99], v[16:19]
    ds_read_b64_tr_b16 a[192:193], v10 offset:57344
    v_mfma_f32_16x16x32_bf16 v[20:23], a[160:163], v[100:103], v[20:23]
    ds_read_b64_tr_b16 a[194:195], v10 offset:61440
    v_mfma_f32_16x16x32_bf16 v[24:27], a[164:167], v[96:99], v[24:27]
    ds_read_b64_tr_b16 a[196:197], v11 offset:57344
    v_mfma_f32_16x16x32_bf16 v[28:31], a[164:167], v[100:103], v[28:31]
    ds_read_b64_tr_b16 a[198:199], v11 offset:61440
    buffer_load_dwordx4 v5, s[20:23], s30 offen offset:1024  lds
    v_mfma_f32_16x16x32_bf16 v[32:35], a[168:171], v[96:99], v[32:35]
    ds_read_b64_tr_b16 a[200:201], v12 offset:57344
    s_add_u32 m0, s28, 73728
    v_mfma_f32_16x16x32_bf16 v[36:39], a[168:171], v[100:103], v[36:39]
    ds_read_b64_tr_b16 a[202:203], v12 offset:61440
    s_add_u32 s30, s11, s37
    v_mfma_f32_16x16x32_bf16 v[40:43], a[172:175], v[96:99], v[40:43]
    ds_read_b64_tr_b16 a[204:205], v13 offset:57344
    buffer_load_dwordx4 v[136:139], v14, s[80:83], s47 offen offset:2048 sc1
    v_mfma_f32_16x16x32_bf16 v[44:47], a[172:175], v[100:103], v[44:47]
    ds_read_b64_tr_b16 a[206:207], v13 offset:61440
    s_waitcnt lgkmcnt(8)
    v_mfma_f32_16x16x32_bf16 v[16:19], a[176:179], v[104:107], v[16:19]
    ds_read_b64_tr_b16 a[160:161], v10 offset:58368
    v_mfma_f32_16x16x32_bf16 v[20:23], a[176:179], v[108:111], v[20:23]
    ds_read_b64_tr_b16 a[162:163], v10 offset:62464
    v_mfma_f32_16x16x32_bf16 v[24:27], a[180:183], v[104:107], v[24:27]
    ds_read_b64_tr_b16 a[164:165], v11 offset:58368
    v_mfma_f32_16x16x32_bf16 v[28:31], a[180:183], v[108:111], v[28:31]
    ds_read_b64_tr_b16 a[166:167], v11 offset:62464
    buffer_load_dwordx4 v4, s[20:23], s30 offen  lds
    v_mfma_f32_16x16x32_bf16 v[32:35], a[184:187], v[104:107], v[32:35]
    ds_read_b64_tr_b16 a[168:169], v12 offset:58368
    v_mfma_f32_16x16x32_bf16 v[36:39], a[184:187], v[108:111], v[36:39]
    ds_read_b64_tr_b16 a[170:171], v12 offset:62464
    v_mfma_f32_16x16x32_bf16 v[40:43], a[188:191], v[104:107], v[40:43]
    ds_read_b64_tr_b16 a[172:173], v13 offset:58368
    buffer_load_dwordx4 v[140:143], v14, s[80:83], s47 offen offset:3072 sc1
    v_mfma_f32_16x16x32_bf16 v[44:47], a[188:191], v[108:111], v[44:47]
    ds_read_b64_tr_b16 a[174:175], v13 offset:62464
    s_waitcnt vmcnt(20) lgkmcnt(8)
    v_mfma_f32_16x16x32_bf16 v[16:19], a[192:195], v[144:147], v[16:19]
    s_barrier
    ds_read_b64_tr_b16 a[176:177], v6 offset:0
    v_mfma_f32_16x16x32_bf16 v[20:23], a[192:195], v[148:151], v[20:23]
    ds_read_b64_tr_b16 a[178:179], v6 offset:4096
    s_add_u32 s47, s46, 20480
    v_mfma_f32_16x16x32_bf16 v[24:27], a[196:199], v[144:147], v[24:27]
    ds_read_b64_tr_b16 a[180:181], v7 offset:0
    v_mfma_f32_16x16x32_bf16 v[28:31], a[196:199], v[148:151], v[28:31]
    ds_read_b64_tr_b16 a[182:183], v7 offset:4096
    buffer_load_dwordx4 v5, s[20:23], s30 offen offset:1024  lds
    v_mfma_f32_16x16x32_bf16 v[32:35], a[200:203], v[144:147], v[32:35]
    ds_read_b64_tr_b16 a[184:185], v8 offset:0
    s_add_u32 m0, s28, 81920
    v_mfma_f32_16x16x32_bf16 v[36:39], a[200:203], v[148:151], v[36:39]
    ds_read_b64_tr_b16 a[186:187], v8 offset:4096
    s_add_u32 s30, s84, s32
    v_mfma_f32_16x16x32_bf16 v[40:43], a[204:207], v[144:147], v[40:43]
    ds_read_b64_tr_b16 a[188:189], v9 offset:0
    buffer_load_dwordx4 v[176:179], v14, s[80:83], s47 offen offset:0 sc1
    v_mfma_f32_16x16x32_bf16 v[44:47], a[204:207], v[148:151], v[44:47]
    ds_read_b64_tr_b16 a[190:191], v9 offset:4096
    s_waitcnt lgkmcnt(8)
    v_mfma_f32_16x16x32_bf16 v[16:19], a[160:163], v[152:155], v[16:19]
    ds_read_b64_tr_b16 a[192:193], v6 offset:1024
    v_mfma_f32_16x16x32_bf16 v[20:23], a[160:163], v[156:159], v[20:23]
    ds_read_b64_tr_b16 a[194:195], v6 offset:5120
    v_mfma_f32_16x16x32_bf16 v[24:27], a[164:167], v[152:155], v[24:27]
    ds_read_b64_tr_b16 a[196:197], v7 offset:1024
    v_mfma_f32_16x16x32_bf16 v[28:31], a[164:167], v[156:159], v[28:31]
    ds_read_b64_tr_b16 a[198:199], v7 offset:5120
    buffer_load_dwordx4 v4, s[20:23], s30 offen  lds
    v_mfma_f32_16x16x32_bf16 v[32:35], a[168:171], v[152:155], v[32:35]
    ds_read_b64_tr_b16 a[200:201], v8 offset:1024
    v_mfma_f32_16x16x32_bf16 v[36:39], a[168:171], v[156:159], v[36:39]
    ds_read_b64_tr_b16 a[202:203], v8 offset:5120
    v_mfma_f32_16x16x32_bf16 v[40:43], a[172:175], v[152:155], v[40:43]
    ds_read_b64_tr_b16 a[204:205], v9 offset:1024
    buffer_load_dwordx4 v[180:183], v14, s[80:83], s47 offen offset:1024 sc1
    v_mfma_f32_16x16x32_bf16 v[44:47], a[172:175], v[156:159], v[44:47]
    ds_read_b64_tr_b16 a[206:207], v9 offset:5120
    s_waitcnt lgkmcnt(8)
    v_mfma_f32_16x16x32_bf16 v[16:19], a[176:179], v[112:115], v[16:19]
    ds_read_b64_tr_b16 a[160:161], v6 offset:8192
    v_mfma_f32_16x16x32_bf16 v[20:23], a[176:179], v[116:119], v[20:23]
    ds_read_b64_tr_b16 a[162:163], v6 offset:12288
    v_mfma_f32_16x16x32_bf16 v[24:27], a[180:183], v[112:115], v[24:27]
    ds_read_b64_tr_b16 a[164:165], v7 offset:8192
    v_mfma_f32_16x16x32_bf16 v[28:31], a[180:183], v[116:119], v[28:31]
    ds_read_b64_tr_b16 a[166:167], v7 offset:12288
    buffer_load_dwordx4 v5, s[20:23], s30 offen offset:1024  lds
    v_mfma_f32_16x16x32_bf16 v[32:35], a[184:187], v[112:115], v[32:35]
    ds_read_b64_tr_b16 a[168:169], v8 offset:8192
    s_add_u32 m0, s28, 90112
    v_mfma_f32_16x16x32_bf16 v[36:39], a[184:187], v[116:119], v[36:39]
    ds_read_b64_tr_b16 a[170:171], v8 offset:12288
    s_add_u32 s30, s84, s33
    v_mfma_f32_16x16x32_bf16 v[40:43], a[188:191], v[112:115], v[40:43]
    ds_read_b64_tr_b16 a[172:173], v9 offset:8192
    buffer_load_dwordx4 v[184:187], v14, s[80:83], s47 offen offset:2048 sc1
    v_mfma_f32_16x16x32_bf16 v[44:47], a[188:191], v[116:119], v[44:47]
    ds_read_b64_tr_b16 a[174:175], v9 offset:12288
    s_waitcnt vmcnt(24) lgkmcnt(8)
    v_mfma_f32_16x16x32_bf16 v[16:19], a[192:195], v[120:123], v[16:19]
    ds_read_b64_tr_b16 a[176:177], v6 offset:9216
    v_mfma_f32_16x16x32_bf16 v[20:23], a[192:195], v[124:127], v[20:23]
    ds_read_b64_tr_b16 a[178:179], v6 offset:13312
    v_mfma_f32_16x16x32_bf16 v[24:27], a[196:199], v[120:123], v[24:27]
    ds_read_b64_tr_b16 a[180:181], v7 offset:9216
    v_mfma_f32_16x16x32_bf16 v[28:31], a[196:199], v[124:127], v[28:31]
    ds_read_b64_tr_b16 a[182:183], v7 offset:13312
    buffer_load_dwordx4 v4, s[20:23], s30 offen  lds
    v_mfma_f32_16x16x32_bf16 v[32:35], a[200:203], v[120:123], v[32:35]
    ds_read_b64_tr_b16 a[184:185], v8 offset:9216
    v_mfma_f32_16x16x32_bf16 v[36:39], a[200:203], v[124:127], v[36:39]
    ds_read_b64_tr_b16 a[186:187], v8 offset:13312
    v_mfma_f32_16x16x32_bf16 v[40:43], a[204:207], v[120:123], v[40:43]
    ds_read_b64_tr_b16 a[188:189], v9 offset:9216
    buffer_load_dwordx4 v[188:191], v14, s[80:83], s47 offen offset:3072 sc1
    v_mfma_f32_16x16x32_bf16 v[44:47], a[204:207], v[124:127], v[44:47]
    ds_read_b64_tr_b16 a[190:191], v9 offset:13312
    s_waitcnt vmcnt(21) lgkmcnt(8)
    v_mfma_f32_16x16x32_bf16 v[16:19], a[160:163], v[160:163], v[16:19]
    ds_read_b64_tr_b16 a[192:193], v6 offset:16384
    v_mfma_f32_16x16x32_bf16 v[20:23], a[160:163], v[164:167], v[20:23]
    ds_read_b64_tr_b16 a[194:195], v6 offset:20480
    s_mov_b32 s16, s4
    v_mfma_f32_16x16x32_bf16 v[24:27], a[164:167], v[160:163], v[24:27]
    ds_read_b64_tr_b16 a[196:197], v7 offset:16384
    v_mfma_f32_16x16x32_bf16 v[28:31], a[164:167], v[164:167], v[28:31]
    ds_read_b64_tr_b16 a[198:199], v7 offset:20480
    buffer_load_dwordx4 v5, s[20:23], s30 offen offset:1024  lds
    v_mfma_f32_16x16x32_bf16 v[32:35], a[168:171], v[160:163], v[32:35]
    ds_read_b64_tr_b16 a[200:201], v8 offset:16384
    s_add_u32 m0, s28, 98304
    v_mfma_f32_16x16x32_bf16 v[36:39], a[168:171], v[164:167], v[36:39]
    ds_read_b64_tr_b16 a[202:203], v8 offset:20480
    s_add_u32 s30, s84, s34
    v_mfma_f32_16x16x32_bf16 v[40:43], a[172:175], v[160:163], v[40:43]
    ds_read_b64_tr_b16 a[204:205], v9 offset:16384
    s_mov_b32 s17, s5
    v_mfma_f32_16x16x32_bf16 v[44:47], a[172:175], v[164:167], v[44:47]
    ds_read_b64_tr_b16 a[206:207], v9 offset:20480
    s_waitcnt vmcnt(17) lgkmcnt(8)
    v_mfma_f32_16x16x32_bf16 v[16:19], a[176:179], v[168:171], v[16:19]
    ds_read_b64_tr_b16 a[160:161], v6 offset:17408
    v_mfma_f32_16x16x32_bf16 v[20:23], a[176:179], v[172:175], v[20:23]
    ds_read_b64_tr_b16 a[162:163], v6 offset:21504
    s_mov_b32 s18, 2359296
    v_mfma_f32_16x16x32_bf16 v[24:27], a[180:183], v[168:171], v[24:27]
    ds_read_b64_tr_b16 a[164:165], v7 offset:17408
    v_mfma_f32_16x16x32_bf16 v[28:31], a[180:183], v[172:175], v[28:31]
    ds_read_b64_tr_b16 a[166:167], v7 offset:21504
    buffer_load_dwordx4 v4, s[20:23], s30 offen  lds
    v_mfma_f32_16x16x32_bf16 v[32:35], a[184:187], v[168:171], v[32:35]
    ds_read_b64_tr_b16 a[168:169], v8 offset:17408
    v_mfma_f32_16x16x32_bf16 v[36:39], a[184:187], v[172:175], v[36:39]
    ds_read_b64_tr_b16 a[170:171], v8 offset:21504
    v_mfma_f32_16x16x32_bf16 v[40:43], a[188:191], v[168:171], v[40:43]
    ds_read_b64_tr_b16 a[172:173], v9 offset:17408
    s_add_u32 s76, s52, 36732928
    s_addc_u32 s77, s53, 0
    v_mfma_f32_16x16x32_bf16 v[44:47], a[188:191], v[172:175], v[44:47]
    ds_read_b64_tr_b16 a[174:175], v9 offset:21504
    s_waitcnt vmcnt(14) lgkmcnt(8)
    v_mfma_f32_16x16x32_bf16 v[16:19], a[192:195], v[128:131], v[16:19]
    ds_read_b64_tr_b16 a[176:177], v6 offset:24576
    v_mfma_f32_16x16x32_bf16 v[20:23], a[192:195], v[132:135], v[20:23]
    ds_read_b64_tr_b16 a[178:179], v6 offset:28672
    s_mov_b32 s78, 8192
    v_mfma_f32_16x16x32_bf16 v[24:27], a[196:199], v[128:131], v[24:27]
    ds_read_b64_tr_b16 a[180:181], v7 offset:24576
    v_mfma_f32_16x16x32_bf16 v[28:31], a[196:199], v[132:135], v[28:31]
    ds_read_b64_tr_b16 a[182:183], v7 offset:28672
    buffer_load_dwordx4 v5, s[20:23], s30 offen offset:1024  lds
    v_mfma_f32_16x16x32_bf16 v[32:35], a[200:203], v[128:131], v[32:35]
    ds_read_b64_tr_b16 a[184:185], v8 offset:24576
    s_add_u32 m0, s28, 106496
    v_mfma_f32_16x16x32_bf16 v[36:39], a[200:203], v[132:135], v[36:39]
    ds_read_b64_tr_b16 a[186:187], v8 offset:28672
    s_add_u32 s30, s84, s35
    v_mfma_f32_16x16x32_bf16 v[40:43], a[204:207], v[128:131], v[40:43]
    ds_read_b64_tr_b16 a[188:189], v9 offset:24576
    s_add_u32 s80, s52, 5242880
    s_addc_u32 s81, s53, 0
    v_mfma_f32_16x16x32_bf16 v[44:47], a[204:207], v[132:135], v[44:47]
    ds_read_b64_tr_b16 a[190:191], v9 offset:28672
    s_waitcnt vmcnt(11) lgkmcnt(8)
    v_mfma_f32_16x16x32_bf16 v[16:19], a[160:163], v[136:139], v[16:19]
    ds_read_b64_tr_b16 a[192:193], v6 offset:25600
    v_mfma_f32_16x16x32_bf16 v[20:23], a[160:163], v[140:143], v[20:23]
    ds_read_b64_tr_b16 a[194:195], v6 offset:29696
    s_mov_b32 s82, 2359296
    buffer_load_dword a252, v246, s[76:79], 0 offen sc1
    v_mfma_f32_16x16x32_bf16 v[24:27], a[164:167], v[136:139], v[24:27]
    ds_read_b64_tr_b16 a[196:197], v7 offset:25600
L_pm7:
    s_cbranch_execz L_pmb1
    v_mfma_f32_16x16x32_bf16 v[28:31], a[164:167], v[140:143], v[28:31]
    ds_read_b64_tr_b16 a[198:199], v7 offset:29696
    buffer_load_dwordx4 v4, s[20:23], s30 offen  lds
    v_mfma_f32_16x16x32_bf16 v[32:35], a[168:171], v[136:139], v[32:35]
    ds_read_b64_tr_b16 a[200:201], v8 offset:25600
    v_mfma_f32_16x16x32_bf16 v[36:39], a[168:171], v[140:143], v[36:39]
    ds_read_b64_tr_b16 a[202:203], v8 offset:29696
    v_mfma_f32_16x16x32_bf16 v[40:43], a[172:175], v[136:139], v[40:43]
    ds_read_b64_tr_b16 a[204:205], v9 offset:25600
    v_mfma_f32_16x16x32_bf16 v[44:47], a[172:175], v[140:143], v[44:47]
    ds_read_b64_tr_b16 a[206:207], v9 offset:29696
    s_waitcnt vmcnt(9)
    s_waitcnt lgkmcnt(8)
    v_mfma_f32_16x16x32_bf16 v[16:19], a[176:179], v[176:179], v[16:19]
    s_barrier
    ds_read_b64_tr_b16 a[160:161], v6 offset:32768
    v_mfma_f32_16x16x32_bf16 v[20:23], a[176:179], v[180:183], v[20:23]
    ds_read_b64_tr_b16 a[162:163], v6 offset:36864
    v_mfma_f32_16x16x32_bf16 v[24:27], a[180:183], v[176:179], v[24:27]
    ds_read_b64_tr_b16 a[164:165], v7 offset:32768
    v_mfma_f32_16x16x32_bf16 v[28:31], a[180:183], v[180:183], v[28:31]
    ds_read_b64_tr_b16 a[166:167], v7 offset:36864
    buffer_load_dwordx4 v5, s[20:23], s30 offen offset:1024  lds
    v_mfma_f32_16x16x32_bf16 v[32:35], a[184:187], v[176:179], v[32:35]
    ds_read_b64_tr_b16 a[168:169], v8 offset:32768
    s_add_u32 m0, s28, 114688
    v_mfma_f32_16x16x32_bf16 v[36:39], a[184:187], v[180:183], v[36:39]
    ds_read_b64_tr_b16 a[170:171], v8 offset:36864
    s_add_u32 s30, s84, s36
    v_mfma_f32_16x16x32_bf16 v[40:43], a[188:191], v[176:179], v[40:43]
    ds_read_b64_tr_b16 a[172:173], v9 offset:32768
    v_mfma_f32_16x16x32_bf16 v[44:47], a[188:191], v[180:183], v[44:47]
    ds_read_b64_tr_b16 a[174:175], v9 offset:36864
    s_waitcnt vmcnt(6) lgkmcnt(8)
    v_mfma_f32_16x16x32_bf16 v[16:19], a[192:195], v[184:187], v[16:19]
    ds_read_b64_tr_b16 a[176:177], v6 offset:33792
    v_mfma_f32_16x16x32_bf16 v[20:23], a[192:195], v[188:191], v[20:23]
    ds_read_b64_tr_b16 a[178:179], v6 offset:37888
    buffer_load_dwordx4 a[240:243], v243, s[16:19], s57 offen
    v_mfma_f32_16x16x32_bf16 v[24:27], a[196:199], v[184:187], v[24:27]
    ds_read_b64_tr_b16 a[180:181], v7 offset:33792
    v_mfma_f32_16x16x32_bf16 v[28:31], a[196:199], v[188:191], v[28:31]
    ds_read_b64_tr_b16 a[182:183], v7 offset:37888
    buffer_load_dwordx4 v4, s[20:23], s30 offen  lds
    v_mfma_f32_16x16x32_bf16 v[32:35], a[200:203], v[184:187], v[32:35]
    ds_read_b64_tr_b16 a[184:185], v8 offset:33792
    v_mfma_f32_16x16x32_bf16 v[36:39], a[200:203], v[188:191], v[36:39]
    ds_read_b64_tr_b16 a[186:187], v8 offset:37888
    v_mfma_f32_16x16x32_bf16 v[40:43], a[204:207], v[184:187], v[40:43]
    ds_read_b64_tr_b16 a[188:189], v9 offset:33792
    v_mfma_f32_16x16x32_bf16 v[44:47], a[204:207], v[188:191], v[44:47]
    ds_read_b64_tr_b16 a[190:191], v9 offset:37888
    s_waitcnt lgkmcnt(8)
    v_mfma_f32_16x16x32_bf16 v[48:51], a[160:163], v[96:99], v[48:51]
    ds_read_b64_tr_b16 a[192:193], v6 offset:40960
    v_cvt_pk_bf16_f32 v80, v16, v17
    v_mfma_f32_16x16x32_bf16 v[52:55], a[160:163], v[100:103], v[52:55]
    ds_read_b64_tr_b16 a[194:195], v6 offset:45056
    v_cvt_pk_bf16_f32 v81, v18, v19
    v_mfma_f32_16x16x32_bf16 v[56:59], a[164:167], v[96:99], v[56:59]
    ds_read_b64_tr_b16 a[196:197], v7 offset:40960
    v_cvt_pk_bf16_f32 v82, v24, v25
    v_mfma_f32_16x16x32_bf16 v[60:63], a[164:167], v[100:103], v[60:63]
    ds_read_b64_tr_b16 a[198:199], v7 offset:45056
    buffer_load_dwordx4 v5, s[20:23], s30 offen offset:1024  lds
    v_mfma_f32_16x16x32_bf16 v[64:67], a[168:171], v[96:99], v[64:67]
    ds_read_b64_tr_b16 a[200:201], v8 offset:40960
    v_cvt_pk_bf16_f32 v83, v26, v27
    v_mfma_f32_16x16x32_bf16 v[68:71], a[168:171], v[100:103], v[68:71]
    ds_read_b64_tr_b16 a[202:203], v8 offset:45056
    s_add_u32 s31, s60, 0
    v_mfma_f32_16x16x32_bf16 v[72:75], a[172:175], v[96:99], v[72:75]
    ds_read_b64_tr_b16 a[204:205], v9 offset:40960
    buffer_store_dwordx4 v[80:83], v14, s[24:27], s31 offen sc1
    v_mfma_f32_16x16x32_bf16 v[76:79], a[172:175], v[100:103], v[76:79]
    ds_read_b64_tr_b16 a[206:207], v9 offset:45056
    s_waitcnt lgkmcnt(8)
    v_mfma_f32_16x16x32_bf16 v[48:51], a[176:179], v[104:107], v[48:51]
    ds_read_b64_tr_b16 a[160:161], v6 offset:41984
    s_add_u32 m0, s28, 122880
    v_mfma_f32_16x16x32_bf16 v[52:55], a[176:179], v[108:111], v[52:55]
    ds_read_b64_tr_b16 a[162:163], v6 offset:46080
    buffer_load_dwordx4 a[244:247], v243, s[16:19], s58 offen
    v_mfma_f32_16x16x32_bf16 v[56:59], a[180:183], v[104:107], v[56:59]
    ds_read_b64_tr_b16 a[164:165], v7 offset:41984
    s_add_u32 s30, s84, s37
    v_mfma_f32_16x16x32_bf16 v[60:63], a[180:183], v[108:111], v[60:63]
    ds_read_b64_tr_b16 a[166:167], v7 offset:46080
    buffer_load_dwordx4 v4, s[20:23], s30 offen  lds
    v_mfma_f32_16x16x32_bf16 v[64:67], a[184:187], v[104:107], v[64:67]
    ds_read_b64_tr_b16 a[168:169], v8 offset:41984
    v_cvt_pk_bf16_f32 v84, v20, v21
    v_mfma_f32_16x16x32_bf16 v[68:71], a[184:187], v[108:111], v[68:71]
    ds_read_b64_tr_b16 a[170:171], v8 offset:46080
    v_cvt_pk_bf16_f32 v85, v22, v23
    v_mfma_f32_16x16x32_bf16 v[72:75], a[188:191], v[104:107], v[72:75]
    ds_read_b64_tr_b16 a[172:173], v9 offset:41984
    v_cvt_pk_bf16_f32 v86, v28, v29
    v_mfma_f32_16x16x32_bf16 v[76:79], a[188:191], v[108:111], v[76:79]
    ds_read_b64_tr_b16 a[174:175], v9 offset:46080
    s_waitcnt lgkmcnt(8)
    v_mfma_f32_16x16x32_bf16 v[48:51], a[192:195], v[144:147], v[48:51]
    ds_read_b64_tr_b16 a[176:177], v6 offset:49152
    v_cvt_pk_bf16_f32 v87, v30, v31
    v_mfma_f32_16x16x32_bf16 v[52:55], a[192:195], v[148:151], v[52:55]
    ds_read_b64_tr_b16 a[178:179], v6 offset:53248
    s_add_u32 s31, s60, 4096
    v_mfma_f32_16x16x32_bf16 v[56:59], a[196:199], v[144:147], v[56:59]
    ds_read_b64_tr_b16 a[180:181], v7 offset:49152
    v_mfma_f32_16x16x32_bf16 v[60:63], a[196:199], v[148:151], v[60:63]
    ds_read_b64_tr_b16 a[182:183], v7 offset:53248
    buffer_load_dwordx4 v5, s[20:23], s30 offen offset:1024  lds
    v_mfma_f32_16x16x32_bf16 v[64:67], a[200:203], v[144:147], v[64:67]
    ds_read_b64_tr_b16 a[184:185], v8 offset:49152
    buffer_store_dwordx4 v[84:87], v14, s[24:27], s31 offen sc1
    v_mfma_f32_16x16x32_bf16 v[68:71], a[200:203], v[148:151], v[68:71]
    ds_read_b64_tr_b16 a[186:187], v8 offset:53248
    v_cvt_pk_bf16_f32 v88, v32, v33
    v_mfma_f32_16x16x32_bf16 v[72:75], a[204:207], v[144:147], v[72:75]
    ds_read_b64_tr_b16 a[188:189], v9 offset:49152
    v_cvt_pk_bf16_f32 v89, v34, v35
    v_mfma_f32_16x16x32_bf16 v[76:79], a[204:207], v[148:151], v[76:79]
    ds_read_b64_tr_b16 a[190:191], v9 offset:53248
    s_waitcnt lgkmcnt(8)
    v_mfma_f32_16x16x32_bf16 v[48:51], a[160:163], v[152:155], v[48:51]
    ds_read_b64_tr_b16 a[192:193], v6 offset:50176
    s_add_u32 m0, s28, 0
    v_mfma_f32_16x16x32_bf16 v[52:55], a[160:163], v[156:159], v[52:55]
    ds_read_b64_tr_b16 a[194:195], v6 offset:54272
    buffer_load_dwordx4 a[248:251], v243, s[16:19], s59 offen
    v_mfma_f32_16x16x32_bf16 v[56:59], a[164:167], v[152:155], v[56:59]
    ds_read_b64_tr_b16 a[196:197], v7 offset:50176
    s_add_u32 s30, s100, s32
    v_mfma_f32_16x16x32_bf16 v[60:63], a[164:167], v[156:159], v[60:63]
    ds_read_b64_tr_b16 a[198:199], v7 offset:54272
    buffer_load_dwordx4 v4, s[20:23], s30 offen  lds
    v_mfma_f32_16x16x32_bf16 v[64:67], a[168:171], v[152:155], v[64:67]
    ds_read_b64_tr_b16 a[200:201], v8 offset:50176
    v_cvt_pk_bf16_f32 v90, v40, v41
    v_mfma_f32_16x16x32_bf16 v[68:71], a[168:171], v[156:159], v[68:71]
    ds_read_b64_tr_b16 a[202:203], v8 offset:54272
    v_cvt_pk_bf16_f32 v91, v42, v43
    v_mfma_f32_16x16x32_bf16 v[72:75], a[172:175], v[152:155], v[72:75]
    ds_read_b64_tr_b16 a[204:205], v9 offset:50176
    s_add_u32 s31, s60, 16384
    v_mfma_f32_16x16x32_bf16 v[76:79], a[172:175], v[156:159], v[76:79]
    ds_read_b64_tr_b16 a[206:207], v9 offset:54272
    s_waitcnt lgkmcnt(8)
    v_mfma_f32_16x16x32_bf16 v[48:51], a[176:179], v[112:115], v[48:51]
    ds_read_b64_tr_b16 a[160:161], v6 offset:57344
    v_mfma_f32_16x16x32_bf16 v[52:55], a[176:179], v[116:119], v[52:55]
    ds_read_b64_tr_b16 a[162:163], v6 offset:61440
    v_mfma_f32_16x16x32_bf16 v[56:59], a[180:183], v[112:115], v[56:59]
    ds_read_b64_tr_b16 a[164:165], v7 offset:57344
    v_mfma_f32_16x16x32_bf16 v[60:63], a[180:183], v[116:119], v[60:63]
    ds_read_b64_tr_b16 a[166:167], v7 offset:61440
    buffer_load_dwordx4 v5, s[20:23], s30 offen offset:1024  lds
    v_mfma_f32_16x16x32_bf16 v[64:67], a[184:187], v[112:115], v[64:67]
    ds_read_b64_tr_b16 a[168:169], v8 offset:57344
    buffer_store_dwordx4 v[88:91], v14, s[24:27], s31 offen sc1
    v_mfma_f32_16x16x32_bf16 v[68:71], a[184:187], v[116:119], v[68:71]
    ds_read_b64_tr_b16 a[170:171], v8 offset:61440
    v_cvt_pk_bf16_f32 v92, v36, v37
    v_mfma_f32_16x16x32_bf16 v[72:75], a[188:191], v[112:115], v[72:75]
    ds_read_b64_tr_b16 a[172:173], v9 offset:57344
    v_cvt_pk_bf16_f32 v93, v38, v39
    v_mfma_f32_16x16x32_bf16 v[76:79], a[188:191], v[116:119], v[76:79]
    ds_read_b64_tr_b16 a[174:175], v9 offset:61440
    s_waitcnt lgkmcnt(8)
    v_mfma_f32_16x16x32_bf16 v[48:51], a[192:195], v[120:123], v[48:51]
    ds_read_b64_tr_b16 a[176:177], v6 offset:58368
    s_add_u32 m0, s28, 8192
    v_mfma_f32_16x16x32_bf16 v[52:55], a[192:195], v[124:127], v[52:55]
    ds_read_b64_tr_b16 a[178:179], v6 offset:62464
    s_add_u32 s30, s100, s33
    v_mfma_f32_16x16x32_bf16 v[56:59], a[196:199], v[120:123], v[56:59]
    ds_read_b64_tr_b16 a[180:181], v7 offset:58368
    v_cvt_pk_bf16_f32 v94, v44, v45
    v_mfma_f32_16x16x32_bf16 v[60:63], a[196:199], v[124:127], v[60:63]
    ds_read_b64_tr_b16 a[182:183], v7 offset:62464
    buffer_load_dwordx4 v4, s[20:23], s30 offen  lds
    v_mfma_f32_16x16x32_bf16 v[64:67], a[200:203], v[120:123], v[64:67]
    ds_read_b64_tr_b16 a[184:185], v8 offset:58368
    v_cvt_pk_bf16_f32 v95, v46, v47
    v_mfma_f32_16x16x32_bf16 v[68:71], a[200:203], v[124:127], v[68:71]
    ds_read_b64_tr_b16 a[186:187], v8 offset:62464
    s_add_u32 s31, s60, 20480
    v_mfma_f32_16x16x32_bf16 v[72:75], a[204:207], v[120:123], v[72:75]
    ds_read_b64_tr_b16 a[188:189], v9 offset:58368
    buffer_store_dwordx4 v[92:95], v14, s[24:27], s31 offen sc1
    v_mfma_f32_16x16x32_bf16 v[76:79], a[204:207], v[124:127], v[76:79]
    ds_read_b64_tr_b16 a[190:191], v9 offset:62464
    s_waitcnt vmcnt(19) lgkmcnt(8)
    v_mfma_f32_16x16x32_bf16 v[48:51], a[160:163], v[160:163], v[48:51]
    s_barrier
    ds_read_b64_tr_b16 a[192:193], v10 offset:0
    v_mfma_f32_16x16x32_bf16 v[52:55], a[160:163], v[164:167], v[52:55]
    ds_read_b64_tr_b16 a[194:195], v10 offset:4096
    v_mfma_f32_16x16x32_bf16 v[56:59], a[164:167], v[160:163], v[56:59]
    ds_read_b64_tr_b16 a[196:197], v11 offset:0
    v_mfma_f32_16x16x32_bf16 v[60:63], a[164:167], v[164:167], v[60:63]
    ds_read_b64_tr_b16 a[198:199], v11 offset:4096
    buffer_load_dwordx4 v5, s[20:23], s30 offen offset:1024  lds
    v_mfma_f32_16x16x32_bf16 v[64:67], a[168:171], v[160:163], v[64:67]
    ds_read_b64_tr_b16 a[200:201], v12 offset:0
    s_add_u32 m0, s28, 16384
    v_mfma_f32_16x16x32_bf16 v[68:71], a[168:171], v[164:167], v[68:71]
    ds_read_b64_tr_b16 a[202:203], v12 offset:4096
    s_add_u32 s30, s100, s34
    v_mfma_f32_16x16x32_bf16 v[72:75], a[172:175], v[160:163], v[72:75]
    ds_read_b64_tr_b16 a[204:205], v13 offset:0
    v_mfma_f32_16x16x32_bf16 v[76:79], a[172:175], v[164:167], v[76:79]
    ds_read_b64_tr_b16 a[206:207], v13 offset:4096
    s_waitcnt lgkmcnt(8)
    v_mfma_f32_16x16x32_bf16 v[48:51], a[176:179], v[168:171], v[48:51]
    ds_read_b64_tr_b16 a[160:161], v10 offset:1024
    v_mfma_f32_16x16x32_bf16 v[52:55], a[176:179], v[172:175], v[52:55]
    ds_read_b64_tr_b16 a[162:163], v10 offset:5120
    v_mfma_f32_16x16x32_bf16 v[56:59], a[180:183], v[168:171], v[56:59]
    ds_read_b64_tr_b16 a[164:165], v11 offset:1024
    v_mfma_f32_16x16x32_bf16 v[60:63], a[180:183], v[172:175], v[60:63]
    ds_read_b64_tr_b16 a[166:167], v11 offset:5120
    buffer_load_dwordx4 v4, s[20:23], s30 offen  lds
    v_mfma_f32_16x16x32_bf16 v[64:67], a[184:187], v[168:171], v[64:67]
    ds_read_b64_tr_b16 a[168:169], v12 offset:1024
    v_mfma_f32_16x16x32_bf16 v[68:71], a[184:187], v[172:175], v[68:71]
    ds_read_b64_tr_b16 a[170:171], v12 offset:5120
    v_mfma_f32_16x16x32_bf16 v[72:75], a[188:191], v[168:171], v[72:75]
    ds_read_b64_tr_b16 a[172:173], v13 offset:1024
    v_mfma_f32_16x16x32_bf16 v[76:79], a[188:191], v[172:175], v[76:79]
    ds_read_b64_tr_b16 a[174:175], v13 offset:5120
    s_waitcnt lgkmcnt(8)
    v_mfma_f32_16x16x32_bf16 v[48:51], a[192:195], v[128:131], v[48:51]
    ds_read_b64_tr_b16 a[176:177], v10 offset:8192
    v_mfma_f32_16x16x32_bf16 v[52:55], a[192:195], v[132:135], v[52:55]
    ds_read_b64_tr_b16 a[178:179], v10 offset:12288
    v_mfma_f32_16x16x32_bf16 v[56:59], a[196:199], v[128:131], v[56:59]
    ds_read_b64_tr_b16 a[180:181], v11 offset:8192
    v_mfma_f32_16x16x32_bf16 v[60:63], a[196:199], v[132:135], v[60:63]
    ds_read_b64_tr_b16 a[182:183], v11 offset:12288
    buffer_load_dwordx4 v5, s[20:23], s30 offen offset:1024  lds
    v_mfma_f32_16x16x32_bf16 v[64:67], a[200:203], v[128:131], v[64:67]
    ds_read_b64_tr_b16 a[184:185], v12 offset:8192
    s_add_u32 m0, s28, 24576
    v_mfma_f32_16x16x32_bf16 v[68:71], a[200:203], v[132:135], v[68:71]
    ds_read_b64_tr_b16 a[186:187], v12 offset:12288
    s_add_u32 s30, s101, s32
    v_mfma_f32_16x16x32_bf16 v[72:75], a[204:207], v[128:131], v[72:75]
    ds_read_b64_tr_b16 a[188:189], v13 offset:8192
    v_mfma_f32_16x16x32_bf16 v[76:79], a[204:207], v[132:135], v[76:79]
    ds_read_b64_tr_b16 a[190:191], v13 offset:12288
    s_waitcnt lgkmcnt(8)
    v_mfma_f32_16x16x32_bf16 v[48:51], a[160:163], v[136:139], v[48:51]
    ds_read_b64_tr_b16 a[192:193], v10 offset:9216
    v_mfma_f32_16x16x32_bf16 v[52:55], a[160:163], v[140:143], v[52:55]
    ds_read_b64_tr_b16 a[194:195], v10 offset:13312
    v_mfma_f32_16x16x32_bf16 v[56:59], a[164:167], v[136:139], v[56:59]
    ds_read_b64_tr_b16 a[196:197], v11 offset:9216
    v_mfma_f32_16x16x32_bf16 v[60:63], a[164:167], v[140:143], v[60:63]
    ds_read_b64_tr_b16 a[198:199], v11 offset:13312
    buffer_load_dwordx4 v4, s[20:23], s30 offen  lds
    v_mfma_f32_16x16x32_bf16 v[64:67], a[168:171], v[136:139], v[64:67]
    ds_read_b64_tr_b16 a[200:201], v12 offset:9216
    v_mfma_f32_16x16x32_bf16 v[68:71], a[168:171], v[140:143], v[68:71]
    ds_read_b64_tr_b16 a[202:203], v12 offset:13312
    v_mfma_f32_16x16x32_bf16 v[72:75], a[172:175], v[136:139], v[72:75]
    ds_read_b64_tr_b16 a[204:205], v13 offset:9216
    v_mfma_f32_16x16x32_bf16 v[76:79], a[172:175], v[140:143], v[76:79]
    ds_read_b64_tr_b16 a[206:207], v13 offset:13312
    s_waitcnt lgkmcnt(8)
    v_mfma_f32_16x16x32_bf16 v[48:51], a[176:179], v[176:179], v[48:51]
    ds_read_b64_tr_b16 a[160:161], v10 offset:16384
    v_mfma_f32_16x16x32_bf16 v[52:55], a[176:179], v[180:183], v[52:55]
    ds_read_b64_tr_b16 a[162:163], v10 offset:20480
    v_mfma_f32_16x16x32_bf16 v[56:59], a[180:183], v[176:179], v[56:59]
    ds_read_b64_tr_b16 a[164:165], v11 offset:16384
    v_mfma_f32_16x16x32_bf16 v[60:63], a[180:183], v[180:183], v[60:63]
    ds_read_b64_tr_b16 a[166:167], v11 offset:20480
    buffer_load_dwordx4 v5, s[20:23], s30 offen offset:1024  lds
    v_mfma_f32_16x16x32_bf16 v[64:67], a[184:187], v[176:179], v[64:67]
    ds_read_b64_tr_b16 a[168:169], v12 offset:16384
    s_add_u32 m0, s28, 32768
    v_mfma_f32_16x16x32_bf16 v[68:71], a[184:187], v[180:183], v[68:71]
    ds_read_b64_tr_b16 a[170:171], v12 offset:20480
    s_add_u32 s30, s101, s33
    v_mfma_f32_16x16x32_bf16 v[72:75], a[188:191], v[176:179], v[72:75]
    ds_read_b64_tr_b16 a[172:173], v13 offset:16384
    v_mfma_f32_16x16x32_bf16 v[76:79], a[188:191], v[180:183], v[76:79]
    ds_read_b64_tr_b16 a[174:175], v13 offset:20480
    s_waitcnt lgkmcnt(8)
    v_mfma_f32_16x16x32_bf16 v[48:51], a[192:195], v[184:187], v[48:51]
    ds_read_b64_tr_b16 a[176:177], v10 offset:17408
    v_mfma_f32_16x16x32_bf16 v[52:55], a[192:195], v[188:191], v[52:55]
    ds_read_b64_tr_b16 a[178:179], v10 offset:21504
    v_mfma_f32_16x16x32_bf16 v[56:59], a[196:199], v[184:187], v[56:59]
    ds_read_b64_tr_b16 a[180:181], v11 offset:17408
    v_mfma_f32_16x16x32_bf16 v[60:63], a[196:199], v[188:191], v[60:63]
    ds_read_b64_tr_b16 a[182:183], v11 offset:21504
    buffer_load_dwordx4 v4, s[20:23], s30 offen  lds
    v_mfma_f32_16x16x32_bf16 v[64:67], a[200:203], v[184:187], v[64:67]
    ds_read_b64_tr_b16 a[184:185], v12 offset:17408
    v_mfma_f32_16x16x32_bf16 v[68:71], a[200:203], v[188:191], v[68:71]
    ds_read_b64_tr_b16 a[186:187], v12 offset:21504
    v_mfma_f32_16x16x32_bf16 v[72:75], a[204:207], v[184:187], v[72:75]
    ds_read_b64_tr_b16 a[188:189], v13 offset:17408
    v_mfma_f32_16x16x32_bf16 v[76:79], a[204:207], v[188:191], v[76:79]
    ds_read_b64_tr_b16 a[190:191], v13 offset:21504
    s_waitcnt lgkmcnt(8)
    v_mfma_f32_16x16x32_bf16 v[16:19], a[160:163], a[0:3], 0
    ds_read_b64_tr_b16 a[192:193], v10 offset:24576
    v_cvt_pk_bf16_f32 v80, v48, v49
    v_mfma_f32_16x16x32_bf16 v[20:23], a[160:163], a[4:7], 0
    ds_read_b64_tr_b16 a[194:195], v10 offset:28672
    v_cvt_pk_bf16_f32 v81, v50, v51
    v_mfma_f32_16x16x32_bf16 v[24:27], a[164:167], a[0:3], 0
    ds_read_b64_tr_b16 a[196:197], v11 offset:24576
    v_cvt_pk_bf16_f32 v82, v56, v57
    v_mfma_f32_16x16x32_bf16 v[28:31], a[164:167], a[4:7], 0
    ds_read_b64_tr_b16 a[198:199], v11 offset:28672
    buffer_load_dwordx4 v5, s[20:23], s30 offen offset:1024  lds
    v_mfma_f32_16x16x32_bf16 v[32:35], a[168:171], a[0:3], 0
    ds_read_b64_tr_b16 a[200:201], v12 offset:24576
    v_cvt_pk_bf16_f32 v83, v58, v59
    v_mfma_f32_16x16x32_bf16 v[36:39], a[168:171], a[4:7], 0
    ds_read_b64_tr_b16 a[202:203], v12 offset:28672
    s_add_u32 s31, s61, 0
    v_mfma_f32_16x16x32_bf16 v[40:43], a[172:175], a[0:3], 0
    ds_read_b64_tr_b16 a[204:205], v13 offset:24576
    buffer_store_dwordx4 v[80:83], v14, s[24:27], s31 offen sc1
    v_mfma_f32_16x16x32_bf16 v[44:47], a[172:175], a[4:7], 0
    ds_read_b64_tr_b16 a[206:207], v13 offset:28672
    s_waitcnt lgkmcnt(8)
    v_mfma_f32_16x16x32_bf16 v[16:19], a[176:179], a[8:11], v[16:19]
    ds_read_b64_tr_b16 a[160:161], v10 offset:25600
    s_add_u32 m0, s28, 40960
    v_mfma_f32_16x16x32_bf16 v[20:23], a[176:179], a[12:15], v[20:23]
    ds_read_b64_tr_b16 a[162:163], v10 offset:29696
    s_add_u32 s30, s101, s34
    v_mfma_f32_16x16x32_bf16 v[24:27], a[180:183], a[8:11], v[24:27]
    ds_read_b64_tr_b16 a[164:165], v11 offset:25600
    v_cvt_pk_bf16_f32 v84, v52, v53
    v_mfma_f32_16x16x32_bf16 v[28:31], a[180:183], a[12:15], v[28:31]
    ds_read_b64_tr_b16 a[166:167], v11 offset:29696
    buffer_load_dwordx4 v4, s[20:23], s30 offen  lds
    v_mfma_f32_16x16x32_bf16 v[32:35], a[184:187], a[8:11], v[32:35]
    ds_read_b64_tr_b16 a[168:169], v12 offset:25600
    v_cvt_pk_bf16_f32 v85, v54, v55
    v_mfma_f32_16x16x32_bf16 v[36:39], a[184:187], a[12:15], v[36:39]
    ds_read_b64_tr_b16 a[170:171], v12 offset:29696
    v_cvt_pk_bf16_f32 v86, v60, v61
    v_mfma_f32_16x16x32_bf16 v[40:43], a[188:191], a[8:11], v[40:43]
    ds_read_b64_tr_b16 a[172:173], v13 offset:25600
    v_cvt_pk_bf16_f32 v87, v62, v63
    v_mfma_f32_16x16x32_bf16 v[44:47], a[188:191], a[12:15], v[44:47]
    ds_read_b64_tr_b16 a[174:175], v13 offset:29696
    s_waitcnt vmcnt(9) lgkmcnt(8)
    v_mfma_f32_16x16x32_bf16 v[16:19], a[192:195], a[16:19], v[16:19]
    s_barrier
    ds_read_b64_tr_b16 a[176:177], v10 offset:32768
    v_mfma_f32_16x16x32_bf16 v[20:23], a[192:195], a[20:23], v[20:23]
    ds_read_b64_tr_b16 a[178:179], v10 offset:36864
    v_mov_b32 v242, 5
    v_mfma_f32_16x16x32_bf16 v[24:27], a[196:199], a[16:19], v[24:27]
    ds_read_b64_tr_b16 a[180:181], v11 offset:32768
    s_mov_b64 exec, s[66:67]
    buffer_store_dword v242, off, s[72:75], s56 sc1
    s_mov_b64 exec, -1
    v_mfma_f32_16x16x32_bf16 v[28:31], a[196:199], a[20:23], v[28:31]
    ds_read_b64_tr_b16 a[182:183], v11 offset:36864
    buffer_load_dwordx4 v5, s[20:23], s30 offen offset:1024  lds
    v_mfma_f32_16x16x32_bf16 v[32:35], a[200:203], a[16:19], v[32:35]
    ds_read_b64_tr_b16 a[184:185], v12 offset:32768
    s_add_u32 s31, s61, 4096
    v_mfma_f32_16x16x32_bf16 v[36:39], a[200:203], a[20:23], v[36:39]
    ds_read_b64_tr_b16 a[186:187], v12 offset:36864
    buffer_store_dwordx4 v[84:87], v14, s[24:27], s31 offen sc1
    v_mfma_f32_16x16x32_bf16 v[40:43], a[204:207], a[16:19], v[40:43]
    ds_read_b64_tr_b16 a[188:189], v13 offset:32768
    v_cvt_pk_bf16_f32 v88, v64, v65
    v_mfma_f32_16x16x32_bf16 v[44:47], a[204:207], a[20:23], v[44:47]
    ds_read_b64_tr_b16 a[190:191], v13 offset:36864
    s_waitcnt lgkmcnt(8)
    v_mfma_f32_16x16x32_bf16 v[16:19], a[160:163], a[24:27], v[16:19]
    ds_read_b64_tr_b16 a[192:193], v10 offset:33792
    s_add_u32 m0, s28, 49152
    v_mfma_f32_16x16x32_bf16 v[20:23], a[160:163], a[28:31], v[20:23]
    ds_read_b64_tr_b16 a[194:195], v10 offset:37888
    s_add_u32 s30, s100, s35
    v_mfma_f32_16x16x32_bf16 v[24:27], a[164:167], a[24:27], v[24:27]
    ds_read_b64_tr_b16 a[196:197], v11 offset:33792
    v_cvt_pk_bf16_f32 v89, v66, v67
    v_mfma_f32_16x16x32_bf16 v[28:31], a[164:167], a[28:31], v[28:31]
    ds_read_b64_tr_b16 a[198:199], v11 offset:37888
    buffer_load_dwordx4 v4, s[20:23], s30 offen  lds
    v_mfma_f32_16x16x32_bf16 v[32:35], a[168:171], a[24:27], v[32:35]
    ds_read_b64_tr_b16 a[200:201], v12 offset:33792
    v_cvt_pk_bf16_f32 v90, v72, v73
    v_mfma_f32_16x16x32_bf16 v[36:39], a[168:171], a[28:31], v[36:39]
    ds_read_b64_tr_b16 a[202:203], v12 offset:37888
    v_cvt_pk_bf16_f32 v91, v74, v75
    v_mfma_f32_16x16x32_bf16 v[40:43], a[172:175], a[24:27], v[40:43]
    ds_read_b64_tr_b16 a[204:205], v13 offset:33792
    s_add_u32 s31, s61, 16384
    v_mfma_f32_16x16x32_bf16 v[44:47], a[172:175], a[28:31], v[44:47]
    ds_read_b64_tr_b16 a[206:207], v13 offset:37888
    s_waitcnt lgkmcnt(8)
    v_mfma_f32_16x16x32_bf16 v[16:19], a[176:179], a[32:35], v[16:19]
    ds_read_b64_tr_b16 a[160:161], v10 offset:40960
    v_mfma_f32_16x16x32_bf16 v[20:23], a[176:179], a[36:39], v[20:23]
    ds_read_b64_tr_b16 a[162:163], v10 offset:45056
    v_mfma_f32_16x16x32_bf16 v[24:27], a[180:183], a[32:35], v[24:27]
    ds_read_b64_tr_b16 a[164:165], v11 offset:40960
    v_mfma_f32_16x16x32_bf16 v[28:31], a[180:183], a[36:39], v[28:31]
    ds_read_b64_tr_b16 a[166:167], v11 offset:45056
    buffer_load_dwordx4 v5, s[20:23], s30 offen offset:1024  lds
    v_mfma_f32_16x16x32_bf16 v[32:35], a[184:187], a[32:35], v[32:35]
    ds_read_b64_tr_b16 a[168:169], v12 offset:40960
    buffer_store_dwordx4 v[88:91], v14, s[24:27], s31 offen sc1
    v_mfma_f32_16x16x32_bf16 v[36:39], a[184:187], a[36:39], v[36:39]
    ds_read_b64_tr_b16 a[170:171], v12 offset:45056
    v_cvt_pk_bf16_f32 v92, v68, v69
    v_mfma_f32_16x16x32_bf16 v[40:43], a[188:191], a[32:35], v[40:43]
    ds_read_b64_tr_b16 a[172:173], v13 offset:40960
    v_cvt_pk_bf16_f32 v93, v70, v71
    v_mfma_f32_16x16x32_bf16 v[44:47], a[188:191], a[36:39], v[44:47]
    ds_read_b64_tr_b16 a[174:175], v13 offset:45056
    s_waitcnt lgkmcnt(8)
    v_mfma_f32_16x16x32_bf16 v[16:19], a[192:195], a[40:43], v[16:19]
    ds_read_b64_tr_b16 a[176:177], v10 offset:41984
    s_add_u32 m0, s28, 57344
    v_mfma_f32_16x16x32_bf16 v[20:23], a[192:195], a[44:47], v[20:23]
    ds_read_b64_tr_b16 a[178:179], v10 offset:46080
    s_add_u32 s30, s101, s35
    v_mfma_f32_16x16x32_bf16 v[24:27], a[196:199], a[40:43], v[24:27]
    ds_read_b64_tr_b16 a[180:181], v11 offset:41984
    v_cvt_pk_bf16_f32 v94, v76, v77
    v_mfma_f32_16x16x32_bf16 v[28:31], a[196:199], a[44:47], v[28:31]
    ds_read_b64_tr_b16 a[182:183], v11 offset:46080
    buffer_load_dwordx4 v4, s[20:23], s30 offen  lds
    v_mfma_f32_16x16x32_bf16 v[32:35], a[200:203], a[40:43], v[32:35]
    ds_read_b64_tr_b16 a[184:185], v12 offset:41984
    v_cvt_pk_bf16_f32 v95, v78, v79
    v_mfma_f32_16x16x32_bf16 v[36:39], a[200:203], a[44:47], v[36:39]
    ds_read_b64_tr_b16 a[186:187], v12 offset:46080
    s_add_u32 s31, s61, 20480
    v_mfma_f32_16x16x32_bf16 v[40:43], a[204:207], a[40:43], v[40:43]
    ds_read_b64_tr_b16 a[188:189], v13 offset:41984
    buffer_store_dwordx4 v[92:95], v14, s[24:27], s31 offen sc1
    v_mfma_f32_16x16x32_bf16 v[44:47], a[204:207], a[44:47], v[44:47]
    ds_read_b64_tr_b16 a[190:191], v13 offset:46080
    s_waitcnt lgkmcnt(8)
    v_mfma_f32_16x16x32_bf16 v[16:19], a[160:163], a[48:51], v[16:19]
    ds_read_b64_tr_b16 a[192:193], v10 offset:49152
    v_mfma_f32_16x16x32_bf16 v[20:23], a[160:163], a[52:55], v[20:23]
    ds_read_b64_tr_b16 a[194:195], v10 offset:53248
    v_mfma_f32_16x16x32_bf16 v[24:27], a[164:167], a[48:51], v[24:27]
    ds_read_b64_tr_b16 a[196:197], v11 offset:49152
    v_mfma_f32_16x16x32_bf16 v[28:31], a[164:167], a[52:55], v[28:31]
    ds_read_b64_tr_b16 a[198:199], v11 offset:53248
    buffer_load_dwordx4 v5, s[20:23], s30 offen offset:1024  lds
    v_mfma_f32_16x16x32_bf16 v[32:35], a[168:171], a[48:51], v[32:35]
    ds_read_b64_tr_b16 a[200:201], v12 offset:49152
    s_add_u32 m0, s28, 65536
    v_mfma_f32_16x16x32_bf16 v[36:39], a[168:171], a[52:55], v[36:39]
    ds_read_b64_tr_b16 a[202:203], v12 offset:53248
    s_add_u32 s30, s100, s36
    v_mfma_f32_16x16x32_bf16 v[40:43], a[172:175], a[48:51], v[40:43]
    ds_read_b64_tr_b16 a[204:205], v13 offset:49152
    v_mfma_f32_16x16x32_bf16 v[44:47], a[172:175], a[52:55], v[44:47]
    ds_read_b64_tr_b16 a[206:207], v13 offset:53248
    s_waitcnt lgkmcnt(8)
    v_mfma_f32_16x16x32_bf16 v[16:19], a[176:179], a[56:59], v[16:19]
    ds_read_b64_tr_b16 a[160:161], v10 offset:50176
    v_mfma_f32_16x16x32_bf16 v[20:23], a[176:179], a[60:63], v[20:23]
    ds_read_b64_tr_b16 a[162:163], v10 offset:54272
    v_mfma_f32_16x16x32_bf16 v[24:27], a[180:183], a[56:59], v[24:27]
    ds_read_b64_tr_b16 a[164:165], v11 offset:50176
    v_mfma_f32_16x16x32_bf16 v[28:31], a[180:183], a[60:63], v[28:31]
    ds_read_b64_tr_b16 a[166:167], v11 offset:54272
    buffer_load_dwordx4 v4, s[20:23], s30 offen  lds
    v_mfma_f32_16x16x32_bf16 v[32:35], a[184:187], a[56:59], v[32:35]
    ds_read_b64_tr_b16 a[168:169], v12 offset:50176
    v_mfma_f32_16x16x32_bf16 v[36:39], a[184:187], a[60:63], v[36:39]
    ds_read_b64_tr_b16 a[170:171], v12 offset:54272
    v_mfma_f32_16x16x32_bf16 v[40:43], a[188:191], a[56:59], v[40:43]
    ds_read_b64_tr_b16 a[172:173], v13 offset:50176
    v_mfma_f32_16x16x32_bf16 v[44:47], a[188:191], a[60:63], v[44:47]
    ds_read_b64_tr_b16 a[174:175], v13 offset:54272
    s_waitcnt lgkmcnt(8)
    v_mfma_f32_16x16x32_bf16 v[16:19], a[192:195], a[64:67], v[16:19]
    ds_read_b64_tr_b16 a[176:177], v10 offset:57344
    v_mfma_f32_16x16x32_bf16 v[20:23], a[192:195], a[68:71], v[20:23]
    ds_read_b64_tr_b16 a[178:179], v10 offset:61440
    v_mfma_f32_16x16x32_bf16 v[24:27], a[196:199], a[64:67], v[24:27]
    ds_read_b64_tr_b16 a[180:181], v11 offset:57344
    v_mfma_f32_16x16x32_bf16 v[28:31], a[196:199], a[68:71], v[28:31]
    ds_read_b64_tr_b16 a[182:183], v11 offset:61440
    buffer_load_dwordx4 v5, s[20:23], s30 offen offset:1024  lds
    v_mfma_f32_16x16x32_bf16 v[32:35], a[200:203], a[64:67], v[32:35]
    ds_read_b64_tr_b16 a[184:185], v12 offset:57344
    s_add_u32 m0, s28, 73728
    v_mfma_f32_16x16x32_bf16 v[36:39], a[200:203], a[68:71], v[36:39]
    ds_read_b64_tr_b16 a[186:187], v12 offset:61440
    s_add_u32 s30, s101, s36
    v_mfma_f32_16x16x32_bf16 v[40:43], a[204:207], a[64:67], v[40:43]
    ds_read_b64_tr_b16 a[188:189], v13 offset:57344
    v_mfma_f32_16x16x32_bf16 v[44:47], a[204:207], a[68:71], v[44:47]
    ds_read_b64_tr_b16 a[190:191], v13 offset:61440
    s_waitcnt lgkmcnt(8)
    v_mfma_f32_16x16x32_bf16 v[16:19], a[160:163], a[72:75], v[16:19]
    ds_read_b64_tr_b16 a[192:193], v10 offset:58368
    v_mfma_f32_16x16x32_bf16 v[20:23], a[160:163], a[76:79], v[20:23]
    ds_read_b64_tr_b16 a[194:195], v10 offset:62464
    v_mfma_f32_16x16x32_bf16 v[24:27], a[164:167], a[72:75], v[24:27]
    ds_read_b64_tr_b16 a[196:197], v11 offset:58368
    v_mfma_f32_16x16x32_bf16 v[28:31], a[164:167], a[76:79], v[28:31]
    ds_read_b64_tr_b16 a[198:199], v11 offset:62464
    buffer_load_dwordx4 v4, s[20:23], s30 offen  lds
    v_mfma_f32_16x16x32_bf16 v[32:35], a[168:171], a[72:75], v[32:35]
    ds_read_b64_tr_b16 a[200:201], v12 offset:58368
    v_mfma_f32_16x16x32_bf16 v[36:39], a[168:171], a[76:79], v[36:39]
    ds_read_b64_tr_b16 a[202:203], v12 offset:62464
    v_mfma_f32_16x16x32_bf16 v[40:43], a[172:175], a[72:75], v[40:43]
    ds_read_b64_tr_b16 a[204:205], v13 offset:58368
    v_mfma_f32_16x16x32_bf16 v[44:47], a[172:175], a[76:79], v[44:47]
    ds_read_b64_tr_b16 a[206:207], v13 offset:62464
    s_waitcnt vmcnt(15) lgkmcnt(8)
    v_mfma_f32_16x16x32_bf16 v[16:19], a[176:179], a[80:83], v[16:19]
    s_barrier
    ds_read_b64_tr_b16 a[160:161], v6 offset:0
    v_mfma_f32_16x16x32_bf16 v[20:23], a[176:179], a[84:87], v[20:23]
    ds_read_b64_tr_b16 a[162:163], v6 offset:4096
    v_mfma_f32_16x16x32_bf16 v[24:27], a[180:183], a[80:83], v[24:27]
    ds_read_b64_tr_b16 a[164:165], v7 offset:0
    v_mfma_f32_16x16x32_bf16 v[28:31], a[180:183], a[84:87], v[28:31]
    ds_read_b64_tr_b16 a[166:167], v7 offset:4096
L_pm8:
    s_cbranch_execz L_pmb2
    buffer_load_dwordx4 v5, s[20:23], s30 offen offset:1024  lds
    v_mfma_f32_16x16x32_bf16 v[32:35], a[184:187], a[80:83], v[32:35]
    ds_read_b64_tr_b16 a[168:169], v8 offset:0
    s_add_u32 m0, s28, 81920
    v_mfma_f32_16x16x32_bf16 v[36:39], a[184:187], a[84:87], v[36:39]
    ds_read_b64_tr_b16 a[170:171], v8 offset:4096
    s_add_u32 s30, s100, s37
    v_mfma_f32_16x16x32_bf16 v[40:43], a[188:191], a[80:83], v[40:43]
    ds_read_b64_tr_b16 a[172:173], v9 offset:0
    v_mfma_f32_16x16x32_bf16 v[44:47], a[188:191], a[84:87], v[44:47]
    ds_read_b64_tr_b16 a[174:175], v9 offset:4096
    s_waitcnt lgkmcnt(8)
    v_mfma_f32_16x16x32_bf16 v[16:19], a[192:195], a[88:91], v[16:19]
    ds_read_b64_tr_b16 a[176:177], v6 offset:1024
    v_mfma_f32_16x16x32_bf16 v[20:23], a[192:195], a[92:95], v[20:23]
    ds_read_b64_tr_b16 a[178:179], v6 offset:5120
    v_mfma_f32_16x16x32_bf16 v[24:27], a[196:199], a[88:91], v[24:27]
    ds_read_b64_tr_b16 a[180:181], v7 offset:1024
    v_mfma_f32_16x16x32_bf16 v[28:31], a[196:199], a[92:95], v[28:31]
    ds_read_b64_tr_b16 a[182:183], v7 offset:5120
    buffer_load_dwordx4 v4, s[20:23], s30 offen  lds
    v_mfma_f32_16x16x32_bf16 v[32:35], a[200:203], a[88:91], v[32:35]
    ds_read_b64_tr_b16 a[184:185], v8 offset:1024
    v_mfma_f32_16x16x32_bf16 v[36:39], a[200:203], a[92:95], v[36:39]
    ds_read_b64_tr_b16 a[186:187], v8 offset:5120
    v_mfma_f32_16x16x32_bf16 v[40:43], a[204:207], a[88:91], v[40:43]
    ds_read_b64_tr_b16 a[188:189], v9 offset:1024
    v_mfma_f32_16x16x32_bf16 v[44:47], a[204:207], a[92:95], v[44:47]
    ds_read_b64_tr_b16 a[190:191], v9 offset:5120
    s_waitcnt lgkmcnt(8)
    v_mfma_f32_16x16x32_bf16 v[16:19], a[160:163], a[96:99], v[16:19]
    ds_read_b64_tr_b16 a[192:193], v6 offset:8192
    v_mfma_f32_16x16x32_bf16 v[20:23], a[160:163], a[100:103], v[20:23]
    ds_read_b64_tr_b16 a[194:195], v6 offset:12288
    v_mfma_f32_16x16x32_bf16 v[24:27], a[164:167], a[96:99], v[24:27]
    ds_read_b64_tr_b16 a[196:197], v7 offset:8192
    v_mfma_f32_16x16x32_bf16 v[28:31], a[164:167], a[100:103], v[28:31]
    ds_read_b64_tr_b16 a[198:199], v7 offset:12288
    buffer_load_dwordx4 v5, s[20:23], s30 offen offset:1024  lds
    v_mfma_f32_16x16x32_bf16 v[32:35], a[168:171], a[96:99], v[32:35]
    ds_read_b64_tr_b16 a[200:201], v8 offset:8192
    s_add_u32 m0, s28, 90112
    v_mfma_f32_16x16x32_bf16 v[36:39], a[168:171], a[100:103], v[36:39]
    ds_read_b64_tr_b16 a[202:203], v8 offset:12288
    s_add_u32 s30, s101, s37
    v_mfma_f32_16x16x32_bf16 v[40:43], a[172:175], a[96:99], v[40:43]
    ds_read_b64_tr_b16 a[204:205], v9 offset:8192
    v_mfma_f32_16x16x32_bf16 v[44:47], a[172:175], a[100:103], v[44:47]
    ds_read_b64_tr_b16 a[206:207], v9 offset:12288
    s_waitcnt lgkmcnt(8)
    v_mfma_f32_16x16x32_bf16 v[16:19], a[176:179], a[104:107], v[16:19]
    ds_read_b64_tr_b16 a[160:161], v6 offset:9216
    v_mfma_f32_16x16x32_bf16 v[20:23], a[176:179], a[108:111], v[20:23]
    ds_read_b64_tr_b16 a[162:163], v6 offset:13312
    v_mfma_f32_16x16x32_bf16 v[24:27], a[180:183], a[104:107], v[24:27]
    ds_read_b64_tr_b16 a[164:165], v7 offset:9216
    v_mfma_f32_16x16x32_bf16 v[28:31], a[180:183], a[108:111], v[28:31]
    ds_read_b64_tr_b16 a[166:167], v7 offset:13312
    buffer_load_dwordx4 v4, s[20:23], s30 offen  lds
    v_mfma_f32_16x16x32_bf16 v[32:35], a[184:187], a[104:107], v[32:35]
    ds_read_b64_tr_b16 a[168:169], v8 offset:9216
    v_mfma_f32_16x16x32_bf16 v[36:39], a[184:187], a[108:111], v[36:39]
    ds_read_b64_tr_b16 a[170:171], v8 offset:13312
    v_mfma_f32_16x16x32_bf16 v[40:43], a[188:191], a[104:107], v[40:43]
    ds_read_b64_tr_b16 a[172:173], v9 offset:9216
    v_mfma_f32_16x16x32_bf16 v[44:47], a[188:191], a[108:111], v[44:47]
    ds_read_b64_tr_b16 a[174:175], v9 offset:13312
    s_waitcnt lgkmcnt(8)
    v_mfma_f32_16x16x32_bf16 v[16:19], a[192:195], a[112:115], v[16:19]
    ds_read_b64_tr_b16 a[176:177], v6 offset:16384
    v_mfma_f32_16x16x32_bf16 v[20:23], a[192:195], a[116:119], v[20:23]
    ds_read_b64_tr_b16 a[178:179], v6 offset:20480
    buffer_load_dword v248, v247, s[72:75], 0 offen sc1
    v_mfma_f32_16x16x32_bf16 v[24:27], a[196:199], a[112:115], v[24:27]
    ds_read_b64_tr_b16 a[180:181], v7 offset:16384
    v_mfma_f32_16x16x32_bf16 v[28:31], a[196:199], a[116:119], v[28:31]
    ds_read_b64_tr_b16 a[182:183], v7 offset:20480
    buffer_load_dwordx4 v5, s[20:23], s30 offen offset:1024  lds
    v_mfma_f32_16x16x32_bf16 v[32:35], a[200:203], a[112:115], v[32:35]
    ds_read_b64_tr_b16 a[184:185], v8 offset:16384
    v_mfma_f32_16x16x32_bf16 v[36:39], a[200:203], a[116:119], v[36:39]
    ds_read_b64_tr_b16 a[186:187], v8 offset:20480
    v_mfma_f32_16x16x32_bf16 v[40:43], a[204:207], a[112:115], v[40:43]
    ds_read_b64_tr_b16 a[188:189], v9 offset:16384
    v_mfma_f32_16x16x32_bf16 v[44:47], a[204:207], a[116:119], v[44:47]
    ds_read_b64_tr_b16 a[190:191], v9 offset:20480
    s_waitcnt lgkmcnt(8)
    v_mfma_f32_16x16x32_bf16 v[16:19], a[160:163], a[120:123], v[16:19]
    ds_read_b64_tr_b16 a[192:193], v6 offset:17408
    v_mfma_f32_16x16x32_bf16 v[20:23], a[160:163], a[124:127], v[20:23]
    ds_read_b64_tr_b16 a[194:195], v6 offset:21504
    v_mfma_f32_16x16x32_bf16 v[24:27], a[164:167], a[120:123], v[24:27]
    ds_read_b64_tr_b16 a[196:197], v7 offset:17408
    v_mfma_f32_16x16x32_bf16 v[28:31], a[164:167], a[124:127], v[28:31]
    ds_read_b64_tr_b16 a[198:199], v7 offset:21504
    v_mfma_f32_16x16x32_bf16 v[32:35], a[168:171], a[120:123], v[32:35]
    ds_read_b64_tr_b16 a[200:201], v8 offset:17408
    v_mfma_f32_16x16x32_bf16 v[36:39], a[168:171], a[124:127], v[36:39]
    ds_read_b64_tr_b16 a[202:203], v8 offset:21504
    v_mfma_f32_16x16x32_bf16 v[40:43], a[172:175], a[120:123], v[40:43]
    ds_read_b64_tr_b16 a[204:205], v9 offset:17408
    v_mfma_f32_16x16x32_bf16 v[44:47], a[172:175], a[124:127], v[44:47]
    ds_read_b64_tr_b16 a[206:207], v9 offset:21504
    s_waitcnt lgkmcnt(8)
    v_mfma_f32_16x16x32_bf16 v[16:19], a[176:179], a[128:131], v[16:19]
    ds_read_b64_tr_b16 a[160:161], v6 offset:24576
    v_mfma_f32_16x16x32_bf16 v[20:23], a[176:179], a[132:135], v[20:23]
    ds_read_b64_tr_b16 a[162:163], v6 offset:28672
    v_mfma_f32_16x16x32_bf16 v[24:27], a[180:183], a[128:131], v[24:27]
    ds_read_b64_tr_b16 a[164:165], v7 offset:24576
    v_mfma_f32_16x16x32_bf16 v[28:31], a[180:183], a[132:135], v[28:31]
    ds_read_b64_tr_b16 a[166:167], v7 offset:28672
    v_mfma_f32_16x16x32_bf16 v[32:35], a[184:187], a[128:131], v[32:35]
    ds_read_b64_tr_b16 a[168:169], v8 offset:24576
    v_mfma_f32_16x16x32_bf16 v[36:39], a[184:187], a[132:135], v[36:39]
    ds_read_b64_tr_b16 a[170:171], v8 offset:28672
    v_mfma_f32_16x16x32_bf16 v[40:43], a[188:191], a[128:131], v[40:43]
    ds_read_b64_tr_b16 a[172:173], v9 offset:24576
    v_mfma_f32_16x16x32_bf16 v[44:47], a[188:191], a[132:135], v[44:47]
    ds_read_b64_tr_b16 a[174:175], v9 offset:28672
    s_waitcnt lgkmcnt(8)
    v_mfma_f32_16x16x32_bf16 v[16:19], a[192:195], a[136:139], v[16:19]
    ds_read_b64_tr_b16 a[176:177], v6 offset:25600
    v_mfma_f32_16x16x32_bf16 v[20:23], a[192:195], a[140:143], v[20:23]
    ds_read_b64_tr_b16 a[178:179], v6 offset:29696
    v_mfma_f32_16x16x32_bf16 v[24:27], a[196:199], a[136:139], v[24:27]
    ds_read_b64_tr_b16 a[180:181], v7 offset:25600
    v_mfma_f32_16x16x32_bf16 v[28:31], a[196:199], a[140:143], v[28:31]
    ds_read_b64_tr_b16 a[182:183], v7 offset:29696
    v_mfma_f32_16x16x32_bf16 v[32:35], a[200:203], a[136:139], v[32:35]
    ds_read_b64_tr_b16 a[184:185], v8 offset:25600
    v_mfma_f32_16x16x32_bf16 v[36:39], a[200:203], a[140:143], v[36:39]
    ds_read_b64_tr_b16 a[186:187], v8 offset:29696
    v_mfma_f32_16x16x32_bf16 v[40:43], a[204:207], a[136:139], v[40:43]
    ds_read_b64_tr_b16 a[188:189], v9 offset:25600
    v_mfma_f32_16x16x32_bf16 v[44:47], a[204:207], a[140:143], v[44:47]
    ds_read_b64_tr_b16 a[190:191], v9 offset:29696
    s_waitcnt vmcnt(9) lgkmcnt(8)
    v_mfma_f32_16x16x32_bf16 v[16:19], a[160:163], a[144:147], v[16:19]
    s_barrier
    ds_read_b64_tr_b16 a[192:193], v6 offset:32768
    v_mfma_f32_16x16x32_bf16 v[20:23], a[160:163], a[148:151], v[20:23]
    ds_read_b64_tr_b16 a[194:195], v6 offset:36864
    s_mov_b32 s44, s48
    v_mfma_f32_16x16x32_bf16 v[24:27], a[164:167], a[144:147], v[24:27]
    ds_read_b64_tr_b16 a[196:197], v7 offset:32768
    v_mov_b32 v242, 6
    v_mfma_f32_16x16x32_bf16 v[28:31], a[164:167], a[148:151], v[28:31]
    ds_read_b64_tr_b16 a[198:199], v7 offset:36864
    s_mov_b64 exec, s[66:67]
    buffer_store_dword v242, off, s[72:75], s56 sc1
    s_mov_b64 exec, -1
    v_mfma_f32_16x16x32_bf16 v[32:35], a[168:171], a[144:147], v[32:35]
    ds_read_b64_tr_b16 a[200:201], v8 offset:32768
    v_mfma_f32_16x16x32_bf16 v[36:39], a[168:171], a[148:151], v[36:39]
    ds_read_b64_tr_b16 a[202:203], v8 offset:36864
    v_mfma_f32_16x16x32_bf16 v[40:43], a[172:175], a[144:147], v[40:43]
    ds_read_b64_tr_b16 a[204:205], v9 offset:32768
    s_mov_b32 s45, s49
    v_mfma_f32_16x16x32_bf16 v[44:47], a[172:175], a[148:151], v[44:47]
    ds_read_b64_tr_b16 a[206:207], v9 offset:36864
    s_waitcnt lgkmcnt(8)
    v_mfma_f32_16x16x32_bf16 v[16:19], a[176:179], a[152:155], v[16:19]
    ds_read_b64_tr_b16 a[160:161], v6 offset:33792
    v_mfma_f32_16x16x32_bf16 v[20:23], a[176:179], a[156:159], v[20:23]
    ds_read_b64_tr_b16 a[162:163], v6 offset:37888
    s_mov_b32 s46, 2359296
    v_mfma_f32_16x16x32_bf16 v[24:27], a[180:183], a[152:155], v[24:27]
    ds_read_b64_tr_b16 a[164:165], v7 offset:33792
    v_mfma_f32_16x16x32_bf16 v[28:31], a[180:183], a[156:159], v[28:31]
    ds_read_b64_tr_b16 a[166:167], v7 offset:37888
    v_mfma_f32_16x16x32_bf16 v[32:35], a[184:187], a[152:155], v[32:35]
    ds_read_b64_tr_b16 a[168:169], v8 offset:33792
    v_mfma_f32_16x16x32_bf16 v[36:39], a[184:187], a[156:159], v[36:39]
    ds_read_b64_tr_b16 a[170:171], v8 offset:37888
    v_mfma_f32_16x16x32_bf16 v[40:43], a[188:191], a[152:155], v[40:43]
    ds_read_b64_tr_b16 a[172:173], v9 offset:33792
    s_mov_b32 s47, 0x20000
    v_mfma_f32_16x16x32_bf16 v[44:47], a[188:191], a[156:159], v[44:47]
    ds_read_b64_tr_b16 a[174:175], v9 offset:37888
    s_waitcnt lgkmcnt(8)
    v_mfma_f32_16x16x32_bf16 v[16:19], a[192:195], a[208:211], v[16:19]
    ds_read_b64_tr_b16 a[176:177], v6 offset:40960
    v_mfma_f32_16x16x32_bf16 v[20:23], a[192:195], a[212:215], v[20:23]
    ds_read_b64_tr_b16 a[178:179], v6 offset:45056
    v_mfma_f32_16x16x32_bf16 v[24:27], a[196:199], a[208:211], v[24:27]
    ds_read_b64_tr_b16 a[180:181], v7 offset:40960
    v_mfma_f32_16x16x32_bf16 v[28:31], a[196:199], a[212:215], v[28:31]
    ds_read_b64_tr_b16 a[182:183], v7 offset:45056
    v_mfma_f32_16x16x32_bf16 v[32:35], a[200:203], a[208:211], v[32:35]
    ds_read_b64_tr_b16 a[184:185], v8 offset:40960
    v_mfma_f32_16x16x32_bf16 v[36:39], a[200:203], a[212:215], v[36:39]
    ds_read_b64_tr_b16 a[186:187], v8 offset:45056
    v_mfma_f32_16x16x32_bf16 v[40:43], a[204:207], a[208:211], v[40:43]
    ds_read_b64_tr_b16 a[188:189], v9 offset:40960
    v_mfma_f32_16x16x32_bf16 v[44:47], a[204:207], a[212:215], v[44:47]
    ds_read_b64_tr_b16 a[190:191], v9 offset:45056
    s_waitcnt lgkmcnt(8)
    v_mfma_f32_16x16x32_bf16 v[16:19], a[160:163], a[216:219], v[16:19]
    ds_read_b64_tr_b16 a[192:193], v6 offset:41984
    v_mfma_f32_16x16x32_bf16 v[20:23], a[160:163], a[220:223], v[20:23]
    ds_read_b64_tr_b16 a[194:195], v6 offset:46080
    v_mfma_f32_16x16x32_bf16 v[24:27], a[164:167], a[216:219], v[24:27]
    ds_read_b64_tr_b16 a[196:197], v7 offset:41984
    v_mfma_f32_16x16x32_bf16 v[28:31], a[164:167], a[220:223], v[28:31]
    ds_read_b64_tr_b16 a[198:199], v7 offset:46080
    v_mfma_f32_16x16x32_bf16 v[32:35], a[168:171], a[216:219], v[32:35]
    ds_read_b64_tr_b16 a[200:201], v8 offset:41984
    v_mfma_f32_16x16x32_bf16 v[36:39], a[168:171], a[220:223], v[36:39]
    ds_read_b64_tr_b16 a[202:203], v8 offset:46080
    v_mfma_f32_16x16x32_bf16 v[40:43], a[172:175], a[216:219], v[40:43]
    ds_read_b64_tr_b16 a[204:205], v9 offset:41984
    v_mfma_f32_16x16x32_bf16 v[44:47], a[172:175], a[220:223], v[44:47]
    ds_read_b64_tr_b16 a[206:207], v9 offset:46080
    s_waitcnt vmcnt(1)
    v_cmp_le_u32 vcc, 5, v248
    s_nop 1
    s_cmp_eq_u64 vcc, -1
    s_cbranch_scc0 L_f0_slow
L_f0_back:
    s_waitcnt lgkmcnt(8)
    v_mfma_f32_16x16x32_bf16 v[16:19], a[176:179], a[224:227], v[16:19]
    ds_read_b64_tr_b16 a[160:161], v6 offset:49152
    v_mfma_f32_16x16x32_bf16 v[20:23], a[176:179], a[228:231], v[20:23]
    ds_read_b64_tr_b16 a[162:163], v6 offset:53248
    buffer_load_dwordx4 v[192:195], v14, s[12:15], s85 offen offset:0 sc1
    v_mfma_f32_16x16x32_bf16 v[24:27], a[180:183], a[224:227], v[24:27]
    ds_read_b64_tr_b16 a[164:165], v7 offset:49152
    v_mfma_f32_16x16x32_bf16 v[28:31], a[180:183], a[228:231], v[28:31]
    ds_read_b64_tr_b16 a[166:167], v7 offset:53248
    v_mfma_f32_16x16x32_bf16 v[32:35], a[184:187], a[224:227], v[32:35]
    ds_read_b64_tr_b16 a[168:169], v8 offset:49152
    v_mfma_f32_16x16x32_bf16 v[36:39], a[184:187], a[228:231], v[36:39]
    ds_read_b64_tr_b16 a[170:171], v8 offset:53248
    v_mfma_f32_16x16x32_bf16 v[40:43], a[188:191], a[224:227], v[40:43]
    ds_read_b64_tr_b16 a[172:173], v9 offset:49152
    buffer_load_dwordx4 v[196:199], v14, s[12:15], s85 offen offset:1024 sc1
    v_mfma_f32_16x16x32_bf16 v[44:47], a[188:191], a[228:231], v[44:47]
    ds_read_b64_tr_b16 a[174:175], v9 offset:53248
    s_waitcnt lgkmcnt(8)
    v_mfma_f32_16x16x32_bf16 v[16:19], a[192:195], a[232:235], v[16:19]
    ds_read_b64_tr_b16 a[176:177], v6 offset:50176
    v_mfma_f32_16x16x32_bf16 v[20:23], a[192:195], a[236:239], v[20:23]
    ds_read_b64_tr_b16 a[178:179], v6 offset:54272
    v_mfma_f32_16x16x32_bf16 v[24:27], a[196:199], a[232:235], v[24:27]
    ds_read_b64_tr_b16 a[180:181], v7 offset:50176
    v_mfma_f32_16x16x32_bf16 v[28:31], a[196:199], a[236:239], v[28:31]
    ds_read_b64_tr_b16 a[182:183], v7 offset:54272
    v_mfma_f32_16x16x32_bf16 v[32:35], a[200:203], a[232:235], v[32:35]
    ds_read_b64_tr_b16 a[184:185], v8 offset:50176
    v_mfma_f32_16x16x32_bf16 v[36:39], a[200:203], a[236:239], v[36:39]
    ds_read_b64_tr_b16 a[186:187], v8 offset:54272
    v_mfma_f32_16x16x32_bf16 v[40:43], a[204:207], a[232:235], v[40:43]
    ds_read_b64_tr_b16 a[188:189], v9 offset:50176
    buffer_load_dwordx4 v[200:203], v14, s[12:15], s85 offen offset:2048 sc1
    v_mfma_f32_16x16x32_bf16 v[44:47], a[204:207], a[236:239], v[44:47]
    ds_read_b64_tr_b16 a[190:191], v9 offset:54272
    s_waitcnt lgkmcnt(8)
    v_mfma_f32_16x16x32_bf16 v[16:19], a[160:163], v[96:99], v[16:19]
    ds_read_b64_tr_b16 a[192:193], v6 offset:57344
    v_mfma_f32_16x16x32_bf16 v[20:23], a[160:163], v[100:103], v[20:23]
    ds_read_b64_tr_b16 a[194:195], v6 offset:61440
    v_mfma_f32_16x16x32_bf16 v[24:27], a[164:167], v[96:99], v[24:27]
    ds_read_b64_tr_b16 a[196:197], v7 offset:57344
    v_mfma_f32_16x16x32_bf16 v[28:31], a[164:167], v[100:103], v[28:31]
    ds_read_b64_tr_b16 a[198:199], v7 offset:61440
    v_mfma_f32_16x16x32_bf16 v[32:35], a[168:171], v[96:99], v[32:35]
    ds_read_b64_tr_b16 a[200:201], v8 offset:57344
    v_mfma_f32_16x16x32_bf16 v[36:39], a[168:171], v[100:103], v[36:39]
    ds_read_b64_tr_b16 a[202:203], v8 offset:61440
    v_mfma_f32_16x16x32_bf16 v[40:43], a[172:175], v[96:99], v[40:43]
    ds_read_b64_tr_b16 a[204:205], v9 offset:57344
    buffer_load_dwordx4 v[204:207], v14, s[12:15], s85 offen offset:3072 sc1
    v_mfma_f32_16x16x32_bf16 v[44:47], a[172:175], v[100:103], v[44:47]
    ds_read_b64_tr_b16 a[206:207], v9 offset:61440
    s_waitcnt lgkmcnt(8)
    v_mfma_f32_16x16x32_bf16 v[16:19], a[176:179], v[104:107], v[16:19]
    ds_read_b64_tr_b16 a[160:161], v6 offset:58368
    v_mfma_f32_16x16x32_bf16 v[20:23], a[176:179], v[108:111], v[20:23]
    ds_read_b64_tr_b16 a[162:163], v6 offset:62464
    v_mfma_f32_16x16x32_bf16 v[24:27], a[180:183], v[104:107], v[24:27]
    ds_read_b64_tr_b16 a[164:165], v7 offset:58368
    v_mfma_f32_16x16x32_bf16 v[28:31], a[180:183], v[108:111], v[28:31]
    ds_read_b64_tr_b16 a[166:167], v7 offset:62464
    v_mfma_f32_16x16x32_bf16 v[32:35], a[184:187], v[104:107], v[32:35]
    ds_read_b64_tr_b16 a[168:169], v8 offset:58368
    v_mfma_f32_16x16x32_bf16 v[36:39], a[184:187], v[108:111], v[36:39]
    ds_read_b64_tr_b16 a[170:171], v8 offset:62464
    v_mfma_f32_16x16x32_bf16 v[40:43], a[188:191], v[104:107], v[40:43]
    ds_read_b64_tr_b16 a[172:173], v9 offset:58368
    v_mfma_f32_16x16x32_bf16 v[44:47], a[188:191], v[108:111], v[44:47]
    ds_read_b64_tr_b16 a[174:175], v9 offset:62464
    s_waitcnt vmcnt(4) lgkmcnt(8)
    v_mfma_f32_16x16x32_bf16 v[16:19], a[192:195], v[144:147], v[16:19]
    s_barrier
    ds_read_b64_tr_b16 a[176:177], v10 offset:0
    v_mfma_f32_16x16x32_bf16 v[20:23], a[192:195], v[148:151], v[20:23]
    ds_read_b64_tr_b16 a[178:179], v10 offset:4096
    v_mfma_f32_16x16x32_bf16 v[24:27], a[196:199], v[144:147], v[24:27]
    ds_read_b64_tr_b16 a[180:181], v11 offset:0
    v_mfma_f32_16x16x32_bf16 v[28:31], a[196:199], v[148:151], v[28:31]
    ds_read_b64_tr_b16 a[182:183], v11 offset:4096
    v_mfma_f32_16x16x32_bf16 v[32:35], a[200:203], v[144:147], v[32:35]
    ds_read_b64_tr_b16 a[184:185], v12 offset:0
    v_mfma_f32_16x16x32_bf16 v[36:39], a[200:203], v[148:151], v[36:39]
    ds_read_b64_tr_b16 a[186:187], v12 offset:4096
    v_mfma_f32_16x16x32_bf16 v[40:43], a[204:207], v[144:147], v[40:43]
    ds_read_b64_tr_b16 a[188:189], v13 offset:0
    v_mfma_f32_16x16x32_bf16 v[44:47], a[204:207], v[148:151], v[44:47]
    ds_read_b64_tr_b16 a[190:191], v13 offset:4096
    s_waitcnt lgkmcnt(8)
    v_mfma_f32_16x16x32_bf16 v[16:19], a[160:163], v[152:155], v[16:19]
    ds_read_b64_tr_b16 a[192:193], v10 offset:1024
    v_mfma_f32_16x16x32_bf16 v[20:23], a[160:163], v[156:159], v[20:23]
    ds_read_b64_tr_b16 a[194:195], v10 offset:5120
    v_mfma_f32_16x16x32_bf16 v[24:27], a[164:167], v[152:155], v[24:27]
    ds_read_b64_tr_b16 a[196:197], v11 offset:1024
    v_mfma_f32_16x16x32_bf16 v[28:31], a[164:167], v[156:159], v[28:31]
    ds_read_b64_tr_b16 a[198:199], v11 offset:5120
    v_mfma_f32_16x16x32_bf16 v[32:35], a[168:171], v[152:155], v[32:35]
    ds_read_b64_tr_b16 a[200:201], v12 offset:1024
    v_mfma_f32_16x16x32_bf16 v[36:39], a[168:171], v[156:159], v[36:39]
    ds_read_b64_tr_b16 a[202:203], v12 offset:5120
    v_mfma_f32_16x16x32_bf16 v[40:43], a[172:175], v[152:155], v[40:43]
    ds_read_b64_tr_b16 a[204:205], v13 offset:1024
    v_mfma_f32_16x16x32_bf16 v[44:47], a[172:175], v[156:159], v[44:47]
    ds_read_b64_tr_b16 a[206:207], v13 offset:5120
    s_waitcnt lgkmcnt(8)
    v_mfma_f32_16x16x32_bf16 v[16:19], a[176:179], v[112:115], v[16:19]
    ds_read_b64_tr_b16 a[160:161], v10 offset:8192
    v_mfma_f32_16x16x32_bf16 v[20:23], a[176:179], v[116:119], v[20:23]
    ds_read_b64_tr_b16 a[162:163], v10 offset:12288
    v_mfma_f32_16x16x32_bf16 v[24:27], a[180:183], v[112:115], v[24:27]
    ds_read_b64_tr_b16 a[164:165], v11 offset:8192
    v_mfma_f32_16x16x32_bf16 v[28:31], a[180:183], v[116:119], v[28:31]
    ds_read_b64_tr_b16 a[166:167], v11 offset:12288
    v_mfma_f32_16x16x32_bf16 v[32:35], a[184:187], v[112:115], v[32:35]
    ds_read_b64_tr_b16 a[168:169], v12 offset:8192
    v_mfma_f32_16x16x32_bf16 v[36:39], a[184:187], v[116:119], v[36:39]
    ds_read_b64_tr_b16 a[170:171], v12 offset:12288
    v_mfma_f32_16x16x32_bf16 v[40:43], a[188:191], v[112:115], v[40:43]
    ds_read_b64_tr_b16 a[172:173], v13 offset:8192
    v_mfma_f32_16x16x32_bf16 v[44:47], a[188:191], v[116:119], v[44:47]
    ds_read_b64_tr_b16 a[174:175], v13 offset:12288
    s_waitcnt lgkmcnt(8)
    v_mfma_f32_16x16x32_bf16 v[16:19], a[192:195], v[120:123], v[16:19]
    ds_read_b64_tr_b16 a[176:177], v10 offset:9216
    v_mfma_f32_16x16x32_bf16 v[20:23], a[192:195], v[124:127], v[20:23]
    ds_read_b64_tr_b16 a[178:179], v10 offset:13312
    v_mfma_f32_16x16x32_bf16 v[24:27], a[196:199], v[120:123], v[24:27]
    ds_read_b64_tr_b16 a[180:181], v11 offset:9216
    v_mfma_f32_16x16x32_bf16 v[28:31], a[196:199], v[124:127], v[28:31]
    ds_read_b64_tr_b16 a[182:183], v11 offset:13312
    v_mfma_f32_16x16x32_bf16 v[32:35], a[200:203], v[120:123], v[32:35]
    ds_read_b64_tr_b16 a[184:185], v12 offset:9216
    v_mfma_f32_16x16x32_bf16 v[36:39], a[200:203], v[124:127], v[36:39]
    ds_read_b64_tr_b16 a[186:187], v12 offset:13312
    v_mfma_f32_16x16x32_bf16 v[40:43], a[204:207], v[120:123], v[40:43]
    ds_read_b64_tr_b16 a[188:189], v13 offset:9216
    v_mfma_f32_16x16x32_bf16 v[44:47], a[204:207], v[124:127], v[44:47]
    ds_read_b64_tr_b16 a[190:191], v13 offset:13312
    s_waitcnt lgkmcnt(8)
    v_mfma_f32_16x16x32_bf16 v[16:19], a[160:163], v[160:163], v[16:19]
    ds_read_b64_tr_b16 a[192:193], v10 offset:16384
    v_mfma_f32_16x16x32_bf16 v[20:23], a[160:163], v[164:167], v[20:23]
    ds_read_b64_tr_b16 a[194:195], v10 offset:20480
    v_mfma_f32_16x16x32_bf16 v[24:27], a[164:167], v[160:163], v[24:27]
    ds_read_b64_tr_b16 a[196:197], v11 offset:16384
    v_mfma_f32_16x16x32_bf16 v[28:31], a[164:167], v[164:167], v[28:31]
    ds_read_b64_tr_b16 a[198:199], v11 offset:20480
    v_mfma_f32_16x16x32_bf16 v[32:35], a[168:171], v[160:163], v[32:35]
    ds_read_b64_tr_b16 a[200:201], v12 offset:16384
    v_mfma_f32_16x16x32_bf16 v[36:39], a[168:171], v[164:167], v[36:39]
    ds_read_b64_tr_b16 a[202:203], v12 offset:20480
    v_mfma_f32_16x16x32_bf16 v[40:43], a[172:175], v[160:163], v[40:43]
    ds_read_b64_tr_b16 a[204:205], v13 offset:16384
    v_mfma_f32_16x16x32_bf16 v[44:47], a[172:175], v[164:167], v[44:47]
    ds_read_b64_tr_b16 a[206:207], v13 offset:20480
    s_waitcnt lgkmcnt(8)
    v_mfma_f32_16x16x32_bf16 v[16:19], a[176:179], v[168:171], v[16:19]
    ds_read_b64_tr_b16 a[160:161], v10 offset:17408
    v_mfma_f32_16x16x32_bf16 v[20:23], a[176:179], v[172:175], v[20:23]
    ds_read_b64_tr_b16 a[162:163], v10 offset:21504
    v_mfma_f32_16x16x32_bf16 v[24:27], a[180:183], v[168:171], v[24:27]
    ds_read_b64_tr_b16 a[164:165], v11 offset:17408
    v_mfma_f32_16x16x32_bf16 v[28:31], a[180:183], v[172:175], v[28:31]
    ds_read_b64_tr_b16 a[166:167], v11 offset:21504
    v_mfma_f32_16x16x32_bf16 v[32:35], a[184:187], v[168:171], v[32:35]
    ds_read_b64_tr_b16 a[168:169], v12 offset:17408
    v_mfma_f32_16x16x32_bf16 v[36:39], a[184:187], v[172:175], v[36:39]
    ds_read_b64_tr_b16 a[170:171], v12 offset:21504
    v_mfma_f32_16x16x32_bf16 v[40:43], a[188:191], v[168:171], v[40:43]
    ds_read_b64_tr_b16 a[172:173], v13 offset:17408
    v_mfma_f32_16x16x32_bf16 v[44:47], a[188:191], v[172:175], v[44:47]
    ds_read_b64_tr_b16 a[174:175], v13 offset:21504
    s_waitcnt lgkmcnt(8)
    v_mfma_f32_16x16x32_bf16 v[16:19], a[192:195], v[128:131], v[16:19]
    ds_read_b64_tr_b16 a[176:177], v10 offset:24576
    v_mfma_f32_16x16x32_bf16 v[20:23], a[192:195], v[132:135], v[20:23]
    ds_read_b64_tr_b16 a[178:179], v10 offset:28672
    v_mfma_f32_16x16x32_bf16 v[24:27], a[196:199], v[128:131], v[24:27]
    ds_read_b64_tr_b16 a[180:181], v11 offset:24576
    v_mfma_f32_16x16x32_bf16 v[28:31], a[196:199], v[132:135], v[28:31]
    ds_read_b64_tr_b16 a[182:183], v11 offset:28672
    v_mfma_f32_16x16x32_bf16 v[32:35], a[200:203], v[128:131], v[32:35]
    ds_read_b64_tr_b16 a[184:185], v12 offset:24576
    v_mfma_f32_16x16x32_bf16 v[36:39], a[200:203], v[132:135], v[36:39]
    ds_read_b64_tr_b16 a[186:187], v12 offset:28672
    v_mfma_f32_16x16x32_bf16 v[40:43], a[204:207], v[128:131], v[40:43]
    ds_read_b64_tr_b16 a[188:189], v13 offset:24576
    v_mfma_f32_16x16x32_bf16 v[44:47], a[204:207], v[132:135], v[44:47]
    ds_read_b64_tr_b16 a[190:191], v13 offset:28672
    s_waitcnt lgkmcnt(8)
    v_mfma_f32_16x16x32_bf16 v[16:19], a[160:163], v[136:139], v[16:19]
    ds_read_b64_tr_b16 a[192:193], v10 offset:25600
    v_mfma_f32_16x16x32_bf16 v[20:23], a[160:163], v[140:143], v[20:23]
    ds_read_b64_tr_b16 a[194:195], v10 offset:29696
    v_mfma_f32_16x16x32_bf16 v[24:27], a[164:167], v[136:139], v[24:27]
    ds_read_b64_tr_b16 a[196:197], v11 offset:25600
    v_mfma_f32_16x16x32_bf16 v[28:31], a[164:167], v[140:143], v[28:31]
    ds_read_b64_tr_b16 a[198:199], v11 offset:29696
    v_mfma_f32_16x16x32_bf16 v[32:35], a[168:171], v[136:139], v[32:35]
    ds_read_b64_tr_b16 a[200:201], v12 offset:25600
    v_mfma_f32_16x16x32_bf16 v[36:39], a[168:171], v[140:143], v[36:39]
    ds_read_b64_tr_b16 a[202:203], v12 offset:29696
    v_mfma_f32_16x16x32_bf16 v[40:43], a[172:175], v[136:139], v[40:43]
    ds_read_b64_tr_b16 a[204:205], v13 offset:25600
    v_mfma_f32_16x16x32_bf16 v[44:47], a[172:175], v[140:143], v[44:47]
    ds_read_b64_tr_b16 a[206:207], v13 offset:29696
    s_waitcnt lgkmcnt(8)
    v_mfma_f32_16x16x32_bf16 v[16:19], a[176:179], v[176:179], v[16:19]
    v_mfma_f32_16x16x32_bf16 v[20:23], a[176:179], v[180:183], v[20:23]
    v_mfma_f32_16x16x32_bf16 v[24:27], a[180:183], v[176:179], v[24:27]
    v_mfma_f32_16x16x32_bf16 v[28:31], a[180:183], v[180:183], v[28:31]
    v_mfma_f32_16x16x32_bf16 v[32:35], a[184:187], v[176:179], v[32:35]
    v_mfma_f32_16x16x32_bf16 v[36:39], a[184:187], v[180:183], v[36:39]
    v_mfma_f32_16x16x32_bf16 v[40:43], a[188:191], v[176:179], v[40:43]
    v_mfma_f32_16x16x32_bf16 v[44:47], a[188:191], v[180:183], v[44:47]
    s_waitcnt lgkmcnt(0)
    v_mfma_f32_16x16x32_bf16 v[16:19], a[192:195], v[184:187], v[16:19]
    v_mfma_f32_16x16x32_bf16 v[20:23], a[192:195], v[188:191], v[20:23]
    v_mfma_f32_16x16x32_bf16 v[24:27], a[196:199], v[184:187], v[24:27]
    v_mfma_f32_16x16x32_bf16 v[28:31], a[196:199], v[188:191], v[28:31]
    v_mfma_f32_16x16x32_bf16 v[32:35], a[200:203], v[184:187], v[32:35]
    v_mfma_f32_16x16x32_bf16 v[36:39], a[200:203], v[188:191], v[36:39]
    v_mfma_f32_16x16x32_bf16 v[40:43], a[204:207], v[184:187], v[40:43]
    v_mfma_f32_16x16x32_bf16 v[44:47], a[204:207], v[188:191], v[44:47]
    s_nop 7
    v_cvt_pk_bf16_f32 v80, v16, v17
    v_cvt_pk_bf16_f32 v81, v18, v19
    v_cvt_pk_bf16_f32 v82, v24, v25
    v_cvt_pk_bf16_f32 v83, v26, v27
    s_add_u32 s31, s98, 0
    buffer_store_dwordx4 v[80:83], v14, s[24:27], s31 offen sc1
    v_cvt_pk_bf16_f32 v84, v20, v21
    v_cvt_pk_bf16_f32 v85, v22, v23
    v_cvt_pk_bf16_f32 v86, v28, v29
    v_cvt_pk_bf16_f32 v87, v30, v31
    s_add_u32 s31, s98, 4096
    buffer_store_dwordx4 v[84:87], v14, s[24:27], s31 offen sc1
    v_cvt_pk_bf16_f32 v88, v32, v33
    v_cvt_pk_bf16_f32 v89, v34, v35
    v_cvt_pk_bf16_f32 v90, v40, v41
    v_cvt_pk_bf16_f32 v91, v42, v43
    s_add_u32 s31, s98, 16384
    buffer_store_dwordx4 v[88:91], v14, s[24:27], s31 offen sc1
    v_cvt_pk_bf16_f32 v92, v36, v37
    v_cvt_pk_bf16_f32 v93, v38, v39
    v_cvt_pk_bf16_f32 v94, v44, v45
    v_cvt_pk_bf16_f32 v95, v46, v47
    s_add_u32 s31, s98, 20480
    buffer_store_dwordx4 v[92:95], v14, s[24:27], s31 offen sc1
    buffer_load_dword v248, v247, s[72:75], 0 offen sc1
    buffer_load_dword v241, v249, s[72:75], 0 offen sc1
    v_accvgpr_read_b32 v40, a240
    v_accvgpr_read_b32 v41, a241
    v_accvgpr_read_b32 v42, a242
    v_accvgpr_read_b32 v43, a243
    v_accvgpr_read_b32 v44, a244
    v_accvgpr_read_b32 v45, a245
    v_accvgpr_read_b32 v46, a246
    v_accvgpr_read_b32 v47, a247
    v_accvgpr_read_b32 v48, a248
    v_accvgpr_read_b32 v49, a249
    v_accvgpr_read_b32 v50, a250
    v_accvgpr_read_b32 v51, a251
    v_accvgpr_read_b32 v70, a252
    s_waitcnt vmcnt(9)
    v_lshlrev_b32 v16, 16, v192
    v_and_b32 v17, 0xffff0000, v192
    v_lshlrev_b32 v18, 16, v193
    v_and_b32 v19, 0xffff0000, v193
    v_lshlrev_b32 v20, 16, v194
    v_and_b32 v21, 0xffff0000, v194
    v_lshlrev_b32 v22, 16, v195
    v_and_b32 v23, 0xffff0000, v195
    s_waitcnt vmcnt(8)
    v_lshlrev_b32 v2, 16, v196
    v_and_b32 v3, 0xffff0000, v196
    v_pk_add_f32 v[16:17], v[16:17], v[2:3]
    v_lshlrev_b32 v4, 16, v197
    v_and_b32 v5, 0xffff0000, v197
    v_pk_add_f32 v[18:19], v[18:19], v[4:5]
    v_lshlrev_b32 v2, 16, v198
    v_and_b32 v3, 0xffff0000, v198
    v_pk_add_f32 v[20:21], v[20:21], v[2:3]
    v_lshlrev_b32 v4, 16, v199
    v_and_b32 v5, 0xffff0000, v199
    v_pk_add_f32 v[22:23], v[22:23], v[4:5]
    s_waitcnt vmcnt(7)
    v_lshlrev_b32 v2, 16, v200
    v_and_b32 v3, 0xffff0000, v200
    v_pk_add_f32 v[16:17], v[16:17], v[2:3]
    v_lshlrev_b32 v4, 16, v201
    v_and_b32 v5, 0xffff0000, v201
    v_pk_add_f32 v[18:19], v[18:19], v[4:5]
    v_lshlrev_b32 v2, 16, v202
    v_and_b32 v3, 0xffff0000, v202
    v_pk_add_f32 v[20:21], v[20:21], v[2:3]
    v_lshlrev_b32 v4, 16, v203
    v_and_b32 v5, 0xffff0000, v203
    v_pk_add_f32 v[22:23], v[22:23], v[4:5]
    s_waitcnt vmcnt(6)
    v_lshlrev_b32 v2, 16, v204
    v_and_b32 v3, 0xffff0000, v204
    v_pk_add_f32 v[16:17], v[16:17], v[2:3]
    v_lshlrev_b32 v4, 16, v205
    v_and_b32 v5, 0xffff0000, v205
    v_pk_add_f32 v[18:19], v[18:19], v[4:5]
    v_lshlrev_b32 v2, 16, v206
    v_and_b32 v3, 0xffff0000, v206
    v_pk_add_f32 v[20:21], v[20:21], v[2:3]
    v_lshlrev_b32 v4, 16, v207
    v_and_b32 v5, 0xffff0000, v207
    v_pk_add_f32 v[22:23], v[22:23], v[4:5]
    s_waitcnt vmcnt(2)
    s_barrier
    v_mov_b32 v242, 7
    s_mov_b64 exec, s[66:67]
    buffer_store_dword v242, off, s[72:75], s56 sc1
    s_mov_b64 exec, -1
    s_waitcnt vmcnt(0)
    v_cmp_le_u32 vcc, 6, v248
    s_nop 1
    s_cmp_eq_u64 vcc, -1
    s_cbranch_scc0 L_f1_slow
L_f1_back:
    buffer_load_dwordx4 v[208:211], v14, s[12:15], s86 offen offset:0 sc1
    buffer_load_dwordx4 v[212:215], v14, s[12:15], s86 offen offset:1024 sc1
L_pm9:
    s_cbranch_execz L_pmb2
    buffer_load_dwordx4 v[216:219], v14, s[12:15], s86 offen offset:2048 sc1
    buffer_load_dwordx4 v[220:223], v14, s[12:15], s86 offen offset:3072 sc1
    v_cmp_le_u32 vcc, s38, v241
    s_nop 1
    s_cmp_eq_u64 vcc, -1
    s_cbranch_scc0 L_y_slow
L_y_back:
    s_add_u32 m0, s65, 0
    s_lshl_b32 s40, s57, 11
    buffer_load_dwordx4 v244, s[80:83], s40 offen sc1 lds
    s_add_u32 m0, s65, 1024
    s_lshl_b32 s40, s58, 11
    buffer_load_dwordx4 v244, s[80:83], s40 offen sc1 lds
    s_add_u32 m0, s65, 2048
    s_lshl_b32 s40, s59, 11
    buffer_load_dwordx4 v244, s[80:83], s40 offen sc1 lds
    buffer_load_dword v248, v247, s[72:75], 0 offen sc1
    s_waitcnt vmcnt(7)
    v_lshlrev_b32 v24, 16, v208
    v_and_b32 v25, 0xffff0000, v208
    v_lshlrev_b32 v26, 16, v209
    v_and_b32 v27, 0xffff0000, v209
    v_lshlrev_b32 v28, 16, v210
    v_and_b32 v29, 0xffff0000, v210
    v_lshlrev_b32 v30, 16, v211
    v_and_b32 v31, 0xffff0000, v211
    s_waitcnt vmcnt(6)
    v_lshlrev_b32 v2, 16, v212
    v_and_b32 v3, 0xffff0000, v212
    v_pk_add_f32 v[24:25], v[24:25], v[2:3]
    v_lshlrev_b32 v4, 16, v213
    v_and_b32 v5, 0xffff0000, v213
    v_pk_add_f32 v[26:27], v[26:27], v[4:5]
    v_lshlrev_b32 v2, 16, v214
    v_and_b32 v3, 0xffff0000, v214
    v_pk_add_f32 v[28:29], v[28:29], v[2:3]
    v_lshlrev_b32 v4, 16, v215
    v_and_b32 v5, 0xffff0000, v215
    v_pk_add_f32 v[30:31], v[30:31], v[4:5]
    s_waitcnt vmcnt(5)
    v_lshlrev_b32 v2, 16, v216
    v_and_b32 v3, 0xffff0000, v216
    v_pk_add_f32 v[24:25], v[24:25], v[2:3]
    v_lshlrev_b32 v4, 16, v217
    v_and_b32 v5, 0xffff0000, v217
    v_pk_add_f32 v[26:27], v[26:27], v[4:5]
    v_lshlrev_b32 v2, 16, v218
    v_and_b32 v3, 0xffff0000, v218
    v_pk_add_f32 v[28:29], v[28:29], v[2:3]
    v_lshlrev_b32 v4, 16, v219
    v_and_b32 v5, 0xffff0000, v219
    v_pk_add_f32 v[30:31], v[30:31], v[4:5]
    s_waitcnt vmcnt(4)
    v_lshlrev_b32 v2, 16, v220
    v_and_b32 v3, 0xffff0000, v220
    v_pk_add_f32 v[24:25], v[24:25], v[2:3]
    v_lshlrev_b32 v4, 16, v221
    v_and_b32 v5, 0xffff0000, v221
    v_pk_add_f32 v[26:27], v[26:27], v[4:5]
    v_lshlrev_b32 v2, 16, v222
    v_and_b32 v3, 0xffff0000, v222
    v_pk_add_f32 v[28:29], v[28:29], v[2:3]
    v_lshlrev_b32 v4, 16, v223
    v_and_b32 v5, 0xffff0000, v223
    v_pk_add_f32 v[30:31], v[30:31], v[4:5]
    s_waitcnt vmcnt(0)
    v_cmp_le_u32 vcc, 7, v248
    s_nop 1
    s_cmp_eq_u64 vcc, -1
    s_cbranch_scc0 L_f2_slow
L_f2_back:
    buffer_load_dwordx4 v[224:227], v14, s[12:15], s87 offen offset:0 sc1
    buffer_load_dwordx4 v[228:231], v14, s[12:15], s87 offen offset:1024 sc1
    buffer_load_dwordx4 v[232:235], v14, s[12:15], s87 offen offset:2048 sc1
    buffer_load_dwordx4 v[236:239], v14, s[12:15], s87 offen offset:3072 sc1
    ds_read_b64_tr_b16 v[52:53], v245 offset:0
    ds_read_b64_tr_b16 v[54:55], v245 offset:128
    ds_read_b64_tr_b16 v[56:57], v245 offset:1024
    ds_read_b64_tr_b16 v[58:59], v245 offset:1152
    ds_read_b64_tr_b16 v[60:61], v245 offset:2048
    ds_read_b64_tr_b16 v[62:63], v245 offset:2176
    s_waitcnt lgkmcnt(4)
    v_lshlrev_b32 v72, 16, v40
    v_and_b32 v73, 0xffff0000, v40
    v_lshlrev_b32 v74, 16, v41
    v_and_b32 v75, 0xffff0000, v41
    v_lshlrev_b32 v76, 16, v42
    v_and_b32 v77, 0xffff0000, v42
    v_lshlrev_b32 v78, 16, v43
    v_and_b32 v79, 0xffff0000, v43
    v_lshlrev_b32 v2, 16, v52
    v_and_b32 v3, 0xffff0000, v52
    v_pk_add_f32 v[72:73], v[72:73], v[2:3]
    v_lshlrev_b32 v4, 16, v53
    v_and_b32 v5, 0xffff0000, v53
    v_pk_add_f32 v[74:75], v[74:75], v[4:5]
    v_lshlrev_b32 v2, 16, v54
    v_and_b32 v3, 0xffff0000, v54
    v_pk_add_f32 v[76:77], v[76:77], v[2:3]
    v_lshlrev_b32 v4, 16, v55
    v_and_b32 v5, 0xffff0000, v55
    v_pk_add_f32 v[78:79], v[78:79], v[4:5]
    s_nop 1
    v_permlane16_swap_b32 v16, v20
    v_permlane16_swap_b32 v17, v21
    v_permlane16_swap_b32 v18, v22
    v_permlane16_swap_b32 v19, v23
    v_fma_f32 v16, v16, v70, v72
    v_fma_f32 v17, v17, v70, v73
    v_fma_f32 v18, v18, v70, v74
    v_fma_f32 v19, v19, v70, v75
    v_fma_f32 v20, v20, v70, v76
    v_fma_f32 v21, v21, v70, v77
    v_fma_f32 v22, v22, v70, v78
    v_fma_f32 v23, v23, v70, v79
    v_cvt_pk_bf16_f32 v40, v16, v17
    v_cvt_pk_bf16_f32 v41, v18, v19
    v_cvt_pk_bf16_f32 v42, v20, v21
    v_cvt_pk_bf16_f32 v43, v22, v23
    buffer_store_dwordx4 v[40:43], v243, s[44:47], s57 offen sc1
    s_waitcnt lgkmcnt(2)
    v_lshlrev_b32 v80, 16, v44
    v_and_b32 v81, 0xffff0000, v44
    v_lshlrev_b32 v82, 16, v45
    v_and_b32 v83, 0xffff0000, v45
    v_lshlrev_b32 v84, 16, v46
    v_and_b32 v85, 0xffff0000, v46
    v_lshlrev_b32 v86, 16, v47
    v_and_b32 v87, 0xffff0000, v47
    v_lshlrev_b32 v2, 16, v56
    v_and_b32 v3, 0xffff0000, v56
    v_pk_add_f32 v[80:81], v[80:81], v[2:3]
    v_lshlrev_b32 v4, 16, v57
    v_and_b32 v5, 0xffff0000, v57
    v_pk_add_f32 v[82:83], v[82:83], v[4:5]
    v_lshlrev_b32 v2, 16, v58
    v_and_b32 v3, 0xffff0000, v58
    v_pk_add_f32 v[84:85], v[84:85], v[2:3]
    v_lshlrev_b32 v4, 16, v59
    v_and_b32 v5, 0xffff0000, v59
    v_pk_add_f32 v[86:87], v[86:87], v[4:5]
    s_nop 1
    v_permlane16_swap_b32 v24, v28
    v_permlane16_swap_b32 v25, v29
    v_permlane16_swap_b32 v26, v30
    v_permlane16_swap_b32 v27, v31
    v_fma_f32 v24, v24, v70, v80
    v_fma_f32 v25, v25, v70, v81
    v_fma_f32 v26, v26, v70, v82
    v_fma_f32 v27, v27, v70, v83
    v_fma_f32 v28, v28, v70, v84
    v_fma_f32 v29, v29, v70, v85
    v_fma_f32 v30, v30, v70, v86
    v_fma_f32 v31, v31, v70, v87
    v_cvt_pk_bf16_f32 v44, v24, v25
    v_cvt_pk_bf16_f32 v45, v26, v27
    v_cvt_pk_bf16_f32 v46, v28, v29
    v_cvt_pk_bf16_f32 v47, v30, v31
    buffer_store_dwordx4 v[44:47], v243, s[44:47], s58 offen sc1
    s_waitcnt lgkmcnt(0)
    v_lshlrev_b32 v88, 16, v48
    v_and_b32 v89, 0xffff0000, v48
    v_lshlrev_b32 v90, 16, v49
    v_and_b32 v91, 0xffff0000, v49
    v_lshlrev_b32 v92, 16, v50
    v_and_b32 v93, 0xffff0000, v50
    v_lshlrev_b32 v94, 16, v51
    v_and_b32 v95, 0xffff0000, v51
    v_lshlrev_b32 v2, 16, v60
    v_and_b32 v3, 0xffff0000, v60
    v_pk_add_f32 v[88:89], v[88:89], v[2:3]
    v_lshlrev_b32 v4, 16, v61
    v_and_b32 v5, 0xffff0000, v61
    v_pk_add_f32 v[90:91], v[90:91], v[4:5]
    v_lshlrev_b32 v2, 16, v62
    v_and_b32 v3, 0xffff0000, v62
    v_pk_add_f32 v[92:93], v[92:93], v[2:3]
    v_lshlrev_b32 v4, 16, v63
    v_and_b32 v5, 0xffff0000, v63
    v_pk_add_f32 v[94:95], v[94:95], v[4:5]
    s_waitcnt vmcnt(5)
    v_lshlrev_b32 v32, 16, v224
    v_and_b32 v33, 0xffff0000, v224
    v_lshlrev_b32 v34, 16, v225
    v_and_b32 v35, 0xffff0000, v225
    v_lshlrev_b32 v36, 16, v226
    v_and_b32 v37, 0xffff0000, v226
    v_lshlrev_b32 v38, 16, v227
    v_and_b32 v39, 0xffff0000, v227
    s_waitcnt vmcnt(4)
    v_lshlrev_b32 v2, 16, v228
    v_and_b32 v3, 0xffff0000, v228
    v_pk_add_f32 v[32:33], v[32:33], v[2:3]
    v_lshlrev_b32 v4, 16, v229
    v_and_b32 v5, 0xffff0000, v229
    v_pk_add_f32 v[34:35], v[34:35], v[4:5]
    v_lshlrev_b32 v2, 16, v230
    v_and_b32 v3, 0xffff0000, v230
    v_pk_add_f32 v[36:37], v[36:37], v[2:3]
    v_lshlrev_b32 v4, 16, v231
    v_and_b32 v5, 0xffff0000, v231
    v_pk_add_f32 v[38:39], v[38:39], v[4:5]
    s_waitcnt vmcnt(3)
    v_lshlrev_b32 v2, 16, v232
    v_and_b32 v3, 0xffff0000, v232
    v_pk_add_f32 v[32:33], v[32:33], v[2:3]
    v_lshlrev_b32 v4, 16, v233
    v_and_b32 v5, 0xffff0000, v233
    v_pk_add_f32 v[34:35], v[34:35], v[4:5]
    v_lshlrev_b32 v2, 16, v234
    v_and_b32 v3, 0xffff0000, v234
    v_pk_add_f32 v[36:37], v[36:37], v[2:3]
    v_lshlrev_b32 v4, 16, v235
    v_and_b32 v5, 0xffff0000, v235
    v_pk_add_f32 v[38:39], v[38:39], v[4:5]
    s_waitcnt vmcnt(2)
    v_lshlrev_b32 v2, 16, v236
    v_and_b32 v3, 0xffff0000, v236
    v_pk_add_f32 v[32:33], v[32:33], v[2:3]
    v_lshlrev_b32 v4, 16, v237
    v_and_b32 v5, 0xffff0000, v237
    v_pk_add_f32 v[34:35], v[34:35], v[4:5]
    v_lshlrev_b32 v2, 16, v238
    v_and_b32 v3, 0xffff0000, v238
    v_pk_add_f32 v[36:37], v[36:37], v[2:3]
    v_lshlrev_b32 v4, 16, v239
    v_and_b32 v5, 0xffff0000, v239
    v_pk_add_f32 v[38:39], v[38:39], v[4:5]
    s_nop 1
    v_permlane16_swap_b32 v32, v36
    v_permlane16_swap_b32 v33, v37
    v_permlane16_swap_b32 v34, v38
    v_permlane16_swap_b32 v35, v39
    v_fma_f32 v32, v32, v70, v88
    v_fma_f32 v33, v33, v70, v89
    v_fma_f32 v34, v34, v70, v90
    v_fma_f32 v35, v35, v70, v91
    v_fma_f32 v36, v36, v70, v92
    v_fma_f32 v37, v37, v70, v93
    v_fma_f32 v38, v38, v70, v94
    v_fma_f32 v39, v39, v70, v95
    v_cvt_pk_bf16_f32 v48, v32, v33
    v_cvt_pk_bf16_f32 v49, v34, v35
    v_cvt_pk_bf16_f32 v50, v36, v37
    v_cvt_pk_bf16_f32 v51, v38, v39
    buffer_store_dwordx4 v[48:51], v243, s[44:47], s59 offen sc1
    s_endpgm
L_f2_slow:
    s_mov_b32 s88, 0
L_poll1:
    buffer_load_dword v248, v247, s[72:75], 0 offen sc1
    s_waitcnt vmcnt(0)
    v_cmp_le_u32 vcc, 7, v248
    s_add_u32 s88, s88, 1
    s_nop 0
    s_cmp_eq_u64 vcc, -1
    s_cbranch_scc1 L_pdone1
    s_cmp_ge_u32 s88, 200000
    s_cbranch_scc1 L_pdone1
    s_sleep 1
    s_branch L_poll1
L_pdone1:
    s_branch L_f2_back
L_f1_slow:
    s_mov_b32 s88, 0
L_poll2:
    buffer_load_dword v248, v247, s[72:75], 0 offen sc1
    s_waitcnt vmcnt(0)
    v_cmp_le_u32 vcc, 6, v248
    s_add_u32 s88, s88, 1
    s_nop 0
    s_cmp_eq_u64 vcc, -1
    s_cbranch_scc1 L_pdone2
    s_cmp_ge_u32 s88, 200000
    s_cbranch_scc1 L_pdone2
    s_sleep 1
    s_branch L_poll2
L_pdone2:
    s_branch L_f1_back
L_y_slow:
    s_mov_b32 s88, 0
L_poll3:
    buffer_load_dword v241, v249, s[72:75], 0 offen sc1
    s_waitcnt vmcnt(0)
    v_cmp_le_u32 vcc, s38, v241
    s_add_u32 s88, s88, 1
    s_nop 0
    s_cmp_eq_u64 vcc, -1
    s_cbranch_scc1 L_pdone3
    s_cmp_ge_u32 s88, 200000
    s_cbranch_scc1 L_pdone3
    s_sleep 2
    s_branch L_poll3
L_pdone3:
    s_branch L_y_back
L_chk_slow:
    s_mov_b32 s88, 0
L_poll4:
    buffer_load_dword v241, v240, s[68:71], 0 offen sc1
    s_waitcnt vmcnt(0)
    v_cmp_le_u32 vcc, s38, v241
    s_add_u32 s88, s88, 1
    s_nop 0
    s_cmp_eq_u64 vcc, -1
    s_cbranch_scc1 L_pdone4
    s_cmp_ge_u32 s88, 200000
    s_cbranch_scc1 L_pdone4
    s_sleep 16
    s_branch L_poll4
L_pdone4:
    s_branch L_chk_back
L_f0_slow:
    s_mov_b32 s88, 0
L_poll5:
    buffer_load_dword v248, v247, s[72:75], 0 offen sc1
    s_waitcnt vmcnt(0)
    v_cmp_le_u32 vcc, 5, v248
    s_add_u32 s88, s88, 1
    s_nop 0
    s_cmp_eq_u64 vcc, -1
    s_cbranch_scc1 L_pdone5
    s_cmp_ge_u32 s88, 200000
    s_cbranch_scc1 L_pdone5
    s_sleep 2
    s_branch L_poll5
L_pdone5:
    s_branch L_f0_back
L_h0_slow:
    s_mov_b32 s88, 0
L_poll6:
    buffer_load_dword v248, v253, s[72:75], 0 offen sc1
    s_waitcnt vmcnt(0)
    v_cmp_le_u32 vcc, 1, v248
    s_add_u32 s88, s88, 1
    s_nop 0
    s_cmp_eq_u64 vcc, -1
    s_cbranch_scc1 L_pdone6
    s_cmp_ge_u32 s88, 200000
    s_cbranch_scc1 L_pdone6
    s_sleep 1
    s_branch L_poll6
L_pdone6:
    s_branch L_h0_back
L_h1_slow:
    s_mov_b32 s88, 0
L_poll7:
    buffer_load_dword v248, v253, s[72:75], 0 offen sc1
    s_waitcnt vmcnt(0)
    v_cmp_le_u32 vcc, 2, v248
    s_add_u32 s88, s88, 1
    s_nop 0
    s_cmp_eq_u64 vcc, -1
    s_cbranch_scc1 L_pdone7
    s_cmp_ge_u32 s88, 200000
    s_cbranch_scc1 L_pdone7
    s_sleep 1
    s_branch L_poll7
L_pdone7:
    s_branch L_h1_back
L_h2_slow:
    s_mov_b32 s88, 0
L_poll8:
    buffer_load_dword v248, v253, s[72:75], 0 offen sc1
    s_waitcnt vmcnt(0)
    v_cmp_le_u32 vcc, 3, v248
    s_add_u32 s88, s88, 1
    s_nop 0
    s_cmp_eq_u64 vcc, -1
    s_cbranch_scc1 L_pdone8
    s_cmp_ge_u32 s88, 200000
    s_cbranch_scc1 L_pdone8
    s_sleep 1
    s_branch L_poll8
L_pdone8:
    s_branch L_h2_back
L_h3_slow:
    s_mov_b32 s88, 0
L_poll9:
    buffer_load_dword v248, v253, s[72:75], 0 offen sc1
    s_waitcnt vmcnt(0)
    v_cmp_le_u32 vcc, 4, v248
    s_add_u32 s88, s88, 1
    s_nop 0
    s_cmp_eq_u64 vcc, -1
    s_cbranch_scc1 L_pdone9
    s_cmp_ge_u32 s88, 200000
    s_cbranch_scc1 L_pdone9
    s_sleep 1
    s_branch L_poll9
L_pdone9:
    s_branch L_h3_back
L_mlp_end:
.p2align 12
L_conv2:
    s_mov_b64 exec, 0
    s_cmp_eq_u32 s3, 0
    s_cbranch_scc1 L_pv0
    s_cmp_eq_u32 s3, 1
    s_cbranch_scc1 L_pv1
    s_cmp_eq_u32 s3, 2
    s_cbranch_scc1 L_pv2
    s_branch L_pv3
L_pvb:
    s_mov_b64 exec, -1
    s_mul_i32 s46, s3, 16640
    s_mul_i32 s47, s3, 21248
    s_add_u32 s47, s47, 66560
    v_and_b32 v156, 31, v0
    v_lshrrev_b32 v157, 5, v0
    v_mul_u32_u24 v158, 43, v156
    v_lshrrev_b32 v158, 8, v158
    v_mul_u32_u24 v159, 6, v158
    v_sub_u32 v159, v156, v159
    v_mul_u32_u24 v159, 5, v159
    v_mov_b32 v160, 172066848
    v_cmp_eq_u32 vcc, 1, v158
    v_mov_b32 v161, 446996710
    s_nop 0
    v_cndmask_b32 v160, v160, v161, vcc
    v_cmp_eq_u32 vcc, 2, v158
    v_mov_b32 v161, 518533482
    s_nop 0
    v_cndmask_b32 v160, v160, v161, vcc
    v_cmp_eq_u32 vcc, 3, v158
    v_mov_b32 v161, 830031507
    s_nop 0
    v_cndmask_b32 v160, v160, v161, vcc
    v_cmp_eq_u32 vcc, 4, v158
    v_mov_b32 v161, 898630357
    s_nop 0
    v_cndmask_b32 v160, v160, v161, vcc
    v_cmp_eq_u32 vcc, 5, v158
    v_mov_b32 v161, 0
    s_nop 0
    v_cndmask_b32 v160, v160, v161, vcc
    v_bfe_u32 v160, v160, v159, 5
    v_mul_u32_u24 v160, 272, v160
    v_lshl_add_u32 v146, v157, 4, v160
    v_mul_u32_u24 v160, 272, v156
    v_lshl_add_u32 v160, v157, 4, v160
    v_add_u32 v147, 7344, v160
    s_add_u32 s40, s47, 17120
    v_lshl_add_u32 v160, v156, 4, s40
    v_lshl_add_u32 v148, v157, 3, v160
    v_lshl_add_u32 v149, v157, 9, v160
    v_lshl_add_u32 v150, v157, 10, v160
    v_and_b32 v156, 15, v0
    v_lshrrev_b32 v157, 4, v0
    v_lshlrev_b32 v160, 5, v156
    v_lshrrev_b32 v161, 1, v157
    v_lshl_add_u32 v154, v161, 4, v160
    v_and_b32 v161, 1, v157
    v_lshl_add_u32 v154, v161, 9, v154
    v_lshl_add_u32 v160, v157, 4, v160
    s_add_u32 s40, s47, 16640
    v_add_u32 v151, s40, v160
    v_and_b32 v160, 3, v156
    v_sub_u32 v160, 3, v160
    v_mul_u32_u24 v160, 4160, v160
    v_lshl_add_u32 v160, v157, 4, v160
    v_lshrrev_b32 v161, 2, v156
    v_lshlrev_b32 v161, 3, v161
    v_sub_u32 v160, v160, v161
    s_add_u32 s40, s47, 24
    v_add_u32 v152, s40, v160
    s_add_u32 s40, s46, 24
    v_add_u32 v162, s40, v160
    v_lshlrev_b32 v153, 4, v0
    v_lshlrev_b32 v155, 2, v0
    s_mov_b32 s48, 0x55555555
    s_mov_b32 s49, 0x55555555
    s_mov_b32 s50, 1
    s_mov_b32 s51, 0
    v_mov_b32 v160, 0
    v_mov_b32 v161, 0
    v_min_u32 v158, 59, v0
    s_add_u32 s40, s47, 16640
    v_lshl_add_u32 v158, v158, 3, s40
    ds_write_b64 v158, v[160:161]
    v_lshrrev_b32 v158, 4, v0
    v_mul_u32_u24 v158, 4160, v158
    v_and_b32 v159, 15, v0
    v_lshl_add_u32 v158, v159, 2, v158
    v_add_u32 v163, s46, v158
    v_add_u32 v158, s47, v158
    ds_write_b32 v158, v160 offset:4096
    s_waitcnt vmcnt(16)
    v_lshlrev_b32 v64, 16, v16
    v_and_b32 v65, 0xffff0000, v16
    v_mov_b32 v8, v64
    v_mov_b32 v9, v65
    v_lshlrev_b32 v66, 16, v17
    v_and_b32 v67, 0xffff0000, v17
    v_mov_b32 v10, v66
    v_mov_b32 v11, v67
    v_lshlrev_b32 v68, 16, v18
    v_and_b32 v69, 0xffff0000, v18
    v_pk_add_f32 v[8:9], v[8:9], v[68:69]
    v_lshlrev_b32 v70, 16, v19
    v_and_b32 v71, 0xffff0000, v19
    v_pk_add_f32 v[10:11], v[10:11], v[70:71]
    s_waitcnt vmcnt(15)
    v_lshlrev_b32 v72, 16, v20
    v_and_b32 v73, 0xffff0000, v20
    v_pk_add_f32 v[8:9], v[8:9], v[72:73]
    v_lshlrev_b32 v74, 16, v21
    v_and_b32 v75, 0xffff0000, v21
    v_pk_add_f32 v[10:11], v[10:11], v[74:75]
    v_lshlrev_b32 v76, 16, v22
    v_and_b32 v77, 0xffff0000, v22
    v_pk_add_f32 v[8:9], v[8:9], v[76:77]
    v_lshlrev_b32 v78, 16, v23
    v_and_b32 v79, 0xffff0000, v23
    v_pk_add_f32 v[10:11], v[10:11], v[78:79]
    s_waitcnt vmcnt(14)
    v_lshlrev_b32 v80, 16, v24
    v_and_b32 v81, 0xffff0000, v24
    v_pk_add_f32 v[8:9], v[8:9], v[80:81]
    v_lshlrev_b32 v82, 16, v25
    v_and_b32 v83, 0xffff0000, v25
    v_pk_add_f32 v[10:11], v[10:11], v[82:83]
    v_lshlrev_b32 v84, 16, v26
    v_and_b32 v85, 0xffff0000, v26
    v_pk_add_f32 v[8:9], v[8:9], v[84:85]
    v_lshlrev_b32 v86, 16, v27
    v_and_b32 v87, 0xffff0000, v27
    v_pk_add_f32 v[10:11], v[10:11], v[86:87]
    s_waitcnt vmcnt(13)
    v_lshlrev_b32 v88, 16, v28
    v_and_b32 v89, 0xffff0000, v28
    v_pk_add_f32 v[8:9], v[8:9], v[88:89]
    v_lshlrev_b32 v90, 16, v29
    v_and_b32 v91, 0xffff0000, v29
    v_pk_add_f32 v[10:11], v[10:11], v[90:91]
    v_lshlrev_b32 v92, 16, v30
    v_and_b32 v93, 0xffff0000, v30
    v_pk_add_f32 v[8:9], v[8:9], v[92:93]
    v_lshlrev_b32 v94, 16, v31
    v_and_b32 v95, 0xffff0000, v31
    v_pk_add_f32 v[10:11], v[10:11], v[94:95]
    s_waitcnt vmcnt(12)
    v_lshlrev_b32 v96, 16, v32
    v_and_b32 v97, 0xffff0000, v32
    v_pk_add_f32 v[8:9], v[8:9], v[96:97]
    v_lshlrev_b32 v98, 16, v33
    v_and_b32 v99, 0xffff0000, v33
    v_pk_add_f32 v[10:11], v[10:11], v[98:99]
    v_lshlrev_b32 v100, 16, v34
    v_and_b32 v101, 0xffff0000, v34
    v_pk_add_f32 v[8:9], v[8:9], v[100:101]
    v_lshlrev_b32 v102, 16, v35
    v_and_b32 v103, 0xffff0000, v35
    v_pk_add_f32 v[10:11], v[10:11], v[102:103]
    s_waitcnt vmcnt(11)
    v_lshlrev_b32 v104, 16, v36
    v_and_b32 v105, 0xffff0000, v36
    v_pk_add_f32 v[8:9], v[8:9], v[104:105]
    v_lshlrev_b32 v106, 16, v37
    v_and_b32 v107, 0xffff0000, v37
    v_pk_add_f32 v[10:11], v[10:11], v[106:107]
    v_lshlrev_b32 v108, 16, v38
    v_and_b32 v109, 0xffff0000, v38
    v_pk_add_f32 v[8:9], v[8:9], v[108:109]
    v_lshlrev_b32 v110, 16, v39
    v_and_b32 v111, 0xffff0000, v39
    v_pk_add_f32 v[10:11], v[10:11], v[110:111]
    s_waitcnt vmcnt(10)
    v_lshlrev_b32 v112, 16, v40
    v_and_b32 v113, 0xffff0000, v40
    v_pk_add_f32 v[8:9], v[8:9], v[112:113]
    v_lshlrev_b32 v114, 16, v41
    v_and_b32 v115, 0xffff0000, v41
    v_pk_add_f32 v[10:11], v[10:11], v[114:115]
    v_lshlrev_b32 v116, 16, v42
    v_and_b32 v117, 0xffff0000, v42
    v_pk_add_f32 v[8:9], v[8:9], v[116:117]
    v_lshlrev_b32 v118, 16, v43
    v_and_b32 v119, 0xffff0000, v43
    v_pk_add_f32 v[10:11], v[10:11], v[118:119]
    s_waitcnt vmcnt(9)
    v_lshlrev_b32 v120, 16, v44
    v_and_b32 v121, 0xffff0000, v44
    v_pk_add_f32 v[8:9], v[8:9], v[120:121]
    v_lshlrev_b32 v122, 16, v45
    v_and_b32 v123, 0xffff0000, v45
    v_pk_add_f32 v[10:11], v[10:11], v[122:123]
    v_lshlrev_b32 v124, 16, v46
    v_and_b32 v125, 0xffff0000, v46
    v_pk_add_f32 v[8:9], v[8:9], v[124:125]
    v_lshlrev_b32 v126, 16, v47
    v_and_b32 v127, 0xffff0000, v47
    v_pk_add_f32 v[10:11], v[10:11], v[126:127]
    s_waitcnt vmcnt(8)
    v_lshlrev_b32 v128, 16, v48
    v_and_b32 v129, 0xffff0000, v48
    v_pk_add_f32 v[8:9], v[8:9], v[128:129]
    v_lshlrev_b32 v130, 16, v49
    v_and_b32 v131, 0xffff0000, v49
    v_pk_add_f32 v[10:11], v[10:11], v[130:131]
    v_lshlrev_b32 v132, 16, v50
    v_and_b32 v133, 0xffff0000, v50
    v_pk_add_f32 v[8:9], v[8:9], v[132:133]
    v_lshlrev_b32 v134, 16, v51
    v_and_b32 v135, 0xffff0000, v51
    v_pk_add_f32 v[10:11], v[10:11], v[134:135]
    v_pk_add_f32 v[8:9], v[8:9], v[10:11]
    s_nop 0
    v_add_f32 v8, v8, v9
    s_nop 1
    v_add_f32_dpp v8, v8, v8 quad_perm:[1,0,3,2] row_mask:0xf bank_mask:0xf
    s_nop 1
    v_add_f32_dpp v8, v8, v8 quad_perm:[2,3,0,1] row_mask:0xf bank_mask:0xf
    s_nop 1
    v_add_f32_dpp v8, v8, v8 row_half_mirror row_mask:0xf bank_mask:0xf
    v_mul_f32 v8, 0xbae38e39, v8
    s_nop 0
    v_mov_b32 v9, v8
    v_pk_add_f32 v[136:137], v[64:65], v[8:9]
    v_pk_mul_f32 v[12:13], v[136:137], v[136:137]
    v_pk_add_f32 v[138:139], v[66:67], v[8:9]
    v_pk_mul_f32 v[14:15], v[138:139], v[138:139]
    v_pk_add_f32 v[136:137], v[68:69], v[8:9]
    v_pk_fma_f32 v[12:13], v[136:137], v[136:137], v[12:13]
    v_pk_add_f32 v[138:139], v[70:71], v[8:9]
    v_pk_fma_f32 v[14:15], v[138:139], v[138:139], v[14:15]
    v_pk_add_f32 v[136:137], v[72:73], v[8:9]
    v_pk_fma_f32 v[12:13], v[136:137], v[136:137], v[12:13]
    v_pk_add_f32 v[138:139], v[74:75], v[8:9]
    v_pk_fma_f32 v[14:15], v[138:139], v[138:139], v[14:15]
    v_pk_add_f32 v[136:137], v[76:77], v[8:9]
    v_pk_fma_f32 v[12:13], v[136:137], v[136:137], v[12:13]
    v_pk_add_f32 v[138:139], v[78:79], v[8:9]
    v_pk_fma_f32 v[14:15], v[138:139], v[138:139], v[14:15]
    v_pk_add_f32 v[136:137], v[80:81], v[8:9]
    v_pk_fma_f32 v[12:13], v[136:137], v[136:137], v[12:13]
    v_pk_add_f32 v[138:139], v[82:83], v[8:9]
    v_pk_fma_f32 v[14:15], v[138:139], v[138:139], v[14:15]
    v_pk_add_f32 v[136:137], v[84:85], v[8:9]
    v_pk_fma_f32 v[12:13], v[136:137], v[136:137], v[12:13]
    v_pk_add_f32 v[138:139], v[86:87], v[8:9]
    v_pk_fma_f32 v[14:15], v[138:139], v[138:139], v[14:15]
    v_pk_add_f32 v[136:137], v[88:89], v[8:9]
    v_pk_fma_f32 v[12:13], v[136:137], v[136:137], v[12:13]
    v_pk_add_f32 v[138:139], v[90:91], v[8:9]
    v_pk_fma_f32 v[14:15], v[138:139], v[138:139], v[14:15]
    v_pk_add_f32 v[136:137], v[92:93], v[8:9]
    v_pk_fma_f32 v[12:13], v[136:137], v[136:137], v[12:13]
    v_pk_add_f32 v[138:139], v[94:95], v[8:9]
    v_pk_fma_f32 v[14:15], v[138:139], v[138:139], v[14:15]
    v_pk_add_f32 v[136:137], v[96:97], v[8:9]
    v_pk_fma_f32 v[12:13], v[136:137], v[136:137], v[12:13]
    v_pk_add_f32 v[138:139], v[98:99], v[8:9]
    v_pk_fma_f32 v[14:15], v[138:139], v[138:139], v[14:15]
    v_pk_add_f32 v[136:137], v[100:101], v[8:9]
    v_pk_fma_f32 v[12:13], v[136:137], v[136:137], v[12:13]
    v_pk_add_f32 v[138:139], v[102:103], v[8:9]
    v_pk_fma_f32 v[14:15], v[138:139], v[138:139], v[14:15]
    v_pk_add_f32 v[136:137], v[104:105], v[8:9]
    v_pk_fma_f32 v[12:13], v[136:137], v[136:137], v[12:13]
    v_pk_add_f32 v[138:139], v[106:107], v[8:9]
    v_pk_fma_f32 v[14:15], v[138:139], v[138:139], v[14:15]
    v_pk_add_f32 v[136:137], v[108:109], v[8:9]
    v_pk_fma_f32 v[12:13], v[136:137], v[136:137], v[12:13]
    v_pk_add_f32 v[138:139], v[110:111], v[8:9]
    v_pk_fma_f32 v[14:15], v[138:139], v[138:139], v[14:15]
    v_pk_add_f32 v[136:137], v[112:113], v[8:9]
    v_pk_fma_f32 v[12:13], v[136:137], v[136:137], v[12:13]
    v_pk_add_f32 v[138:139], v[114:115], v[8:9]
    v_pk_fma_f32 v[14:15], v[138:139], v[138:139], v[14:15]
    v_pk_add_f32 v[136:137], v[116:117], v[8:9]
    v_pk_fma_f32 v[12:13], v[136:137], v[136:137], v[12:13]
    v_pk_add_f32 v[138:139], v[118:119], v[8:9]
    v_pk_fma_f32 v[14:15], v[138:139], v[138:139], v[14:15]
    v_pk_add_f32 v[136:137], v[120:121], v[8:9]
    v_pk_fma_f32 v[12:13], v[136:137], v[136:137], v[12:13]
    v_pk_add_f32 v[138:139], v[122:123], v[8:9]
    v_pk_fma_f32 v[14:15], v[138:139], v[138:139], v[14:15]
    v_pk_add_f32 v[136:137], v[124:125], v[8:9]
    v_pk_fma_f32 v[12:13], v[136:137], v[136:137], v[12:13]
    v_pk_add_f32 v[138:139], v[126:127], v[8:9]
    v_pk_fma_f32 v[14:15], v[138:139], v[138:139], v[14:15]
    v_pk_add_f32 v[136:137], v[128:129], v[8:9]
    v_pk_fma_f32 v[12:13], v[136:137], v[136:137], v[12:13]
    v_pk_add_f32 v[138:139], v[130:131], v[8:9]
    v_pk_fma_f32 v[14:15], v[138:139], v[138:139], v[14:15]
    v_pk_add_f32 v[136:137], v[132:133], v[8:9]
    v_pk_fma_f32 v[12:13], v[136:137], v[136:137], v[12:13]
    v_pk_add_f32 v[138:139], v[134:135], v[8:9]
    v_pk_fma_f32 v[14:15], v[138:139], v[138:139], v[14:15]
    v_pk_add_f32 v[12:13], v[12:13], v[14:15]
    s_nop 0
    v_add_f32 v12, v12, v13
    s_nop 1
    v_add_f32_dpp v12, v12, v12 quad_perm:[1,0,3,2] row_mask:0xf bank_mask:0xf
    s_nop 1
    v_add_f32_dpp v12, v12, v12 quad_perm:[2,3,0,1] row_mask:0xf bank_mask:0xf
    s_nop 1
    v_add_f32_dpp v12, v12, v12 row_half_mirror row_mask:0xf bank_mask:0xf
    v_mul_f32 v12, 0x3ae38e39, v12
    v_cvt_pk_bf16_f32 v12, v12, v12
    v_and_b32 v12, 0xffff0000, v12
    v_add_f32 v12, 0x3727c5ac, v12
    v_cvt_pk_bf16_f32 v12, v12, v12
    v_and_b32 v12, 0xffff0000, v12
    v_sqrt_f32 v12, v12
    s_nop 0
    v_cvt_pk_bf16_f32 v12, v12, v12
    v_and_b32 v12, 0xffff0000, v12
    v_rcp_f32 v12, v12
    v_cvt_pk_bf16_f32 v8, v8, v8
    v_and_b32 v8, 0xffff0000, v8
    v_mul_f32 v14, v8, v12
    v_mov_b32 v13, v12
    v_mov_b32 v15, v14
    s_lshl_b32 s41, s89, 7
    v_lshlrev_b32 v9, 2, v1
    s_mov_b32 s42, 0x01010101
    s_mov_b32 s43, s42
    s_mov_b64 exec, s[42:43]
    buffer_store_dword v12, v9, s[32:35], s41 offen sc1
    s_mov_b64 exec, -1
    v_pk_fma_f32 v[64:65], v[64:65], v[12:13], v[14:15]
    v_cvt_pk_bf16_f32 v16, v64, v65
    v_pk_fma_f32 v[66:67], v[66:67], v[12:13], v[14:15]
    v_cvt_pk_bf16_f32 v17, v66, v67
    v_pk_fma_f32 v[68:69], v[68:69], v[12:13], v[14:15]
    v_cvt_pk_bf16_f32 v18, v68, v69
    v_pk_fma_f32 v[70:71], v[70:71], v[12:13], v[14:15]
    v_cvt_pk_bf16_f32 v19, v70, v71
    ds_write_b128 v4, v[16:19] offset:0
    v_pk_fma_f32 v[72:73], v[72:73], v[12:13], v[14:15]
    v_cvt_pk_bf16_f32 v20, v72, v73
    v_pk_fma_f32 v[74:75], v[74:75], v[12:13], v[14:15]
    v_cvt_pk_bf16_f32 v21, v74, v75
    v_pk_fma_f32 v[76:77], v[76:77], v[12:13], v[14:15]
    v_cvt_pk_bf16_f32 v22, v76, v77
    v_pk_fma_f32 v[78:79], v[78:79], v[12:13], v[14:15]
    v_cvt_pk_bf16_f32 v23, v78, v79
    ds_write_b128 v4, v[20:23] offset:128
    v_pk_fma_f32 v[80:81], v[80:81], v[12:13], v[14:15]
    v_cvt_pk_bf16_f32 v24, v80, v81
    v_pk_fma_f32 v[82:83], v[82:83], v[12:13], v[14:15]
    v_cvt_pk_bf16_f32 v25, v82, v83
    v_pk_fma_f32 v[84:85], v[84:85], v[12:13], v[14:15]
    v_cvt_pk_bf16_f32 v26, v84, v85
    v_pk_fma_f32 v[86:87], v[86:87], v[12:13], v[14:15]
    v_cvt_pk_bf16_f32 v27, v86, v87
    ds_write_b128 v4, v[24:27] offset:256
    v_pk_fma_f32 v[88:89], v[88:89], v[12:13], v[14:15]
    v_cvt_pk_bf16_f32 v28, v88, v89
    v_pk_fma_f32 v[90:91], v[90:91], v[12:13], v[14:15]
    v_cvt_pk_bf16_f32 v29, v90, v91
    v_pk_fma_f32 v[92:93], v[92:93], v[12:13], v[14:15]
    v_cvt_pk_bf16_f32 v30, v92, v93
    v_pk_fma_f32 v[94:95], v[94:95], v[12:13], v[14:15]
    v_cvt_pk_bf16_f32 v31, v94, v95
    ds_write_b128 v4, v[28:31] offset:384
    v_pk_fma_f32 v[96:97], v[96:97], v[12:13], v[14:15]
    v_cvt_pk_bf16_f32 v32, v96, v97
    v_pk_fma_f32 v[98:99], v[98:99], v[12:13], v[14:15]
    v_cvt_pk_bf16_f32 v33, v98, v99
    v_pk_fma_f32 v[100:101], v[100:101], v[12:13], v[14:15]
    v_cvt_pk_bf16_f32 v34, v100, v101
    v_pk_fma_f32 v[102:103], v[102:103], v[12:13], v[14:15]
    v_cvt_pk_bf16_f32 v35, v102, v103
    ds_write_b128 v4, v[32:35] offset:512
    v_pk_fma_f32 v[104:105], v[104:105], v[12:13], v[14:15]
    v_cvt_pk_bf16_f32 v36, v104, v105
    v_pk_fma_f32 v[106:107], v[106:107], v[12:13], v[14:15]
    v_cvt_pk_bf16_f32 v37, v106, v107
    v_pk_fma_f32 v[108:109], v[108:109], v[12:13], v[14:15]
    v_cvt_pk_bf16_f32 v38, v108, v109
    v_pk_fma_f32 v[110:111], v[110:111], v[12:13], v[14:15]
    v_cvt_pk_bf16_f32 v39, v110, v111
    ds_write_b128 v4, v[36:39] offset:640
    v_pk_fma_f32 v[112:113], v[112:113], v[12:13], v[14:15]
    v_cvt_pk_bf16_f32 v40, v112, v113
    v_pk_fma_f32 v[114:115], v[114:115], v[12:13], v[14:15]
    v_cvt_pk_bf16_f32 v41, v114, v115
    v_pk_fma_f32 v[116:117], v[116:117], v[12:13], v[14:15]
    v_cvt_pk_bf16_f32 v42, v116, v117
    v_pk_fma_f32 v[118:119], v[118:119], v[12:13], v[14:15]
    v_cvt_pk_bf16_f32 v43, v118, v119
    ds_write_b128 v4, v[40:43] offset:768
    v_pk_fma_f32 v[120:121], v[120:121], v[12:13], v[14:15]
    v_cvt_pk_bf16_f32 v44, v120, v121
    v_pk_fma_f32 v[122:123], v[122:123], v[12:13], v[14:15]
    v_cvt_pk_bf16_f32 v45, v122, v123
    v_pk_fma_f32 v[124:125], v[124:125], v[12:13], v[14:15]
    v_cvt_pk_bf16_f32 v46, v124, v125
    v_pk_fma_f32 v[126:127], v[126:127], v[12:13], v[14:15]
    v_cvt_pk_bf16_f32 v47, v126, v127
    ds_write_b128 v4, v[44:47] offset:896
    v_pk_fma_f32 v[128:129], v[128:129], v[12:13], v[14:15]
    v_cvt_pk_bf16_f32 v48, v128, v129
    v_pk_fma_f32 v[130:131], v[130:131], v[12:13], v[14:15]
    v_cvt_pk_bf16_f32 v49, v130, v131
    v_pk_fma_f32 v[132:133], v[132:133], v[12:13], v[14:15]
    v_cvt_pk_bf16_f32 v50, v132, v133
    v_pk_fma_f32 v[134:135], v[134:135], v[12:13], v[14:15]
    v_cvt_pk_bf16_f32 v51, v134, v135
    ds_write_b128 v4, v[48:51] offset:1024
    s_waitcnt lgkmcnt(0)
    s_barrier
    ds_read_b64_tr_b16 v[64:65], v6 offset:4672
    ds_read_b64_tr_b16 v[66:67], v6 offset:0
    ds_read_b64_tr_b16 v[68:69], v6 offset:4704
    ds_read_b64_tr_b16 v[70:71], v6 offset:32
    ds_read_b64_tr_b16 v[72:73], v6 offset:4736
    ds_read_b64_tr_b16 v[74:75], v6 offset:64
    ds_read_b64_tr_b16 v[76:77], v6 offset:4768
    ds_read_b64_tr_b16 v[78:79], v6 offset:96
    ds_read_b64_tr_b16 v[80:81], v6 offset:4800
    ds_read_b64_tr_b16 v[82:83], v6 offset:128
    ds_read_b64_tr_b16 v[84:85], v6 offset:4832
    ds_read_b64_tr_b16 v[86:87], v6 offset:160
    ds_read_b64_tr_b16 v[88:89], v6 offset:4864
    ds_read_b64_tr_b16 v[90:91], v6 offset:192
    ds_read_b64_tr_b16 v[92:93], v6 offset:4896
    ds_read_b64_tr_b16 v[94:95], v6 offset:224
    ds_read_b64_tr_b16 v[96:97], v6 offset:4928
    ds_read_b64_tr_b16 v[98:99], v6 offset:256
    s_waitcnt lgkmcnt(15)
    s_mov_b32 s43, 0
    buffer_store_dwordx4 v[64:67], v7, s[28:31], s43 offen sc1
    s_waitcnt lgkmcnt(14)
    s_mov_b32 s43, 67584
    buffer_store_dwordx4 v[68:71], v7, s[28:31], s43 offen sc1
    s_waitcnt lgkmcnt(12)
    s_mov_b32 s43, 135168
    buffer_store_dwordx4 v[72:75], v7, s[28:31], s43 offen sc1
    s_waitcnt lgkmcnt(10)
    s_mov_b32 s43, 202752
    buffer_store_dwordx4 v[76:79], v7, s[28:31], s43 offen sc1
    s_waitcnt lgkmcnt(8)
    s_mov_b32 s43, 270336
    buffer_store_dwordx4 v[80:83], v7, s[28:31], s43 offen sc1
    s_waitcnt lgkmcnt(6)
    s_mov_b32 s43, 337920
    buffer_store_dwordx4 v[84:87], v7, s[28:31], s43 offen sc1
    s_waitcnt lgkmcnt(4)
    s_mov_b32 s43, 405504
    buffer_store_dwordx4 v[88:91], v7, s[28:31], s43 offen sc1
    s_waitcnt lgkmcnt(2)
    s_mov_b32 s43, 473088
    buffer_store_dwordx4 v[92:95], v7, s[28:31], s43 offen sc1
    s_waitcnt lgkmcnt(0)
    s_mov_b32 s43, 540672
    buffer_store_dwordx4 v[96:99], v7, s[28:31], s43 offen sc1
    s_add_u32 s32, s4, 5242880
    s_addc_u32 s33, s5, 0
    s_mov_b32 s34, 2359296
    s_barrier
    s_lshl_b32 s64, s60, 2
    s_mov_b32 s65, 0x01010101
    s_add_u32 s45, s63, 8
    s_mov_b32 s53, 0
    s_add_u32 s44, s62, 4
    s_waitcnt vmcnt(12)
    v_add_u32 v158, s46, v146
    v_add_u32 v159, s46, v147
    v_lshlrev_b32 v16, 16, v144
    v_mul_f32 v16, 0x3fb8aa3b, v16
    v_exp_f32 v16, v16
    v_lshlrev_b32 v97, 16, v145
    v_cvt_pk_bf16_f32 v16, v16, v16
    v_and_b32 v16, 0xffff0000, v16
    v_lshlrev_b32 v18, 16, v140
    v_mul_f32 v18, 0x3fb8aa3b, v18
    v_exp_f32 v18, v18
    v_lshlrev_b32 v19, 16, v141
    v_lshlrev_b32 v20, 16, v142
    v_lshlrev_b32 v21, 16, v143
    v_cvt_pk_bf16_f32 v18, v18, v18
    v_and_b32 v18, 0xffff0000, v18
    v_mul_f32 v18, v18, v16
    v_mul_f32 v19, v19, v16
    v_mul_f32 v20, v20, v16
    v_mul_f32 v21, v21, v16
    v_mul_f32 v18, 0xbfb8aa3b, v18
    v_mul_f32 v19, 0x3e22f983, v19
    v_add_f32 v20, v20, v20
    v_add_f32 v21, v21, v21
    v_mul_f32 v62, 0x3f800000, v18
    v_mul_f32 v63, 0x3f800000, v19
    v_exp_f32 v62, v62
    v_fract_f32 v63, v63
    v_cos_f32 v22, v63
    v_sin_f32 v23, v63
    s_nop 0
    v_mul_f32 v22, v22, v62
    v_mul_f32 v23, v23, v62
    v_mul_f32 v62, 0x41000000, v18
    v_mul_f32 v63, 0x41000000, v19
    v_exp_f32 v62, v62
    v_fract_f32 v63, v63
    v_cos_f32 v24, v63
    v_sin_f32 v25, v63
    s_nop 0
    v_mul_f32 v24, v24, v62
    v_mul_f32 v25, v25, v62
    v_mul_f32 v62, 0x43800000, v18
    v_mul_f32 v63, 0x43800000, v19
    v_exp_f32 v62, v62
    v_fract_f32 v63, v63
    v_cos_f32 v26, v63
    v_sin_f32 v27, v63
    s_nop 0
    v_mul_f32 v26, v26, v62
    v_mul_f32 v27, v27, v62
    s_mov_b32 m0, s46
    v_mov_b32 v66, 0x3f80
    ds_write_addtid_b32 v66 offset:7344
    v_cvt_pk_bf16_f32 v62, v20, -v21
    ds_write_addtid_b32 v62 offset:0
    v_cvt_pk_bf16_f32 v63, v24, v25
    ds_write_addtid_b32 v63 offset:7616
    v_pk_mul_f32 v[60:61], v[20:21], v[22:23] op_sel:[0,0] op_sel_hi:[0,1]
    v_pk_fma_f32 v[34:35], v[20:21], v[22:23], v[60:61] op_sel:[1,1,0] op_sel_hi:[1,0,1] neg_lo:[1,0,0]
    v_cvt_pk_bf16_f32 v64, v34, -v35
    ds_write_addtid_b32 v64 offset:272
    v_pk_mul_f32 v[32:33], v[24:25], v[24:25] op_sel:[0,0] op_sel_hi:[0,1]
    v_pk_fma_f32 v[28:29], v[24:25], v[24:25], v[32:33] op_sel:[1,1,0] op_sel_hi:[1,0,1] neg_lo:[1,0,0]
    v_cvt_pk_bf16_f32 v65, v28, v29
    ds_write_addtid_b32 v65 offset:7888
    v_pk_mul_f32 v[60:61], v[34:35], v[22:23] op_sel:[0,0] op_sel_hi:[0,1]
    v_pk_fma_f32 v[36:37], v[34:35], v[22:23], v[60:61] op_sel:[1,1,0] op_sel_hi:[1,0,1] neg_lo:[1,0,0]
    v_cvt_pk_bf16_f32 v62, v36, -v37
    ds_write_addtid_b32 v62 offset:544
    v_pk_mul_f32 v[32:33], v[28:29], v[24:25] op_sel:[0,0] op_sel_hi:[0,1]
    v_pk_fma_f32 v[30:31], v[28:29], v[24:25], v[32:33] op_sel:[1,1,0] op_sel_hi:[1,0,1] neg_lo:[1,0,0]
    v_cvt_pk_bf16_f32 v63, v30, v31
    ds_write_addtid_b32 v63 offset:8160
    v_pk_mul_f32 v[60:61], v[36:37], v[22:23] op_sel:[0,0] op_sel_hi:[0,1]
    v_pk_fma_f32 v[38:39], v[36:37], v[22:23], v[60:61] op_sel:[1,1,0] op_sel_hi:[1,0,1] neg_lo:[1,0,0]
    v_cvt_pk_bf16_f32 v64, v38, -v39
    ds_write_addtid_b32 v64 offset:816
    v_pk_mul_f32 v[32:33], v[30:31], v[24:25] op_sel:[0,0] op_sel_hi:[0,1]
    v_pk_fma_f32 v[28:29], v[30:31], v[24:25], v[32:33] op_sel:[1,1,0] op_sel_hi:[1,0,1] neg_lo:[1,0,0]
    v_cvt_pk_bf16_f32 v65, v28, v29
    ds_write_addtid_b32 v65 offset:8432
    v_pk_mul_f32 v[60:61], v[38:39], v[22:23] op_sel:[0,0] op_sel_hi:[0,1]
    v_pk_fma_f32 v[40:41], v[38:39], v[22:23], v[60:61] op_sel:[1,1,0] op_sel_hi:[1,0,1] neg_lo:[1,0,0]
    v_cvt_pk_bf16_f32 v62, v40, -v41
    ds_write_addtid_b32 v62 offset:1088
    v_pk_mul_f32 v[32:33], v[28:29], v[24:25] op_sel:[0,0] op_sel_hi:[0,1]
    v_pk_fma_f32 v[30:31], v[28:29], v[24:25], v[32:33] op_sel:[1,1,0] op_sel_hi:[1,0,1] neg_lo:[1,0,0]
    v_cvt_pk_bf16_f32 v63, v30, v31
    ds_write_addtid_b32 v63 offset:8704
    v_pk_mul_f32 v[60:61], v[40:41], v[22:23] op_sel:[0,0] op_sel_hi:[0,1]
    v_pk_fma_f32 v[42:43], v[40:41], v[22:23], v[60:61] op_sel:[1,1,0] op_sel_hi:[1,0,1] neg_lo:[1,0,0]
    v_cvt_pk_bf16_f32 v64, v42, -v43
    ds_write_addtid_b32 v64 offset:1360
    v_pk_mul_f32 v[32:33], v[30:31], v[24:25] op_sel:[0,0] op_sel_hi:[0,1]
    v_pk_fma_f32 v[28:29], v[30:31], v[24:25], v[32:33] op_sel:[1,1,0] op_sel_hi:[1,0,1] neg_lo:[1,0,0]
    v_cvt_pk_bf16_f32 v65, v28, v29
    ds_write_addtid_b32 v65 offset:8976
    v_pk_mul_f32 v[60:61], v[42:43], v[22:23] op_sel:[0,0] op_sel_hi:[0,1]
    v_pk_fma_f32 v[44:45], v[42:43], v[22:23], v[60:61] op_sel:[1,1,0] op_sel_hi:[1,0,1] neg_lo:[1,0,0]
    v_cvt_pk_bf16_f32 v62, v44, -v45
    ds_write_addtid_b32 v62 offset:1632
    v_pk_mul_f32 v[32:33], v[28:29], v[24:25] op_sel:[0,0] op_sel_hi:[0,1]
    v_pk_fma_f32 v[30:31], v[28:29], v[24:25], v[32:33] op_sel:[1,1,0] op_sel_hi:[1,0,1] neg_lo:[1,0,0]
    v_cvt_pk_bf16_f32 v63, v30, v31
    ds_write_addtid_b32 v63 offset:9248
    v_pk_mul_f32 v[60:61], v[44:45], v[22:23] op_sel:[0,0] op_sel_hi:[0,1]
    v_pk_fma_f32 v[46:47], v[44:45], v[22:23], v[60:61] op_sel:[1,1,0] op_sel_hi:[1,0,1] neg_lo:[1,0,0]
    v_cvt_pk_bf16_f32 v64, v46, -v47
    ds_write_addtid_b32 v64 offset:1904
    v_pk_mul_f32 v[32:33], v[30:31], v[24:25] op_sel:[0,0] op_sel_hi:[0,1]
    v_pk_fma_f32 v[28:29], v[30:31], v[24:25], v[32:33] op_sel:[1,1,0] op_sel_hi:[1,0,1] neg_lo:[1,0,0]
    v_cvt_pk_bf16_f32 v65, v28, v29
    ds_write_addtid_b32 v65 offset:9520
    v_pk_mul_f32 v[60:61], v[46:47], v[22:23] op_sel:[0,0] op_sel_hi:[0,1]
    v_pk_fma_f32 v[48:49], v[46:47], v[22:23], v[60:61] op_sel:[1,1,0] op_sel_hi:[1,0,1] neg_lo:[1,0,0]
    v_pk_mul_f32 v[32:33], v[28:29], v[24:25] op_sel:[0,0] op_sel_hi:[0,1]
    v_pk_fma_f32 v[30:31], v[28:29], v[24:25], v[32:33] op_sel:[1,1,0] op_sel_hi:[1,0,1] neg_lo:[1,0,0]
    v_cvt_pk_bf16_f32 v62, v30, v31
    ds_write_addtid_b32 v62 offset:9792
    v_pk_mul_f32 v[60:61], v[20:21], v[26:27] op_sel:[0,0] op_sel_hi:[0,1]
    v_pk_fma_f32 v[50:51], v[20:21], v[26:27], v[60:61] op_sel:[1,1,0] op_sel_hi:[1,0,1] neg_lo:[1,0,0]
    v_cvt_pk_bf16_f32 v63, v50, -v51
    ds_write_addtid_b32 v63 offset:2176
    s_waitcnt vmcnt(0)
    s_barrier
    v_mov_b32 v252, s65
    s_mov_b64 exec, s[66:67]
    buffer_store_dword v252, off, s[68:71], s64 sc1
    s_mov_b64 exec, -1
    v_pk_mul_f32 v[32:33], v[30:31], v[24:25] op_sel:[0,0] op_sel_hi:[0,1]
    v_pk_fma_f32 v[28:29], v[30:31], v[24:25], v[32:33] op_sel:[1,1,0] op_sel_hi:[1,0,1] neg_lo:[1,0,0]
    v_cvt_pk_bf16_f32 v64, v28, v29
    ds_write_addtid_b32 v64 offset:10064
    v_pk_mul_f32 v[60:61], v[36:37], v[26:27] op_sel:[0,0] op_sel_hi:[0,1]
    v_pk_fma_f32 v[52:53], v[36:37], v[26:27], v[60:61] op_sel:[1,1,0] op_sel_hi:[1,0,1] neg_lo:[1,0,0]
    v_cvt_pk_bf16_f32 v65, v52, -v53
    ds_write_addtid_b32 v65 offset:2448
    buffer_load_dword v243, v240, s[76:79], s84 offen offset:512
    v_pk_mul_f32 v[32:33], v[28:29], v[24:25] op_sel:[0,0] op_sel_hi:[0,1]
    v_pk_fma_f32 v[30:31], v[28:29], v[24:25], v[32:33] op_sel:[1,1,0] op_sel_hi:[1,0,1] neg_lo:[1,0,0]
    v_cvt_pk_bf16_f32 v62, v30, v31
    ds_write_addtid_b32 v62 offset:10336
    v_pk_mul_f32 v[60:61], v[40:41], v[26:27] op_sel:[0,0] op_sel_hi:[0,1]
    v_pk_fma_f32 v[54:55], v[40:41], v[26:27], v[60:61] op_sel:[1,1,0] op_sel_hi:[1,0,1] neg_lo:[1,0,0]
    v_cvt_pk_bf16_f32 v63, v54, -v55
L_pv0:
    s_cbranch_execz L_pv4
    ds_write_addtid_b32 v63 offset:2720
    v_pk_mul_f32 v[32:33], v[30:31], v[24:25] op_sel:[0,0] op_sel_hi:[0,1]
    v_pk_fma_f32 v[28:29], v[30:31], v[24:25], v[32:33] op_sel:[1,1,0] op_sel_hi:[1,0,1] neg_lo:[1,0,0]
    v_cvt_pk_bf16_f32 v64, v28, v29
    ds_write_addtid_b32 v64 offset:10608
    v_pk_mul_f32 v[60:61], v[44:45], v[26:27] op_sel:[0,0] op_sel_hi:[0,1]
    v_pk_fma_f32 v[56:57], v[44:45], v[26:27], v[60:61] op_sel:[1,1,0] op_sel_hi:[1,0,1] neg_lo:[1,0,0]
    v_cvt_pk_bf16_f32 v65, v56, -v57
    ds_write_addtid_b32 v65 offset:2992
    v_pk_mul_f32 v[32:33], v[28:29], v[24:25] op_sel:[0,0] op_sel_hi:[0,1]
    v_pk_fma_f32 v[30:31], v[28:29], v[24:25], v[32:33] op_sel:[1,1,0] op_sel_hi:[1,0,1] neg_lo:[1,0,0]
    v_cvt_pk_bf16_f32 v62, v30, v31
    ds_write_addtid_b32 v62 offset:10880
    v_pk_mul_f32 v[60:61], v[48:49], v[26:27] op_sel:[0,0] op_sel_hi:[0,1]
    v_pk_fma_f32 v[58:59], v[48:49], v[26:27], v[60:61] op_sel:[1,1,0] op_sel_hi:[1,0,1] neg_lo:[1,0,0]
    v_cvt_pk_bf16_f32 v63, v58, -v59
    ds_write_addtid_b32 v63 offset:3264
    v_pk_mul_f32 v[32:33], v[30:31], v[24:25] op_sel:[0,0] op_sel_hi:[0,1]
    v_pk_fma_f32 v[28:29], v[30:31], v[24:25], v[32:33] op_sel:[1,1,0] op_sel_hi:[1,0,1] neg_lo:[1,0,0]
    v_cvt_pk_bf16_f32 v64, v28, v29
    ds_write_addtid_b32 v64 offset:11152
    v_pk_mul_f32 v[60:61], v[50:51], v[26:27] op_sel:[0,0] op_sel_hi:[0,1]
    v_pk_fma_f32 v[50:51], v[50:51], v[26:27], v[60:61] op_sel:[1,1,0] op_sel_hi:[1,0,1] neg_lo:[1,0,0]
    v_cvt_pk_bf16_f32 v65, v50, -v51
    ds_write_addtid_b32 v65 offset:3536
    v_pk_mul_f32 v[32:33], v[28:29], v[24:25] op_sel:[0,0] op_sel_hi:[0,1]
    v_pk_fma_f32 v[30:31], v[28:29], v[24:25], v[32:33] op_sel:[1,1,0] op_sel_hi:[1,0,1] neg_lo:[1,0,0]
    v_cvt_pk_bf16_f32 v62, v30, v31
    ds_write_addtid_b32 v62 offset:11424
    v_pk_mul_f32 v[60:61], v[54:55], v[26:27] op_sel:[0,0] op_sel_hi:[0,1]
    v_pk_fma_f32 v[54:55], v[54:55], v[26:27], v[60:61] op_sel:[1,1,0] op_sel_hi:[1,0,1] neg_lo:[1,0,0]
    v_cvt_pk_bf16_f32 v63, v54, -v55
    ds_write_addtid_b32 v63 offset:3808
    v_pk_mul_f32 v[32:33], v[30:31], v[24:25] op_sel:[0,0] op_sel_hi:[0,1]
    v_pk_fma_f32 v[28:29], v[30:31], v[24:25], v[32:33] op_sel:[1,1,0] op_sel_hi:[1,0,1] neg_lo:[1,0,0]
    v_cvt_pk_bf16_f32 v64, v28, v29
    ds_write_addtid_b32 v64 offset:11696
    v_pk_mul_f32 v[60:61], v[58:59], v[26:27] op_sel:[0,0] op_sel_hi:[0,1]
    v_pk_fma_f32 v[58:59], v[58:59], v[26:27], v[60:61] op_sel:[1,1,0] op_sel_hi:[1,0,1] neg_lo:[1,0,0]
    v_cvt_pk_bf16_f32 v65, v58, -v59
    ds_write_addtid_b32 v65 offset:4080
    v_pk_mul_f32 v[32:33], v[28:29], v[24:25] op_sel:[0,0] op_sel_hi:[0,1]
    v_pk_fma_f32 v[30:31], v[28:29], v[24:25], v[32:33] op_sel:[1,1,0] op_sel_hi:[1,0,1] neg_lo:[1,0,0]
    v_cvt_pk_bf16_f32 v62, v30, v31
    ds_write_addtid_b32 v62 offset:11968
    v_pk_mul_f32 v[60:61], v[50:51], v[26:27] op_sel:[0,0] op_sel_hi:[0,1]
    v_pk_fma_f32 v[50:51], v[50:51], v[26:27], v[60:61] op_sel:[1,1,0] op_sel_hi:[1,0,1] neg_lo:[1,0,0]
    v_cvt_pk_bf16_f32 v63, v50, -v51
    ds_write_addtid_b32 v63 offset:4352
    v_pk_mul_f32 v[32:33], v[30:31], v[24:25] op_sel:[0,0] op_sel_hi:[0,1]
    v_pk_fma_f32 v[28:29], v[30:31], v[24:25], v[32:33] op_sel:[1,1,0] op_sel_hi:[1,0,1] neg_lo:[1,0,0]
    v_cvt_pk_bf16_f32 v64, v28, v29
    ds_write_addtid_b32 v64 offset:12240
    v_pk_mul_f32 v[60:61], v[54:55], v[26:27] op_sel:[0,0] op_sel_hi:[0,1]
    v_pk_fma_f32 v[54:55], v[54:55], v[26:27], v[60:61] op_sel:[1,1,0] op_sel_hi:[1,0,1] neg_lo:[1,0,0]
    v_cvt_pk_bf16_f32 v65, v54, -v55
    ds_write_addtid_b32 v65 offset:4624
    v_pk_mul_f32 v[32:33], v[28:29], v[24:25] op_sel:[0,0] op_sel_hi:[0,1]
    v_pk_fma_f32 v[30:31], v[28:29], v[24:25], v[32:33] op_sel:[1,1,0] op_sel_hi:[1,0,1] neg_lo:[1,0,0]
    v_cvt_pk_bf16_f32 v62, v30, v31
    ds_write_addtid_b32 v62 offset:12512
    v_pk_mul_f32 v[60:61], v[58:59], v[26:27] op_sel:[0,0] op_sel_hi:[0,1]
    v_pk_fma_f32 v[58:59], v[58:59], v[26:27], v[60:61] op_sel:[1,1,0] op_sel_hi:[1,0,1] neg_lo:[1,0,0]
    v_cvt_pk_bf16_f32 v63, v58, -v59
    ds_write_addtid_b32 v63 offset:4896
    v_pk_mul_f32 v[32:33], v[30:31], v[24:25] op_sel:[0,0] op_sel_hi:[0,1]
    v_pk_fma_f32 v[28:29], v[30:31], v[24:25], v[32:33] op_sel:[1,1,0] op_sel_hi:[1,0,1] neg_lo:[1,0,0]
    v_cvt_pk_bf16_f32 v64, v28, v29
    ds_write_addtid_b32 v64 offset:12784
    v_pk_mul_f32 v[60:61], v[50:51], v[26:27] op_sel:[0,0] op_sel_hi:[0,1]
    v_pk_fma_f32 v[50:51], v[50:51], v[26:27], v[60:61] op_sel:[1,1,0] op_sel_hi:[1,0,1] neg_lo:[1,0,0]
    v_cvt_pk_bf16_f32 v65, v50, -v51
    ds_write_addtid_b32 v65 offset:5168
    v_pk_mul_f32 v[32:33], v[28:29], v[24:25] op_sel:[0,0] op_sel_hi:[0,1]
    v_pk_fma_f32 v[30:31], v[28:29], v[24:25], v[32:33] op_sel:[1,1,0] op_sel_hi:[1,0,1] neg_lo:[1,0,0]
    v_cvt_pk_bf16_f32 v62, v30, v31
    ds_write_addtid_b32 v62 offset:13056
    v_pk_mul_f32 v[60:61], v[58:59], v[26:27] op_sel:[0,0] op_sel_hi:[0,1]
    v_pk_fma_f32 v[58:59], v[58:59], v[26:27], v[60:61] op_sel:[1,1,0] op_sel_hi:[1,0,1] neg_lo:[1,0,0]
    v_cvt_pk_bf16_f32 v63, v58, -v59
    ds_write_addtid_b32 v63 offset:5440
    v_pk_mul_f32 v[32:33], v[30:31], v[24:25] op_sel:[0,0] op_sel_hi:[0,1]
    v_pk_fma_f32 v[28:29], v[30:31], v[24:25], v[32:33] op_sel:[1,1,0] op_sel_hi:[1,0,1] neg_lo:[1,0,0]
    v_cvt_pk_bf16_f32 v64, v28, v29
    ds_write_addtid_b32 v64 offset:13328
    v_pk_mul_f32 v[60:61], v[50:51], v[26:27] op_sel:[0,0] op_sel_hi:[0,1]
    v_pk_fma_f32 v[50:51], v[50:51], v[26:27], v[60:61] op_sel:[1,1,0] op_sel_hi:[1,0,1] neg_lo:[1,0,0]
    v_cvt_pk_bf16_f32 v65, v50, -v51
    ds_write_addtid_b32 v65 offset:5712
    v_pk_mul_f32 v[32:33], v[28:29], v[24:25] op_sel:[0,0] op_sel_hi:[0,1]
    v_pk_fma_f32 v[30:31], v[28:29], v[24:25], v[32:33] op_sel:[1,1,0] op_sel_hi:[1,0,1] neg_lo:[1,0,0]
    v_cvt_pk_bf16_f32 v62, v30, v31
    ds_write_addtid_b32 v62 offset:13600
    v_pk_mul_f32 v[60:61], v[58:59], v[26:27] op_sel:[0,0] op_sel_hi:[0,1]
    v_pk_fma_f32 v[58:59], v[58:59], v[26:27], v[60:61] op_sel:[1,1,0] op_sel_hi:[1,0,1] neg_lo:[1,0,0]
    v_cvt_pk_bf16_f32 v63, v58, -v59
    ds_write_addtid_b32 v63 offset:5984
    v_pk_mul_f32 v[32:33], v[30:31], v[24:25] op_sel:[0,0] op_sel_hi:[0,1]
    v_pk_fma_f32 v[28:29], v[30:31], v[24:25], v[32:33] op_sel:[1,1,0] op_sel_hi:[1,0,1] neg_lo:[1,0,0]
    v_cvt_pk_bf16_f32 v64, v28, v29
    ds_write_addtid_b32 v64 offset:13872
    v_pk_mul_f32 v[60:61], v[50:51], v[26:27] op_sel:[0,0] op_sel_hi:[0,1]
    v_pk_fma_f32 v[50:51], v[50:51], v[26:27], v[60:61] op_sel:[1,1,0] op_sel_hi:[1,0,1] neg_lo:[1,0,0]
    v_cvt_pk_bf16_f32 v65, v50, -v51
    ds_write_addtid_b32 v65 offset:6256
    v_pk_mul_f32 v[32:33], v[28:29], v[24:25] op_sel:[0,0] op_sel_hi:[0,1]
    v_pk_fma_f32 v[30:31], v[28:29], v[24:25], v[32:33] op_sel:[1,1,0] op_sel_hi:[1,0,1] neg_lo:[1,0,0]
    v_cvt_pk_bf16_f32 v62, v30, v31
    ds_write_addtid_b32 v62 offset:14144
    v_pk_mul_f32 v[60:61], v[58:59], v[26:27] op_sel:[0,0] op_sel_hi:[0,1]
    v_pk_fma_f32 v[58:59], v[58:59], v[26:27], v[60:61] op_sel:[1,1,0] op_sel_hi:[1,0,1] neg_lo:[1,0,0]
    v_cvt_pk_bf16_f32 v63, v58, -v59
    ds_write_addtid_b32 v63 offset:6528
    v_pk_mul_f32 v[32:33], v[30:31], v[24:25] op_sel:[0,0] op_sel_hi:[0,1]
    v_pk_fma_f32 v[28:29], v[30:31], v[24:25], v[32:33] op_sel:[1,1,0] op_sel_hi:[1,0,1] neg_lo:[1,0,0]
    v_cvt_pk_bf16_f32 v64, v28, v29
    ds_write_addtid_b32 v64 offset:14416
    v_pk_mul_f32 v[60:61], v[50:51], v[26:27] op_sel:[0,0] op_sel_hi:[0,1]
    v_pk_fma_f32 v[50:51], v[50:51], v[26:27], v[60:61] op_sel:[1,1,0] op_sel_hi:[1,0,1] neg_lo:[1,0,0]
    v_cvt_pk_bf16_f32 v65, v50, -v51
    ds_write_addtid_b32 v65 offset:6800
    v_pk_mul_f32 v[32:33], v[28:29], v[24:25] op_sel:[0,0] op_sel_hi:[0,1]
    v_pk_fma_f32 v[30:31], v[28:29], v[24:25], v[32:33] op_sel:[1,1,0] op_sel_hi:[1,0,1] neg_lo:[1,0,0]
    v_cvt_pk_bf16_f32 v62, v30, v31
    ds_write_addtid_b32 v62 offset:14688
    v_pk_mul_f32 v[60:61], v[58:59], v[26:27] op_sel:[0,0] op_sel_hi:[0,1]
    v_pk_fma_f32 v[58:59], v[58:59], v[26:27], v[60:61] op_sel:[1,1,0] op_sel_hi:[1,0,1] neg_lo:[1,0,0]
    v_cvt_pk_bf16_f32 v63, v58, -v59
    ds_write_addtid_b32 v63 offset:7072
    s_add_u32 s86, s85, 0
    buffer_load_dword v243, v242, s[80:83], s86 offen
    v_pk_mul_f32 v[32:33], v[30:31], v[24:25] op_sel:[0,0] op_sel_hi:[0,1]
    v_pk_fma_f32 v[28:29], v[30:31], v[24:25], v[32:33] op_sel:[1,1,0] op_sel_hi:[1,0,1] neg_lo:[1,0,0]
    v_cvt_pk_bf16_f32 v64, v28, v29
    ds_write_addtid_b32 v64 offset:14960
    v_pk_mul_f32 v[32:33], v[28:29], v[24:25] op_sel:[0,0] op_sel_hi:[0,1]
    v_pk_fma_f32 v[30:31], v[28:29], v[24:25], v[32:33] op_sel:[1,1,0] op_sel_hi:[1,0,1] neg_lo:[1,0,0]
    v_cvt_pk_bf16_f32 v65, v30, v31
    ds_write_addtid_b32 v65 offset:15232
    v_pk_mul_f32 v[32:33], v[30:31], v[24:25] op_sel:[0,0] op_sel_hi:[0,1]
    v_pk_fma_f32 v[28:29], v[30:31], v[24:25], v[32:33] op_sel:[1,1,0] op_sel_hi:[1,0,1] neg_lo:[1,0,0]
    v_cvt_pk_bf16_f32 v62, v28, v29
    ds_write_addtid_b32 v62 offset:15504
    v_pk_mul_f32 v[32:33], v[28:29], v[24:25] op_sel:[0,0] op_sel_hi:[0,1]
    v_pk_fma_f32 v[30:31], v[28:29], v[24:25], v[32:33] op_sel:[1,1,0] op_sel_hi:[1,0,1] neg_lo:[1,0,0]
    v_cvt_pk_bf16_f32 v63, v30, v31
    ds_write_addtid_b32 v63 offset:15776
    ds_read_b128 a[160:163], v158 offset:0
    ds_read_b128 a[164:167], v159 offset:0
    ds_read_b128 a[168:171], v158 offset:32
    ds_read_b128 a[172:175], v159 offset:32
    ds_read_b128 a[176:179], v158 offset:64
    ds_read_b128 a[180:183], v159 offset:64
    ds_read_b128 a[184:187], v158 offset:96
    ds_read_b128 a[188:191], v159 offset:96
    ds_read_b128 a[192:195], v158 offset:128
    ds_read_b128 a[196:199], v159 offset:128
    ds_read_b128 a[200:203], v158 offset:160
    ds_read_b128 a[204:207], v159 offset:160
    ds_read_b128 a[208:211], v158 offset:192
    ds_read_b128 a[212:215], v159 offset:192
    ds_read_b128 a[216:219], v158 offset:224
    ds_read_b128 a[220:223], v159 offset:224
    v_and_b32 v18, 0xffff0000, v140
    v_mul_f32 v18, 0x3fb8aa3b, v18
    v_exp_f32 v18, v18
    v_and_b32 v19, 0xffff0000, v141
    v_and_b32 v20, 0xffff0000, v142
    v_and_b32 v21, 0xffff0000, v143
    v_cvt_pk_bf16_f32 v18, v18, v18
    v_and_b32 v18, 0xffff0000, v18
    v_mul_f32 v18, v18, v16
    v_mul_f32 v19, v19, v16
    v_mul_f32 v20, v20, v16
    v_mul_f32 v21, v21, v16
    v_mul_f32 v18, 0xbfb8aa3b, v18
    v_mul_f32 v19, 0x3e22f983, v19
    v_add_f32 v20, v20, v20
    v_add_f32 v21, v21, v21
    v_mul_f32 v62, 0x3f800000, v18
    v_mul_f32 v63, 0x3f800000, v19
    v_exp_f32 v62, v62
    v_fract_f32 v63, v63
    v_cos_f32 v22, v63
    v_sin_f32 v23, v63
    s_nop 0
    v_mul_f32 v22, v22, v62
    v_mul_f32 v23, v23, v62
    v_mul_f32 v62, 0x41000000, v18
    v_mul_f32 v63, 0x41000000, v19
    v_exp_f32 v62, v62
    v_fract_f32 v63, v63
    v_cos_f32 v24, v63
    v_sin_f32 v25, v63
    s_nop 0
    v_mul_f32 v24, v24, v62
    v_mul_f32 v25, v25, v62
    v_mul_f32 v62, 0x43800000, v18
    v_mul_f32 v63, 0x43800000, v19
    v_exp_f32 v62, v62
    v_fract_f32 v63, v63
    v_cos_f32 v26, v63
    v_sin_f32 v27, v63
    s_nop 0
    v_mul_f32 v26, v26, v62
    v_mul_f32 v27, v27, v62
    s_mov_b32 m0, s46
    s_waitcnt lgkmcnt(0)
    v_mfma_f32_32x32x16_bf16 v[80:95], a[160:163], a[164:167], 0
    s_lshl_b32 s54, s44, 8
    buffer_load_dword v140, v155, s[12:15], s54 offen
    buffer_load_dword v141, v155, s[16:19], s54 offen
    buffer_load_dword v142, v155, s[20:23], s54 offen
    buffer_load_dword v143, v155, s[24:27], s54 offen
    s_lshl_b32 s54, s44, 1
    buffer_load_ushort v144, off, s[36:39], s54
    buffer_load_ushort v145, off, s[56:59], s54
    v_mov_b32 v66, 0x3f80
    ds_write_addtid_b32 v66 offset:7344
    v_cvt_pk_bf16_f32 v62, v20, -v21
    ds_write_addtid_b32 v62 offset:0
    v_cvt_pk_bf16_f32 v63, v24, v25
    ds_write_addtid_b32 v63 offset:7616
    v_pk_mul_f32 v[60:61], v[20:21], v[22:23] op_sel:[0,0] op_sel_hi:[0,1]
    v_pk_fma_f32 v[34:35], v[20:21], v[22:23], v[60:61] op_sel:[1,1,0] op_sel_hi:[1,0,1] neg_lo:[1,0,0]
    v_cvt_pk_bf16_f32 v64, v34, -v35
    ds_write_addtid_b32 v64 offset:272
    v_mfma_f32_32x32x16_bf16 v[80:95], a[168:171], a[172:175], v[80:95]
    v_pk_mul_f32 v[32:33], v[24:25], v[24:25] op_sel:[0,0] op_sel_hi:[0,1]
    v_pk_fma_f32 v[28:29], v[24:25], v[24:25], v[32:33] op_sel:[1,1,0] op_sel_hi:[1,0,1] neg_lo:[1,0,0]
    v_cvt_pk_bf16_f32 v65, v28, v29
    ds_write_addtid_b32 v65 offset:7888
    v_pk_mul_f32 v[60:61], v[34:35], v[22:23] op_sel:[0,0] op_sel_hi:[0,1]
    v_pk_fma_f32 v[36:37], v[34:35], v[22:23], v[60:61] op_sel:[1,1,0] op_sel_hi:[1,0,1] neg_lo:[1,0,0]
    v_cvt_pk_bf16_f32 v62, v36, -v37
    ds_write_addtid_b32 v62 offset:544
    v_pk_mul_f32 v[32:33], v[28:29], v[24:25] op_sel:[0,0] op_sel_hi:[0,1]
    v_pk_fma_f32 v[30:31], v[28:29], v[24:25], v[32:33] op_sel:[1,1,0] op_sel_hi:[1,0,1] neg_lo:[1,0,0]
    v_cvt_pk_bf16_f32 v63, v30, v31
    ds_write_addtid_b32 v63 offset:8160
    v_pk_mul_f32 v[60:61], v[36:37], v[22:23] op_sel:[0,0] op_sel_hi:[0,1]
    v_pk_fma_f32 v[38:39], v[36:37], v[22:23], v[60:61] op_sel:[1,1,0] op_sel_hi:[1,0,1] neg_lo:[1,0,0]
    v_cvt_pk_bf16_f32 v64, v38, -v39
    ds_write_addtid_b32 v64 offset:816
    v_mfma_f32_32x32x16_bf16 v[80:95], a[176:179], a[180:183], v[80:95]
    v_pk_mul_f32 v[32:33], v[30:31], v[24:25] op_sel:[0,0] op_sel_hi:[0,1]
    v_pk_fma_f32 v[28:29], v[30:31], v[24:25], v[32:33] op_sel:[1,1,0] op_sel_hi:[1,0,1] neg_lo:[1,0,0]
    v_cvt_pk_bf16_f32 v65, v28, v29
    ds_write_addtid_b32 v65 offset:8432
    v_pk_mul_f32 v[60:61], v[38:39], v[22:23] op_sel:[0,0] op_sel_hi:[0,1]
    v_pk_fma_f32 v[40:41], v[38:39], v[22:23], v[60:61] op_sel:[1,1,0] op_sel_hi:[1,0,1] neg_lo:[1,0,0]
    v_cvt_pk_bf16_f32 v62, v40, -v41
    ds_write_addtid_b32 v62 offset:1088
    v_pk_mul_f32 v[32:33], v[28:29], v[24:25] op_sel:[0,0] op_sel_hi:[0,1]
    v_pk_fma_f32 v[30:31], v[28:29], v[24:25], v[32:33] op_sel:[1,1,0] op_sel_hi:[1,0,1] neg_lo:[1,0,0]
    v_cvt_pk_bf16_f32 v63, v30, v31
    ds_write_addtid_b32 v63 offset:8704
    v_pk_mul_f32 v[60:61], v[40:41], v[22:23] op_sel:[0,0] op_sel_hi:[0,1]
    v_pk_fma_f32 v[42:43], v[40:41], v[22:23], v[60:61] op_sel:[1,1,0] op_sel_hi:[1,0,1] neg_lo:[1,0,0]
    v_cvt_pk_bf16_f32 v64, v42, -v43
    ds_write_addtid_b32 v64 offset:1360
    v_mfma_f32_32x32x16_bf16 v[80:95], a[184:187], a[188:191], v[80:95]
    v_pk_mul_f32 v[32:33], v[30:31], v[24:25] op_sel:[0,0] op_sel_hi:[0,1]
    v_pk_fma_f32 v[28:29], v[30:31], v[24:25], v[32:33] op_sel:[1,1,0] op_sel_hi:[1,0,1] neg_lo:[1,0,0]
    v_cvt_pk_bf16_f32 v65, v28, v29
    ds_write_addtid_b32 v65 offset:8976
    v_pk_mul_f32 v[60:61], v[42:43], v[22:23] op_sel:[0,0] op_sel_hi:[0,1]
    v_pk_fma_f32 v[44:45], v[42:43], v[22:23], v[60:61] op_sel:[1,1,0] op_sel_hi:[1,0,1] neg_lo:[1,0,0]
    v_cvt_pk_bf16_f32 v62, v44, -v45
    ds_write_addtid_b32 v62 offset:1632
    v_pk_mul_f32 v[32:33], v[28:29], v[24:25] op_sel:[0,0] op_sel_hi:[0,1]
    v_pk_fma_f32 v[30:31], v[28:29], v[24:25], v[32:33] op_sel:[1,1,0] op_sel_hi:[1,0,1] neg_lo:[1,0,0]
    v_cvt_pk_bf16_f32 v63, v30, v31
    ds_write_addtid_b32 v63 offset:9248
    v_pk_mul_f32 v[60:61], v[44:45], v[22:23] op_sel:[0,0] op_sel_hi:[0,1]
    v_pk_fma_f32 v[46:47], v[44:45], v[22:23], v[60:61] op_sel:[1,1,0] op_sel_hi:[1,0,1] neg_lo:[1,0,0]
    v_cvt_pk_bf16_f32 v64, v46, -v47
    ds_write_addtid_b32 v64 offset:1904
    v_mfma_f32_32x32x16_bf16 v[80:95], a[192:195], a[196:199], v[80:95]
    v_pk_mul_f32 v[32:33], v[30:31], v[24:25] op_sel:[0,0] op_sel_hi:[0,1]
    v_pk_fma_f32 v[28:29], v[30:31], v[24:25], v[32:33] op_sel:[1,1,0] op_sel_hi:[1,0,1] neg_lo:[1,0,0]
    v_cvt_pk_bf16_f32 v65, v28, v29
    ds_write_addtid_b32 v65 offset:9520
    v_pk_mul_f32 v[60:61], v[46:47], v[22:23] op_sel:[0,0] op_sel_hi:[0,1]
    v_pk_fma_f32 v[48:49], v[46:47], v[22:23], v[60:61] op_sel:[1,1,0] op_sel_hi:[1,0,1] neg_lo:[1,0,0]
    v_pk_mul_f32 v[32:33], v[28:29], v[24:25] op_sel:[0,0] op_sel_hi:[0,1]
    v_pk_fma_f32 v[30:31], v[28:29], v[24:25], v[32:33] op_sel:[1,1,0] op_sel_hi:[1,0,1] neg_lo:[1,0,0]
    v_cvt_pk_bf16_f32 v62, v30, v31
    ds_write_addtid_b32 v62 offset:9792
    v_pk_mul_f32 v[60:61], v[20:21], v[26:27] op_sel:[0,0] op_sel_hi:[0,1]
    v_pk_fma_f32 v[50:51], v[20:21], v[26:27], v[60:61] op_sel:[1,1,0] op_sel_hi:[1,0,1] neg_lo:[1,0,0]
    v_cvt_pk_bf16_f32 v63, v50, -v51
    ds_write_addtid_b32 v63 offset:2176
    v_mfma_f32_32x32x16_bf16 v[80:95], a[200:203], a[204:207], v[80:95]
    v_pk_mul_f32 v[32:33], v[30:31], v[24:25] op_sel:[0,0] op_sel_hi:[0,1]
    v_pk_fma_f32 v[28:29], v[30:31], v[24:25], v[32:33] op_sel:[1,1,0] op_sel_hi:[1,0,1] neg_lo:[1,0,0]
    v_cvt_pk_bf16_f32 v64, v28, v29
    ds_write_addtid_b32 v64 offset:10064
    v_pk_mul_f32 v[60:61], v[36:37], v[26:27] op_sel:[0,0] op_sel_hi:[0,1]
    v_pk_fma_f32 v[52:53], v[36:37], v[26:27], v[60:61] op_sel:[1,1,0] op_sel_hi:[1,0,1] neg_lo:[1,0,0]
    v_cvt_pk_bf16_f32 v65, v52, -v53
    ds_write_addtid_b32 v65 offset:2448
    v_pk_mul_f32 v[32:33], v[28:29], v[24:25] op_sel:[0,0] op_sel_hi:[0,1]
    v_pk_fma_f32 v[30:31], v[28:29], v[24:25], v[32:33] op_sel:[1,1,0] op_sel_hi:[1,0,1] neg_lo:[1,0,0]
    v_cvt_pk_bf16_f32 v62, v30, v31
    ds_write_addtid_b32 v62 offset:10336
    v_pk_mul_f32 v[60:61], v[40:41], v[26:27] op_sel:[0,0] op_sel_hi:[0,1]
    v_pk_fma_f32 v[54:55], v[40:41], v[26:27], v[60:61] op_sel:[1,1,0] op_sel_hi:[1,0,1] neg_lo:[1,0,0]
    v_cvt_pk_bf16_f32 v63, v54, -v55
    ds_write_addtid_b32 v63 offset:2720
    s_add_u32 s86, s85, 442368
    buffer_load_dword v243, v242, s[80:83], s86 offen
    v_mfma_f32_32x32x16_bf16 v[80:95], a[208:211], a[212:215], v[80:95]
    v_pk_mul_f32 v[32:33], v[30:31], v[24:25] op_sel:[0,0] op_sel_hi:[0,1]
    v_pk_fma_f32 v[28:29], v[30:31], v[24:25], v[32:33] op_sel:[1,1,0] op_sel_hi:[1,0,1] neg_lo:[1,0,0]
    v_cvt_pk_bf16_f32 v64, v28, v29
    ds_write_addtid_b32 v64 offset:10608
    v_pk_mul_f32 v[60:61], v[44:45], v[26:27] op_sel:[0,0] op_sel_hi:[0,1]
    v_pk_fma_f32 v[56:57], v[44:45], v[26:27], v[60:61] op_sel:[1,1,0] op_sel_hi:[1,0,1] neg_lo:[1,0,0]
    v_cvt_pk_bf16_f32 v65, v56, -v57
    ds_write_addtid_b32 v65 offset:2992
    v_pk_mul_f32 v[32:33], v[28:29], v[24:25] op_sel:[0,0] op_sel_hi:[0,1]
    v_pk_fma_f32 v[30:31], v[28:29], v[24:25], v[32:33] op_sel:[1,1,0] op_sel_hi:[1,0,1] neg_lo:[1,0,0]
    v_cvt_pk_bf16_f32 v62, v30, v31
    ds_write_addtid_b32 v62 offset:10880
    v_pk_mul_f32 v[60:61], v[48:49], v[26:27] op_sel:[0,0] op_sel_hi:[0,1]
    v_pk_fma_f32 v[58:59], v[48:49], v[26:27], v[60:61] op_sel:[1,1,0] op_sel_hi:[1,0,1] neg_lo:[1,0,0]
    v_cvt_pk_bf16_f32 v63, v58, -v59
    ds_write_addtid_b32 v63 offset:3264
    v_mfma_f32_32x32x16_bf16 v[80:95], a[216:219], a[220:223], v[80:95]
    v_pk_mul_f32 v[32:33], v[30:31], v[24:25] op_sel:[0,0] op_sel_hi:[0,1]
    v_pk_fma_f32 v[28:29], v[30:31], v[24:25], v[32:33] op_sel:[1,1,0] op_sel_hi:[1,0,1] neg_lo:[1,0,0]
    v_cvt_pk_bf16_f32 v64, v28, v29
    ds_write_addtid_b32 v64 offset:11152
    v_pk_mul_f32 v[60:61], v[50:51], v[26:27] op_sel:[0,0] op_sel_hi:[0,1]
    v_pk_fma_f32 v[50:51], v[50:51], v[26:27], v[60:61] op_sel:[1,1,0] op_sel_hi:[1,0,1] neg_lo:[1,0,0]
    v_cvt_pk_bf16_f32 v65, v50, -v51
    ds_write_addtid_b32 v65 offset:3536
    v_pk_mul_f32 v[32:33], v[28:29], v[24:25] op_sel:[0,0] op_sel_hi:[0,1]
    v_pk_fma_f32 v[30:31], v[28:29], v[24:25], v[32:33] op_sel:[1,1,0] op_sel_hi:[1,0,1] neg_lo:[1,0,0]
    v_cvt_pk_bf16_f32 v62, v30, v31
    ds_write_addtid_b32 v62 offset:11424
    v_pk_mul_f32 v[60:61], v[54:55], v[26:27] op_sel:[0,0] op_sel_hi:[0,1]
    v_pk_fma_f32 v[54:55], v[54:55], v[26:27], v[60:61] op_sel:[1,1,0] op_sel_hi:[1,0,1] neg_lo:[1,0,0]
    v_cvt_pk_bf16_f32 v63, v54, -v55
    ds_write_addtid_b32 v63 offset:3808
    v_pk_mul_f32 v[32:33], v[30:31], v[24:25] op_sel:[0,0] op_sel_hi:[0,1]
    v_pk_fma_f32 v[28:29], v[30:31], v[24:25], v[32:33] op_sel:[1,1,0] op_sel_hi:[1,0,1] neg_lo:[1,0,0]
    v_cvt_pk_bf16_f32 v64, v28, v29
    ds_write_addtid_b32 v64 offset:11696
    v_pk_mul_f32 v[60:61], v[58:59], v[26:27] op_sel:[0,0] op_sel_hi:[0,1]
    v_pk_fma_f32 v[58:59], v[58:59], v[26:27], v[60:61] op_sel:[1,1,0] op_sel_hi:[1,0,1] neg_lo:[1,0,0]
    v_cvt_pk_bf16_f32 v65, v58, -v59
    ds_write_addtid_b32 v65 offset:4080
    v_pk_mul_f32 v[32:33], v[28:29], v[24:25] op_sel:[0,0] op_sel_hi:[0,1]
    v_pk_fma_f32 v[30:31], v[28:29], v[24:25], v[32:33] op_sel:[1,1,0] op_sel_hi:[1,0,1] neg_lo:[1,0,0]
    v_cvt_pk_bf16_f32 v62, v30, v31
    ds_write_addtid_b32 v62 offset:11968
    v_pk_mul_f32 v[60:61], v[50:51], v[26:27] op_sel:[0,0] op_sel_hi:[0,1]
    v_pk_fma_f32 v[50:51], v[50:51], v[26:27], v[60:61] op_sel:[1,1,0] op_sel_hi:[1,0,1] neg_lo:[1,0,0]
    v_cvt_pk_bf16_f32 v63, v50, -v51
    ds_write_addtid_b32 v63 offset:4352
    v_pk_mul_f32 v[32:33], v[30:31], v[24:25] op_sel:[0,0] op_sel_hi:[0,1]
    v_pk_fma_f32 v[28:29], v[30:31], v[24:25], v[32:33] op_sel:[1,1,0] op_sel_hi:[1,0,1] neg_lo:[1,0,0]
    v_cvt_pk_bf16_f32 v64, v28, v29
    ds_write_addtid_b32 v64 offset:12240
    v_pk_mul_f32 v[60:61], v[54:55], v[26:27] op_sel:[0,0] op_sel_hi:[0,1]
    v_pk_fma_f32 v[54:55], v[54:55], v[26:27], v[60:61] op_sel:[1,1,0] op_sel_hi:[1,0,1] neg_lo:[1,0,0]
    v_cvt_pk_bf16_f32 v65, v54, -v55
    ds_write_addtid_b32 v65 offset:4624
    v_pk_mul_f32 v[32:33], v[28:29], v[24:25] op_sel:[0,0] op_sel_hi:[0,1]
    v_pk_fma_f32 v[30:31], v[28:29], v[24:25], v[32:33] op_sel:[1,1,0] op_sel_hi:[1,0,1] neg_lo:[1,0,0]
    v_cvt_pk_bf16_f32 v62, v30, v31
    ds_write_addtid_b32 v62 offset:12512
    v_pk_mul_f32 v[60:61], v[58:59], v[26:27] op_sel:[0,0] op_sel_hi:[0,1]
    v_pk_fma_f32 v[58:59], v[58:59], v[26:27], v[60:61] op_sel:[1,1,0] op_sel_hi:[1,0,1] neg_lo:[1,0,0]
    v_cvt_pk_bf16_f32 v63, v58, -v59
    ds_write_addtid_b32 v63 offset:4896
    v_pk_mul_f32 v[32:33], v[30:31], v[24:25] op_sel:[0,0] op_sel_hi:[0,1]
    v_pk_fma_f32 v[28:29], v[30:31], v[24:25], v[32:33] op_sel:[1,1,0] op_sel_hi:[1,0,1] neg_lo:[1,0,0]
    v_cvt_pk_bf16_f32 v64, v28, v29
    ds_write_addtid_b32 v64 offset:12784
    v_pk_mul_f32 v[60:61], v[50:51], v[26:27] op_sel:[0,0] op_sel_hi:[0,1]
    v_pk_fma_f32 v[50:51], v[50:51], v[26:27], v[60:61] op_sel:[1,1,0] op_sel_hi:[1,0,1] neg_lo:[1,0,0]
    v_cvt_pk_bf16_f32 v65, v50, -v51
    ds_write_addtid_b32 v65 offset:5168
    v_pk_mul_f32 v[32:33], v[28:29], v[24:25] op_sel:[0,0] op_sel_hi:[0,1]
    v_pk_fma_f32 v[30:31], v[28:29], v[24:25], v[32:33] op_sel:[1,1,0] op_sel_hi:[1,0,1] neg_lo:[1,0,0]
    v_cvt_pk_bf16_f32 v62, v30, v31
    ds_write_addtid_b32 v62 offset:13056
    v_pk_mul_f32 v[60:61], v[58:59], v[26:27] op_sel:[0,0] op_sel_hi:[0,1]
    v_pk_fma_f32 v[58:59], v[58:59], v[26:27], v[60:61] op_sel:[1,1,0] op_sel_hi:[1,0,1] neg_lo:[1,0,0]
    v_cvt_pk_bf16_f32 v63, v58, -v59
    ds_write_addtid_b32 v63 offset:5440
    v_pk_mul_f32 v[32:33], v[30:31], v[24:25] op_sel:[0,0] op_sel_hi:[0,1]
    v_pk_fma_f32 v[28:29], v[30:31], v[24:25], v[32:33] op_sel:[1,1,0] op_sel_hi:[1,0,1] neg_lo:[1,0,0]
    v_cvt_pk_bf16_f32 v64, v28, v29
    ds_write_addtid_b32 v64 offset:13328
    v_pk_mul_f32 v[60:61], v[50:51], v[26:27] op_sel:[0,0] op_sel_hi:[0,1]
    v_pk_fma_f32 v[50:51], v[50:51], v[26:27], v[60:61] op_sel:[1,1,0] op_sel_hi:[1,0,1] neg_lo:[1,0,0]
    v_cvt_pk_bf16_f32 v65, v50, -v51
    ds_write_addtid_b32 v65 offset:5712
    v_pk_mul_f32 v[32:33], v[28:29], v[24:25] op_sel:[0,0] op_sel_hi:[0,1]
    v_pk_fma_f32 v[30:31], v[28:29], v[24:25], v[32:33] op_sel:[1,1,0] op_sel_hi:[1,0,1] neg_lo:[1,0,0]
    v_cvt_pk_bf16_f32 v62, v30, v31
    ds_write_addtid_b32 v62 offset:13600
    v_pk_mul_f32 v[60:61], v[58:59], v[26:27] op_sel:[0,0] op_sel_hi:[0,1]
    v_pk_fma_f32 v[58:59], v[58:59], v[26:27], v[60:61] op_sel:[1,1,0] op_sel_hi:[1,0,1] neg_lo:[1,0,0]
    v_cvt_pk_bf16_f32 v63, v58, -v59
    ds_write_addtid_b32 v63 offset:5984
    v_pk_mul_f32 v[32:33], v[30:31], v[24:25] op_sel:[0,0] op_sel_hi:[0,1]
    v_pk_fma_f32 v[28:29], v[30:31], v[24:25], v[32:33] op_sel:[1,1,0] op_sel_hi:[1,0,1] neg_lo:[1,0,0]
    v_cvt_pk_bf16_f32 v64, v28, v29
    ds_write_addtid_b32 v64 offset:13872
    v_pk_mul_f32 v[60:61], v[50:51], v[26:27] op_sel:[0,0] op_sel_hi:[0,1]
    v_pk_fma_f32 v[50:51], v[50:51], v[26:27], v[60:61] op_sel:[1,1,0] op_sel_hi:[1,0,1] neg_lo:[1,0,0]
    v_cvt_pk_bf16_f32 v65, v50, -v51
    ds_write_addtid_b32 v65 offset:6256
    v_pk_mul_f32 v[32:33], v[28:29], v[24:25] op_sel:[0,0] op_sel_hi:[0,1]
    v_pk_fma_f32 v[30:31], v[28:29], v[24:25], v[32:33] op_sel:[1,1,0] op_sel_hi:[1,0,1] neg_lo:[1,0,0]
    v_cvt_pk_bf16_f32 v62, v30, v31
    ds_write_addtid_b32 v62 offset:14144
    v_pk_mul_f32 v[60:61], v[58:59], v[26:27] op_sel:[0,0] op_sel_hi:[0,1]
    v_pk_fma_f32 v[58:59], v[58:59], v[26:27], v[60:61] op_sel:[1,1,0] op_sel_hi:[1,0,1] neg_lo:[1,0,0]
    v_cvt_pk_bf16_f32 v63, v58, -v59
    ds_write_addtid_b32 v63 offset:6528
    v_pk_mul_f32 v[32:33], v[30:31], v[24:25] op_sel:[0,0] op_sel_hi:[0,1]
    v_pk_fma_f32 v[28:29], v[30:31], v[24:25], v[32:33] op_sel:[1,1,0] op_sel_hi:[1,0,1] neg_lo:[1,0,0]
    v_cvt_pk_bf16_f32 v64, v28, v29
    ds_write_addtid_b32 v64 offset:14416
    v_pk_mul_f32 v[60:61], v[50:51], v[26:27] op_sel:[0,0] op_sel_hi:[0,1]
    v_pk_fma_f32 v[50:51], v[50:51], v[26:27], v[60:61] op_sel:[1,1,0] op_sel_hi:[1,0,1] neg_lo:[1,0,0]
    v_cvt_pk_bf16_f32 v65, v50, -v51
    ds_write_addtid_b32 v65 offset:6800
    v_pk_mul_f32 v[32:33], v[28:29], v[24:25] op_sel:[0,0] op_sel_hi:[0,1]
    v_pk_fma_f32 v[30:31], v[28:29], v[24:25], v[32:33] op_sel:[1,1,0] op_sel_hi:[1,0,1] neg_lo:[1,0,0]
    v_cvt_pk_bf16_f32 v62, v30, v31
    ds_write_addtid_b32 v62 offset:14688
    v_pk_mul_f32 v[60:61], v[58:59], v[26:27] op_sel:[0,0] op_sel_hi:[0,1]
    v_pk_fma_f32 v[58:59], v[58:59], v[26:27], v[60:61] op_sel:[1,1,0] op_sel_hi:[1,0,1] neg_lo:[1,0,0]
    v_cvt_pk_bf16_f32 v63, v58, -v59
    ds_write_addtid_b32 v63 offset:7072
    v_pk_mul_f32 v[32:33], v[30:31], v[24:25] op_sel:[0,0] op_sel_hi:[0,1]
    v_pk_fma_f32 v[28:29], v[30:31], v[24:25], v[32:33] op_sel:[1,1,0] op_sel_hi:[1,0,1] neg_lo:[1,0,0]
    v_cvt_pk_bf16_f32 v64, v28, v29
    ds_write_addtid_b32 v64 offset:14960
    v_pk_mul_f32 v[32:33], v[28:29], v[24:25] op_sel:[0,0] op_sel_hi:[0,1]
    v_pk_fma_f32 v[30:31], v[28:29], v[24:25], v[32:33] op_sel:[1,1,0] op_sel_hi:[1,0,1] neg_lo:[1,0,0]
    v_cvt_pk_bf16_f32 v65, v30, v31
    ds_write_addtid_b32 v65 offset:15232
    s_add_u32 s86, s85, 884736
    buffer_load_dword v243, v242, s[80:83], s86 offen
    v_pk_mul_f32 v[32:33], v[30:31], v[24:25] op_sel:[0,0] op_sel_hi:[0,1]
    v_pk_fma_f32 v[28:29], v[30:31], v[24:25], v[32:33] op_sel:[1,1,0] op_sel_hi:[1,0,1] neg_lo:[1,0,0]
    v_cvt_pk_bf16_f32 v62, v28, v29
    ds_write_addtid_b32 v62 offset:15504
    v_pk_mul_f32 v[32:33], v[28:29], v[24:25] op_sel:[0,0] op_sel_hi:[0,1]
    v_pk_fma_f32 v[30:31], v[28:29], v[24:25], v[32:33] op_sel:[1,1,0] op_sel_hi:[1,0,1] neg_lo:[1,0,0]
    v_cvt_pk_bf16_f32 v63, v30, v31
    ds_write_addtid_b32 v63 offset:15776
    ds_read_b128 a[96:99], v158 offset:0
    ds_read_b128 a[100:103], v159 offset:0
    ds_read_b128 a[104:107], v158 offset:32
    ds_read_b128 a[108:111], v159 offset:32
    ds_read_b128 a[112:115], v158 offset:64
    ds_read_b128 a[116:119], v159 offset:64
    ds_read_b128 a[120:123], v158 offset:96
    ds_read_b128 a[124:127], v159 offset:96
    ds_read_b128 a[128:131], v158 offset:128
    ds_read_b128 a[132:135], v159 offset:128
    ds_read_b128 a[136:139], v158 offset:160
    ds_read_b128 a[140:143], v159 offset:160
    ds_read_b128 a[144:147], v158 offset:192
    ds_read_b128 a[148:151], v159 offset:192
    ds_read_b128 a[152:155], v158 offset:224
    ds_read_b128 a[156:159], v159 offset:224
    s_waitcnt vmcnt(2)
    v_add_u32 v158, s46, v146
    v_add_u32 v159, s46, v147
    v_mov_b32 v98, v97
    s_waitcnt lgkmcnt(14)
    v_mfma_f32_32x32x16_bf16 v[80:95], a[96:99], a[100:103], v[80:95]
    v_lshlrev_b32 v16, 16, v144
    v_mul_f32 v16, 0x3fb8aa3b, v16
    v_exp_f32 v16, v16
    v_lshlrev_b32 v97, 16, v145
    v_cvt_pk_bf16_f32 v16, v16, v16
    v_and_b32 v16, 0xffff0000, v16
    s_waitcnt lgkmcnt(12)
    v_mfma_f32_32x32x16_bf16 v[80:95], a[104:107], a[108:111], v[80:95]
    v_lshlrev_b32 v18, 16, v140
    v_mul_f32 v18, 0x3fb8aa3b, v18
    v_exp_f32 v18, v18
    v_lshlrev_b32 v19, 16, v141
    v_lshlrev_b32 v20, 16, v142
    v_lshlrev_b32 v21, 16, v143
    s_waitcnt lgkmcnt(10)
    v_mfma_f32_32x32x16_bf16 v[80:95], a[112:115], a[116:119], v[80:95]
    v_cvt_pk_bf16_f32 v18, v18, v18
    v_and_b32 v18, 0xffff0000, v18
    v_mul_f32 v18, v18, v16
    v_mul_f32 v19, v19, v16
    v_mul_f32 v20, v20, v16
    v_mul_f32 v21, v21, v16
    s_waitcnt lgkmcnt(8)
    v_mfma_f32_32x32x16_bf16 v[80:95], a[120:123], a[124:127], v[80:95]
    v_mul_f32 v18, 0xbfb8aa3b, v18
    v_mul_f32 v19, 0x3e22f983, v19
    v_add_f32 v20, v20, v20
    v_add_f32 v21, v21, v21
    v_mul_f32 v62, 0x3f800000, v18
    v_mul_f32 v63, 0x3f800000, v19
    s_waitcnt lgkmcnt(6)
    v_mfma_f32_32x32x16_bf16 v[80:95], a[128:131], a[132:135], v[80:95]
    v_exp_f32 v62, v62
    v_fract_f32 v63, v63
    v_cos_f32 v22, v63
    v_sin_f32 v23, v63
    s_nop 0
    v_mul_f32 v22, v22, v62
    s_waitcnt lgkmcnt(4)
    v_mfma_f32_32x32x16_bf16 v[80:95], a[136:139], a[140:143], v[80:95]
    v_mul_f32 v23, v23, v62
    v_mul_f32 v62, 0x41000000, v18
    v_mul_f32 v63, 0x41000000, v19
    v_exp_f32 v62, v62
    v_fract_f32 v63, v63
    v_cos_f32 v24, v63
    s_waitcnt lgkmcnt(2)
    v_mfma_f32_32x32x16_bf16 v[80:95], a[144:147], a[148:151], v[80:95]
    v_sin_f32 v25, v63
    s_nop 0
    v_mul_f32 v24, v24, v62
    v_mul_f32 v25, v25, v62
    v_mul_f32 v62, 0x43800000, v18
    v_mul_f32 v63, 0x43800000, v19
    s_waitcnt lgkmcnt(0)
    v_mfma_f32_32x32x16_bf16 v[80:95], a[152:155], a[156:159], v[80:95]
    v_exp_f32 v62, v62
    v_fract_f32 v63, v63
    v_cos_f32 v26, v63
    v_sin_f32 v27, v63
    s_nop 0
    v_mul_f32 v26, v26, v62
    v_mul_f32 v27, v27, v62
    v_cndmask_b32 v98, 0, v98, s[50:51]
    s_nop 10
    v_add_f32 v80, v80, v98
    v_cvt_pk_bf16_f32 v64, v80, v81
    v_cvt_pk_bf16_f32 v65, v82, v83
    ds_write_b64 v148, v[64:65]
    v_cvt_pk_bf16_f32 v66, v84, v84
    v_cvt_pk_bf16_f32 v67, v85, v86
    ds_write_b64 v148, v[66:67] offset:512
    v_cvt_pk_bf16_f32 v68, v87, v87
L_pv1:
    s_cbranch_execz L_pv5
    v_cvt_pk_bf16_f32 v69, v87, v88
    v_cvt_pk_bf16_f32 v70, v88, v88
    v_cvt_pk_bf16_f32 v71, v89, v89
    ds_write_b128 v149, v[68:71] offset:1024
    v_cndmask_b32 v62, v91, v90, s[48:49]
    v_cvt_pk_bf16_f32 v72, v90, v90
    v_cvt_pk_bf16_f32 v73, v90, v90
    v_cvt_pk_bf16_f32 v74, v62, v91
    v_cvt_pk_bf16_f32 v75, v91, v91
    ds_write_b128 v150, v[72:75] offset:2048
    v_cndmask_b32 v62, v93, v92, s[48:49]
    v_cvt_pk_bf16_f32 v76, v92, v92
    v_cvt_pk_bf16_f32 v77, v92, v92
    v_cvt_pk_bf16_f32 v78, v62, v93
    v_cvt_pk_bf16_f32 v79, v93, v93
    ds_write_b128 v150, v[76:79] offset:2560
    s_mov_b32 m0, s46
    v_mov_b32 v66, 0x3f80
    ds_write_addtid_b32 v66 offset:7344
    v_cvt_pk_bf16_f32 v62, v20, -v21
    ds_write_addtid_b32 v62 offset:0
    v_cvt_pk_bf16_f32 v63, v24, v25
    ds_write_addtid_b32 v63 offset:7616
    v_pk_mul_f32 v[60:61], v[20:21], v[22:23] op_sel:[0,0] op_sel_hi:[0,1]
    v_pk_fma_f32 v[34:35], v[20:21], v[22:23], v[60:61] op_sel:[1,1,0] op_sel_hi:[1,0,1] neg_lo:[1,0,0]
    v_cvt_pk_bf16_f32 v64, v34, -v35
    ds_write_addtid_b32 v64 offset:272
    v_pk_mul_f32 v[32:33], v[24:25], v[24:25] op_sel:[0,0] op_sel_hi:[0,1]
    v_pk_fma_f32 v[28:29], v[24:25], v[24:25], v[32:33] op_sel:[1,1,0] op_sel_hi:[1,0,1] neg_lo:[1,0,0]
    v_cvt_pk_bf16_f32 v65, v28, v29
    ds_write_addtid_b32 v65 offset:7888
    v_pk_mul_f32 v[60:61], v[34:35], v[22:23] op_sel:[0,0] op_sel_hi:[0,1]
    v_pk_fma_f32 v[36:37], v[34:35], v[22:23], v[60:61] op_sel:[1,1,0] op_sel_hi:[1,0,1] neg_lo:[1,0,0]
    v_cvt_pk_bf16_f32 v62, v36, -v37
    ds_write_addtid_b32 v62 offset:544
    v_pk_mul_f32 v[32:33], v[28:29], v[24:25] op_sel:[0,0] op_sel_hi:[0,1]
    v_pk_fma_f32 v[30:31], v[28:29], v[24:25], v[32:33] op_sel:[1,1,0] op_sel_hi:[1,0,1] neg_lo:[1,0,0]
    v_cvt_pk_bf16_f32 v63, v30, v31
    ds_write_addtid_b32 v63 offset:8160
    v_pk_mul_f32 v[60:61], v[36:37], v[22:23] op_sel:[0,0] op_sel_hi:[0,1]
    v_pk_fma_f32 v[38:39], v[36:37], v[22:23], v[60:61] op_sel:[1,1,0] op_sel_hi:[1,0,1] neg_lo:[1,0,0]
    v_cvt_pk_bf16_f32 v64, v38, -v39
    ds_write_addtid_b32 v64 offset:816
    v_pk_mul_f32 v[32:33], v[30:31], v[24:25] op_sel:[0,0] op_sel_hi:[0,1]
    v_pk_fma_f32 v[28:29], v[30:31], v[24:25], v[32:33] op_sel:[1,1,0] op_sel_hi:[1,0,1] neg_lo:[1,0,0]
    v_cvt_pk_bf16_f32 v65, v28, v29
    ds_write_addtid_b32 v65 offset:8432
    v_pk_mul_f32 v[60:61], v[38:39], v[22:23] op_sel:[0,0] op_sel_hi:[0,1]
    v_pk_fma_f32 v[40:41], v[38:39], v[22:23], v[60:61] op_sel:[1,1,0] op_sel_hi:[1,0,1] neg_lo:[1,0,0]
    v_cvt_pk_bf16_f32 v62, v40, -v41
    ds_write_addtid_b32 v62 offset:1088
    v_pk_mul_f32 v[32:33], v[28:29], v[24:25] op_sel:[0,0] op_sel_hi:[0,1]
    v_pk_fma_f32 v[30:31], v[28:29], v[24:25], v[32:33] op_sel:[1,1,0] op_sel_hi:[1,0,1] neg_lo:[1,0,0]
    v_cvt_pk_bf16_f32 v63, v30, v31
    ds_write_addtid_b32 v63 offset:8704
    v_pk_mul_f32 v[60:61], v[40:41], v[22:23] op_sel:[0,0] op_sel_hi:[0,1]
    v_pk_fma_f32 v[42:43], v[40:41], v[22:23], v[60:61] op_sel:[1,1,0] op_sel_hi:[1,0,1] neg_lo:[1,0,0]
    v_cvt_pk_bf16_f32 v64, v42, -v43
    ds_write_addtid_b32 v64 offset:1360
    v_pk_mul_f32 v[32:33], v[30:31], v[24:25] op_sel:[0,0] op_sel_hi:[0,1]
    v_pk_fma_f32 v[28:29], v[30:31], v[24:25], v[32:33] op_sel:[1,1,0] op_sel_hi:[1,0,1] neg_lo:[1,0,0]
    v_cvt_pk_bf16_f32 v65, v28, v29
    ds_write_addtid_b32 v65 offset:8976
    v_pk_mul_f32 v[60:61], v[42:43], v[22:23] op_sel:[0,0] op_sel_hi:[0,1]
    v_pk_fma_f32 v[44:45], v[42:43], v[22:23], v[60:61] op_sel:[1,1,0] op_sel_hi:[1,0,1] neg_lo:[1,0,0]
    v_cvt_pk_bf16_f32 v62, v44, -v45
    ds_write_addtid_b32 v62 offset:1632
    v_pk_mul_f32 v[32:33], v[28:29], v[24:25] op_sel:[0,0] op_sel_hi:[0,1]
    v_pk_fma_f32 v[30:31], v[28:29], v[24:25], v[32:33] op_sel:[1,1,0] op_sel_hi:[1,0,1] neg_lo:[1,0,0]
    v_cvt_pk_bf16_f32 v63, v30, v31
    ds_write_addtid_b32 v63 offset:9248
    v_pk_mul_f32 v[60:61], v[44:45], v[22:23] op_sel:[0,0] op_sel_hi:[0,1]
    v_pk_fma_f32 v[46:47], v[44:45], v[22:23], v[60:61] op_sel:[1,1,0] op_sel_hi:[1,0,1] neg_lo:[1,0,0]
    v_cvt_pk_bf16_f32 v64, v46, -v47
    ds_write_addtid_b32 v64 offset:1904
    v_pk_mul_f32 v[32:33], v[30:31], v[24:25] op_sel:[0,0] op_sel_hi:[0,1]
    v_pk_fma_f32 v[28:29], v[30:31], v[24:25], v[32:33] op_sel:[1,1,0] op_sel_hi:[1,0,1] neg_lo:[1,0,0]
    v_cvt_pk_bf16_f32 v65, v28, v29
    ds_write_addtid_b32 v65 offset:9520
    v_pk_mul_f32 v[60:61], v[46:47], v[22:23] op_sel:[0,0] op_sel_hi:[0,1]
    v_pk_fma_f32 v[48:49], v[46:47], v[22:23], v[60:61] op_sel:[1,1,0] op_sel_hi:[1,0,1] neg_lo:[1,0,0]
    v_pk_mul_f32 v[32:33], v[28:29], v[24:25] op_sel:[0,0] op_sel_hi:[0,1]
    v_pk_fma_f32 v[30:31], v[28:29], v[24:25], v[32:33] op_sel:[1,1,0] op_sel_hi:[1,0,1] neg_lo:[1,0,0]
    v_cvt_pk_bf16_f32 v62, v30, v31
    ds_write_addtid_b32 v62 offset:9792
    v_pk_mul_f32 v[60:61], v[20:21], v[26:27] op_sel:[0,0] op_sel_hi:[0,1]
    v_pk_fma_f32 v[50:51], v[20:21], v[26:27], v[60:61] op_sel:[1,1,0] op_sel_hi:[1,0,1] neg_lo:[1,0,0]
    v_cvt_pk_bf16_f32 v63, v50, -v51
    ds_write_addtid_b32 v63 offset:2176
    v_pk_mul_f32 v[32:33], v[30:31], v[24:25] op_sel:[0,0] op_sel_hi:[0,1]
    v_pk_fma_f32 v[28:29], v[30:31], v[24:25], v[32:33] op_sel:[1,1,0] op_sel_hi:[1,0,1] neg_lo:[1,0,0]
    v_cvt_pk_bf16_f32 v64, v28, v29
    ds_write_addtid_b32 v64 offset:10064
    v_pk_mul_f32 v[60:61], v[36:37], v[26:27] op_sel:[0,0] op_sel_hi:[0,1]
    v_pk_fma_f32 v[52:53], v[36:37], v[26:27], v[60:61] op_sel:[1,1,0] op_sel_hi:[1,0,1] neg_lo:[1,0,0]
    v_cvt_pk_bf16_f32 v65, v52, -v53
    ds_write_addtid_b32 v65 offset:2448
    v_pk_mul_f32 v[32:33], v[28:29], v[24:25] op_sel:[0,0] op_sel_hi:[0,1]
    v_pk_fma_f32 v[30:31], v[28:29], v[24:25], v[32:33] op_sel:[1,1,0] op_sel_hi:[1,0,1] neg_lo:[1,0,0]
    v_cvt_pk_bf16_f32 v62, v30, v31
    ds_write_addtid_b32 v62 offset:10336
    v_pk_mul_f32 v[60:61], v[40:41], v[26:27] op_sel:[0,0] op_sel_hi:[0,1]
    v_pk_fma_f32 v[54:55], v[40:41], v[26:27], v[60:61] op_sel:[1,1,0] op_sel_hi:[1,0,1] neg_lo:[1,0,0]
    v_cvt_pk_bf16_f32 v63, v54, -v55
    ds_write_addtid_b32 v63 offset:2720
    v_pk_mul_f32 v[32:33], v[30:31], v[24:25] op_sel:[0,0] op_sel_hi:[0,1]
    v_pk_fma_f32 v[28:29], v[30:31], v[24:25], v[32:33] op_sel:[1,1,0] op_sel_hi:[1,0,1] neg_lo:[1,0,0]
    v_cvt_pk_bf16_f32 v64, v28, v29
    ds_write_addtid_b32 v64 offset:10608
    v_pk_mul_f32 v[60:61], v[44:45], v[26:27] op_sel:[0,0] op_sel_hi:[0,1]
    v_pk_fma_f32 v[56:57], v[44:45], v[26:27], v[60:61] op_sel:[1,1,0] op_sel_hi:[1,0,1] neg_lo:[1,0,0]
    v_cvt_pk_bf16_f32 v65, v56, -v57
    ds_write_addtid_b32 v65 offset:2992
    v_pk_mul_f32 v[32:33], v[28:29], v[24:25] op_sel:[0,0] op_sel_hi:[0,1]
    v_pk_fma_f32 v[30:31], v[28:29], v[24:25], v[32:33] op_sel:[1,1,0] op_sel_hi:[1,0,1] neg_lo:[1,0,0]
    v_cvt_pk_bf16_f32 v62, v30, v31
    ds_write_addtid_b32 v62 offset:10880
    v_pk_mul_f32 v[60:61], v[48:49], v[26:27] op_sel:[0,0] op_sel_hi:[0,1]
    v_pk_fma_f32 v[58:59], v[48:49], v[26:27], v[60:61] op_sel:[1,1,0] op_sel_hi:[1,0,1] neg_lo:[1,0,0]
    v_cvt_pk_bf16_f32 v63, v58, -v59
    ds_write_addtid_b32 v63 offset:3264
    v_pk_mul_f32 v[32:33], v[30:31], v[24:25] op_sel:[0,0] op_sel_hi:[0,1]
    v_pk_fma_f32 v[28:29], v[30:31], v[24:25], v[32:33] op_sel:[1,1,0] op_sel_hi:[1,0,1] neg_lo:[1,0,0]
    v_cvt_pk_bf16_f32 v64, v28, v29
    ds_write_addtid_b32 v64 offset:11152
    v_pk_mul_f32 v[60:61], v[50:51], v[26:27] op_sel:[0,0] op_sel_hi:[0,1]
    v_pk_fma_f32 v[50:51], v[50:51], v[26:27], v[60:61] op_sel:[1,1,0] op_sel_hi:[1,0,1] neg_lo:[1,0,0]
    v_cvt_pk_bf16_f32 v65, v50, -v51
    ds_write_addtid_b32 v65 offset:3536
    v_pk_mul_f32 v[32:33], v[28:29], v[24:25] op_sel:[0,0] op_sel_hi:[0,1]
    v_pk_fma_f32 v[30:31], v[28:29], v[24:25], v[32:33] op_sel:[1,1,0] op_sel_hi:[1,0,1] neg_lo:[1,0,0]
    v_cvt_pk_bf16_f32 v62, v30, v31
    ds_write_addtid_b32 v62 offset:11424
    v_pk_mul_f32 v[60:61], v[54:55], v[26:27] op_sel:[0,0] op_sel_hi:[0,1]
    v_pk_fma_f32 v[54:55], v[54:55], v[26:27], v[60:61] op_sel:[1,1,0] op_sel_hi:[1,0,1] neg_lo:[1,0,0]
    v_cvt_pk_bf16_f32 v63, v54, -v55
    ds_write_addtid_b32 v63 offset:3808
    v_pk_mul_f32 v[32:33], v[30:31], v[24:25] op_sel:[0,0] op_sel_hi:[0,1]
    v_pk_fma_f32 v[28:29], v[30:31], v[24:25], v[32:33] op_sel:[1,1,0] op_sel_hi:[1,0,1] neg_lo:[1,0,0]
    v_cvt_pk_bf16_f32 v64, v28, v29
    ds_write_addtid_b32 v64 offset:11696
    v_pk_mul_f32 v[60:61], v[58:59], v[26:27] op_sel:[0,0] op_sel_hi:[0,1]
    v_pk_fma_f32 v[58:59], v[58:59], v[26:27], v[60:61] op_sel:[1,1,0] op_sel_hi:[1,0,1] neg_lo:[1,0,0]
    v_cvt_pk_bf16_f32 v65, v58, -v59
    ds_write_addtid_b32 v65 offset:4080
    v_pk_mul_f32 v[32:33], v[28:29], v[24:25] op_sel:[0,0] op_sel_hi:[0,1]
    v_pk_fma_f32 v[30:31], v[28:29], v[24:25], v[32:33] op_sel:[1,1,0] op_sel_hi:[1,0,1] neg_lo:[1,0,0]
    v_cvt_pk_bf16_f32 v62, v30, v31
    ds_write_addtid_b32 v62 offset:11968
    v_pk_mul_f32 v[60:61], v[50:51], v[26:27] op_sel:[0,0] op_sel_hi:[0,1]
    v_pk_fma_f32 v[50:51], v[50:51], v[26:27], v[60:61] op_sel:[1,1,0] op_sel_hi:[1,0,1] neg_lo:[1,0,0]
    v_cvt_pk_bf16_f32 v63, v50, -v51
    ds_write_addtid_b32 v63 offset:4352
    v_pk_mul_f32 v[32:33], v[30:31], v[24:25] op_sel:[0,0] op_sel_hi:[0,1]
    v_pk_fma_f32 v[28:29], v[30:31], v[24:25], v[32:33] op_sel:[1,1,0] op_sel_hi:[1,0,1] neg_lo:[1,0,0]
    v_cvt_pk_bf16_f32 v64, v28, v29
    ds_write_addtid_b32 v64 offset:12240
    v_pk_mul_f32 v[60:61], v[54:55], v[26:27] op_sel:[0,0] op_sel_hi:[0,1]
    v_pk_fma_f32 v[54:55], v[54:55], v[26:27], v[60:61] op_sel:[1,1,0] op_sel_hi:[1,0,1] neg_lo:[1,0,0]
    v_cvt_pk_bf16_f32 v65, v54, -v55
    ds_write_addtid_b32 v65 offset:4624
    v_pk_mul_f32 v[32:33], v[28:29], v[24:25] op_sel:[0,0] op_sel_hi:[0,1]
    v_pk_fma_f32 v[30:31], v[28:29], v[24:25], v[32:33] op_sel:[1,1,0] op_sel_hi:[1,0,1] neg_lo:[1,0,0]
    v_cvt_pk_bf16_f32 v62, v30, v31
    ds_write_addtid_b32 v62 offset:12512
    v_pk_mul_f32 v[60:61], v[58:59], v[26:27] op_sel:[0,0] op_sel_hi:[0,1]
    v_pk_fma_f32 v[58:59], v[58:59], v[26:27], v[60:61] op_sel:[1,1,0] op_sel_hi:[1,0,1] neg_lo:[1,0,0]
    v_cvt_pk_bf16_f32 v63, v58, -v59
    ds_write_addtid_b32 v63 offset:4896
    v_pk_mul_f32 v[32:33], v[30:31], v[24:25] op_sel:[0,0] op_sel_hi:[0,1]
    v_pk_fma_f32 v[28:29], v[30:31], v[24:25], v[32:33] op_sel:[1,1,0] op_sel_hi:[1,0,1] neg_lo:[1,0,0]
    v_cvt_pk_bf16_f32 v64, v28, v29
    ds_write_addtid_b32 v64 offset:12784
    v_pk_mul_f32 v[60:61], v[50:51], v[26:27] op_sel:[0,0] op_sel_hi:[0,1]
    v_pk_fma_f32 v[50:51], v[50:51], v[26:27], v[60:61] op_sel:[1,1,0] op_sel_hi:[1,0,1] neg_lo:[1,0,0]
    v_cvt_pk_bf16_f32 v65, v50, -v51
    ds_write_addtid_b32 v65 offset:5168
    v_pk_mul_f32 v[32:33], v[28:29], v[24:25] op_sel:[0,0] op_sel_hi:[0,1]
    v_pk_fma_f32 v[30:31], v[28:29], v[24:25], v[32:33] op_sel:[1,1,0] op_sel_hi:[1,0,1] neg_lo:[1,0,0]
    v_cvt_pk_bf16_f32 v62, v30, v31
    ds_write_addtid_b32 v62 offset:13056
    v_pk_mul_f32 v[60:61], v[58:59], v[26:27] op_sel:[0,0] op_sel_hi:[0,1]
    v_pk_fma_f32 v[58:59], v[58:59], v[26:27], v[60:61] op_sel:[1,1,0] op_sel_hi:[1,0,1] neg_lo:[1,0,0]
    v_cvt_pk_bf16_f32 v63, v58, -v59
    ds_write_addtid_b32 v63 offset:5440
    v_pk_mul_f32 v[32:33], v[30:31], v[24:25] op_sel:[0,0] op_sel_hi:[0,1]
    v_pk_fma_f32 v[28:29], v[30:31], v[24:25], v[32:33] op_sel:[1,1,0] op_sel_hi:[1,0,1] neg_lo:[1,0,0]
    v_cvt_pk_bf16_f32 v64, v28, v29
    ds_write_addtid_b32 v64 offset:13328
    v_pk_mul_f32 v[60:61], v[50:51], v[26:27] op_sel:[0,0] op_sel_hi:[0,1]
    v_pk_fma_f32 v[50:51], v[50:51], v[26:27], v[60:61] op_sel:[1,1,0] op_sel_hi:[1,0,1] neg_lo:[1,0,0]
    v_cvt_pk_bf16_f32 v65, v50, -v51
    ds_write_addtid_b32 v65 offset:5712
    v_pk_mul_f32 v[32:33], v[28:29], v[24:25] op_sel:[0,0] op_sel_hi:[0,1]
    v_pk_fma_f32 v[30:31], v[28:29], v[24:25], v[32:33] op_sel:[1,1,0] op_sel_hi:[1,0,1] neg_lo:[1,0,0]
    v_cvt_pk_bf16_f32 v62, v30, v31
    ds_write_addtid_b32 v62 offset:13600
    v_pk_mul_f32 v[60:61], v[58:59], v[26:27] op_sel:[0,0] op_sel_hi:[0,1]
    v_pk_fma_f32 v[58:59], v[58:59], v[26:27], v[60:61] op_sel:[1,1,0] op_sel_hi:[1,0,1] neg_lo:[1,0,0]
    v_cvt_pk_bf16_f32 v63, v58, -v59
    ds_write_addtid_b32 v63 offset:5984
    v_pk_mul_f32 v[32:33], v[30:31], v[24:25] op_sel:[0,0] op_sel_hi:[0,1]
    v_pk_fma_f32 v[28:29], v[30:31], v[24:25], v[32:33] op_sel:[1,1,0] op_sel_hi:[1,0,1] neg_lo:[1,0,0]
    v_cvt_pk_bf16_f32 v64, v28, v29
    ds_write_addtid_b32 v64 offset:13872
    v_pk_mul_f32 v[60:61], v[50:51], v[26:27] op_sel:[0,0] op_sel_hi:[0,1]
    v_pk_fma_f32 v[50:51], v[50:51], v[26:27], v[60:61] op_sel:[1,1,0] op_sel_hi:[1,0,1] neg_lo:[1,0,0]
    v_cvt_pk_bf16_f32 v65, v50, -v51
    ds_write_addtid_b32 v65 offset:6256
    v_pk_mul_f32 v[32:33], v[28:29], v[24:25] op_sel:[0,0] op_sel_hi:[0,1]
    v_pk_fma_f32 v[30:31], v[28:29], v[24:25], v[32:33] op_sel:[1,1,0] op_sel_hi:[1,0,1] neg_lo:[1,0,0]
    v_cvt_pk_bf16_f32 v62, v30, v31
    ds_write_addtid_b32 v62 offset:14144
    v_pk_mul_f32 v[60:61], v[58:59], v[26:27] op_sel:[0,0] op_sel_hi:[0,1]
    v_pk_fma_f32 v[58:59], v[58:59], v[26:27], v[60:61] op_sel:[1,1,0] op_sel_hi:[1,0,1] neg_lo:[1,0,0]
    v_cvt_pk_bf16_f32 v63, v58, -v59
    ds_write_addtid_b32 v63 offset:6528
    v_pk_mul_f32 v[32:33], v[30:31], v[24:25] op_sel:[0,0] op_sel_hi:[0,1]
    v_pk_fma_f32 v[28:29], v[30:31], v[24:25], v[32:33] op_sel:[1,1,0] op_sel_hi:[1,0,1] neg_lo:[1,0,0]
    v_cvt_pk_bf16_f32 v64, v28, v29
    ds_write_addtid_b32 v64 offset:14416
    v_pk_mul_f32 v[60:61], v[50:51], v[26:27] op_sel:[0,0] op_sel_hi:[0,1]
    v_pk_fma_f32 v[50:51], v[50:51], v[26:27], v[60:61] op_sel:[1,1,0] op_sel_hi:[1,0,1] neg_lo:[1,0,0]
    v_cvt_pk_bf16_f32 v65, v50, -v51
    ds_write_addtid_b32 v65 offset:6800
    v_pk_mul_f32 v[32:33], v[28:29], v[24:25] op_sel:[0,0] op_sel_hi:[0,1]
    v_pk_fma_f32 v[30:31], v[28:29], v[24:25], v[32:33] op_sel:[1,1,0] op_sel_hi:[1,0,1] neg_lo:[1,0,0]
    v_cvt_pk_bf16_f32 v62, v30, v31
    ds_write_addtid_b32 v62 offset:14688
    v_pk_mul_f32 v[60:61], v[58:59], v[26:27] op_sel:[0,0] op_sel_hi:[0,1]
    v_pk_fma_f32 v[58:59], v[58:59], v[26:27], v[60:61] op_sel:[1,1,0] op_sel_hi:[1,0,1] neg_lo:[1,0,0]
    v_cvt_pk_bf16_f32 v63, v58, -v59
    ds_write_addtid_b32 v63 offset:7072
    v_pk_mul_f32 v[32:33], v[30:31], v[24:25] op_sel:[0,0] op_sel_hi:[0,1]
    v_pk_fma_f32 v[28:29], v[30:31], v[24:25], v[32:33] op_sel:[1,1,0] op_sel_hi:[1,0,1] neg_lo:[1,0,0]
    v_cvt_pk_bf16_f32 v64, v28, v29
    ds_write_addtid_b32 v64 offset:14960
    v_pk_mul_f32 v[32:33], v[28:29], v[24:25] op_sel:[0,0] op_sel_hi:[0,1]
    v_pk_fma_f32 v[30:31], v[28:29], v[24:25], v[32:33] op_sel:[1,1,0] op_sel_hi:[1,0,1] neg_lo:[1,0,0]
    v_cvt_pk_bf16_f32 v65, v30, v31
    ds_write_addtid_b32 v65 offset:15232
    v_pk_mul_f32 v[32:33], v[30:31], v[24:25] op_sel:[0,0] op_sel_hi:[0,1]
    v_pk_fma_f32 v[28:29], v[30:31], v[24:25], v[32:33] op_sel:[1,1,0] op_sel_hi:[1,0,1] neg_lo:[1,0,0]
    v_cvt_pk_bf16_f32 v62, v28, v29
    ds_write_addtid_b32 v62 offset:15504
    v_pk_mul_f32 v[32:33], v[28:29], v[24:25] op_sel:[0,0] op_sel_hi:[0,1]
    v_pk_fma_f32 v[30:31], v[28:29], v[24:25], v[32:33] op_sel:[1,1,0] op_sel_hi:[1,0,1] neg_lo:[1,0,0]
    v_cvt_pk_bf16_f32 v63, v30, v31
    ds_write_addtid_b32 v63 offset:15776
    ds_read_b128 a[160:163], v158 offset:0
    ds_read_b128 a[164:167], v159 offset:0
    ds_read_b128 a[168:171], v158 offset:32
    ds_read_b128 a[172:175], v159 offset:32
    ds_read_b128 a[176:179], v158 offset:64
    ds_read_b128 a[180:183], v159 offset:64
    ds_read_b128 a[184:187], v158 offset:96
    ds_read_b128 a[188:191], v159 offset:96
    ds_read_b128 a[192:195], v158 offset:128
    ds_read_b128 a[196:199], v159 offset:128
    ds_read_b128 a[200:203], v158 offset:160
    ds_read_b128 a[204:207], v159 offset:160
    ds_read_b128 a[208:211], v158 offset:192
    ds_read_b128 a[212:215], v159 offset:192
    ds_read_b128 a[216:219], v158 offset:224
    ds_read_b128 a[220:223], v159 offset:224
    v_and_b32 v18, 0xffff0000, v140
    v_mul_f32 v18, 0x3fb8aa3b, v18
    v_exp_f32 v18, v18
    v_and_b32 v19, 0xffff0000, v141
    v_and_b32 v20, 0xffff0000, v142
    v_and_b32 v21, 0xffff0000, v143
    v_cvt_pk_bf16_f32 v18, v18, v18
    v_and_b32 v18, 0xffff0000, v18
    v_mul_f32 v18, v18, v16
    v_mul_f32 v19, v19, v16
    v_mul_f32 v20, v20, v16
    v_mul_f32 v21, v21, v16
    v_mul_f32 v18, 0xbfb8aa3b, v18
    v_mul_f32 v19, 0x3e22f983, v19
    v_add_f32 v20, v20, v20
    v_add_f32 v21, v21, v21
    v_mul_f32 v62, 0x3f800000, v18
    v_mul_f32 v63, 0x3f800000, v19
    v_exp_f32 v62, v62
    v_fract_f32 v63, v63
    v_cos_f32 v22, v63
    v_sin_f32 v23, v63
    s_nop 0
    v_mul_f32 v22, v22, v62
    v_mul_f32 v23, v23, v62
    v_mul_f32 v62, 0x41000000, v18
    v_mul_f32 v63, 0x41000000, v19
    v_exp_f32 v62, v62
    v_fract_f32 v63, v63
    v_cos_f32 v24, v63
    v_sin_f32 v25, v63
    s_nop 0
    v_mul_f32 v24, v24, v62
    v_mul_f32 v25, v25, v62
    v_mul_f32 v62, 0x43800000, v18
    v_mul_f32 v63, 0x43800000, v19
    v_exp_f32 v62, v62
    v_fract_f32 v63, v63
    v_cos_f32 v26, v63
    v_sin_f32 v27, v63
    s_nop 0
    v_mul_f32 v26, v26, v62
    v_mul_f32 v27, v27, v62
    s_mov_b32 m0, s46
    s_waitcnt lgkmcnt(0)
    v_mfma_f32_32x32x16_bf16 v[80:95], a[160:163], a[164:167], 0
    v_mov_b32 v66, 0x3f80
    ds_write_addtid_b32 v66 offset:7344
    v_cvt_pk_bf16_f32 v62, v20, -v21
    ds_write_addtid_b32 v62 offset:0
    v_cvt_pk_bf16_f32 v63, v24, v25
    ds_write_addtid_b32 v63 offset:7616
    v_pk_mul_f32 v[60:61], v[20:21], v[22:23] op_sel:[0,0] op_sel_hi:[0,1]
    v_pk_fma_f32 v[34:35], v[20:21], v[22:23], v[60:61] op_sel:[1,1,0] op_sel_hi:[1,0,1] neg_lo:[1,0,0]
    v_cvt_pk_bf16_f32 v64, v34, -v35
    ds_write_addtid_b32 v64 offset:272
    v_mfma_f32_32x32x16_bf16 v[80:95], a[168:171], a[172:175], v[80:95]
    v_pk_mul_f32 v[32:33], v[24:25], v[24:25] op_sel:[0,0] op_sel_hi:[0,1]
    v_pk_fma_f32 v[28:29], v[24:25], v[24:25], v[32:33] op_sel:[1,1,0] op_sel_hi:[1,0,1] neg_lo:[1,0,0]
    v_cvt_pk_bf16_f32 v65, v28, v29
    ds_write_addtid_b32 v65 offset:7888
    v_pk_mul_f32 v[60:61], v[34:35], v[22:23] op_sel:[0,0] op_sel_hi:[0,1]
    v_pk_fma_f32 v[36:37], v[34:35], v[22:23], v[60:61] op_sel:[1,1,0] op_sel_hi:[1,0,1] neg_lo:[1,0,0]
    v_cvt_pk_bf16_f32 v62, v36, -v37
    ds_write_addtid_b32 v62 offset:544
    v_pk_mul_f32 v[32:33], v[28:29], v[24:25] op_sel:[0,0] op_sel_hi:[0,1]
    v_pk_fma_f32 v[30:31], v[28:29], v[24:25], v[32:33] op_sel:[1,1,0] op_sel_hi:[1,0,1] neg_lo:[1,0,0]
    v_cvt_pk_bf16_f32 v63, v30, v31
    ds_write_addtid_b32 v63 offset:8160
    v_pk_mul_f32 v[60:61], v[36:37], v[22:23] op_sel:[0,0] op_sel_hi:[0,1]
    v_pk_fma_f32 v[38:39], v[36:37], v[22:23], v[60:61] op_sel:[1,1,0] op_sel_hi:[1,0,1] neg_lo:[1,0,0]
    v_cvt_pk_bf16_f32 v64, v38, -v39
    ds_write_addtid_b32 v64 offset:816
    v_mfma_f32_32x32x16_bf16 v[80:95], a[176:179], a[180:183], v[80:95]
    v_pk_mul_f32 v[32:33], v[30:31], v[24:25] op_sel:[0,0] op_sel_hi:[0,1]
    v_pk_fma_f32 v[28:29], v[30:31], v[24:25], v[32:33] op_sel:[1,1,0] op_sel_hi:[1,0,1] neg_lo:[1,0,0]
    v_cvt_pk_bf16_f32 v65, v28, v29
    ds_write_addtid_b32 v65 offset:8432
    v_pk_mul_f32 v[60:61], v[38:39], v[22:23] op_sel:[0,0] op_sel_hi:[0,1]
    v_pk_fma_f32 v[40:41], v[38:39], v[22:23], v[60:61] op_sel:[1,1,0] op_sel_hi:[1,0,1] neg_lo:[1,0,0]
    v_cvt_pk_bf16_f32 v62, v40, -v41
    ds_write_addtid_b32 v62 offset:1088
    v_pk_mul_f32 v[32:33], v[28:29], v[24:25] op_sel:[0,0] op_sel_hi:[0,1]
    v_pk_fma_f32 v[30:31], v[28:29], v[24:25], v[32:33] op_sel:[1,1,0] op_sel_hi:[1,0,1] neg_lo:[1,0,0]
    v_cvt_pk_bf16_f32 v63, v30, v31
    ds_write_addtid_b32 v63 offset:8704
    v_pk_mul_f32 v[60:61], v[40:41], v[22:23] op_sel:[0,0] op_sel_hi:[0,1]
    v_pk_fma_f32 v[42:43], v[40:41], v[22:23], v[60:61] op_sel:[1,1,0] op_sel_hi:[1,0,1] neg_lo:[1,0,0]
    v_cvt_pk_bf16_f32 v64, v42, -v43
    ds_write_addtid_b32 v64 offset:1360
    v_mfma_f32_32x32x16_bf16 v[80:95], a[184:187], a[188:191], v[80:95]
    v_pk_mul_f32 v[32:33], v[30:31], v[24:25] op_sel:[0,0] op_sel_hi:[0,1]
    v_pk_fma_f32 v[28:29], v[30:31], v[24:25], v[32:33] op_sel:[1,1,0] op_sel_hi:[1,0,1] neg_lo:[1,0,0]
    v_cvt_pk_bf16_f32 v65, v28, v29
    ds_write_addtid_b32 v65 offset:8976
    v_pk_mul_f32 v[60:61], v[42:43], v[22:23] op_sel:[0,0] op_sel_hi:[0,1]
    v_pk_fma_f32 v[44:45], v[42:43], v[22:23], v[60:61] op_sel:[1,1,0] op_sel_hi:[1,0,1] neg_lo:[1,0,0]
    v_cvt_pk_bf16_f32 v62, v44, -v45
    ds_write_addtid_b32 v62 offset:1632
    v_pk_mul_f32 v[32:33], v[28:29], v[24:25] op_sel:[0,0] op_sel_hi:[0,1]
    v_pk_fma_f32 v[30:31], v[28:29], v[24:25], v[32:33] op_sel:[1,1,0] op_sel_hi:[1,0,1] neg_lo:[1,0,0]
    v_cvt_pk_bf16_f32 v63, v30, v31
    ds_write_addtid_b32 v63 offset:9248
    v_pk_mul_f32 v[60:61], v[44:45], v[22:23] op_sel:[0,0] op_sel_hi:[0,1]
    v_pk_fma_f32 v[46:47], v[44:45], v[22:23], v[60:61] op_sel:[1,1,0] op_sel_hi:[1,0,1] neg_lo:[1,0,0]
    v_cvt_pk_bf16_f32 v64, v46, -v47
    ds_write_addtid_b32 v64 offset:1904
    v_mfma_f32_32x32x16_bf16 v[80:95], a[192:195], a[196:199], v[80:95]
    v_pk_mul_f32 v[32:33], v[30:31], v[24:25] op_sel:[0,0] op_sel_hi:[0,1]
    v_pk_fma_f32 v[28:29], v[30:31], v[24:25], v[32:33] op_sel:[1,1,0] op_sel_hi:[1,0,1] neg_lo:[1,0,0]
    v_cvt_pk_bf16_f32 v65, v28, v29
    ds_write_addtid_b32 v65 offset:9520
    v_pk_mul_f32 v[60:61], v[46:47], v[22:23] op_sel:[0,0] op_sel_hi:[0,1]
    v_pk_fma_f32 v[48:49], v[46:47], v[22:23], v[60:61] op_sel:[1,1,0] op_sel_hi:[1,0,1] neg_lo:[1,0,0]
    v_pk_mul_f32 v[32:33], v[28:29], v[24:25] op_sel:[0,0] op_sel_hi:[0,1]
    v_pk_fma_f32 v[30:31], v[28:29], v[24:25], v[32:33] op_sel:[1,1,0] op_sel_hi:[1,0,1] neg_lo:[1,0,0]
    v_cvt_pk_bf16_f32 v62, v30, v31
    ds_write_addtid_b32 v62 offset:9792
    v_pk_mul_f32 v[60:61], v[20:21], v[26:27] op_sel:[0,0] op_sel_hi:[0,1]
    v_pk_fma_f32 v[50:51], v[20:21], v[26:27], v[60:61] op_sel:[1,1,0] op_sel_hi:[1,0,1] neg_lo:[1,0,0]
    v_cvt_pk_bf16_f32 v63, v50, -v51
    ds_write_addtid_b32 v63 offset:2176
    v_mfma_f32_32x32x16_bf16 v[80:95], a[200:203], a[204:207], v[80:95]
    v_pk_mul_f32 v[32:33], v[30:31], v[24:25] op_sel:[0,0] op_sel_hi:[0,1]
    v_pk_fma_f32 v[28:29], v[30:31], v[24:25], v[32:33] op_sel:[1,1,0] op_sel_hi:[1,0,1] neg_lo:[1,0,0]
    v_cvt_pk_bf16_f32 v64, v28, v29
    ds_write_addtid_b32 v64 offset:10064
    v_pk_mul_f32 v[60:61], v[36:37], v[26:27] op_sel:[0,0] op_sel_hi:[0,1]
    v_pk_fma_f32 v[52:53], v[36:37], v[26:27], v[60:61] op_sel:[1,1,0] op_sel_hi:[1,0,1] neg_lo:[1,0,0]
    v_cvt_pk_bf16_f32 v65, v52, -v53
    ds_write_addtid_b32 v65 offset:2448
    v_pk_mul_f32 v[32:33], v[28:29], v[24:25] op_sel:[0,0] op_sel_hi:[0,1]
    v_pk_fma_f32 v[30:31], v[28:29], v[24:25], v[32:33] op_sel:[1,1,0] op_sel_hi:[1,0,1] neg_lo:[1,0,0]
    v_cvt_pk_bf16_f32 v62, v30, v31
    ds_write_addtid_b32 v62 offset:10336
    v_pk_mul_f32 v[60:61], v[40:41], v[26:27] op_sel:[0,0] op_sel_hi:[0,1]
    v_pk_fma_f32 v[54:55], v[40:41], v[26:27], v[60:61] op_sel:[1,1,0] op_sel_hi:[1,0,1] neg_lo:[1,0,0]
    v_cvt_pk_bf16_f32 v63, v54, -v55
    ds_write_addtid_b32 v63 offset:2720
    v_mfma_f32_32x32x16_bf16 v[80:95], a[208:211], a[212:215], v[80:95]
    s_cmp_lg_u32 s3, 0
    s_cbranch_scc1 L_pdone10
    s_mov_b32 s88, 0
L_poll10:
    buffer_load_dword v241, v155, s[68:71], 0 offen sc1
    s_waitcnt vmcnt(0)
    v_cmp_le_u32 vcc, s65, v241
    s_add_u32 s88, s88, 1
    s_nop 0
    s_cmp_eq_u64 vcc, -1
    s_cbranch_scc1 L_pdone10
    s_cmp_ge_u32 s88, 200000
    s_cbranch_scc1 L_pdone10
    s_sleep 4
    s_branch L_poll10
L_pdone10:
    s_barrier
    s_mul_i32 s55, s62, 4224
    s_add_u32 m0, s47, 0
    s_nop 0
    buffer_load_dwordx4 v153, s[28:31], s55 offen offset:0 sc1 lds
    buffer_load_dwordx4 v153, s[28:31], s55 offen offset:1024 sc1 lds
    buffer_load_dwordx4 v153, s[28:31], s55 offen offset:2048 sc1 lds
    buffer_load_dwordx4 v153, s[28:31], s55 offen offset:3072 sc1 lds
    s_mov_b32 m0, s46
    s_nop 0
    v_pk_mul_f32 v[32:33], v[30:31], v[24:25] op_sel:[0,0] op_sel_hi:[0,1]
    v_pk_fma_f32 v[28:29], v[30:31], v[24:25], v[32:33] op_sel:[1,1,0] op_sel_hi:[1,0,1] neg_lo:[1,0,0]
    v_cvt_pk_bf16_f32 v64, v28, v29
    ds_write_addtid_b32 v64 offset:10608
    v_pk_mul_f32 v[60:61], v[44:45], v[26:27] op_sel:[0,0] op_sel_hi:[0,1]
    v_pk_fma_f32 v[56:57], v[44:45], v[26:27], v[60:61] op_sel:[1,1,0] op_sel_hi:[1,0,1] neg_lo:[1,0,0]
    v_cvt_pk_bf16_f32 v65, v56, -v57
    ds_write_addtid_b32 v65 offset:2992
    v_pk_mul_f32 v[32:33], v[28:29], v[24:25] op_sel:[0,0] op_sel_hi:[0,1]
    v_pk_fma_f32 v[30:31], v[28:29], v[24:25], v[32:33] op_sel:[1,1,0] op_sel_hi:[1,0,1] neg_lo:[1,0,0]
    v_cvt_pk_bf16_f32 v62, v30, v31
    ds_write_addtid_b32 v62 offset:10880
    v_pk_mul_f32 v[60:61], v[48:49], v[26:27] op_sel:[0,0] op_sel_hi:[0,1]
    v_pk_fma_f32 v[58:59], v[48:49], v[26:27], v[60:61] op_sel:[1,1,0] op_sel_hi:[1,0,1] neg_lo:[1,0,0]
    v_cvt_pk_bf16_f32 v63, v58, -v59
    ds_write_addtid_b32 v63 offset:3264
    v_mfma_f32_32x32x16_bf16 v[80:95], a[216:219], a[220:223], v[80:95]
    v_pk_mul_f32 v[32:33], v[30:31], v[24:25] op_sel:[0,0] op_sel_hi:[0,1]
    v_pk_fma_f32 v[28:29], v[30:31], v[24:25], v[32:33] op_sel:[1,1,0] op_sel_hi:[1,0,1] neg_lo:[1,0,0]
    v_cvt_pk_bf16_f32 v64, v28, v29
    ds_write_addtid_b32 v64 offset:11152
    v_pk_mul_f32 v[60:61], v[50:51], v[26:27] op_sel:[0,0] op_sel_hi:[0,1]
    v_pk_fma_f32 v[50:51], v[50:51], v[26:27], v[60:61] op_sel:[1,1,0] op_sel_hi:[1,0,1] neg_lo:[1,0,0]
    v_cvt_pk_bf16_f32 v65, v50, -v51
    ds_write_addtid_b32 v65 offset:3536
    v_pk_mul_f32 v[32:33], v[28:29], v[24:25] op_sel:[0,0] op_sel_hi:[0,1]
    v_pk_fma_f32 v[30:31], v[28:29], v[24:25], v[32:33] op_sel:[1,1,0] op_sel_hi:[1,0,1] neg_lo:[1,0,0]
    v_cvt_pk_bf16_f32 v62, v30, v31
    ds_write_addtid_b32 v62 offset:11424
    v_pk_mul_f32 v[60:61], v[54:55], v[26:27] op_sel:[0,0] op_sel_hi:[0,1]
    v_pk_fma_f32 v[54:55], v[54:55], v[26:27], v[60:61] op_sel:[1,1,0] op_sel_hi:[1,0,1] neg_lo:[1,0,0]
    v_cvt_pk_bf16_f32 v63, v54, -v55
    ds_write_addtid_b32 v63 offset:3808
    s_add_u32 s55, s55, 2
    s_add_u32 m0, s47, 4160
    s_nop 0
    buffer_load_dwordx4 v153, s[28:31], s55 offen offset:0 sc1 lds
    buffer_load_dwordx4 v153, s[28:31], s55 offen offset:1024 sc1 lds
    buffer_load_dwordx4 v153, s[28:31], s55 offen offset:2048 sc1 lds
    buffer_load_dwordx4 v153, s[28:31], s55 offen offset:3072 sc1 lds
    s_mov_b32 m0, s46
    s_nop 0
    v_pk_mul_f32 v[32:33], v[30:31], v[24:25] op_sel:[0,0] op_sel_hi:[0,1]
    v_pk_fma_f32 v[28:29], v[30:31], v[24:25], v[32:33] op_sel:[1,1,0] op_sel_hi:[1,0,1] neg_lo:[1,0,0]
    v_cvt_pk_bf16_f32 v64, v28, v29
    ds_write_addtid_b32 v64 offset:11696
    v_pk_mul_f32 v[60:61], v[58:59], v[26:27] op_sel:[0,0] op_sel_hi:[0,1]
    v_pk_fma_f32 v[58:59], v[58:59], v[26:27], v[60:61] op_sel:[1,1,0] op_sel_hi:[1,0,1] neg_lo:[1,0,0]
    v_cvt_pk_bf16_f32 v65, v58, -v59
    ds_write_addtid_b32 v65 offset:4080
    v_pk_mul_f32 v[32:33], v[28:29], v[24:25] op_sel:[0,0] op_sel_hi:[0,1]
    v_pk_fma_f32 v[30:31], v[28:29], v[24:25], v[32:33] op_sel:[1,1,0] op_sel_hi:[1,0,1] neg_lo:[1,0,0]
    v_cvt_pk_bf16_f32 v62, v30, v31
    ds_write_addtid_b32 v62 offset:11968
    v_pk_mul_f32 v[60:61], v[50:51], v[26:27] op_sel:[0,0] op_sel_hi:[0,1]
    v_pk_fma_f32 v[50:51], v[50:51], v[26:27], v[60:61] op_sel:[1,1,0] op_sel_hi:[1,0,1] neg_lo:[1,0,0]
    v_cvt_pk_bf16_f32 v63, v50, -v51
    ds_write_addtid_b32 v63 offset:4352
    v_pk_mul_f32 v[32:33], v[30:31], v[24:25] op_sel:[0,0] op_sel_hi:[0,1]
    v_pk_fma_f32 v[28:29], v[30:31], v[24:25], v[32:33] op_sel:[1,1,0] op_sel_hi:[1,0,1] neg_lo:[1,0,0]
    v_cvt_pk_bf16_f32 v64, v28, v29
    ds_write_addtid_b32 v64 offset:12240
    v_pk_mul_f32 v[60:61], v[54:55], v[26:27] op_sel:[0,0] op_sel_hi:[0,1]
    v_pk_fma_f32 v[54:55], v[54:55], v[26:27], v[60:61] op_sel:[1,1,0] op_sel_hi:[1,0,1] neg_lo:[1,0,0]
    v_cvt_pk_bf16_f32 v65, v54, -v55
    ds_write_addtid_b32 v65 offset:4624
    v_pk_mul_f32 v[32:33], v[28:29], v[24:25] op_sel:[0,0] op_sel_hi:[0,1]
    v_pk_fma_f32 v[30:31], v[28:29], v[24:25], v[32:33] op_sel:[1,1,0] op_sel_hi:[1,0,1] neg_lo:[1,0,0]
    v_cvt_pk_bf16_f32 v62, v30, v31
    ds_write_addtid_b32 v62 offset:12512
    v_pk_mul_f32 v[60:61], v[58:59], v[26:27] op_sel:[0,0] op_sel_hi:[0,1]
    v_pk_fma_f32 v[58:59], v[58:59], v[26:27], v[60:61] op_sel:[1,1,0] op_sel_hi:[1,0,1] neg_lo:[1,0,0]
    v_cvt_pk_bf16_f32 v63, v58, -v59
    ds_write_addtid_b32 v63 offset:4896
    s_add_u32 s55, s55, 2
    s_add_u32 m0, s47, 8320
    s_nop 0
    buffer_load_dwordx4 v153, s[28:31], s55 offen offset:0 sc1 lds
    buffer_load_dwordx4 v153, s[28:31], s55 offen offset:1024 sc1 lds
    buffer_load_dwordx4 v153, s[28:31], s55 offen offset:2048 sc1 lds
    buffer_load_dwordx4 v153, s[28:31], s55 offen offset:3072 sc1 lds
    s_mov_b32 m0, s46
    s_nop 0
    v_pk_mul_f32 v[32:33], v[30:31], v[24:25] op_sel:[0,0] op_sel_hi:[0,1]
    v_pk_fma_f32 v[28:29], v[30:31], v[24:25], v[32:33] op_sel:[1,1,0] op_sel_hi:[1,0,1] neg_lo:[1,0,0]
    v_cvt_pk_bf16_f32 v64, v28, v29
    ds_write_addtid_b32 v64 offset:12784
    v_pk_mul_f32 v[60:61], v[50:51], v[26:27] op_sel:[0,0] op_sel_hi:[0,1]
    v_pk_fma_f32 v[50:51], v[50:51], v[26:27], v[60:61] op_sel:[1,1,0] op_sel_hi:[1,0,1] neg_lo:[1,0,0]
    v_cvt_pk_bf16_f32 v65, v50, -v51
    ds_write_addtid_b32 v65 offset:5168
    v_pk_mul_f32 v[32:33], v[28:29], v[24:25] op_sel:[0,0] op_sel_hi:[0,1]
    v_pk_fma_f32 v[30:31], v[28:29], v[24:25], v[32:33] op_sel:[1,1,0] op_sel_hi:[1,0,1] neg_lo:[1,0,0]
    v_cvt_pk_bf16_f32 v62, v30, v31
    ds_write_addtid_b32 v62 offset:13056
    v_pk_mul_f32 v[60:61], v[58:59], v[26:27] op_sel:[0,0] op_sel_hi:[0,1]
    v_pk_fma_f32 v[58:59], v[58:59], v[26:27], v[60:61] op_sel:[1,1,0] op_sel_hi:[1,0,1] neg_lo:[1,0,0]
    v_cvt_pk_bf16_f32 v63, v58, -v59
    ds_write_addtid_b32 v63 offset:5440
    v_pk_mul_f32 v[32:33], v[30:31], v[24:25] op_sel:[0,0] op_sel_hi:[0,1]
    v_pk_fma_f32 v[28:29], v[30:31], v[24:25], v[32:33] op_sel:[1,1,0] op_sel_hi:[1,0,1] neg_lo:[1,0,0]
    v_cvt_pk_bf16_f32 v64, v28, v29
    ds_write_addtid_b32 v64 offset:13328
    v_pk_mul_f32 v[60:61], v[50:51], v[26:27] op_sel:[0,0] op_sel_hi:[0,1]
    v_pk_fma_f32 v[50:51], v[50:51], v[26:27], v[60:61] op_sel:[1,1,0] op_sel_hi:[1,0,1] neg_lo:[1,0,0]
    v_cvt_pk_bf16_f32 v65, v50, -v51
    ds_write_addtid_b32 v65 offset:5712
    v_pk_mul_f32 v[32:33], v[28:29], v[24:25] op_sel:[0,0] op_sel_hi:[0,1]
    v_pk_fma_f32 v[30:31], v[28:29], v[24:25], v[32:33] op_sel:[1,1,0] op_sel_hi:[1,0,1] neg_lo:[1,0,0]
    v_cvt_pk_bf16_f32 v62, v30, v31
    ds_write_addtid_b32 v62 offset:13600
    v_pk_mul_f32 v[60:61], v[58:59], v[26:27] op_sel:[0,0] op_sel_hi:[0,1]
L_pv2:
    s_cbranch_execz L_pvb
    v_pk_fma_f32 v[58:59], v[58:59], v[26:27], v[60:61] op_sel:[1,1,0] op_sel_hi:[1,0,1] neg_lo:[1,0,0]
    v_cvt_pk_bf16_f32 v63, v58, -v59
    ds_write_addtid_b32 v63 offset:5984
    s_add_u32 s55, s55, 2
    s_add_u32 m0, s47, 12480
    s_nop 0
    buffer_load_dwordx4 v153, s[28:31], s55 offen offset:0 sc1 lds
    buffer_load_dwordx4 v153, s[28:31], s55 offen offset:1024 sc1 lds
    buffer_load_dwordx4 v153, s[28:31], s55 offen offset:2048 sc1 lds
    buffer_load_dwordx4 v153, s[28:31], s55 offen offset:3072 sc1 lds
    s_mov_b32 m0, s46
    s_nop 0
    v_pk_mul_f32 v[32:33], v[30:31], v[24:25] op_sel:[0,0] op_sel_hi:[0,1]
    v_pk_fma_f32 v[28:29], v[30:31], v[24:25], v[32:33] op_sel:[1,1,0] op_sel_hi:[1,0,1] neg_lo:[1,0,0]
    v_cvt_pk_bf16_f32 v64, v28, v29
    ds_write_addtid_b32 v64 offset:13872
    v_pk_mul_f32 v[60:61], v[50:51], v[26:27] op_sel:[0,0] op_sel_hi:[0,1]
    v_pk_fma_f32 v[50:51], v[50:51], v[26:27], v[60:61] op_sel:[1,1,0] op_sel_hi:[1,0,1] neg_lo:[1,0,0]
    v_cvt_pk_bf16_f32 v65, v50, -v51
    ds_write_addtid_b32 v65 offset:6256
    v_pk_mul_f32 v[32:33], v[28:29], v[24:25] op_sel:[0,0] op_sel_hi:[0,1]
    v_pk_fma_f32 v[30:31], v[28:29], v[24:25], v[32:33] op_sel:[1,1,0] op_sel_hi:[1,0,1] neg_lo:[1,0,0]
    v_cvt_pk_bf16_f32 v62, v30, v31
    ds_write_addtid_b32 v62 offset:14144
    v_pk_mul_f32 v[60:61], v[58:59], v[26:27] op_sel:[0,0] op_sel_hi:[0,1]
    v_pk_fma_f32 v[58:59], v[58:59], v[26:27], v[60:61] op_sel:[1,1,0] op_sel_hi:[1,0,1] neg_lo:[1,0,0]
    v_cvt_pk_bf16_f32 v63, v58, -v59
    ds_write_addtid_b32 v63 offset:6528
    v_pk_mul_f32 v[32:33], v[30:31], v[24:25] op_sel:[0,0] op_sel_hi:[0,1]
    v_pk_fma_f32 v[28:29], v[30:31], v[24:25], v[32:33] op_sel:[1,1,0] op_sel_hi:[1,0,1] neg_lo:[1,0,0]
    v_cvt_pk_bf16_f32 v64, v28, v29
    ds_write_addtid_b32 v64 offset:14416
    v_pk_mul_f32 v[60:61], v[50:51], v[26:27] op_sel:[0,0] op_sel_hi:[0,1]
    v_pk_fma_f32 v[50:51], v[50:51], v[26:27], v[60:61] op_sel:[1,1,0] op_sel_hi:[1,0,1] neg_lo:[1,0,0]
    v_cvt_pk_bf16_f32 v65, v50, -v51
    ds_write_addtid_b32 v65 offset:6800
    v_pk_mul_f32 v[32:33], v[28:29], v[24:25] op_sel:[0,0] op_sel_hi:[0,1]
    v_pk_fma_f32 v[30:31], v[28:29], v[24:25], v[32:33] op_sel:[1,1,0] op_sel_hi:[1,0,1] neg_lo:[1,0,0]
    v_cvt_pk_bf16_f32 v62, v30, v31
    ds_write_addtid_b32 v62 offset:14688
    v_pk_mul_f32 v[60:61], v[58:59], v[26:27] op_sel:[0,0] op_sel_hi:[0,1]
    v_pk_fma_f32 v[58:59], v[58:59], v[26:27], v[60:61] op_sel:[1,1,0] op_sel_hi:[1,0,1] neg_lo:[1,0,0]
    v_cvt_pk_bf16_f32 v63, v58, -v59
    ds_write_addtid_b32 v63 offset:7072
    v_pk_mul_f32 v[32:33], v[30:31], v[24:25] op_sel:[0,0] op_sel_hi:[0,1]
    v_pk_fma_f32 v[28:29], v[30:31], v[24:25], v[32:33] op_sel:[1,1,0] op_sel_hi:[1,0,1] neg_lo:[1,0,0]
    v_cvt_pk_bf16_f32 v64, v28, v29
    ds_write_addtid_b32 v64 offset:14960
    v_pk_mul_f32 v[32:33], v[28:29], v[24:25] op_sel:[0,0] op_sel_hi:[0,1]
    v_pk_fma_f32 v[30:31], v[28:29], v[24:25], v[32:33] op_sel:[1,1,0] op_sel_hi:[1,0,1] neg_lo:[1,0,0]
    v_cvt_pk_bf16_f32 v65, v30, v31
    ds_write_addtid_b32 v65 offset:15232
    v_pk_mul_f32 v[32:33], v[30:31], v[24:25] op_sel:[0,0] op_sel_hi:[0,1]
    v_pk_fma_f32 v[28:29], v[30:31], v[24:25], v[32:33] op_sel:[1,1,0] op_sel_hi:[1,0,1] neg_lo:[1,0,0]
    v_cvt_pk_bf16_f32 v62, v28, v29
    ds_write_addtid_b32 v62 offset:15504
    v_pk_mul_f32 v[32:33], v[28:29], v[24:25] op_sel:[0,0] op_sel_hi:[0,1]
    v_pk_fma_f32 v[30:31], v[28:29], v[24:25], v[32:33] op_sel:[1,1,0] op_sel_hi:[1,0,1] neg_lo:[1,0,0]
    v_cvt_pk_bf16_f32 v63, v30, v31
    ds_write_addtid_b32 v63 offset:15776
    ds_read_b128 a[96:99], v158 offset:0
    ds_read_b128 a[100:103], v159 offset:0
    ds_read_b128 a[104:107], v158 offset:32
    ds_read_b128 a[108:111], v159 offset:32
    ds_read_b128 a[112:115], v158 offset:64
    ds_read_b128 a[116:119], v159 offset:64
    ds_read_b128 a[120:123], v158 offset:96
    ds_read_b128 a[124:127], v159 offset:96
    ds_read_b128 a[128:131], v158 offset:128
    ds_read_b128 a[132:135], v159 offset:128
    ds_read_b128 a[136:139], v158 offset:160
    ds_read_b128 a[140:143], v159 offset:160
    ds_read_b128 a[144:147], v158 offset:192
    ds_read_b128 a[148:151], v159 offset:192
    ds_read_b128 a[152:155], v158 offset:224
    ds_read_b128 a[156:159], v159 offset:224
    s_waitcnt lgkmcnt(14)
    v_mfma_f32_32x32x16_bf16 v[80:95], a[96:99], a[100:103], v[80:95]
    s_waitcnt lgkmcnt(12)
    v_mfma_f32_32x32x16_bf16 v[80:95], a[104:107], a[108:111], v[80:95]
    s_waitcnt lgkmcnt(10)
    v_mfma_f32_32x32x16_bf16 v[80:95], a[112:115], a[116:119], v[80:95]
    s_waitcnt lgkmcnt(8)
    v_mfma_f32_32x32x16_bf16 v[80:95], a[120:123], a[124:127], v[80:95]
    s_waitcnt lgkmcnt(6)
    v_mfma_f32_32x32x16_bf16 v[80:95], a[128:131], a[132:135], v[80:95]
    s_waitcnt lgkmcnt(4)
    v_mfma_f32_32x32x16_bf16 v[80:95], a[136:139], a[140:143], v[80:95]
    s_waitcnt lgkmcnt(2)
    v_mfma_f32_32x32x16_bf16 v[80:95], a[144:147], a[148:151], v[80:95]
    s_waitcnt lgkmcnt(0)
    v_mfma_f32_32x32x16_bf16 v[80:95], a[152:155], a[156:159], v[80:95]
    v_mov_b32 v160, 0
    ds_write_b32 v163, v160 offset:4096
    s_waitcnt vmcnt(0) lgkmcnt(0)
    ds_read_b64 a[64:65], v152 offset:3584
    ds_read_b64 a[66:67], v152 offset:3592
    ds_read_b128 a[32:35], v151 offset:0
    ds_read_b64 a[68:69], v152 offset:3072
    ds_read_b64 a[70:71], v152 offset:3080
    ds_read_b128 a[36:39], v151 offset:512
    ds_read_b64 a[72:73], v152 offset:2560
    ds_read_b64 a[74:75], v152 offset:2568
    ds_read_b128 a[40:43], v151 offset:1024
    s_waitcnt lgkmcnt(6)
    v_mfma_f32_16x16x32_bf16 v[16:19], a[64:67], a[32:35], 0
    ds_read_b64 a[76:77], v152 offset:2048
    ds_read_b64 a[78:79], v152 offset:2056
    s_waitcnt lgkmcnt(6)
    v_mfma_f32_16x16x32_bf16 v[20:23], a[68:71], a[32:35], 0
    ds_read_b128 a[44:47], v151 offset:1536
    ds_read_b64 a[80:81], v152 offset:1536
    s_waitcnt lgkmcnt(7)
    v_mfma_f32_16x16x32_bf16 v[20:23], a[64:67], a[36:39], v[20:23]
    ds_read_b64 a[82:83], v152 offset:1544
    ds_read_b128 a[48:51], v151 offset:2048
    v_mfma_f32_16x16x32_bf16 v[24:27], a[68:71], a[36:39], 0
    ds_read_b64 a[84:85], v152 offset:1024
    ds_read_b64 a[86:87], v152 offset:1032
    s_waitcnt lgkmcnt(9)
    v_mfma_f32_16x16x32_bf16 v[24:27], a[72:75], a[32:35], v[24:27]
    ds_read_b128 a[52:55], v151 offset:2560
    ds_read_b64 a[88:89], v152 offset:512
    v_mfma_f32_16x16x32_bf16 v[28:31], a[72:75], a[36:39], 0
    ds_read_b64 a[90:91], v152 offset:520
    ds_read_b128 a[56:59], v151 offset:3072
    s_waitcnt lgkmcnt(12)
    v_mfma_f32_16x16x32_bf16 v[24:27], a[64:67], a[40:43], v[24:27]
    ds_read_b64 a[92:93], v152 offset:0
    v_mfma_f32_16x16x32_bf16 v[28:31], a[68:71], a[40:43], v[28:31]
    ds_read_b64 a[94:95], v152 offset:8
    v_mfma_f32_16x16x32_bf16 v[32:35], a[72:75], a[40:43], 0
    ds_read_b128 a[60:63], v151 offset:3584
    s_waitcnt lgkmcnt(13)
    v_mfma_f32_16x16x32_bf16 v[28:31], a[76:79], a[32:35], v[28:31]
    ds_read_b64 a[128:129], v152 offset:3648
    v_mfma_f32_16x16x32_bf16 v[32:35], a[76:79], a[36:39], v[32:35]
    ds_read_b64 a[130:131], v152 offset:3656
    v_mfma_f32_16x16x32_bf16 v[36:39], a[76:79], a[40:43], 0
    ds_read_b128 a[96:99], v151 offset:64
    s_waitcnt lgkmcnt(15)
    v_mfma_f32_16x16x32_bf16 v[28:31], a[64:67], a[44:47], v[28:31]
    ds_read_b64 a[132:133], v152 offset:3136
    v_mfma_f32_16x16x32_bf16 v[32:35], a[68:71], a[44:47], v[32:35]
    ds_read_b64 a[134:135], v152 offset:3144
    v_mfma_f32_16x16x32_bf16 v[36:39], a[72:75], a[44:47], v[36:39]
    ds_read_b128 a[100:103], v151 offset:576
    v_mfma_f32_16x16x32_bf16 v[40:43], a[76:79], a[44:47], 0
    ds_read_b64 a[136:137], v152 offset:2624
    s_waitcnt lgkmcnt(15)
    v_mfma_f32_16x16x32_bf16 v[32:35], a[80:83], a[32:35], v[32:35]
    ds_read_b64 a[138:139], v152 offset:2632
    v_mfma_f32_16x16x32_bf16 v[36:39], a[80:83], a[36:39], v[36:39]
    ds_read_b128 a[104:107], v151 offset:1088
    v_mfma_f32_16x16x32_bf16 v[40:43], a[80:83], a[40:43], v[40:43]
    ds_read_b64 a[140:141], v152 offset:2112
    v_mfma_f32_16x16x32_bf16 v[44:47], a[80:83], a[44:47], 0
    ds_read_b64 a[142:143], v152 offset:2120
    v_mfma_f32_16x16x32_bf16 v[32:35], a[64:67], a[48:51], v[32:35]
    ds_read_b128 a[108:111], v151 offset:1600
    v_mfma_f32_16x16x32_bf16 v[36:39], a[68:71], a[48:51], v[36:39]
    ds_read_b64 a[144:145], v152 offset:1600
    v_mfma_f32_16x16x32_bf16 v[40:43], a[72:75], a[48:51], v[40:43]
    ds_read_b64 a[146:147], v152 offset:1608
    v_mfma_f32_16x16x32_bf16 v[44:47], a[76:79], a[48:51], v[44:47]
    ds_read_b128 a[112:115], v151 offset:2112
    s_waitcnt lgkmcnt(15)
    v_mfma_f32_16x16x32_bf16 v[36:39], a[84:87], a[32:35], v[36:39]
    ds_read_b64 a[148:149], v152 offset:1088
    v_mfma_f32_16x16x32_bf16 v[40:43], a[84:87], a[36:39], v[40:43]
    ds_read_b64 a[150:151], v152 offset:1096
    v_mfma_f32_16x16x32_bf16 v[44:47], a[84:87], a[40:43], v[44:47]
    ds_read_b128 a[116:119], v151 offset:2624
    v_mfma_f32_16x16x32_bf16 v[36:39], a[64:67], a[52:55], v[36:39]
    ds_read_b64 a[152:153], v152 offset:576
    v_mfma_f32_16x16x32_bf16 v[40:43], a[68:71], a[52:55], v[40:43]
    ds_read_b64 a[154:155], v152 offset:584
    v_mfma_f32_16x16x32_bf16 v[44:47], a[72:75], a[52:55], v[44:47]
    ds_read_b128 a[120:123], v151 offset:3136
    v_mfma_f32_16x16x32_bf16 v[40:43], a[88:91], a[32:35], v[40:43]
    ds_read_b64 a[156:157], v152 offset:64
    v_mfma_f32_16x16x32_bf16 v[44:47], a[88:91], a[36:39], v[44:47]
    ds_read_b64 a[158:159], v152 offset:72
    v_mfma_f32_16x16x32_bf16 v[40:43], a[64:67], a[56:59], v[40:43]
    ds_read_b128 a[124:127], v151 offset:3648
    v_mfma_f32_16x16x32_bf16 v[44:47], a[68:71], a[56:59], v[44:47]
    v_mfma_f32_16x16x32_bf16 v[44:47], a[92:95], a[32:35], v[44:47]
    v_mfma_f32_16x16x32_bf16 v[44:47], a[64:67], a[60:63], v[44:47]
    s_waitcnt lgkmcnt(15)
    v_mfma_f32_16x16x32_bf16 v[16:19], a[128:131], a[96:99], v[16:19]
    v_mfma_f32_16x16x32_bf16 v[20:23], a[132:135], a[96:99], v[20:23]
    s_mul_i32 s55, s44, 4224
    v_mfma_f32_16x16x32_bf16 v[20:23], a[128:131], a[100:103], v[20:23]
    v_mfma_f32_16x16x32_bf16 v[24:27], a[132:135], a[100:103], v[24:27]
    s_add_u32 m0, s46, 0
    v_mfma_f32_16x16x32_bf16 v[24:27], a[136:139], a[96:99], v[24:27]
    v_mfma_f32_16x16x32_bf16 v[28:31], a[136:139], a[100:103], v[28:31]
    buffer_load_dwordx4 v153, s[28:31], s55 offen offset:0 sc1 lds
    v_mfma_f32_16x16x32_bf16 v[24:27], a[128:131], a[104:107], v[24:27]
    v_mfma_f32_16x16x32_bf16 v[28:31], a[132:135], a[104:107], v[28:31]
    buffer_load_dwordx4 v153, s[28:31], s55 offen offset:1024 sc1 lds
    v_mfma_f32_16x16x32_bf16 v[32:35], a[136:139], a[104:107], v[32:35]
    ds_read_b64 a[64:65], v152 offset:3712
    s_waitcnt lgkmcnt(14)
    v_mfma_f32_16x16x32_bf16 v[28:31], a[140:143], a[96:99], v[28:31]
    ds_read_b64 a[66:67], v152 offset:3720
    v_mfma_f32_16x16x32_bf16 v[32:35], a[140:143], a[100:103], v[32:35]
    ds_read_b128 a[32:35], v151 offset:128
    v_mfma_f32_16x16x32_bf16 v[36:39], a[140:143], a[104:107], v[36:39]
    ds_read_b64 a[68:69], v152 offset:3200
    s_waitcnt lgkmcnt(15)
    v_mfma_f32_16x16x32_bf16 v[28:31], a[128:131], a[108:111], v[28:31]
    ds_read_b64 a[70:71], v152 offset:3208
    v_mfma_f32_16x16x32_bf16 v[32:35], a[132:135], a[108:111], v[32:35]
    ds_read_b128 a[36:39], v151 offset:640
    v_mfma_f32_16x16x32_bf16 v[36:39], a[136:139], a[108:111], v[36:39]
    ds_read_b64 a[72:73], v152 offset:2688
    v_mfma_f32_16x16x32_bf16 v[40:43], a[140:143], a[108:111], v[40:43]
    ds_read_b64 a[74:75], v152 offset:2696
    s_waitcnt lgkmcnt(15)
    v_mfma_f32_16x16x32_bf16 v[32:35], a[144:147], a[96:99], v[32:35]
    ds_read_b128 a[40:43], v151 offset:1152
    v_mfma_f32_16x16x32_bf16 v[36:39], a[144:147], a[100:103], v[36:39]
    ds_read_b64 a[76:77], v152 offset:2176
    v_mfma_f32_16x16x32_bf16 v[40:43], a[144:147], a[104:107], v[40:43]
    ds_read_b64 a[78:79], v152 offset:2184
    v_mfma_f32_16x16x32_bf16 v[44:47], a[144:147], a[108:111], v[44:47]
    ds_read_b128 a[44:47], v151 offset:1664
    v_mfma_f32_16x16x32_bf16 v[32:35], a[128:131], a[112:115], v[32:35]
    ds_read_b64 a[80:81], v152 offset:1664
    v_mfma_f32_16x16x32_bf16 v[36:39], a[132:135], a[112:115], v[36:39]
    ds_read_b64 a[82:83], v152 offset:1672
    v_mfma_f32_16x16x32_bf16 v[40:43], a[136:139], a[112:115], v[40:43]
    ds_read_b128 a[48:51], v151 offset:2176
    v_mfma_f32_16x16x32_bf16 v[44:47], a[140:143], a[112:115], v[44:47]
    ds_read_b64 a[84:85], v152 offset:1152
    v_mfma_f32_16x16x32_bf16 v[36:39], a[148:151], a[96:99], v[36:39]
    ds_read_b64 a[86:87], v152 offset:1160
    v_mfma_f32_16x16x32_bf16 v[40:43], a[148:151], a[100:103], v[40:43]
    ds_read_b128 a[52:55], v151 offset:2688
    v_mfma_f32_16x16x32_bf16 v[44:47], a[148:151], a[104:107], v[44:47]
    ds_read_b64 a[88:89], v152 offset:640
    s_waitcnt lgkmcnt(15)
    v_mfma_f32_16x16x32_bf16 v[36:39], a[128:131], a[116:119], v[36:39]
    ds_read_b64 a[90:91], v152 offset:648
    v_mfma_f32_16x16x32_bf16 v[40:43], a[132:135], a[116:119], v[40:43]
    ds_read_b128 a[56:59], v151 offset:3200
    v_mfma_f32_16x16x32_bf16 v[44:47], a[136:139], a[116:119], v[44:47]
    ds_read_b64 a[92:93], v152 offset:128
    v_mfma_f32_16x16x32_bf16 v[40:43], a[152:155], a[96:99], v[40:43]
    ds_read_b64 a[94:95], v152 offset:136
    v_mfma_f32_16x16x32_bf16 v[44:47], a[152:155], a[100:103], v[44:47]
    ds_read_b128 a[60:63], v151 offset:3712
    v_mfma_f32_16x16x32_bf16 v[40:43], a[128:131], a[120:123], v[40:43]
    v_mfma_f32_16x16x32_bf16 v[44:47], a[132:135], a[120:123], v[44:47]
    v_mfma_f32_16x16x32_bf16 v[44:47], a[156:159], a[96:99], v[44:47]
    v_mfma_f32_16x16x32_bf16 v[44:47], a[128:131], a[124:127], v[44:47]
    s_lshl_b32 s54, s45, 8
    buffer_load_dword v140, v155, s[12:15], s54 offen
    buffer_load_dword v141, v155, s[16:19], s54 offen
    buffer_load_dword v142, v155, s[20:23], s54 offen
    buffer_load_dword v143, v155, s[24:27], s54 offen
    s_lshl_b32 s54, s45, 1
    buffer_load_ushort v144, off, s[36:39], s54
    buffer_load_ushort v145, off, s[56:59], s54
    v_mfma_f32_16x16x32_bf16 v[16:19], a[64:67], a[32:35], v[16:19]
    s_waitcnt lgkmcnt(15)
    v_mfma_f32_16x16x32_bf16 v[20:23], a[68:71], a[32:35], v[20:23]
    buffer_load_dwordx4 v153, s[28:31], s55 offen offset:2048 sc1 lds
    v_mfma_f32_16x16x32_bf16 v[20:23], a[64:67], a[36:39], v[20:23]
    v_mfma_f32_16x16x32_bf16 v[24:27], a[68:71], a[36:39], v[24:27]
    buffer_load_dwordx4 v153, s[28:31], s55 offen offset:3072 sc1 lds
    v_mfma_f32_16x16x32_bf16 v[24:27], a[72:75], a[32:35], v[24:27]
    v_mfma_f32_16x16x32_bf16 v[28:31], a[72:75], a[36:39], v[28:31]
    s_add_u32 s55, s55, 2
    v_mfma_f32_16x16x32_bf16 v[24:27], a[64:67], a[40:43], v[24:27]
    v_mfma_f32_16x16x32_bf16 v[28:31], a[68:71], a[40:43], v[28:31]
    s_add_u32 m0, s46, 4160
    v_mfma_f32_16x16x32_bf16 v[32:35], a[72:75], a[40:43], v[32:35]
    ds_read_b64 a[128:129], v152 offset:3776
    s_waitcnt lgkmcnt(14)
    v_mfma_f32_16x16x32_bf16 v[28:31], a[76:79], a[32:35], v[28:31]
    ds_read_b64 a[130:131], v152 offset:3784
    v_mfma_f32_16x16x32_bf16 v[32:35], a[76:79], a[36:39], v[32:35]
    ds_read_b128 a[96:99], v151 offset:192
    v_mfma_f32_16x16x32_bf16 v[36:39], a[76:79], a[40:43], v[36:39]
    ds_read_b64 a[132:133], v152 offset:3264
    s_waitcnt lgkmcnt(15)
    v_mfma_f32_16x16x32_bf16 v[28:31], a[64:67], a[44:47], v[28:31]
    ds_read_b64 a[134:135], v152 offset:3272
    v_mfma_f32_16x16x32_bf16 v[32:35], a[68:71], a[44:47], v[32:35]
    ds_read_b128 a[100:103], v151 offset:704
    v_mfma_f32_16x16x32_bf16 v[36:39], a[72:75], a[44:47], v[36:39]
    ds_read_b64 a[136:137], v152 offset:2752
    v_mfma_f32_16x16x32_bf16 v[40:43], a[76:79], a[44:47], v[40:43]
    ds_read_b64 a[138:139], v152 offset:2760
    s_waitcnt lgkmcnt(15)
    v_mfma_f32_16x16x32_bf16 v[32:35], a[80:83], a[32:35], v[32:35]
    ds_read_b128 a[104:107], v151 offset:1216
    v_mfma_f32_16x16x32_bf16 v[36:39], a[80:83], a[36:39], v[36:39]
    ds_read_b64 a[140:141], v152 offset:2240
    v_mfma_f32_16x16x32_bf16 v[40:43], a[80:83], a[40:43], v[40:43]
    ds_read_b64 a[142:143], v152 offset:2248
    v_mfma_f32_16x16x32_bf16 v[44:47], a[80:83], a[44:47], v[44:47]
    ds_read_b128 a[108:111], v151 offset:1728
    v_mfma_f32_16x16x32_bf16 v[32:35], a[64:67], a[48:51], v[32:35]
    ds_read_b64 a[144:145], v152 offset:1728
    v_mfma_f32_16x16x32_bf16 v[36:39], a[68:71], a[48:51], v[36:39]
    ds_read_b64 a[146:147], v152 offset:1736
    v_mfma_f32_16x16x32_bf16 v[40:43], a[72:75], a[48:51], v[40:43]
    ds_read_b128 a[112:115], v151 offset:2240
    v_mfma_f32_16x16x32_bf16 v[44:47], a[76:79], a[48:51], v[44:47]
    ds_read_b64 a[148:149], v152 offset:1216
    v_mfma_f32_16x16x32_bf16 v[36:39], a[84:87], a[32:35], v[36:39]
    ds_read_b64 a[150:151], v152 offset:1224
    v_mfma_f32_16x16x32_bf16 v[40:43], a[84:87], a[36:39], v[40:43]
    ds_read_b128 a[116:119], v151 offset:2752
    v_mfma_f32_16x16x32_bf16 v[44:47], a[84:87], a[40:43], v[44:47]
    ds_read_b64 a[152:153], v152 offset:704
    s_waitcnt lgkmcnt(15)
    v_mfma_f32_16x16x32_bf16 v[36:39], a[64:67], a[52:55], v[36:39]
    ds_read_b64 a[154:155], v152 offset:712
    v_mfma_f32_16x16x32_bf16 v[40:43], a[68:71], a[52:55], v[40:43]
    ds_read_b128 a[120:123], v151 offset:3264
    v_mfma_f32_16x16x32_bf16 v[44:47], a[72:75], a[52:55], v[44:47]
    ds_read_b64 a[156:157], v152 offset:192
    v_mfma_f32_16x16x32_bf16 v[40:43], a[88:91], a[32:35], v[40:43]
    ds_read_b64 a[158:159], v152 offset:200
    v_mfma_f32_16x16x32_bf16 v[44:47], a[88:91], a[36:39], v[44:47]
    ds_read_b128 a[124:127], v151 offset:3776
    v_mfma_f32_16x16x32_bf16 v[40:43], a[64:67], a[56:59], v[40:43]
    v_mfma_f32_16x16x32_bf16 v[44:47], a[68:71], a[56:59], v[44:47]
    v_mfma_f32_16x16x32_bf16 v[44:47], a[92:95], a[32:35], v[44:47]
    v_mfma_f32_16x16x32_bf16 v[44:47], a[64:67], a[60:63], v[44:47]
    v_mfma_f32_16x16x32_bf16 v[16:19], a[128:131], a[96:99], v[16:19]
    s_waitcnt lgkmcnt(15)
    v_mfma_f32_16x16x32_bf16 v[20:23], a[132:135], a[96:99], v[20:23]
    buffer_load_dwordx4 v153, s[28:31], s55 offen offset:0 sc1 lds
    v_mfma_f32_16x16x32_bf16 v[20:23], a[128:131], a[100:103], v[20:23]
    v_mfma_f32_16x16x32_bf16 v[24:27], a[132:135], a[100:103], v[24:27]
    buffer_load_dwordx4 v153, s[28:31], s55 offen offset:1024 sc1 lds
    v_mfma_f32_16x16x32_bf16 v[24:27], a[136:139], a[96:99], v[24:27]
    v_mfma_f32_16x16x32_bf16 v[28:31], a[136:139], a[100:103], v[28:31]
    buffer_load_dwordx4 v153, s[28:31], s55 offen offset:2048 sc1 lds
    v_mfma_f32_16x16x32_bf16 v[24:27], a[128:131], a[104:107], v[24:27]
    v_mfma_f32_16x16x32_bf16 v[28:31], a[132:135], a[104:107], v[28:31]
    buffer_load_dwordx4 v153, s[28:31], s55 offen offset:3072 sc1 lds
    v_mfma_f32_16x16x32_bf16 v[32:35], a[136:139], a[104:107], v[32:35]
    ds_read_b64 a[64:65], v152 offset:3840
    s_waitcnt lgkmcnt(14)
    v_mfma_f32_16x16x32_bf16 v[28:31], a[140:143], a[96:99], v[28:31]
    ds_read_b64 a[66:67], v152 offset:3848
    v_mfma_f32_16x16x32_bf16 v[32:35], a[140:143], a[100:103], v[32:35]
    ds_read_b128 a[32:35], v151 offset:256
    v_mfma_f32_16x16x32_bf16 v[36:39], a[140:143], a[104:107], v[36:39]
    ds_read_b64 a[68:69], v152 offset:3328
    s_waitcnt lgkmcnt(15)
    v_mfma_f32_16x16x32_bf16 v[28:31], a[128:131], a[108:111], v[28:31]
    ds_read_b64 a[70:71], v152 offset:3336
    v_mfma_f32_16x16x32_bf16 v[32:35], a[132:135], a[108:111], v[32:35]
    ds_read_b128 a[36:39], v151 offset:768
    v_mfma_f32_16x16x32_bf16 v[36:39], a[136:139], a[108:111], v[36:39]
    ds_read_b64 a[72:73], v152 offset:2816
    v_mfma_f32_16x16x32_bf16 v[40:43], a[140:143], a[108:111], v[40:43]
    ds_read_b64 a[74:75], v152 offset:2824
    s_waitcnt lgkmcnt(15)
    v_mfma_f32_16x16x32_bf16 v[32:35], a[144:147], a[96:99], v[32:35]
    ds_read_b128 a[40:43], v151 offset:1280
    v_mfma_f32_16x16x32_bf16 v[36:39], a[144:147], a[100:103], v[36:39]
    ds_read_b64 a[76:77], v152 offset:2304
    v_mfma_f32_16x16x32_bf16 v[40:43], a[144:147], a[104:107], v[40:43]
    ds_read_b64 a[78:79], v152 offset:2312
    v_mfma_f32_16x16x32_bf16 v[44:47], a[144:147], a[108:111], v[44:47]
    ds_read_b128 a[44:47], v151 offset:1792
    v_mfma_f32_16x16x32_bf16 v[32:35], a[128:131], a[112:115], v[32:35]
    ds_read_b64 a[80:81], v152 offset:1792
    v_mfma_f32_16x16x32_bf16 v[36:39], a[132:135], a[112:115], v[36:39]
    ds_read_b64 a[82:83], v152 offset:1800
    v_mfma_f32_16x16x32_bf16 v[40:43], a[136:139], a[112:115], v[40:43]
    ds_read_b128 a[48:51], v151 offset:2304
    v_mfma_f32_16x16x32_bf16 v[44:47], a[140:143], a[112:115], v[44:47]
    ds_read_b64 a[84:85], v152 offset:1280
    v_mfma_f32_16x16x32_bf16 v[36:39], a[148:151], a[96:99], v[36:39]
    ds_read_b64 a[86:87], v152 offset:1288
    v_mfma_f32_16x16x32_bf16 v[40:43], a[148:151], a[100:103], v[40:43]
    ds_read_b128 a[52:55], v151 offset:2816
    v_mfma_f32_16x16x32_bf16 v[44:47], a[148:151], a[104:107], v[44:47]
    ds_read_b64 a[88:89], v152 offset:768
    s_waitcnt lgkmcnt(15)
    v_mfma_f32_16x16x32_bf16 v[36:39], a[128:131], a[116:119], v[36:39]
    ds_read_b64 a[90:91], v152 offset:776
    v_mfma_f32_16x16x32_bf16 v[40:43], a[132:135], a[116:119], v[40:43]
    ds_read_b128 a[56:59], v151 offset:3328
    v_mfma_f32_16x16x32_bf16 v[44:47], a[136:139], a[116:119], v[44:47]
    ds_read_b64 a[92:93], v152 offset:256
    v_mfma_f32_16x16x32_bf16 v[40:43], a[152:155], a[96:99], v[40:43]
    ds_read_b64 a[94:95], v152 offset:264
    v_mfma_f32_16x16x32_bf16 v[44:47], a[152:155], a[100:103], v[44:47]
    ds_read_b128 a[60:63], v151 offset:3840
    v_mfma_f32_16x16x32_bf16 v[40:43], a[128:131], a[120:123], v[40:43]
    v_mfma_f32_16x16x32_bf16 v[44:47], a[132:135], a[120:123], v[44:47]
    v_mfma_f32_16x16x32_bf16 v[44:47], a[156:159], a[96:99], v[44:47]
    v_mfma_f32_16x16x32_bf16 v[44:47], a[128:131], a[124:127], v[44:47]
    v_mfma_f32_16x16x32_bf16 v[16:19], a[64:67], a[32:35], v[16:19]
    s_waitcnt lgkmcnt(15)
    v_mfma_f32_16x16x32_bf16 v[20:23], a[68:71], a[32:35], v[20:23]
    s_add_u32 s55, s55, 2
    v_mfma_f32_16x16x32_bf16 v[20:23], a[64:67], a[36:39], v[20:23]
    v_mfma_f32_16x16x32_bf16 v[24:27], a[68:71], a[36:39], v[24:27]
    s_add_u32 m0, s46, 8320
    v_mfma_f32_16x16x32_bf16 v[24:27], a[72:75], a[32:35], v[24:27]
    v_mfma_f32_16x16x32_bf16 v[28:31], a[72:75], a[36:39], v[28:31]
    buffer_load_dwordx4 v153, s[28:31], s55 offen offset:0 sc1 lds
    v_mfma_f32_16x16x32_bf16 v[24:27], a[64:67], a[40:43], v[24:27]
    v_mfma_f32_16x16x32_bf16 v[28:31], a[68:71], a[40:43], v[28:31]
    buffer_load_dwordx4 v153, s[28:31], s55 offen offset:1024 sc1 lds
    v_mfma_f32_16x16x32_bf16 v[32:35], a[72:75], a[40:43], v[32:35]
    ds_read_b64 a[128:129], v152 offset:3904
    s_waitcnt lgkmcnt(14)
    v_mfma_f32_16x16x32_bf16 v[28:31], a[76:79], a[32:35], v[28:31]
    ds_read_b64 a[130:131], v152 offset:3912
    v_mfma_f32_16x16x32_bf16 v[32:35], a[76:79], a[36:39], v[32:35]
    ds_read_b128 a[96:99], v151 offset:320
    v_mfma_f32_16x16x32_bf16 v[36:39], a[76:79], a[40:43], v[36:39]
    ds_read_b64 a[132:133], v152 offset:3392
    s_waitcnt lgkmcnt(15)
    v_mfma_f32_16x16x32_bf16 v[28:31], a[64:67], a[44:47], v[28:31]
    ds_read_b64 a[134:135], v152 offset:3400
    v_mfma_f32_16x16x32_bf16 v[32:35], a[68:71], a[44:47], v[32:35]
    ds_read_b128 a[100:103], v151 offset:832
    v_mfma_f32_16x16x32_bf16 v[36:39], a[72:75], a[44:47], v[36:39]
    ds_read_b64 a[136:137], v152 offset:2880
    v_mfma_f32_16x16x32_bf16 v[40:43], a[76:79], a[44:47], v[40:43]
    ds_read_b64 a[138:139], v152 offset:2888
    s_waitcnt lgkmcnt(15)
    v_mfma_f32_16x16x32_bf16 v[32:35], a[80:83], a[32:35], v[32:35]
    ds_read_b128 a[104:107], v151 offset:1344
    v_mfma_f32_16x16x32_bf16 v[36:39], a[80:83], a[36:39], v[36:39]
    ds_read_b64 a[140:141], v152 offset:2368
    v_mfma_f32_16x16x32_bf16 v[40:43], a[80:83], a[40:43], v[40:43]
    ds_read_b64 a[142:143], v152 offset:2376
    v_mfma_f32_16x16x32_bf16 v[44:47], a[80:83], a[44:47], v[44:47]
    ds_read_b128 a[108:111], v151 offset:1856
    v_mfma_f32_16x16x32_bf16 v[32:35], a[64:67], a[48:51], v[32:35]
    ds_read_b64 a[144:145], v152 offset:1856
    v_mfma_f32_16x16x32_bf16 v[36:39], a[68:71], a[48:51], v[36:39]
    ds_read_b64 a[146:147], v152 offset:1864
    v_mfma_f32_16x16x32_bf16 v[40:43], a[72:75], a[48:51], v[40:43]
    ds_read_b128 a[112:115], v151 offset:2368
    v_mfma_f32_16x16x32_bf16 v[44:47], a[76:79], a[48:51], v[44:47]
    ds_read_b64 a[148:149], v152 offset:1344
    v_mfma_f32_16x16x32_bf16 v[36:39], a[84:87], a[32:35], v[36:39]
    ds_read_b64 a[150:151], v152 offset:1352
    v_mfma_f32_16x16x32_bf16 v[40:43], a[84:87], a[36:39], v[40:43]
    ds_read_b128 a[116:119], v151 offset:2880
    v_mfma_f32_16x16x32_bf16 v[44:47], a[84:87], a[40:43], v[44:47]
    ds_read_b64 a[152:153], v152 offset:832
    s_waitcnt lgkmcnt(15)
    v_mfma_f32_16x16x32_bf16 v[36:39], a[64:67], a[52:55], v[36:39]
    ds_read_b64 a[154:155], v152 offset:840
    v_mfma_f32_16x16x32_bf16 v[40:43], a[68:71], a[52:55], v[40:43]
    ds_read_b128 a[120:123], v151 offset:3392
    v_mfma_f32_16x16x32_bf16 v[44:47], a[72:75], a[52:55], v[44:47]
    ds_read_b64 a[156:157], v152 offset:320
    v_mfma_f32_16x16x32_bf16 v[40:43], a[88:91], a[32:35], v[40:43]
    ds_read_b64 a[158:159], v152 offset:328
    v_mfma_f32_16x16x32_bf16 v[44:47], a[88:91], a[36:39], v[44:47]
    ds_read_b128 a[124:127], v151 offset:3904
    v_mfma_f32_16x16x32_bf16 v[40:43], a[64:67], a[56:59], v[40:43]
    v_mfma_f32_16x16x32_bf16 v[44:47], a[68:71], a[56:59], v[44:47]
    v_mfma_f32_16x16x32_bf16 v[44:47], a[92:95], a[32:35], v[44:47]
    v_mfma_f32_16x16x32_bf16 v[44:47], a[64:67], a[60:63], v[44:47]
    v_mfma_f32_16x16x32_bf16 v[16:19], a[128:131], a[96:99], v[16:19]
    s_waitcnt lgkmcnt(15)
    v_mfma_f32_16x16x32_bf16 v[20:23], a[132:135], a[96:99], v[20:23]
    buffer_load_dwordx4 v153, s[28:31], s55 offen offset:2048 sc1 lds
    v_mfma_f32_16x16x32_bf16 v[20:23], a[128:131], a[100:103], v[20:23]
    v_mfma_f32_16x16x32_bf16 v[24:27], a[132:135], a[100:103], v[24:27]
    buffer_load_dwordx4 v153, s[28:31], s55 offen offset:3072 sc1 lds
    v_mfma_f32_16x16x32_bf16 v[24:27], a[136:139], a[96:99], v[24:27]
    v_mfma_f32_16x16x32_bf16 v[28:31], a[136:139], a[100:103], v[28:31]
    s_add_u32 s55, s55, 2
    v_mfma_f32_16x16x32_bf16 v[24:27], a[128:131], a[104:107], v[24:27]
    v_mfma_f32_16x16x32_bf16 v[28:31], a[132:135], a[104:107], v[28:31]
    s_add_u32 m0, s46, 12480
    v_mfma_f32_16x16x32_bf16 v[32:35], a[136:139], a[104:107], v[32:35]
    ds_read_b64 a[64:65], v152 offset:3968
    s_waitcnt lgkmcnt(14)
    v_mfma_f32_16x16x32_bf16 v[28:31], a[140:143], a[96:99], v[28:31]
    ds_read_b64 a[66:67], v152 offset:3976
    v_mfma_f32_16x16x32_bf16 v[32:35], a[140:143], a[100:103], v[32:35]
    ds_read_b128 a[32:35], v151 offset:384
    v_mfma_f32_16x16x32_bf16 v[36:39], a[140:143], a[104:107], v[36:39]
    ds_read_b64 a[68:69], v152 offset:3456
    s_waitcnt lgkmcnt(15)
    v_mfma_f32_16x16x32_bf16 v[28:31], a[128:131], a[108:111], v[28:31]
    ds_read_b64 a[70:71], v152 offset:3464
    v_mfma_f32_16x16x32_bf16 v[32:35], a[132:135], a[108:111], v[32:35]
    ds_read_b128 a[36:39], v151 offset:896
    v_mfma_f32_16x16x32_bf16 v[36:39], a[136:139], a[108:111], v[36:39]
    ds_read_b64 a[72:73], v152 offset:2944
    v_mfma_f32_16x16x32_bf16 v[40:43], a[140:143], a[108:111], v[40:43]
    ds_read_b64 a[74:75], v152 offset:2952
    s_waitcnt lgkmcnt(15)
    v_mfma_f32_16x16x32_bf16 v[32:35], a[144:147], a[96:99], v[32:35]
    ds_read_b128 a[40:43], v151 offset:1408
    v_mfma_f32_16x16x32_bf16 v[36:39], a[144:147], a[100:103], v[36:39]
    ds_read_b64 a[76:77], v152 offset:2432
    v_mfma_f32_16x16x32_bf16 v[40:43], a[144:147], a[104:107], v[40:43]
    ds_read_b64 a[78:79], v152 offset:2440
    v_mfma_f32_16x16x32_bf16 v[44:47], a[144:147], a[108:111], v[44:47]
    ds_read_b128 a[44:47], v151 offset:1920
    v_mfma_f32_16x16x32_bf16 v[32:35], a[128:131], a[112:115], v[32:35]
    ds_read_b64 a[80:81], v152 offset:1920
    v_mfma_f32_16x16x32_bf16 v[36:39], a[132:135], a[112:115], v[36:39]
    ds_read_b64 a[82:83], v152 offset:1928
    v_mfma_f32_16x16x32_bf16 v[40:43], a[136:139], a[112:115], v[40:43]
    ds_read_b128 a[48:51], v151 offset:2432
    v_mfma_f32_16x16x32_bf16 v[44:47], a[140:143], a[112:115], v[44:47]
    ds_read_b64 a[84:85], v152 offset:1408
    v_mfma_f32_16x16x32_bf16 v[36:39], a[148:151], a[96:99], v[36:39]
    ds_read_b64 a[86:87], v152 offset:1416
    v_mfma_f32_16x16x32_bf16 v[40:43], a[148:151], a[100:103], v[40:43]
    ds_read_b128 a[52:55], v151 offset:2944
    v_mfma_f32_16x16x32_bf16 v[44:47], a[148:151], a[104:107], v[44:47]
    ds_read_b64 a[88:89], v152 offset:896
    s_waitcnt lgkmcnt(15)
    v_mfma_f32_16x16x32_bf16 v[36:39], a[128:131], a[116:119], v[36:39]
    ds_read_b64 a[90:91], v152 offset:904
    v_mfma_f32_16x16x32_bf16 v[40:43], a[132:135], a[116:119], v[40:43]
    ds_read_b128 a[56:59], v151 offset:3456
    v_mfma_f32_16x16x32_bf16 v[44:47], a[136:139], a[116:119], v[44:47]
    ds_read_b64 a[92:93], v152 offset:384
    v_mfma_f32_16x16x32_bf16 v[40:43], a[152:155], a[96:99], v[40:43]
    ds_read_b64 a[94:95], v152 offset:392
    v_mfma_f32_16x16x32_bf16 v[44:47], a[152:155], a[100:103], v[44:47]
    ds_read_b128 a[60:63], v151 offset:3968
    v_mfma_f32_16x16x32_bf16 v[40:43], a[128:131], a[120:123], v[40:43]
    v_mfma_f32_16x16x32_bf16 v[44:47], a[132:135], a[120:123], v[44:47]
L_pv3:
    s_cbranch_execz L_pvb
    v_mfma_f32_16x16x32_bf16 v[44:47], a[156:159], a[96:99], v[44:47]
    v_mfma_f32_16x16x32_bf16 v[44:47], a[128:131], a[124:127], v[44:47]
    v_mfma_f32_16x16x32_bf16 v[16:19], a[64:67], a[32:35], v[16:19]
    s_waitcnt lgkmcnt(15)
    v_mfma_f32_16x16x32_bf16 v[20:23], a[68:71], a[32:35], v[20:23]
    buffer_load_dwordx4 v153, s[28:31], s55 offen offset:0 sc1 lds
    v_mfma_f32_16x16x32_bf16 v[20:23], a[64:67], a[36:39], v[20:23]
    v_mfma_f32_16x16x32_bf16 v[24:27], a[68:71], a[36:39], v[24:27]
    buffer_load_dwordx4 v153, s[28:31], s55 offen offset:1024 sc1 lds
    v_mfma_f32_16x16x32_bf16 v[24:27], a[72:75], a[32:35], v[24:27]
    v_mfma_f32_16x16x32_bf16 v[28:31], a[72:75], a[36:39], v[28:31]
    buffer_load_dwordx4 v153, s[28:31], s55 offen offset:2048 sc1 lds
    v_mfma_f32_16x16x32_bf16 v[24:27], a[64:67], a[40:43], v[24:27]
    v_mfma_f32_16x16x32_bf16 v[28:31], a[68:71], a[40:43], v[28:31]
    buffer_load_dwordx4 v153, s[28:31], s55 offen offset:3072 sc1 lds
    v_mfma_f32_16x16x32_bf16 v[32:35], a[72:75], a[40:43], v[32:35]
    ds_read_b64 a[128:129], v152 offset:4032
    s_waitcnt lgkmcnt(14)
    v_mfma_f32_16x16x32_bf16 v[28:31], a[76:79], a[32:35], v[28:31]
    ds_read_b64 a[130:131], v152 offset:4040
    v_mfma_f32_16x16x32_bf16 v[32:35], a[76:79], a[36:39], v[32:35]
    ds_read_b128 a[96:99], v151 offset:448
    v_mfma_f32_16x16x32_bf16 v[36:39], a[76:79], a[40:43], v[36:39]
    ds_read_b64 a[132:133], v152 offset:3520
    s_waitcnt lgkmcnt(15)
    v_mfma_f32_16x16x32_bf16 v[28:31], a[64:67], a[44:47], v[28:31]
    ds_read_b64 a[134:135], v152 offset:3528
    v_mfma_f32_16x16x32_bf16 v[32:35], a[68:71], a[44:47], v[32:35]
    ds_read_b128 a[100:103], v151 offset:960
    v_mfma_f32_16x16x32_bf16 v[36:39], a[72:75], a[44:47], v[36:39]
    ds_read_b64 a[136:137], v152 offset:3008
    v_mfma_f32_16x16x32_bf16 v[40:43], a[76:79], a[44:47], v[40:43]
    ds_read_b64 a[138:139], v152 offset:3016
    s_waitcnt lgkmcnt(15)
    v_mfma_f32_16x16x32_bf16 v[32:35], a[80:83], a[32:35], v[32:35]
    ds_read_b128 a[104:107], v151 offset:1472
    v_mfma_f32_16x16x32_bf16 v[36:39], a[80:83], a[36:39], v[36:39]
    ds_read_b64 a[140:141], v152 offset:2496
    v_mfma_f32_16x16x32_bf16 v[40:43], a[80:83], a[40:43], v[40:43]
    ds_read_b64 a[142:143], v152 offset:2504
    v_mfma_f32_16x16x32_bf16 v[44:47], a[80:83], a[44:47], v[44:47]
    ds_read_b128 a[108:111], v151 offset:1984
    v_mfma_f32_16x16x32_bf16 v[32:35], a[64:67], a[48:51], v[32:35]
    ds_read_b64 a[144:145], v152 offset:1984
    v_mfma_f32_16x16x32_bf16 v[36:39], a[68:71], a[48:51], v[36:39]
    ds_read_b64 a[146:147], v152 offset:1992
    v_mfma_f32_16x16x32_bf16 v[40:43], a[72:75], a[48:51], v[40:43]
    ds_read_b128 a[112:115], v151 offset:2496
    v_mfma_f32_16x16x32_bf16 v[44:47], a[76:79], a[48:51], v[44:47]
    ds_read_b64 a[148:149], v152 offset:1472
    v_mfma_f32_16x16x32_bf16 v[36:39], a[84:87], a[32:35], v[36:39]
    ds_read_b64 a[150:151], v152 offset:1480
    v_mfma_f32_16x16x32_bf16 v[40:43], a[84:87], a[36:39], v[40:43]
    ds_read_b128 a[116:119], v151 offset:3008
    v_mfma_f32_16x16x32_bf16 v[44:47], a[84:87], a[40:43], v[44:47]
    ds_read_b64 a[152:153], v152 offset:960
    s_waitcnt lgkmcnt(15)
    v_mfma_f32_16x16x32_bf16 v[36:39], a[64:67], a[52:55], v[36:39]
    ds_read_b64 a[154:155], v152 offset:968
    v_mfma_f32_16x16x32_bf16 v[40:43], a[68:71], a[52:55], v[40:43]
    ds_read_b128 a[120:123], v151 offset:3520
    v_mfma_f32_16x16x32_bf16 v[44:47], a[72:75], a[52:55], v[44:47]
    ds_read_b64 a[156:157], v152 offset:448
    v_mfma_f32_16x16x32_bf16 v[40:43], a[88:91], a[32:35], v[40:43]
    ds_read_b64 a[158:159], v152 offset:456
    v_mfma_f32_16x16x32_bf16 v[44:47], a[88:91], a[36:39], v[44:47]
    ds_read_b128 a[124:127], v151 offset:4032
    v_mfma_f32_16x16x32_bf16 v[40:43], a[64:67], a[56:59], v[40:43]
    v_mfma_f32_16x16x32_bf16 v[44:47], a[68:71], a[56:59], v[44:47]
    v_mfma_f32_16x16x32_bf16 v[44:47], a[92:95], a[32:35], v[44:47]
    v_mfma_f32_16x16x32_bf16 v[44:47], a[64:67], a[60:63], v[44:47]
    v_mfma_f32_16x16x32_bf16 v[16:19], a[128:131], a[96:99], v[16:19]
    s_waitcnt lgkmcnt(15)
    v_mfma_f32_16x16x32_bf16 v[20:23], a[132:135], a[96:99], v[20:23]
    v_mfma_f32_16x16x32_bf16 v[20:23], a[128:131], a[100:103], v[20:23]
    v_mfma_f32_16x16x32_bf16 v[24:27], a[132:135], a[100:103], v[24:27]
    v_mfma_f32_16x16x32_bf16 v[24:27], a[136:139], a[96:99], v[24:27]
    v_mfma_f32_16x16x32_bf16 v[28:31], a[136:139], a[100:103], v[28:31]
    v_mfma_f32_16x16x32_bf16 v[24:27], a[128:131], a[104:107], v[24:27]
    v_mfma_f32_16x16x32_bf16 v[28:31], a[132:135], a[104:107], v[28:31]
    v_mfma_f32_16x16x32_bf16 v[32:35], a[136:139], a[104:107], v[32:35]
    s_waitcnt lgkmcnt(13)
    v_mfma_f32_16x16x32_bf16 v[28:31], a[140:143], a[96:99], v[28:31]
    v_mfma_f32_16x16x32_bf16 v[32:35], a[140:143], a[100:103], v[32:35]
    v_mfma_f32_16x16x32_bf16 v[36:39], a[140:143], a[104:107], v[36:39]
    s_waitcnt lgkmcnt(12)
    v_mfma_f32_16x16x32_bf16 v[28:31], a[128:131], a[108:111], v[28:31]
    v_mfma_f32_16x16x32_bf16 v[32:35], a[132:135], a[108:111], v[32:35]
    v_mfma_f32_16x16x32_bf16 v[36:39], a[136:139], a[108:111], v[36:39]
    v_mfma_f32_16x16x32_bf16 v[40:43], a[140:143], a[108:111], v[40:43]
    s_waitcnt lgkmcnt(10)
    v_mfma_f32_16x16x32_bf16 v[32:35], a[144:147], a[96:99], v[32:35]
    v_mfma_f32_16x16x32_bf16 v[36:39], a[144:147], a[100:103], v[36:39]
    v_mfma_f32_16x16x32_bf16 v[40:43], a[144:147], a[104:107], v[40:43]
    v_mfma_f32_16x16x32_bf16 v[44:47], a[144:147], a[108:111], v[44:47]
    s_waitcnt lgkmcnt(9)
    v_mfma_f32_16x16x32_bf16 v[32:35], a[128:131], a[112:115], v[32:35]
    v_mfma_f32_16x16x32_bf16 v[36:39], a[132:135], a[112:115], v[36:39]
    v_mfma_f32_16x16x32_bf16 v[40:43], a[136:139], a[112:115], v[40:43]
    v_mfma_f32_16x16x32_bf16 v[44:47], a[140:143], a[112:115], v[44:47]
    s_waitcnt lgkmcnt(7)
    v_mfma_f32_16x16x32_bf16 v[36:39], a[148:151], a[96:99], v[36:39]
    v_mfma_f32_16x16x32_bf16 v[40:43], a[148:151], a[100:103], v[40:43]
    v_mfma_f32_16x16x32_bf16 v[44:47], a[148:151], a[104:107], v[44:47]
    s_waitcnt lgkmcnt(6)
    v_mfma_f32_16x16x32_bf16 v[36:39], a[128:131], a[116:119], v[36:39]
    v_mfma_f32_16x16x32_bf16 v[40:43], a[132:135], a[116:119], v[40:43]
    v_mfma_f32_16x16x32_bf16 v[44:47], a[136:139], a[116:119], v[44:47]
    s_waitcnt lgkmcnt(4)
    v_mfma_f32_16x16x32_bf16 v[40:43], a[152:155], a[96:99], v[40:43]
    v_mfma_f32_16x16x32_bf16 v[44:47], a[152:155], a[100:103], v[44:47]
    s_waitcnt lgkmcnt(3)
    v_mfma_f32_16x16x32_bf16 v[40:43], a[128:131], a[120:123], v[40:43]
    v_mfma_f32_16x16x32_bf16 v[44:47], a[132:135], a[120:123], v[44:47]
    s_waitcnt lgkmcnt(1)
    v_mfma_f32_16x16x32_bf16 v[44:47], a[156:159], a[96:99], v[44:47]
    s_waitcnt lgkmcnt(0)
    v_mfma_f32_16x16x32_bf16 v[44:47], a[128:131], a[124:127], v[44:47]
    s_nop 7
    s_lshl_b32 s55, s62, 12
    v_cvt_pk_bf16_f32 v48, v16, v17
    v_cvt_pk_bf16_f32 v49, v18, v19
    v_cvt_pk_bf16_f32 v50, v20, v21
    v_cvt_pk_bf16_f32 v51, v22, v23
    s_nop 1
    v_permlane16_swap_b32 v48, v50
    v_permlane16_swap_b32 v49, v51
    buffer_store_dwordx4 v[48:51], v154, s[32:35], s55 offen offset:0 sc1
    v_cvt_pk_bf16_f32 v52, v24, v25
    v_cvt_pk_bf16_f32 v53, v26, v27
    v_cvt_pk_bf16_f32 v54, v28, v29
    v_cvt_pk_bf16_f32 v55, v30, v31
    s_nop 1
    v_permlane16_swap_b32 v52, v54
    v_permlane16_swap_b32 v53, v55
    buffer_store_dwordx4 v[52:55], v154, s[32:35], s55 offen offset:1024 sc1
    v_cvt_pk_bf16_f32 v48, v32, v33
    v_cvt_pk_bf16_f32 v49, v34, v35
    v_cvt_pk_bf16_f32 v50, v36, v37
    v_cvt_pk_bf16_f32 v51, v38, v39
    s_nop 1
    v_permlane16_swap_b32 v48, v50
    v_permlane16_swap_b32 v49, v51
    buffer_store_dwordx4 v[48:51], v154, s[32:35], s55 offen offset:2048 sc1
    v_cvt_pk_bf16_f32 v52, v40, v41
    v_cvt_pk_bf16_f32 v53, v42, v43
    v_cvt_pk_bf16_f32 v54, v44, v45
    v_cvt_pk_bf16_f32 v55, v46, v47
    s_nop 1
    v_permlane16_swap_b32 v52, v54
    v_permlane16_swap_b32 v53, v55
    buffer_store_dwordx4 v[52:55], v154, s[32:35], s55 offen offset:3072 sc1
    v_cndmask_b32 v97, 0, v97, s[50:51]
    s_nop 10
    v_add_f32 v80, v80, v97
    v_cvt_pk_bf16_f32 v64, v80, v81
    v_cvt_pk_bf16_f32 v65, v82, v83
    ds_write_b64 v148, v[64:65]
    v_cvt_pk_bf16_f32 v66, v84, v84
    v_cvt_pk_bf16_f32 v67, v85, v86
    ds_write_b64 v148, v[66:67] offset:512
    v_cvt_pk_bf16_f32 v68, v87, v87
    v_cvt_pk_bf16_f32 v69, v87, v88
    v_cvt_pk_bf16_f32 v70, v88, v88
    v_cvt_pk_bf16_f32 v71, v89, v89
    ds_write_b128 v149, v[68:71] offset:1024
    v_cndmask_b32 v62, v91, v90, s[48:49]
    v_cvt_pk_bf16_f32 v72, v90, v90
    v_cvt_pk_bf16_f32 v73, v90, v90
    v_cvt_pk_bf16_f32 v74, v62, v91
    v_cvt_pk_bf16_f32 v75, v91, v91
    ds_write_b128 v150, v[72:75] offset:2048
    v_cndmask_b32 v62, v93, v92, s[48:49]
    v_cvt_pk_bf16_f32 v76, v92, v92
    v_cvt_pk_bf16_f32 v77, v92, v92
    v_cvt_pk_bf16_f32 v78, v62, v93
    v_cvt_pk_bf16_f32 v79, v93, v93
    ds_write_b128 v150, v[76:79] offset:2560
    s_waitcnt vmcnt(4) lgkmcnt(0)
    ds_read_b64 a[64:65], v162 offset:3584
    ds_read_b64 a[66:67], v162 offset:3592
    ds_read_b128 a[32:35], v151 offset:0
    ds_read_b64 a[68:69], v162 offset:3072
    ds_read_b64 a[70:71], v162 offset:3080
    ds_read_b128 a[36:39], v151 offset:512
    ds_read_b64 a[72:73], v162 offset:2560
    ds_read_b64 a[74:75], v162 offset:2568
    ds_read_b128 a[40:43], v151 offset:1024
    s_waitcnt lgkmcnt(6)
    v_mfma_f32_16x16x32_bf16 v[16:19], a[64:67], a[32:35], 0
    ds_read_b64 a[76:77], v162 offset:2048
    ds_read_b64 a[78:79], v162 offset:2056
    s_waitcnt lgkmcnt(6)
    v_mfma_f32_16x16x32_bf16 v[20:23], a[68:71], a[32:35], 0
    ds_read_b128 a[44:47], v151 offset:1536
    ds_read_b64 a[80:81], v162 offset:1536
    s_waitcnt lgkmcnt(7)
    v_mfma_f32_16x16x32_bf16 v[20:23], a[64:67], a[36:39], v[20:23]
    ds_read_b64 a[82:83], v162 offset:1544
    ds_read_b128 a[48:51], v151 offset:2048
    v_mfma_f32_16x16x32_bf16 v[24:27], a[68:71], a[36:39], 0
    ds_read_b64 a[84:85], v162 offset:1024
    ds_read_b64 a[86:87], v162 offset:1032
    s_waitcnt lgkmcnt(9)
    v_mfma_f32_16x16x32_bf16 v[24:27], a[72:75], a[32:35], v[24:27]
    ds_read_b128 a[52:55], v151 offset:2560
    ds_read_b64 a[88:89], v162 offset:512
    v_mfma_f32_16x16x32_bf16 v[28:31], a[72:75], a[36:39], 0
    ds_read_b64 a[90:91], v162 offset:520
    ds_read_b128 a[56:59], v151 offset:3072
    s_waitcnt lgkmcnt(12)
    v_mfma_f32_16x16x32_bf16 v[24:27], a[64:67], a[40:43], v[24:27]
    ds_read_b64 a[92:93], v162 offset:0
    v_mfma_f32_16x16x32_bf16 v[28:31], a[68:71], a[40:43], v[28:31]
    ds_read_b64 a[94:95], v162 offset:8
    v_mfma_f32_16x16x32_bf16 v[32:35], a[72:75], a[40:43], 0
    ds_read_b128 a[60:63], v151 offset:3584
    s_waitcnt lgkmcnt(13)
    v_mfma_f32_16x16x32_bf16 v[28:31], a[76:79], a[32:35], v[28:31]
    ds_read_b64 a[128:129], v162 offset:3648
    v_mfma_f32_16x16x32_bf16 v[32:35], a[76:79], a[36:39], v[32:35]
    ds_read_b64 a[130:131], v162 offset:3656
    v_mfma_f32_16x16x32_bf16 v[36:39], a[76:79], a[40:43], 0
    ds_read_b128 a[96:99], v151 offset:64
    s_waitcnt lgkmcnt(15)
    v_mfma_f32_16x16x32_bf16 v[28:31], a[64:67], a[44:47], v[28:31]
    ds_read_b64 a[132:133], v162 offset:3136
    v_mfma_f32_16x16x32_bf16 v[32:35], a[68:71], a[44:47], v[32:35]
    ds_read_b64 a[134:135], v162 offset:3144
    v_mfma_f32_16x16x32_bf16 v[36:39], a[72:75], a[44:47], v[36:39]
    ds_read_b128 a[100:103], v151 offset:576
    v_mfma_f32_16x16x32_bf16 v[40:43], a[76:79], a[44:47], 0
    ds_read_b64 a[136:137], v162 offset:2624
    s_waitcnt lgkmcnt(15)
    v_mfma_f32_16x16x32_bf16 v[32:35], a[80:83], a[32:35], v[32:35]
    ds_read_b64 a[138:139], v162 offset:2632
    v_mfma_f32_16x16x32_bf16 v[36:39], a[80:83], a[36:39], v[36:39]
    ds_read_b128 a[104:107], v151 offset:1088
    v_mfma_f32_16x16x32_bf16 v[40:43], a[80:83], a[40:43], v[40:43]
    ds_read_b64 a[140:141], v162 offset:2112
    v_mfma_f32_16x16x32_bf16 v[44:47], a[80:83], a[44:47], 0
    ds_read_b64 a[142:143], v162 offset:2120
    v_mfma_f32_16x16x32_bf16 v[32:35], a[64:67], a[48:51], v[32:35]
    ds_read_b128 a[108:111], v151 offset:1600
    v_mfma_f32_16x16x32_bf16 v[36:39], a[68:71], a[48:51], v[36:39]
    ds_read_b64 a[144:145], v162 offset:1600
    v_mfma_f32_16x16x32_bf16 v[40:43], a[72:75], a[48:51], v[40:43]
    ds_read_b64 a[146:147], v162 offset:1608
    v_mfma_f32_16x16x32_bf16 v[44:47], a[76:79], a[48:51], v[44:47]
    ds_read_b128 a[112:115], v151 offset:2112
    s_waitcnt lgkmcnt(15)
    v_mfma_f32_16x16x32_bf16 v[36:39], a[84:87], a[32:35], v[36:39]
    ds_read_b64 a[148:149], v162 offset:1088
    v_mfma_f32_16x16x32_bf16 v[40:43], a[84:87], a[36:39], v[40:43]
    ds_read_b64 a[150:151], v162 offset:1096
    v_mfma_f32_16x16x32_bf16 v[44:47], a[84:87], a[40:43], v[44:47]
    ds_read_b128 a[116:119], v151 offset:2624
    v_mfma_f32_16x16x32_bf16 v[36:39], a[64:67], a[52:55], v[36:39]
    ds_read_b64 a[152:153], v162 offset:576
    v_mfma_f32_16x16x32_bf16 v[40:43], a[68:71], a[52:55], v[40:43]
    ds_read_b64 a[154:155], v162 offset:584
    v_mfma_f32_16x16x32_bf16 v[44:47], a[72:75], a[52:55], v[44:47]
    ds_read_b128 a[120:123], v151 offset:3136
    v_mfma_f32_16x16x32_bf16 v[40:43], a[88:91], a[32:35], v[40:43]
    ds_read_b64 a[156:157], v162 offset:64
    v_mfma_f32_16x16x32_bf16 v[44:47], a[88:91], a[36:39], v[44:47]
    ds_read_b64 a[158:159], v162 offset:72
    v_mfma_f32_16x16x32_bf16 v[40:43], a[64:67], a[56:59], v[40:43]
    ds_read_b128 a[124:127], v151 offset:3648
    v_mfma_f32_16x16x32_bf16 v[44:47], a[68:71], a[56:59], v[44:47]
    v_mfma_f32_16x16x32_bf16 v[44:47], a[92:95], a[32:35], v[44:47]
    v_mfma_f32_16x16x32_bf16 v[44:47], a[64:67], a[60:63], v[44:47]
    s_waitcnt lgkmcnt(15)
    v_mfma_f32_16x16x32_bf16 v[16:19], a[128:131], a[96:99], v[16:19]
    v_mfma_f32_16x16x32_bf16 v[20:23], a[132:135], a[96:99], v[20:23]
    s_mul_i32 s55, s45, 4224
    v_mfma_f32_16x16x32_bf16 v[20:23], a[128:131], a[100:103], v[20:23]
    v_mfma_f32_16x16x32_bf16 v[24:27], a[132:135], a[100:103], v[24:27]
    s_add_u32 m0, s47, 0
    v_mfma_f32_16x16x32_bf16 v[24:27], a[136:139], a[96:99], v[24:27]
    v_mfma_f32_16x16x32_bf16 v[28:31], a[136:139], a[100:103], v[28:31]
    buffer_load_dwordx4 v153, s[28:31], s55 offen offset:0 sc1 lds
    v_mfma_f32_16x16x32_bf16 v[24:27], a[128:131], a[104:107], v[24:27]
    v_mfma_f32_16x16x32_bf16 v[28:31], a[132:135], a[104:107], v[28:31]
    buffer_load_dwordx4 v153, s[28:31], s55 offen offset:1024 sc1 lds
    v_mfma_f32_16x16x32_bf16 v[32:35], a[136:139], a[104:107], v[32:35]
    ds_read_b64 a[64:65], v162 offset:3712
    s_waitcnt lgkmcnt(14)
    v_mfma_f32_16x16x32_bf16 v[28:31], a[140:143], a[96:99], v[28:31]
    ds_read_b64 a[66:67], v162 offset:3720
    v_mfma_f32_16x16x32_bf16 v[32:35], a[140:143], a[100:103], v[32:35]
    ds_read_b128 a[32:35], v151 offset:128
    v_mfma_f32_16x16x32_bf16 v[36:39], a[140:143], a[104:107], v[36:39]
    ds_read_b64 a[68:69], v162 offset:3200
    s_waitcnt lgkmcnt(15)
    v_mfma_f32_16x16x32_bf16 v[28:31], a[128:131], a[108:111], v[28:31]
    ds_read_b64 a[70:71], v162 offset:3208
    v_mfma_f32_16x16x32_bf16 v[32:35], a[132:135], a[108:111], v[32:35]
    ds_read_b128 a[36:39], v151 offset:640
    v_mfma_f32_16x16x32_bf16 v[36:39], a[136:139], a[108:111], v[36:39]
    ds_read_b64 a[72:73], v162 offset:2688
    v_mfma_f32_16x16x32_bf16 v[40:43], a[140:143], a[108:111], v[40:43]
    ds_read_b64 a[74:75], v162 offset:2696
    s_waitcnt lgkmcnt(15)
    v_mfma_f32_16x16x32_bf16 v[32:35], a[144:147], a[96:99], v[32:35]
    ds_read_b128 a[40:43], v151 offset:1152
    v_mfma_f32_16x16x32_bf16 v[36:39], a[144:147], a[100:103], v[36:39]
    ds_read_b64 a[76:77], v162 offset:2176
    v_mfma_f32_16x16x32_bf16 v[40:43], a[144:147], a[104:107], v[40:43]
    ds_read_b64 a[78:79], v162 offset:2184
    v_mfma_f32_16x16x32_bf16 v[44:47], a[144:147], a[108:111], v[44:47]
    ds_read_b128 a[44:47], v151 offset:1664
    v_mfma_f32_16x16x32_bf16 v[32:35], a[128:131], a[112:115], v[32:35]
    ds_read_b64 a[80:81], v162 offset:1664
    v_mfma_f32_16x16x32_bf16 v[36:39], a[132:135], a[112:115], v[36:39]
    ds_read_b64 a[82:83], v162 offset:1672
    v_mfma_f32_16x16x32_bf16 v[40:43], a[136:139], a[112:115], v[40:43]
    ds_read_b128 a[48:51], v151 offset:2176
    v_mfma_f32_16x16x32_bf16 v[44:47], a[140:143], a[112:115], v[44:47]
    ds_read_b64 a[84:85], v162 offset:1152
    v_mfma_f32_16x16x32_bf16 v[36:39], a[148:151], a[96:99], v[36:39]
    ds_read_b64 a[86:87], v162 offset:1160
    v_mfma_f32_16x16x32_bf16 v[40:43], a[148:151], a[100:103], v[40:43]
    ds_read_b128 a[52:55], v151 offset:2688
    v_mfma_f32_16x16x32_bf16 v[44:47], a[148:151], a[104:107], v[44:47]
    ds_read_b64 a[88:89], v162 offset:640
    s_waitcnt lgkmcnt(15)
    v_mfma_f32_16x16x32_bf16 v[36:39], a[128:131], a[116:119], v[36:39]
    ds_read_b64 a[90:91], v162 offset:648
    v_mfma_f32_16x16x32_bf16 v[40:43], a[132:135], a[116:119], v[40:43]
    ds_read_b128 a[56:59], v151 offset:3200
    v_mfma_f32_16x16x32_bf16 v[44:47], a[136:139], a[116:119], v[44:47]
    ds_read_b64 a[92:93], v162 offset:128
    v_mfma_f32_16x16x32_bf16 v[40:43], a[152:155], a[96:99], v[40:43]
    ds_read_b64 a[94:95], v162 offset:136
    v_mfma_f32_16x16x32_bf16 v[44:47], a[152:155], a[100:103], v[44:47]
    ds_read_b128 a[60:63], v151 offset:3712
    v_mfma_f32_16x16x32_bf16 v[40:43], a[128:131], a[120:123], v[40:43]
    v_mfma_f32_16x16x32_bf16 v[44:47], a[132:135], a[120:123], v[44:47]
    v_mfma_f32_16x16x32_bf16 v[44:47], a[156:159], a[96:99], v[44:47]
    v_mfma_f32_16x16x32_bf16 v[44:47], a[128:131], a[124:127], v[44:47]
    v_mfma_f32_16x16x32_bf16 v[16:19], a[64:67], a[32:35], v[16:19]
    s_waitcnt lgkmcnt(15)
    v_mfma_f32_16x16x32_bf16 v[20:23], a[68:71], a[32:35], v[20:23]
    buffer_load_dwordx4 v153, s[28:31], s55 offen offset:2048 sc1 lds
    v_mfma_f32_16x16x32_bf16 v[20:23], a[64:67], a[36:39], v[20:23]
    v_mfma_f32_16x16x32_bf16 v[24:27], a[68:71], a[36:39], v[24:27]
    buffer_load_dwordx4 v153, s[28:31], s55 offen offset:3072 sc1 lds
    v_mfma_f32_16x16x32_bf16 v[24:27], a[72:75], a[32:35], v[24:27]
    v_mfma_f32_16x16x32_bf16 v[28:31], a[72:75], a[36:39], v[28:31]
    s_add_u32 s55, s55, 2
    v_mfma_f32_16x16x32_bf16 v[24:27], a[64:67], a[40:43], v[24:27]
    v_mfma_f32_16x16x32_bf16 v[28:31], a[68:71], a[40:43], v[28:31]
    s_add_u32 m0, s47, 4160
    v_mfma_f32_16x16x32_bf16 v[32:35], a[72:75], a[40:43], v[32:35]
    ds_read_b64 a[128:129], v162 offset:3776
    s_waitcnt lgkmcnt(14)
    v_mfma_f32_16x16x32_bf16 v[28:31], a[76:79], a[32:35], v[28:31]
    ds_read_b64 a[130:131], v162 offset:3784
    v_mfma_f32_16x16x32_bf16 v[32:35], a[76:79], a[36:39], v[32:35]
    ds_read_b128 a[96:99], v151 offset:192
    v_mfma_f32_16x16x32_bf16 v[36:39], a[76:79], a[40:43], v[36:39]
    ds_read_b64 a[132:133], v162 offset:3264
    s_waitcnt lgkmcnt(15)
    v_mfma_f32_16x16x32_bf16 v[28:31], a[64:67], a[44:47], v[28:31]
    ds_read_b64 a[134:135], v162 offset:3272
    v_mfma_f32_16x16x32_bf16 v[32:35], a[68:71], a[44:47], v[32:35]
    ds_read_b128 a[100:103], v151 offset:704
    v_mfma_f32_16x16x32_bf16 v[36:39], a[72:75], a[44:47], v[36:39]
    ds_read_b64 a[136:137], v162 offset:2752
    v_mfma_f32_16x16x32_bf16 v[40:43], a[76:79], a[44:47], v[40:43]
    ds_read_b64 a[138:139], v162 offset:2760
    s_waitcnt lgkmcnt(15)
    v_mfma_f32_16x16x32_bf16 v[32:35], a[80:83], a[32:35], v[32:35]
    ds_read_b128 a[104:107], v151 offset:1216
    v_mfma_f32_16x16x32_bf16 v[36:39], a[80:83], a[36:39], v[36:39]
    ds_read_b64 a[140:141], v162 offset:2240
    v_mfma_f32_16x16x32_bf16 v[40:43], a[80:83], a[40:43], v[40:43]
    ds_read_b64 a[142:143], v162 offset:2248
    v_mfma_f32_16x16x32_bf16 v[44:47], a[80:83], a[44:47], v[44:47]
    ds_read_b128 a[108:111], v151 offset:1728
    v_mfma_f32_16x16x32_bf16 v[32:35], a[64:67], a[48:51], v[32:35]
    ds_read_b64 a[144:145], v162 offset:1728
    v_mfma_f32_16x16x32_bf16 v[36:39], a[68:71], a[48:51], v[36:39]
    ds_read_b64 a[146:147], v162 offset:1736
    v_mfma_f32_16x16x32_bf16 v[40:43], a[72:75], a[48:51], v[40:43]
    ds_read_b128 a[112:115], v151 offset:2240
    v_mfma_f32_16x16x32_bf16 v[44:47], a[76:79], a[48:51], v[44:47]
    ds_read_b64 a[148:149], v162 offset:1216
    v_mfma_f32_16x16x32_bf16 v[36:39], a[84:87], a[32:35], v[36:39]
    ds_read_b64 a[150:151], v162 offset:1224
    v_mfma_f32_16x16x32_bf16 v[40:43], a[84:87], a[36:39], v[40:43]
    ds_read_b128 a[116:119], v151 offset:2752
    v_mfma_f32_16x16x32_bf16 v[44:47], a[84:87], a[40:43], v[44:47]
    ds_read_b64 a[152:153], v162 offset:704
    s_waitcnt lgkmcnt(15)
    v_mfma_f32_16x16x32_bf16 v[36:39], a[64:67], a[52:55], v[36:39]
    ds_read_b64 a[154:155], v162 offset:712
    v_mfma_f32_16x16x32_bf16 v[40:43], a[68:71], a[52:55], v[40:43]
    ds_read_b128 a[120:123], v151 offset:3264
    v_mfma_f32_16x16x32_bf16 v[44:47], a[72:75], a[52:55], v[44:47]
    ds_read_b64 a[156:157], v162 offset:192
    v_mfma_f32_16x16x32_bf16 v[40:43], a[88:91], a[32:35], v[40:43]
    ds_read_b64 a[158:159], v162 offset:200
    v_mfma_f32_16x16x32_bf16 v[44:47], a[88:91], a[36:39], v[44:47]
    ds_read_b128 a[124:127], v151 offset:3776
    v_mfma_f32_16x16x32_bf16 v[40:43], a[64:67], a[56:59], v[40:43]
    v_mfma_f32_16x16x32_bf16 v[44:47], a[68:71], a[56:59], v[44:47]
    v_mfma_f32_16x16x32_bf16 v[44:47], a[92:95], a[32:35], v[44:47]
    v_mfma_f32_16x16x32_bf16 v[44:47], a[64:67], a[60:63], v[44:47]
    v_mfma_f32_16x16x32_bf16 v[16:19], a[128:131], a[96:99], v[16:19]
    s_waitcnt lgkmcnt(15)
    v_mfma_f32_16x16x32_bf16 v[20:23], a[132:135], a[96:99], v[20:23]
    buffer_load_dwordx4 v153, s[28:31], s55 offen offset:0 sc1 lds
    v_mfma_f32_16x16x32_bf16 v[20:23], a[128:131], a[100:103], v[20:23]
    v_mfma_f32_16x16x32_bf16 v[24:27], a[132:135], a[100:103], v[24:27]
    buffer_load_dwordx4 v153, s[28:31], s55 offen offset:1024 sc1 lds
    v_mfma_f32_16x16x32_bf16 v[24:27], a[136:139], a[96:99], v[24:27]
    v_mfma_f32_16x16x32_bf16 v[28:31], a[136:139], a[100:103], v[28:31]
    buffer_load_dwordx4 v153, s[28:31], s55 offen offset:2048 sc1 lds
    v_mfma_f32_16x16x32_bf16 v[24:27], a[128:131], a[104:107], v[24:27]
    v_mfma_f32_16x16x32_bf16 v[28:31], a[132:135], a[104:107], v[28:31]
    buffer_load_dwordx4 v153, s[28:31], s55 offen offset:3072 sc1 lds
    v_mfma_f32_16x16x32_bf16 v[32:35], a[136:139], a[104:107], v[32:35]
    ds_read_b64 a[64:65], v162 offset:3840
    s_waitcnt lgkmcnt(14)
    v_mfma_f32_16x16x32_bf16 v[28:31], a[140:143], a[96:99], v[28:31]
    ds_read_b64 a[66:67], v162 offset:3848
    v_mfma_f32_16x16x32_bf16 v[32:35], a[140:143], a[100:103], v[32:35]
    ds_read_b128 a[32:35], v151 offset:256
    v_mfma_f32_16x16x32_bf16 v[36:39], a[140:143], a[104:107], v[36:39]
    ds_read_b64 a[68:69], v162 offset:3328
    s_waitcnt lgkmcnt(15)
    v_mfma_f32_16x16x32_bf16 v[28:31], a[128:131], a[108:111], v[28:31]
    ds_read_b64 a[70:71], v162 offset:3336
    v_mfma_f32_16x16x32_bf16 v[32:35], a[132:135], a[108:111], v[32:35]
    ds_read_b128 a[36:39], v151 offset:768
    v_mfma_f32_16x16x32_bf16 v[36:39], a[136:139], a[108:111], v[36:39]
    ds_read_b64 a[72:73], v162 offset:2816
    v_mfma_f32_16x16x32_bf16 v[40:43], a[140:143], a[108:111], v[40:43]
    ds_read_b64 a[74:75], v162 offset:2824
    s_waitcnt lgkmcnt(15)
    v_mfma_f32_16x16x32_bf16 v[32:35], a[144:147], a[96:99], v[32:35]
    ds_read_b128 a[40:43], v151 offset:1280
    v_mfma_f32_16x16x32_bf16 v[36:39], a[144:147], a[100:103], v[36:39]
    ds_read_b64 a[76:77], v162 offset:2304
    v_mfma_f32_16x16x32_bf16 v[40:43], a[144:147], a[104:107], v[40:43]
    ds_read_b64 a[78:79], v162 offset:2312
    v_mfma_f32_16x16x32_bf16 v[44:47], a[144:147], a[108:111], v[44:47]
    ds_read_b128 a[44:47], v151 offset:1792
    v_mfma_f32_16x16x32_bf16 v[32:35], a[128:131], a[112:115], v[32:35]
    ds_read_b64 a[80:81], v162 offset:1792
    v_mfma_f32_16x16x32_bf16 v[36:39], a[132:135], a[112:115], v[36:39]
    ds_read_b64 a[82:83], v162 offset:1800
    v_mfma_f32_16x16x32_bf16 v[40:43], a[136:139], a[112:115], v[40:43]
    ds_read_b128 a[48:51], v151 offset:2304
    v_mfma_f32_16x16x32_bf16 v[44:47], a[140:143], a[112:115], v[44:47]
    ds_read_b64 a[84:85], v162 offset:1280
    v_mfma_f32_16x16x32_bf16 v[36:39], a[148:151], a[96:99], v[36:39]
    ds_read_b64 a[86:87], v162 offset:1288
    v_mfma_f32_16x16x32_bf16 v[40:43], a[148:151], a[100:103], v[40:43]
    ds_read_b128 a[52:55], v151 offset:2816
    v_mfma_f32_16x16x32_bf16 v[44:47], a[148:151], a[104:107], v[44:47]
    ds_read_b64 a[88:89], v162 offset:768
    s_waitcnt lgkmcnt(15)
    v_mfma_f32_16x16x32_bf16 v[36:39], a[128:131], a[116:119], v[36:39]
    ds_read_b64 a[90:91], v162 offset:776
    v_mfma_f32_16x16x32_bf16 v[40:43], a[132:135], a[116:119], v[40:43]
    ds_read_b128 a[56:59], v151 offset:3328
    v_mfma_f32_16x16x32_bf16 v[44:47], a[136:139], a[116:119], v[44:47]
    ds_read_b64 a[92:93], v162 offset:256
    v_mfma_f32_16x16x32_bf16 v[40:43], a[152:155], a[96:99], v[40:43]
    ds_read_b64 a[94:95], v162 offset:264
    v_mfma_f32_16x16x32_bf16 v[44:47], a[152:155], a[100:103], v[44:47]
    ds_read_b128 a[60:63], v151 offset:3840
    v_mfma_f32_16x16x32_bf16 v[40:43], a[128:131], a[120:123], v[40:43]
    v_mfma_f32_16x16x32_bf16 v[44:47], a[132:135], a[120:123], v[44:47]
    v_mfma_f32_16x16x32_bf16 v[44:47], a[156:159], a[96:99], v[44:47]
    v_mfma_f32_16x16x32_bf16 v[44:47], a[128:131], a[124:127], v[44:47]
    v_mfma_f32_16x16x32_bf16 v[16:19], a[64:67], a[32:35], v[16:19]
    s_waitcnt lgkmcnt(15)
    v_mfma_f32_16x16x32_bf16 v[20:23], a[68:71], a[32:35], v[20:23]
    s_add_u32 s55, s55, 2
    v_mfma_f32_16x16x32_bf16 v[20:23], a[64:67], a[36:39], v[20:23]
    v_mfma_f32_16x16x32_bf16 v[24:27], a[68:71], a[36:39], v[24:27]
    s_add_u32 m0, s47, 8320
    v_mfma_f32_16x16x32_bf16 v[24:27], a[72:75], a[32:35], v[24:27]
    v_mfma_f32_16x16x32_bf16 v[28:31], a[72:75], a[36:39], v[28:31]
    buffer_load_dwordx4 v153, s[28:31], s55 offen offset:0 sc1 lds
    v_mfma_f32_16x16x32_bf16 v[24:27], a[64:67], a[40:43], v[24:27]
    v_mfma_f32_16x16x32_bf16 v[28:31], a[68:71], a[40:43], v[28:31]
    buffer_load_dwordx4 v153, s[28:31], s55 offen offset:1024 sc1 lds
    v_mfma_f32_16x16x32_bf16 v[32:35], a[72:75], a[40:43], v[32:35]
    ds_read_b64 a[128:129], v162 offset:3904
    s_waitcnt lgkmcnt(14)
    v_mfma_f32_16x16x32_bf16 v[28:31], a[76:79], a[32:35], v[28:31]
    ds_read_b64 a[130:131], v162 offset:3912
    v_mfma_f32_16x16x32_bf16 v[32:35], a[76:79], a[36:39], v[32:35]
    ds_read_b128 a[96:99], v151 offset:320
    v_mfma_f32_16x16x32_bf16 v[36:39], a[76:79], a[40:43], v[36:39]
    ds_read_b64 a[132:133], v162 offset:3392
    s_waitcnt lgkmcnt(15)
    v_mfma_f32_16x16x32_bf16 v[28:31], a[64:67], a[44:47], v[28:31]
    ds_read_b64 a[134:135], v162 offset:3400
    v_mfma_f32_16x16x32_bf16 v[32:35], a[68:71], a[44:47], v[32:35]
    ds_read_b128 a[100:103], v151 offset:832
    v_mfma_f32_16x16x32_bf16 v[36:39], a[72:75], a[44:47], v[36:39]
    ds_read_b64 a[136:137], v162 offset:2880
    v_mfma_f32_16x16x32_bf16 v[40:43], a[76:79], a[44:47], v[40:43]
    ds_read_b64 a[138:139], v162 offset:2888
    s_waitcnt lgkmcnt(15)
    v_mfma_f32_16x16x32_bf16 v[32:35], a[80:83], a[32:35], v[32:35]
    ds_read_b128 a[104:107], v151 offset:1344
    v_mfma_f32_16x16x32_bf16 v[36:39], a[80:83], a[36:39], v[36:39]
    ds_read_b64 a[140:141], v162 offset:2368
    v_mfma_f32_16x16x32_bf16 v[40:43], a[80:83], a[40:43], v[40:43]
    ds_read_b64 a[142:143], v162 offset:2376
    v_mfma_f32_16x16x32_bf16 v[44:47], a[80:83], a[44:47], v[44:47]
    ds_read_b128 a[108:111], v151 offset:1856
    v_mfma_f32_16x16x32_bf16 v[32:35], a[64:67], a[48:51], v[32:35]
    ds_read_b64 a[144:145], v162 offset:1856
    v_mfma_f32_16x16x32_bf16 v[36:39], a[68:71], a[48:51], v[36:39]
    ds_read_b64 a[146:147], v162 offset:1864
    v_mfma_f32_16x16x32_bf16 v[40:43], a[72:75], a[48:51], v[40:43]
    ds_read_b128 a[112:115], v151 offset:2368
    v_mfma_f32_16x16x32_bf16 v[44:47], a[76:79], a[48:51], v[44:47]
    ds_read_b64 a[148:149], v162 offset:1344
    v_mfma_f32_16x16x32_bf16 v[36:39], a[84:87], a[32:35], v[36:39]
    ds_read_b64 a[150:151], v162 offset:1352
    v_mfma_f32_16x16x32_bf16 v[40:43], a[84:87], a[36:39], v[40:43]
    ds_read_b128 a[116:119], v151 offset:2880
    v_mfma_f32_16x16x32_bf16 v[44:47], a[84:87], a[40:43], v[44:47]
    ds_read_b64 a[152:153], v162 offset:832
    s_waitcnt lgkmcnt(15)
    v_mfma_f32_16x16x32_bf16 v[36:39], a[64:67], a[52:55], v[36:39]
    ds_read_b64 a[154:155], v162 offset:840
    v_mfma_f32_16x16x32_bf16 v[40:43], a[68:71], a[52:55], v[40:43]
    ds_read_b128 a[120:123], v151 offset:3392
    v_mfma_f32_16x16x32_bf16 v[44:47], a[72:75], a[52:55], v[44:47]
    ds_read_b64 a[156:157], v162 offset:320
    v_mfma_f32_16x16x32_bf16 v[40:43], a[88:91], a[32:35], v[40:43]
    ds_read_b64 a[158:159], v162 offset:328
    v_mfma_f32_16x16x32_bf16 v[44:47], a[88:91], a[36:39], v[44:47]
    ds_read_b128 a[124:127], v151 offset:3904
L_pv4:
    s_cbranch_execz L_pvb
    v_mfma_f32_16x16x32_bf16 v[40:43], a[64:67], a[56:59], v[40:43]
    v_mfma_f32_16x16x32_bf16 v[44:47], a[68:71], a[56:59], v[44:47]
    v_mfma_f32_16x16x32_bf16 v[44:47], a[92:95], a[32:35], v[44:47]
    v_mfma_f32_16x16x32_bf16 v[44:47], a[64:67], a[60:63], v[44:47]
    v_mfma_f32_16x16x32_bf16 v[16:19], a[128:131], a[96:99], v[16:19]
    s_waitcnt lgkmcnt(15)
    v_mfma_f32_16x16x32_bf16 v[20:23], a[132:135], a[96:99], v[20:23]
    buffer_load_dwordx4 v153, s[28:31], s55 offen offset:2048 sc1 lds
    v_mfma_f32_16x16x32_bf16 v[20:23], a[128:131], a[100:103], v[20:23]
    v_mfma_f32_16x16x32_bf16 v[24:27], a[132:135], a[100:103], v[24:27]
    buffer_load_dwordx4 v153, s[28:31], s55 offen offset:3072 sc1 lds
    v_mfma_f32_16x16x32_bf16 v[24:27], a[136:139], a[96:99], v[24:27]
    v_mfma_f32_16x16x32_bf16 v[28:31], a[136:139], a[100:103], v[28:31]
    s_add_u32 s55, s55, 2
    v_mfma_f32_16x16x32_bf16 v[24:27], a[128:131], a[104:107], v[24:27]
    v_mfma_f32_16x16x32_bf16 v[28:31], a[132:135], a[104:107], v[28:31]
    s_add_u32 m0, s47, 12480
    v_mfma_f32_16x16x32_bf16 v[32:35], a[136:139], a[104:107], v[32:35]
    ds_read_b64 a[64:65], v162 offset:3968
    s_waitcnt lgkmcnt(14)
    v_mfma_f32_16x16x32_bf16 v[28:31], a[140:143], a[96:99], v[28:31]
    ds_read_b64 a[66:67], v162 offset:3976
    v_mfma_f32_16x16x32_bf16 v[32:35], a[140:143], a[100:103], v[32:35]
    ds_read_b128 a[32:35], v151 offset:384
    v_mfma_f32_16x16x32_bf16 v[36:39], a[140:143], a[104:107], v[36:39]
    ds_read_b64 a[68:69], v162 offset:3456
    s_waitcnt lgkmcnt(15)
    v_mfma_f32_16x16x32_bf16 v[28:31], a[128:131], a[108:111], v[28:31]
    ds_read_b64 a[70:71], v162 offset:3464
    v_mfma_f32_16x16x32_bf16 v[32:35], a[132:135], a[108:111], v[32:35]
    ds_read_b128 a[36:39], v151 offset:896
    v_mfma_f32_16x16x32_bf16 v[36:39], a[136:139], a[108:111], v[36:39]
    ds_read_b64 a[72:73], v162 offset:2944
    v_mfma_f32_16x16x32_bf16 v[40:43], a[140:143], a[108:111], v[40:43]
    ds_read_b64 a[74:75], v162 offset:2952
    s_waitcnt lgkmcnt(15)
    v_mfma_f32_16x16x32_bf16 v[32:35], a[144:147], a[96:99], v[32:35]
    ds_read_b128 a[40:43], v151 offset:1408
    v_mfma_f32_16x16x32_bf16 v[36:39], a[144:147], a[100:103], v[36:39]
    ds_read_b64 a[76:77], v162 offset:2432
    v_mfma_f32_16x16x32_bf16 v[40:43], a[144:147], a[104:107], v[40:43]
    ds_read_b64 a[78:79], v162 offset:2440
    v_mfma_f32_16x16x32_bf16 v[44:47], a[144:147], a[108:111], v[44:47]
    ds_read_b128 a[44:47], v151 offset:1920
    v_mfma_f32_16x16x32_bf16 v[32:35], a[128:131], a[112:115], v[32:35]
    ds_read_b64 a[80:81], v162 offset:1920
    v_mfma_f32_16x16x32_bf16 v[36:39], a[132:135], a[112:115], v[36:39]
    ds_read_b64 a[82:83], v162 offset:1928
    v_mfma_f32_16x16x32_bf16 v[40:43], a[136:139], a[112:115], v[40:43]
    ds_read_b128 a[48:51], v151 offset:2432
    v_mfma_f32_16x16x32_bf16 v[44:47], a[140:143], a[112:115], v[44:47]
    ds_read_b64 a[84:85], v162 offset:1408
    v_mfma_f32_16x16x32_bf16 v[36:39], a[148:151], a[96:99], v[36:39]
    ds_read_b64 a[86:87], v162 offset:1416
    v_mfma_f32_16x16x32_bf16 v[40:43], a[148:151], a[100:103], v[40:43]
    ds_read_b128 a[52:55], v151 offset:2944
    v_mfma_f32_16x16x32_bf16 v[44:47], a[148:151], a[104:107], v[44:47]
    ds_read_b64 a[88:89], v162 offset:896
    s_waitcnt lgkmcnt(15)
    v_mfma_f32_16x16x32_bf16 v[36:39], a[128:131], a[116:119], v[36:39]
    ds_read_b64 a[90:91], v162 offset:904
    v_mfma_f32_16x16x32_bf16 v[40:43], a[132:135], a[116:119], v[40:43]
    ds_read_b128 a[56:59], v151 offset:3456
    v_mfma_f32_16x16x32_bf16 v[44:47], a[136:139], a[116:119], v[44:47]
    ds_read_b64 a[92:93], v162 offset:384
    v_mfma_f32_16x16x32_bf16 v[40:43], a[152:155], a[96:99], v[40:43]
    ds_read_b64 a[94:95], v162 offset:392
    v_mfma_f32_16x16x32_bf16 v[44:47], a[152:155], a[100:103], v[44:47]
    ds_read_b128 a[60:63], v151 offset:3968
    v_mfma_f32_16x16x32_bf16 v[40:43], a[128:131], a[120:123], v[40:43]
    v_mfma_f32_16x16x32_bf16 v[44:47], a[132:135], a[120:123], v[44:47]
    v_mfma_f32_16x16x32_bf16 v[44:47], a[156:159], a[96:99], v[44:47]
    v_mfma_f32_16x16x32_bf16 v[44:47], a[128:131], a[124:127], v[44:47]
    v_mfma_f32_16x16x32_bf16 v[16:19], a[64:67], a[32:35], v[16:19]
    s_waitcnt lgkmcnt(15)
    v_mfma_f32_16x16x32_bf16 v[20:23], a[68:71], a[32:35], v[20:23]
    buffer_load_dwordx4 v153, s[28:31], s55 offen offset:0 sc1 lds
    v_mfma_f32_16x16x32_bf16 v[20:23], a[64:67], a[36:39], v[20:23]
    v_mfma_f32_16x16x32_bf16 v[24:27], a[68:71], a[36:39], v[24:27]
    buffer_load_dwordx4 v153, s[28:31], s55 offen offset:1024 sc1 lds
    v_mfma_f32_16x16x32_bf16 v[24:27], a[72:75], a[32:35], v[24:27]
    v_mfma_f32_16x16x32_bf16 v[28:31], a[72:75], a[36:39], v[28:31]
    buffer_load_dwordx4 v153, s[28:31], s55 offen offset:2048 sc1 lds
    v_mfma_f32_16x16x32_bf16 v[24:27], a[64:67], a[40:43], v[24:27]
    v_mfma_f32_16x16x32_bf16 v[28:31], a[68:71], a[40:43], v[28:31]
    buffer_load_dwordx4 v153, s[28:31], s55 offen offset:3072 sc1 lds
    v_mfma_f32_16x16x32_bf16 v[32:35], a[72:75], a[40:43], v[32:35]
    ds_read_b64 a[128:129], v162 offset:4032
    s_waitcnt lgkmcnt(14)
    v_mfma_f32_16x16x32_bf16 v[28:31], a[76:79], a[32:35], v[28:31]
    ds_read_b64 a[130:131], v162 offset:4040
    v_mfma_f32_16x16x32_bf16 v[32:35], a[76:79], a[36:39], v[32:35]
    ds_read_b128 a[96:99], v151 offset:448
    v_mfma_f32_16x16x32_bf16 v[36:39], a[76:79], a[40:43], v[36:39]
    ds_read_b64 a[132:133], v162 offset:3520
    s_waitcnt lgkmcnt(15)
    v_mfma_f32_16x16x32_bf16 v[28:31], a[64:67], a[44:47], v[28:31]
    ds_read_b64 a[134:135], v162 offset:3528
    v_mfma_f32_16x16x32_bf16 v[32:35], a[68:71], a[44:47], v[32:35]
    ds_read_b128 a[100:103], v151 offset:960
    v_mfma_f32_16x16x32_bf16 v[36:39], a[72:75], a[44:47], v[36:39]
    ds_read_b64 a[136:137], v162 offset:3008
    v_mfma_f32_16x16x32_bf16 v[40:43], a[76:79], a[44:47], v[40:43]
    ds_read_b64 a[138:139], v162 offset:3016
    s_waitcnt lgkmcnt(15)
    v_mfma_f32_16x16x32_bf16 v[32:35], a[80:83], a[32:35], v[32:35]
    ds_read_b128 a[104:107], v151 offset:1472
    v_mfma_f32_16x16x32_bf16 v[36:39], a[80:83], a[36:39], v[36:39]
    ds_read_b64 a[140:141], v162 offset:2496
    v_mfma_f32_16x16x32_bf16 v[40:43], a[80:83], a[40:43], v[40:43]
    ds_read_b64 a[142:143], v162 offset:2504
    v_mfma_f32_16x16x32_bf16 v[44:47], a[80:83], a[44:47], v[44:47]
    ds_read_b128 a[108:111], v151 offset:1984
    v_mfma_f32_16x16x32_bf16 v[32:35], a[64:67], a[48:51], v[32:35]
    ds_read_b64 a[144:145], v162 offset:1984
    v_mfma_f32_16x16x32_bf16 v[36:39], a[68:71], a[48:51], v[36:39]
    ds_read_b64 a[146:147], v162 offset:1992
    v_mfma_f32_16x16x32_bf16 v[40:43], a[72:75], a[48:51], v[40:43]
    ds_read_b128 a[112:115], v151 offset:2496
    v_mfma_f32_16x16x32_bf16 v[44:47], a[76:79], a[48:51], v[44:47]
    ds_read_b64 a[148:149], v162 offset:1472
    v_mfma_f32_16x16x32_bf16 v[36:39], a[84:87], a[32:35], v[36:39]
    ds_read_b64 a[150:151], v162 offset:1480
    v_mfma_f32_16x16x32_bf16 v[40:43], a[84:87], a[36:39], v[40:43]
    ds_read_b128 a[116:119], v151 offset:3008
    v_mfma_f32_16x16x32_bf16 v[44:47], a[84:87], a[40:43], v[44:47]
    ds_read_b64 a[152:153], v162 offset:960
    s_waitcnt lgkmcnt(15)
    v_mfma_f32_16x16x32_bf16 v[36:39], a[64:67], a[52:55], v[36:39]
    ds_read_b64 a[154:155], v162 offset:968
    v_mfma_f32_16x16x32_bf16 v[40:43], a[68:71], a[52:55], v[40:43]
    ds_read_b128 a[120:123], v151 offset:3520
    v_mfma_f32_16x16x32_bf16 v[44:47], a[72:75], a[52:55], v[44:47]
    ds_read_b64 a[156:157], v162 offset:448
    v_mfma_f32_16x16x32_bf16 v[40:43], a[88:91], a[32:35], v[40:43]
    ds_read_b64 a[158:159], v162 offset:456
    v_mfma_f32_16x16x32_bf16 v[44:47], a[88:91], a[36:39], v[44:47]
    ds_read_b128 a[124:127], v151 offset:4032
    v_mfma_f32_16x16x32_bf16 v[40:43], a[64:67], a[56:59], v[40:43]
    v_mfma_f32_16x16x32_bf16 v[44:47], a[68:71], a[56:59], v[44:47]
    v_mfma_f32_16x16x32_bf16 v[44:47], a[92:95], a[32:35], v[44:47]
    v_mfma_f32_16x16x32_bf16 v[44:47], a[64:67], a[60:63], v[44:47]
    v_mfma_f32_16x16x32_bf16 v[16:19], a[128:131], a[96:99], v[16:19]
    s_waitcnt lgkmcnt(15)
    v_mfma_f32_16x16x32_bf16 v[20:23], a[132:135], a[96:99], v[20:23]
    v_mfma_f32_16x16x32_bf16 v[20:23], a[128:131], a[100:103], v[20:23]
    v_mfma_f32_16x16x32_bf16 v[24:27], a[132:135], a[100:103], v[24:27]
    v_mfma_f32_16x16x32_bf16 v[24:27], a[136:139], a[96:99], v[24:27]
    v_mfma_f32_16x16x32_bf16 v[28:31], a[136:139], a[100:103], v[28:31]
    v_mfma_f32_16x16x32_bf16 v[24:27], a[128:131], a[104:107], v[24:27]
    v_mfma_f32_16x16x32_bf16 v[28:31], a[132:135], a[104:107], v[28:31]
    v_mfma_f32_16x16x32_bf16 v[32:35], a[136:139], a[104:107], v[32:35]
    s_waitcnt lgkmcnt(13)
    v_mfma_f32_16x16x32_bf16 v[28:31], a[140:143], a[96:99], v[28:31]
    v_mfma_f32_16x16x32_bf16 v[32:35], a[140:143], a[100:103], v[32:35]
    v_mfma_f32_16x16x32_bf16 v[36:39], a[140:143], a[104:107], v[36:39]
    s_waitcnt lgkmcnt(12)
    v_mfma_f32_16x16x32_bf16 v[28:31], a[128:131], a[108:111], v[28:31]
    v_mfma_f32_16x16x32_bf16 v[32:35], a[132:135], a[108:111], v[32:35]
    v_mfma_f32_16x16x32_bf16 v[36:39], a[136:139], a[108:111], v[36:39]
    v_mfma_f32_16x16x32_bf16 v[40:43], a[140:143], a[108:111], v[40:43]
    s_waitcnt lgkmcnt(10)
    v_mfma_f32_16x16x32_bf16 v[32:35], a[144:147], a[96:99], v[32:35]
    v_mfma_f32_16x16x32_bf16 v[36:39], a[144:147], a[100:103], v[36:39]
    v_mfma_f32_16x16x32_bf16 v[40:43], a[144:147], a[104:107], v[40:43]
    v_mfma_f32_16x16x32_bf16 v[44:47], a[144:147], a[108:111], v[44:47]
    s_waitcnt lgkmcnt(9)
    v_mfma_f32_16x16x32_bf16 v[32:35], a[128:131], a[112:115], v[32:35]
    v_mfma_f32_16x16x32_bf16 v[36:39], a[132:135], a[112:115], v[36:39]
    v_mfma_f32_16x16x32_bf16 v[40:43], a[136:139], a[112:115], v[40:43]
    v_mfma_f32_16x16x32_bf16 v[44:47], a[140:143], a[112:115], v[44:47]
    s_waitcnt lgkmcnt(7)
    v_mfma_f32_16x16x32_bf16 v[36:39], a[148:151], a[96:99], v[36:39]
    v_mfma_f32_16x16x32_bf16 v[40:43], a[148:151], a[100:103], v[40:43]
    v_mfma_f32_16x16x32_bf16 v[44:47], a[148:151], a[104:107], v[44:47]
    s_waitcnt lgkmcnt(6)
    v_mfma_f32_16x16x32_bf16 v[36:39], a[128:131], a[116:119], v[36:39]
    v_mfma_f32_16x16x32_bf16 v[40:43], a[132:135], a[116:119], v[40:43]
    v_mfma_f32_16x16x32_bf16 v[44:47], a[136:139], a[116:119], v[44:47]
    s_waitcnt lgkmcnt(4)
    v_mfma_f32_16x16x32_bf16 v[40:43], a[152:155], a[96:99], v[40:43]
    v_mfma_f32_16x16x32_bf16 v[44:47], a[152:155], a[100:103], v[44:47]
    s_waitcnt lgkmcnt(3)
    v_mfma_f32_16x16x32_bf16 v[40:43], a[128:131], a[120:123], v[40:43]
    v_mfma_f32_16x16x32_bf16 v[44:47], a[132:135], a[120:123], v[44:47]
    s_waitcnt lgkmcnt(1)
    v_mfma_f32_16x16x32_bf16 v[44:47], a[156:159], a[96:99], v[44:47]
    s_waitcnt lgkmcnt(0)
    v_mfma_f32_16x16x32_bf16 v[44:47], a[128:131], a[124:127], v[44:47]
    s_nop 7
    s_lshl_b32 s55, s44, 12
    v_cvt_pk_bf16_f32 v48, v16, v17
    v_cvt_pk_bf16_f32 v49, v18, v19
    v_cvt_pk_bf16_f32 v50, v20, v21
    v_cvt_pk_bf16_f32 v51, v22, v23
    s_nop 1
    v_permlane16_swap_b32 v48, v50
    v_permlane16_swap_b32 v49, v51
    buffer_store_dwordx4 v[48:51], v154, s[32:35], s55 offen offset:0 sc1
    v_cvt_pk_bf16_f32 v52, v24, v25
    v_cvt_pk_bf16_f32 v53, v26, v27
    v_cvt_pk_bf16_f32 v54, v28, v29
    v_cvt_pk_bf16_f32 v55, v30, v31
    s_nop 1
    v_permlane16_swap_b32 v52, v54
    v_permlane16_swap_b32 v53, v55
    buffer_store_dwordx4 v[52:55], v154, s[32:35], s55 offen offset:1024 sc1
    v_cvt_pk_bf16_f32 v48, v32, v33
    v_cvt_pk_bf16_f32 v49, v34, v35
    v_cvt_pk_bf16_f32 v50, v36, v37
    v_cvt_pk_bf16_f32 v51, v38, v39
    s_nop 1
    v_permlane16_swap_b32 v48, v50
    v_permlane16_swap_b32 v49, v51
    buffer_store_dwordx4 v[48:51], v154, s[32:35], s55 offen offset:2048 sc1
    v_cvt_pk_bf16_f32 v52, v40, v41
    v_cvt_pk_bf16_f32 v53, v42, v43
    v_cvt_pk_bf16_f32 v54, v44, v45
    v_cvt_pk_bf16_f32 v55, v46, v47
    s_nop 1
    v_permlane16_swap_b32 v52, v54
    v_permlane16_swap_b32 v53, v55
    buffer_store_dwordx4 v[52:55], v154, s[32:35], s55 offen offset:3072 sc1
    v_lshlrev_b32 v16, 16, v144
    v_mul_f32 v16, 0x3fb8aa3b, v16
    v_exp_f32 v16, v16
    v_lshlrev_b32 v97, 16, v145
    v_cvt_pk_bf16_f32 v16, v16, v16
    v_and_b32 v16, 0xffff0000, v16
    s_and_b32 s40, s3, 1
    s_mul_i32 s41, s40, 16640
    s_xor_b32 s40, s40, 1
    s_lshl_b32 s52, s40, 4
    s_mov_b32 m0, s41
    s_cmp_ge_u32 s3, 2
    s_cbranch_scc1 L_coop_hi
    v_lshlrev_b32 v18, s52, v140
    v_and_b32 v18, 0xffff0000, v18
    v_mul_f32 v18, 0x3fb8aa3b, v18
    v_exp_f32 v18, v18
    v_lshlrev_b32 v19, s52, v141
    v_and_b32 v19, 0xffff0000, v19
    v_lshlrev_b32 v20, s52, v142
    v_and_b32 v20, 0xffff0000, v20
    v_lshlrev_b32 v21, s52, v143
    v_and_b32 v21, 0xffff0000, v21
    v_cvt_pk_bf16_f32 v18, v18, v18
    v_and_b32 v18, 0xffff0000, v18
    v_mul_f32 v18, v18, v16
    v_mul_f32 v19, v19, v16
    v_mul_f32 v20, v20, v16
    v_mul_f32 v21, v21, v16
    v_mul_f32 v18, 0xbfb8aa3b, v18
    v_mul_f32 v19, 0x3e22f983, v19
    v_add_f32 v20, v20, v20
    v_add_f32 v21, v21, v21
    v_mul_f32 v62, 0x41000000, v18
    v_mul_f32 v63, 0x41000000, v19
    v_exp_f32 v62, v62
    v_fract_f32 v63, v63
    v_cos_f32 v24, v63
    v_sin_f32 v25, v63
    s_nop 0
    v_mul_f32 v24, v24, v62
    v_mul_f32 v25, v25, v62
    s_barrier
    v_mov_b32 v66, 0x3f80
    ds_write_addtid_b32 v66 offset:7344
    v_cvt_pk_bf16_f32 v62, v24, v25
    ds_write_addtid_b32 v62 offset:7616
    v_pk_mul_f32 v[32:33], v[24:25], v[24:25] op_sel:[0,0] op_sel_hi:[0,1]
    v_pk_fma_f32 v[28:29], v[24:25], v[24:25], v[32:33] op_sel:[1,1,0] op_sel_hi:[1,0,1] neg_lo:[1,0,0]
    v_cvt_pk_bf16_f32 v63, v28, v29
    ds_write_addtid_b32 v63 offset:7888
    v_pk_mul_f32 v[32:33], v[28:29], v[24:25] op_sel:[0,0] op_sel_hi:[0,1]
    v_pk_fma_f32 v[30:31], v[28:29], v[24:25], v[32:33] op_sel:[1,1,0] op_sel_hi:[1,0,1] neg_lo:[1,0,0]
    v_cvt_pk_bf16_f32 v64, v30, v31
    ds_write_addtid_b32 v64 offset:8160
    v_pk_mul_f32 v[32:33], v[30:31], v[24:25] op_sel:[0,0] op_sel_hi:[0,1]
    v_pk_fma_f32 v[28:29], v[30:31], v[24:25], v[32:33] op_sel:[1,1,0] op_sel_hi:[1,0,1] neg_lo:[1,0,0]
    v_cvt_pk_bf16_f32 v65, v28, v29
    ds_write_addtid_b32 v65 offset:8432
    v_pk_mul_f32 v[32:33], v[28:29], v[24:25] op_sel:[0,0] op_sel_hi:[0,1]
    v_pk_fma_f32 v[30:31], v[28:29], v[24:25], v[32:33] op_sel:[1,1,0] op_sel_hi:[1,0,1] neg_lo:[1,0,0]
    v_cvt_pk_bf16_f32 v62, v30, v31
    ds_write_addtid_b32 v62 offset:8704
    v_pk_mul_f32 v[32:33], v[30:31], v[24:25] op_sel:[0,0] op_sel_hi:[0,1]
    v_pk_fma_f32 v[28:29], v[30:31], v[24:25], v[32:33] op_sel:[1,1,0] op_sel_hi:[1,0,1] neg_lo:[1,0,0]
    v_cvt_pk_bf16_f32 v63, v28, v29
    ds_write_addtid_b32 v63 offset:8976
    v_pk_mul_f32 v[32:33], v[28:29], v[24:25] op_sel:[0,0] op_sel_hi:[0,1]
    v_pk_fma_f32 v[30:31], v[28:29], v[24:25], v[32:33] op_sel:[1,1,0] op_sel_hi:[1,0,1] neg_lo:[1,0,0]
    v_cvt_pk_bf16_f32 v64, v30, v31
    ds_write_addtid_b32 v64 offset:9248
    v_pk_mul_f32 v[32:33], v[30:31], v[24:25] op_sel:[0,0] op_sel_hi:[0,1]
    v_pk_fma_f32 v[28:29], v[30:31], v[24:25], v[32:33] op_sel:[1,1,0] op_sel_hi:[1,0,1] neg_lo:[1,0,0]
    v_cvt_pk_bf16_f32 v65, v28, v29
    ds_write_addtid_b32 v65 offset:9520
    v_pk_mul_f32 v[32:33], v[28:29], v[24:25] op_sel:[0,0] op_sel_hi:[0,1]
    v_pk_fma_f32 v[30:31], v[28:29], v[24:25], v[32:33] op_sel:[1,1,0] op_sel_hi:[1,0,1] neg_lo:[1,0,0]
    v_cvt_pk_bf16_f32 v62, v30, v31
    ds_write_addtid_b32 v62 offset:9792
    v_pk_mul_f32 v[32:33], v[30:31], v[24:25] op_sel:[0,0] op_sel_hi:[0,1]
    v_pk_fma_f32 v[28:29], v[30:31], v[24:25], v[32:33] op_sel:[1,1,0] op_sel_hi:[1,0,1] neg_lo:[1,0,0]
    v_cvt_pk_bf16_f32 v63, v28, v29
    ds_write_addtid_b32 v63 offset:10064
    v_pk_mul_f32 v[32:33], v[28:29], v[24:25] op_sel:[0,0] op_sel_hi:[0,1]
    v_pk_fma_f32 v[30:31], v[28:29], v[24:25], v[32:33] op_sel:[1,1,0] op_sel_hi:[1,0,1] neg_lo:[1,0,0]
    v_cvt_pk_bf16_f32 v64, v30, v31
    ds_write_addtid_b32 v64 offset:10336
    v_pk_mul_f32 v[32:33], v[30:31], v[24:25] op_sel:[0,0] op_sel_hi:[0,1]
    v_pk_fma_f32 v[28:29], v[30:31], v[24:25], v[32:33] op_sel:[1,1,0] op_sel_hi:[1,0,1] neg_lo:[1,0,0]
    v_cvt_pk_bf16_f32 v65, v28, v29
    ds_write_addtid_b32 v65 offset:10608
    v_pk_mul_f32 v[32:33], v[28:29], v[24:25] op_sel:[0,0] op_sel_hi:[0,1]
    v_pk_fma_f32 v[30:31], v[28:29], v[24:25], v[32:33] op_sel:[1,1,0] op_sel_hi:[1,0,1] neg_lo:[1,0,0]
    v_cvt_pk_bf16_f32 v62, v30, v31
    ds_write_addtid_b32 v62 offset:10880
    v_pk_mul_f32 v[32:33], v[30:31], v[24:25] op_sel:[0,0] op_sel_hi:[0,1]
    v_pk_fma_f32 v[28:29], v[30:31], v[24:25], v[32:33] op_sel:[1,1,0] op_sel_hi:[1,0,1] neg_lo:[1,0,0]
    v_cvt_pk_bf16_f32 v63, v28, v29
    ds_write_addtid_b32 v63 offset:11152
    v_pk_mul_f32 v[32:33], v[28:29], v[24:25] op_sel:[0,0] op_sel_hi:[0,1]
    v_pk_fma_f32 v[30:31], v[28:29], v[24:25], v[32:33] op_sel:[1,1,0] op_sel_hi:[1,0,1] neg_lo:[1,0,0]
    v_cvt_pk_bf16_f32 v64, v30, v31
    ds_write_addtid_b32 v64 offset:11424
    v_pk_mul_f32 v[32:33], v[30:31], v[24:25] op_sel:[0,0] op_sel_hi:[0,1]
    v_pk_fma_f32 v[28:29], v[30:31], v[24:25], v[32:33] op_sel:[1,1,0] op_sel_hi:[1,0,1] neg_lo:[1,0,0]
    v_cvt_pk_bf16_f32 v65, v28, v29
    ds_write_addtid_b32 v65 offset:11696
    v_pk_mul_f32 v[32:33], v[28:29], v[24:25] op_sel:[0,0] op_sel_hi:[0,1]
    v_pk_fma_f32 v[30:31], v[28:29], v[24:25], v[32:33] op_sel:[1,1,0] op_sel_hi:[1,0,1] neg_lo:[1,0,0]
    v_cvt_pk_bf16_f32 v62, v30, v31
    ds_write_addtid_b32 v62 offset:11968
    v_pk_mul_f32 v[32:33], v[30:31], v[24:25] op_sel:[0,0] op_sel_hi:[0,1]
    v_pk_fma_f32 v[28:29], v[30:31], v[24:25], v[32:33] op_sel:[1,1,0] op_sel_hi:[1,0,1] neg_lo:[1,0,0]
    v_cvt_pk_bf16_f32 v63, v28, v29
    ds_write_addtid_b32 v63 offset:12240
    v_pk_mul_f32 v[32:33], v[28:29], v[24:25] op_sel:[0,0] op_sel_hi:[0,1]
    v_pk_fma_f32 v[30:31], v[28:29], v[24:25], v[32:33] op_sel:[1,1,0] op_sel_hi:[1,0,1] neg_lo:[1,0,0]
    v_cvt_pk_bf16_f32 v64, v30, v31
    ds_write_addtid_b32 v64 offset:12512
    v_pk_mul_f32 v[32:33], v[30:31], v[24:25] op_sel:[0,0] op_sel_hi:[0,1]
    v_pk_fma_f32 v[28:29], v[30:31], v[24:25], v[32:33] op_sel:[1,1,0] op_sel_hi:[1,0,1] neg_lo:[1,0,0]
    v_cvt_pk_bf16_f32 v65, v28, v29
    ds_write_addtid_b32 v65 offset:12784
    v_pk_mul_f32 v[32:33], v[28:29], v[24:25] op_sel:[0,0] op_sel_hi:[0,1]
    v_pk_fma_f32 v[30:31], v[28:29], v[24:25], v[32:33] op_sel:[1,1,0] op_sel_hi:[1,0,1] neg_lo:[1,0,0]
    v_cvt_pk_bf16_f32 v62, v30, v31
    ds_write_addtid_b32 v62 offset:13056
    v_pk_mul_f32 v[32:33], v[30:31], v[24:25] op_sel:[0,0] op_sel_hi:[0,1]
    v_pk_fma_f32 v[28:29], v[30:31], v[24:25], v[32:33] op_sel:[1,1,0] op_sel_hi:[1,0,1] neg_lo:[1,0,0]
    v_cvt_pk_bf16_f32 v63, v28, v29
    ds_write_addtid_b32 v63 offset:13328
    v_pk_mul_f32 v[32:33], v[28:29], v[24:25] op_sel:[0,0] op_sel_hi:[0,1]
    v_pk_fma_f32 v[30:31], v[28:29], v[24:25], v[32:33] op_sel:[1,1,0] op_sel_hi:[1,0,1] neg_lo:[1,0,0]
    v_cvt_pk_bf16_f32 v64, v30, v31
    ds_write_addtid_b32 v64 offset:13600
    v_pk_mul_f32 v[32:33], v[30:31], v[24:25] op_sel:[0,0] op_sel_hi:[0,1]
    v_pk_fma_f32 v[28:29], v[30:31], v[24:25], v[32:33] op_sel:[1,1,0] op_sel_hi:[1,0,1] neg_lo:[1,0,0]
    v_cvt_pk_bf16_f32 v65, v28, v29
    ds_write_addtid_b32 v65 offset:13872
    v_pk_mul_f32 v[32:33], v[28:29], v[24:25] op_sel:[0,0] op_sel_hi:[0,1]
    v_pk_fma_f32 v[30:31], v[28:29], v[24:25], v[32:33] op_sel:[1,1,0] op_sel_hi:[1,0,1] neg_lo:[1,0,0]
    v_cvt_pk_bf16_f32 v62, v30, v31
    ds_write_addtid_b32 v62 offset:14144
    v_pk_mul_f32 v[32:33], v[30:31], v[24:25] op_sel:[0,0] op_sel_hi:[0,1]
    v_pk_fma_f32 v[28:29], v[30:31], v[24:25], v[32:33] op_sel:[1,1,0] op_sel_hi:[1,0,1] neg_lo:[1,0,0]
    v_cvt_pk_bf16_f32 v63, v28, v29
    ds_write_addtid_b32 v63 offset:14416
    v_pk_mul_f32 v[32:33], v[28:29], v[24:25] op_sel:[0,0] op_sel_hi:[0,1]
    v_pk_fma_f32 v[30:31], v[28:29], v[24:25], v[32:33] op_sel:[1,1,0] op_sel_hi:[1,0,1] neg_lo:[1,0,0]
    v_cvt_pk_bf16_f32 v64, v30, v31
    ds_write_addtid_b32 v64 offset:14688
    v_pk_mul_f32 v[32:33], v[30:31], v[24:25] op_sel:[0,0] op_sel_hi:[0,1]
    v_pk_fma_f32 v[28:29], v[30:31], v[24:25], v[32:33] op_sel:[1,1,0] op_sel_hi:[1,0,1] neg_lo:[1,0,0]
    v_cvt_pk_bf16_f32 v65, v28, v29
    ds_write_addtid_b32 v65 offset:14960
    v_pk_mul_f32 v[32:33], v[28:29], v[24:25] op_sel:[0,0] op_sel_hi:[0,1]
    v_pk_fma_f32 v[30:31], v[28:29], v[24:25], v[32:33] op_sel:[1,1,0] op_sel_hi:[1,0,1] neg_lo:[1,0,0]
    v_cvt_pk_bf16_f32 v62, v30, v31
    ds_write_addtid_b32 v62 offset:15232
    v_pk_mul_f32 v[32:33], v[30:31], v[24:25] op_sel:[0,0] op_sel_hi:[0,1]
    v_pk_fma_f32 v[28:29], v[30:31], v[24:25], v[32:33] op_sel:[1,1,0] op_sel_hi:[1,0,1] neg_lo:[1,0,0]
    v_cvt_pk_bf16_f32 v63, v28, v29
    ds_write_addtid_b32 v63 offset:15504
    v_pk_mul_f32 v[32:33], v[28:29], v[24:25] op_sel:[0,0] op_sel_hi:[0,1]
    v_pk_fma_f32 v[30:31], v[28:29], v[24:25], v[32:33] op_sel:[1,1,0] op_sel_hi:[1,0,1] neg_lo:[1,0,0]
    v_cvt_pk_bf16_f32 v64, v30, v31
    ds_write_addtid_b32 v64 offset:15776
    s_branch L_coop_join
L_coop_hi:
    v_lshlrev_b32 v18, s52, v140
    v_and_b32 v18, 0xffff0000, v18
    v_mul_f32 v18, 0x3fb8aa3b, v18
    v_exp_f32 v18, v18
    v_lshlrev_b32 v19, s52, v141
    v_and_b32 v19, 0xffff0000, v19
    v_lshlrev_b32 v20, s52, v142
    v_and_b32 v20, 0xffff0000, v20
    v_lshlrev_b32 v21, s52, v143
    v_and_b32 v21, 0xffff0000, v21
    v_cvt_pk_bf16_f32 v18, v18, v18
    v_and_b32 v18, 0xffff0000, v18
    v_mul_f32 v18, v18, v16
    v_mul_f32 v19, v19, v16
    v_mul_f32 v20, v20, v16
    v_mul_f32 v21, v21, v16
    v_mul_f32 v18, 0xbfb8aa3b, v18
    v_mul_f32 v19, 0x3e22f983, v19
    v_add_f32 v20, v20, v20
    v_add_f32 v21, v21, v21
    v_mul_f32 v62, 0x3f800000, v18
    v_mul_f32 v63, 0x3f800000, v19
    v_exp_f32 v62, v62
    v_fract_f32 v63, v63
    v_cos_f32 v22, v63
    v_sin_f32 v23, v63
    s_nop 0
    v_mul_f32 v22, v22, v62
    v_mul_f32 v23, v23, v62
    v_mul_f32 v62, 0x43800000, v18
    v_mul_f32 v63, 0x43800000, v19
    v_exp_f32 v62, v62
    v_fract_f32 v63, v63
    v_cos_f32 v26, v63
    v_sin_f32 v27, v63
    s_nop 0
    v_mul_f32 v26, v26, v62
    v_mul_f32 v27, v27, v62
    s_barrier
    v_cvt_pk_bf16_f32 v62, v20, -v21
    ds_write_addtid_b32 v62 offset:0
    v_pk_mul_f32 v[60:61], v[20:21], v[22:23] op_sel:[0,0] op_sel_hi:[0,1]
    v_pk_fma_f32 v[34:35], v[20:21], v[22:23], v[60:61] op_sel:[1,1,0] op_sel_hi:[1,0,1] neg_lo:[1,0,0]
    v_cvt_pk_bf16_f32 v63, v34, -v35
    ds_write_addtid_b32 v63 offset:272
    v_pk_mul_f32 v[60:61], v[34:35], v[22:23] op_sel:[0,0] op_sel_hi:[0,1]
    v_pk_fma_f32 v[36:37], v[34:35], v[22:23], v[60:61] op_sel:[1,1,0] op_sel_hi:[1,0,1] neg_lo:[1,0,0]
    v_cvt_pk_bf16_f32 v64, v36, -v37
    ds_write_addtid_b32 v64 offset:544
    v_pk_mul_f32 v[60:61], v[36:37], v[22:23] op_sel:[0,0] op_sel_hi:[0,1]
    v_pk_fma_f32 v[38:39], v[36:37], v[22:23], v[60:61] op_sel:[1,1,0] op_sel_hi:[1,0,1] neg_lo:[1,0,0]
    v_cvt_pk_bf16_f32 v65, v38, -v39
    ds_write_addtid_b32 v65 offset:816
    v_pk_mul_f32 v[60:61], v[38:39], v[22:23] op_sel:[0,0] op_sel_hi:[0,1]
    v_pk_fma_f32 v[40:41], v[38:39], v[22:23], v[60:61] op_sel:[1,1,0] op_sel_hi:[1,0,1] neg_lo:[1,0,0]
    v_cvt_pk_bf16_f32 v62, v40, -v41
    ds_write_addtid_b32 v62 offset:1088
    v_pk_mul_f32 v[60:61], v[40:41], v[22:23] op_sel:[0,0] op_sel_hi:[0,1]
    v_pk_fma_f32 v[42:43], v[40:41], v[22:23], v[60:61] op_sel:[1,1,0] op_sel_hi:[1,0,1] neg_lo:[1,0,0]
    v_cvt_pk_bf16_f32 v63, v42, -v43
    ds_write_addtid_b32 v63 offset:1360
    v_pk_mul_f32 v[60:61], v[42:43], v[22:23] op_sel:[0,0] op_sel_hi:[0,1]
    v_pk_fma_f32 v[44:45], v[42:43], v[22:23], v[60:61] op_sel:[1,1,0] op_sel_hi:[1,0,1] neg_lo:[1,0,0]
    v_cvt_pk_bf16_f32 v64, v44, -v45
    ds_write_addtid_b32 v64 offset:1632
    v_pk_mul_f32 v[60:61], v[44:45], v[22:23] op_sel:[0,0] op_sel_hi:[0,1]
    v_pk_fma_f32 v[46:47], v[44:45], v[22:23], v[60:61] op_sel:[1,1,0] op_sel_hi:[1,0,1] neg_lo:[1,0,0]
    v_cvt_pk_bf16_f32 v65, v46, -v47
    ds_write_addtid_b32 v65 offset:1904
    v_pk_mul_f32 v[60:61], v[46:47], v[22:23] op_sel:[0,0] op_sel_hi:[0,1]
    v_pk_fma_f32 v[48:49], v[46:47], v[22:23], v[60:61] op_sel:[1,1,0] op_sel_hi:[1,0,1] neg_lo:[1,0,0]
    v_pk_mul_f32 v[60:61], v[20:21], v[26:27] op_sel:[0,0] op_sel_hi:[0,1]
    v_pk_fma_f32 v[50:51], v[20:21], v[26:27], v[60:61] op_sel:[1,1,0] op_sel_hi:[1,0,1] neg_lo:[1,0,0]
    v_cvt_pk_bf16_f32 v62, v50, -v51
    ds_write_addtid_b32 v62 offset:2176
    v_pk_mul_f32 v[60:61], v[36:37], v[26:27] op_sel:[0,0] op_sel_hi:[0,1]
    v_pk_fma_f32 v[52:53], v[36:37], v[26:27], v[60:61] op_sel:[1,1,0] op_sel_hi:[1,0,1] neg_lo:[1,0,0]
    v_cvt_pk_bf16_f32 v63, v52, -v53
    ds_write_addtid_b32 v63 offset:2448
    v_pk_mul_f32 v[60:61], v[40:41], v[26:27] op_sel:[0,0] op_sel_hi:[0,1]
    v_pk_fma_f32 v[54:55], v[40:41], v[26:27], v[60:61] op_sel:[1,1,0] op_sel_hi:[1,0,1] neg_lo:[1,0,0]
    v_cvt_pk_bf16_f32 v64, v54, -v55
    ds_write_addtid_b32 v64 offset:2720
    v_pk_mul_f32 v[60:61], v[44:45], v[26:27] op_sel:[0,0] op_sel_hi:[0,1]
    v_pk_fma_f32 v[56:57], v[44:45], v[26:27], v[60:61] op_sel:[1,1,0] op_sel_hi:[1,0,1] neg_lo:[1,0,0]
    v_cvt_pk_bf16_f32 v65, v56, -v57
    ds_write_addtid_b32 v65 offset:2992
    v_pk_mul_f32 v[60:61], v[48:49], v[26:27] op_sel:[0,0] op_sel_hi:[0,1]
    v_pk_fma_f32 v[58:59], v[48:49], v[26:27], v[60:61] op_sel:[1,1,0] op_sel_hi:[1,0,1] neg_lo:[1,0,0]
    v_cvt_pk_bf16_f32 v62, v58, -v59
    ds_write_addtid_b32 v62 offset:3264
    v_pk_mul_f32 v[60:61], v[50:51], v[26:27] op_sel:[0,0] op_sel_hi:[0,1]
    v_pk_fma_f32 v[50:51], v[50:51], v[26:27], v[60:61] op_sel:[1,1,0] op_sel_hi:[1,0,1] neg_lo:[1,0,0]
    v_cvt_pk_bf16_f32 v63, v50, -v51
    ds_write_addtid_b32 v63 offset:3536
    v_pk_mul_f32 v[60:61], v[54:55], v[26:27] op_sel:[0,0] op_sel_hi:[0,1]
    v_pk_fma_f32 v[54:55], v[54:55], v[26:27], v[60:61] op_sel:[1,1,0] op_sel_hi:[1,0,1] neg_lo:[1,0,0]
    v_cvt_pk_bf16_f32 v64, v54, -v55
    ds_write_addtid_b32 v64 offset:3808
    v_pk_mul_f32 v[60:61], v[58:59], v[26:27] op_sel:[0,0] op_sel_hi:[0,1]
    v_pk_fma_f32 v[58:59], v[58:59], v[26:27], v[60:61] op_sel:[1,1,0] op_sel_hi:[1,0,1] neg_lo:[1,0,0]
    v_cvt_pk_bf16_f32 v65, v58, -v59
    ds_write_addtid_b32 v65 offset:4080
    v_pk_mul_f32 v[60:61], v[50:51], v[26:27] op_sel:[0,0] op_sel_hi:[0,1]
    v_pk_fma_f32 v[50:51], v[50:51], v[26:27], v[60:61] op_sel:[1,1,0] op_sel_hi:[1,0,1] neg_lo:[1,0,0]
    v_cvt_pk_bf16_f32 v62, v50, -v51
    ds_write_addtid_b32 v62 offset:4352
    v_pk_mul_f32 v[60:61], v[54:55], v[26:27] op_sel:[0,0] op_sel_hi:[0,1]
    v_pk_fma_f32 v[54:55], v[54:55], v[26:27], v[60:61] op_sel:[1,1,0] op_sel_hi:[1,0,1] neg_lo:[1,0,0]
    v_cvt_pk_bf16_f32 v63, v54, -v55
    ds_write_addtid_b32 v63 offset:4624
    v_pk_mul_f32 v[60:61], v[58:59], v[26:27] op_sel:[0,0] op_sel_hi:[0,1]
    v_pk_fma_f32 v[58:59], v[58:59], v[26:27], v[60:61] op_sel:[1,1,0] op_sel_hi:[1,0,1] neg_lo:[1,0,0]
    v_cvt_pk_bf16_f32 v64, v58, -v59
    ds_write_addtid_b32 v64 offset:4896
    v_pk_mul_f32 v[60:61], v[50:51], v[26:27] op_sel:[0,0] op_sel_hi:[0,1]
    v_pk_fma_f32 v[50:51], v[50:51], v[26:27], v[60:61] op_sel:[1,1,0] op_sel_hi:[1,0,1] neg_lo:[1,0,0]
    v_cvt_pk_bf16_f32 v65, v50, -v51
    ds_write_addtid_b32 v65 offset:5168
    v_pk_mul_f32 v[60:61], v[58:59], v[26:27] op_sel:[0,0] op_sel_hi:[0,1]
    v_pk_fma_f32 v[58:59], v[58:59], v[26:27], v[60:61] op_sel:[1,1,0] op_sel_hi:[1,0,1] neg_lo:[1,0,0]
    v_cvt_pk_bf16_f32 v62, v58, -v59
    ds_write_addtid_b32 v62 offset:5440
    v_pk_mul_f32 v[60:61], v[50:51], v[26:27] op_sel:[0,0] op_sel_hi:[0,1]
    v_pk_fma_f32 v[50:51], v[50:51], v[26:27], v[60:61] op_sel:[1,1,0] op_sel_hi:[1,0,1] neg_lo:[1,0,0]
    v_cvt_pk_bf16_f32 v63, v50, -v51
    ds_write_addtid_b32 v63 offset:5712
    v_pk_mul_f32 v[60:61], v[58:59], v[26:27] op_sel:[0,0] op_sel_hi:[0,1]
    v_pk_fma_f32 v[58:59], v[58:59], v[26:27], v[60:61] op_sel:[1,1,0] op_sel_hi:[1,0,1] neg_lo:[1,0,0]
    v_cvt_pk_bf16_f32 v64, v58, -v59
    ds_write_addtid_b32 v64 offset:5984
    v_pk_mul_f32 v[60:61], v[50:51], v[26:27] op_sel:[0,0] op_sel_hi:[0,1]
    v_pk_fma_f32 v[50:51], v[50:51], v[26:27], v[60:61] op_sel:[1,1,0] op_sel_hi:[1,0,1] neg_lo:[1,0,0]
    v_cvt_pk_bf16_f32 v65, v50, -v51
    ds_write_addtid_b32 v65 offset:6256
    v_pk_mul_f32 v[60:61], v[58:59], v[26:27] op_sel:[0,0] op_sel_hi:[0,1]
    v_pk_fma_f32 v[58:59], v[58:59], v[26:27], v[60:61] op_sel:[1,1,0] op_sel_hi:[1,0,1] neg_lo:[1,0,0]
    v_cvt_pk_bf16_f32 v62, v58, -v59
    ds_write_addtid_b32 v62 offset:6528
    v_pk_mul_f32 v[60:61], v[50:51], v[26:27] op_sel:[0,0] op_sel_hi:[0,1]
    v_pk_fma_f32 v[50:51], v[50:51], v[26:27], v[60:61] op_sel:[1,1,0] op_sel_hi:[1,0,1] neg_lo:[1,0,0]
    v_cvt_pk_bf16_f32 v63, v50, -v51
    ds_write_addtid_b32 v63 offset:6800
    v_pk_mul_f32 v[60:61], v[58:59], v[26:27] op_sel:[0,0] op_sel_hi:[0,1]
    v_pk_fma_f32 v[58:59], v[58:59], v[26:27], v[60:61] op_sel:[1,1,0] op_sel_hi:[1,0,1] neg_lo:[1,0,0]
    v_cvt_pk_bf16_f32 v64, v58, -v59
    ds_write_addtid_b32 v64 offset:7072
L_coop_join:
    s_waitcnt lgkmcnt(0)
    s_barrier
    v_add_u32 v158, 16640, v146
    v_add_u32 v159, 16640, v147
    ds_read_b128 a[160:163], v146 offset:0
    ds_read_b128 a[164:167], v147 offset:0
    ds_read_b128 a[168:171], v146 offset:32
    ds_read_b128 a[172:175], v147 offset:32
    ds_read_b128 a[176:179], v146 offset:64
    ds_read_b128 a[180:183], v147 offset:64
    ds_read_b128 a[184:187], v146 offset:96
    ds_read_b128 a[188:191], v147 offset:96
    s_waitcnt lgkmcnt(6)
    v_mfma_f32_32x32x16_bf16 v[80:95], a[160:163], a[164:167], 0
    ds_read_b128 a[192:195], v146 offset:128
    ds_read_b128 a[196:199], v147 offset:128
    s_waitcnt lgkmcnt(6)
    v_mfma_f32_32x32x16_bf16 v[80:95], a[168:171], a[172:175], v[80:95]
    ds_read_b128 a[200:203], v146 offset:160
    ds_read_b128 a[204:207], v147 offset:160
    s_waitcnt lgkmcnt(6)
    v_mfma_f32_32x32x16_bf16 v[80:95], a[176:179], a[180:183], v[80:95]
    ds_read_b128 a[208:211], v146 offset:192
L_pv5:
    s_cbranch_execz L_pvb
    ds_read_b128 a[212:215], v147 offset:192
    s_waitcnt lgkmcnt(6)
    v_mfma_f32_32x32x16_bf16 v[80:95], a[184:187], a[188:191], v[80:95]
    ds_read_b128 a[216:219], v146 offset:224
    ds_read_b128 a[220:223], v147 offset:224
    s_waitcnt lgkmcnt(6)
    v_mfma_f32_32x32x16_bf16 v[80:95], a[192:195], a[196:199], v[80:95]
    ds_read_b128 a[96:99], v158 offset:0
    ds_read_b128 a[100:103], v159 offset:0
    s_waitcnt lgkmcnt(6)
    v_mfma_f32_32x32x16_bf16 v[80:95], a[200:203], a[204:207], v[80:95]
    ds_read_b128 a[104:107], v158 offset:32
    ds_read_b128 a[108:111], v159 offset:32
    s_waitcnt lgkmcnt(6)
    v_mfma_f32_32x32x16_bf16 v[80:95], a[208:211], a[212:215], v[80:95]
    ds_read_b128 a[112:115], v158 offset:64
    ds_read_b128 a[116:119], v159 offset:64
    s_waitcnt lgkmcnt(6)
    v_mfma_f32_32x32x16_bf16 v[80:95], a[216:219], a[220:223], v[80:95]
    ds_read_b128 a[120:123], v158 offset:96
    ds_read_b128 a[124:127], v159 offset:96
    s_waitcnt lgkmcnt(6)
    v_mfma_f32_32x32x16_bf16 v[80:95], a[96:99], a[100:103], v[80:95]
    ds_read_b128 a[128:131], v158 offset:128
    ds_read_b128 a[132:135], v159 offset:128
    s_waitcnt lgkmcnt(6)
    v_mfma_f32_32x32x16_bf16 v[80:95], a[104:107], a[108:111], v[80:95]
    ds_read_b128 a[136:139], v158 offset:160
    ds_read_b128 a[140:143], v159 offset:160
    s_waitcnt lgkmcnt(6)
    v_mfma_f32_32x32x16_bf16 v[80:95], a[112:115], a[116:119], v[80:95]
    ds_read_b128 a[144:147], v158 offset:192
    ds_read_b128 a[148:151], v159 offset:192
    s_waitcnt lgkmcnt(6)
    v_mfma_f32_32x32x16_bf16 v[80:95], a[120:123], a[124:127], v[80:95]
    ds_read_b128 a[152:155], v158 offset:224
    ds_read_b128 a[156:159], v159 offset:224
    s_waitcnt lgkmcnt(6)
    v_mfma_f32_32x32x16_bf16 v[80:95], a[128:131], a[132:135], v[80:95]
    s_waitcnt lgkmcnt(4)
    v_mfma_f32_32x32x16_bf16 v[80:95], a[136:139], a[140:143], v[80:95]
    s_waitcnt lgkmcnt(2)
    v_mfma_f32_32x32x16_bf16 v[80:95], a[144:147], a[148:151], v[80:95]
    s_waitcnt lgkmcnt(0)
    v_mfma_f32_32x32x16_bf16 v[80:95], a[152:155], a[156:159], v[80:95]
    v_cndmask_b32 v97, 0, v97, s[50:51]
    s_nop 10
    v_add_f32 v80, v80, v97
    v_cvt_pk_bf16_f32 v64, v80, v81
    v_cvt_pk_bf16_f32 v65, v82, v83
    ds_write_b64 v148, v[64:65]
    v_cvt_pk_bf16_f32 v66, v84, v84
    v_cvt_pk_bf16_f32 v67, v85, v86
    ds_write_b64 v148, v[66:67] offset:512
    v_cvt_pk_bf16_f32 v68, v87, v87
    v_cvt_pk_bf16_f32 v69, v87, v88
    v_cvt_pk_bf16_f32 v70, v88, v88
    v_cvt_pk_bf16_f32 v71, v89, v89
    ds_write_b128 v149, v[68:71] offset:1024
    v_cndmask_b32 v62, v91, v90, s[48:49]
    v_cvt_pk_bf16_f32 v72, v90, v90
    v_cvt_pk_bf16_f32 v73, v90, v90
    v_cvt_pk_bf16_f32 v74, v62, v91
    v_cvt_pk_bf16_f32 v75, v91, v91
    ds_write_b128 v150, v[72:75] offset:2048
    v_cndmask_b32 v62, v93, v92, s[48:49]
    v_cvt_pk_bf16_f32 v76, v92, v92
    v_cvt_pk_bf16_f32 v77, v92, v92
    v_cvt_pk_bf16_f32 v78, v62, v93
    v_cvt_pk_bf16_f32 v79, v93, v93
    ds_write_b128 v150, v[76:79] offset:2560
    s_lshl_b32 s40, s3, 7
    v_add_u32 v158, s40, v151
    v_add_u32 v159, s40, v152
    s_waitcnt vmcnt(4) lgkmcnt(0)
    ds_read_b64 a[64:65], v159 offset:3584
    ds_read_b64 a[66:67], v159 offset:3592
    ds_read_b128 a[32:35], v158 offset:0
    ds_read_b64 a[68:69], v159 offset:3072
    ds_read_b64 a[70:71], v159 offset:3080
    ds_read_b128 a[36:39], v158 offset:512
    ds_read_b64 a[72:73], v159 offset:2560
    ds_read_b64 a[74:75], v159 offset:2568
    ds_read_b128 a[40:43], v158 offset:1024
    s_waitcnt lgkmcnt(6)
    v_mfma_f32_16x16x32_bf16 v[16:19], a[64:67], a[32:35], 0
    ds_read_b64 a[76:77], v159 offset:2048
    ds_read_b64 a[78:79], v159 offset:2056
    s_waitcnt lgkmcnt(6)
    v_mfma_f32_16x16x32_bf16 v[20:23], a[68:71], a[32:35], 0
    ds_read_b128 a[44:47], v158 offset:1536
    ds_read_b64 a[80:81], v159 offset:1536
    s_waitcnt lgkmcnt(7)
    v_mfma_f32_16x16x32_bf16 v[20:23], a[64:67], a[36:39], v[20:23]
    ds_read_b64 a[82:83], v159 offset:1544
    ds_read_b128 a[48:51], v158 offset:2048
    v_mfma_f32_16x16x32_bf16 v[24:27], a[68:71], a[36:39], 0
    ds_read_b64 a[84:85], v159 offset:1024
    ds_read_b64 a[86:87], v159 offset:1032
    s_waitcnt lgkmcnt(9)
    v_mfma_f32_16x16x32_bf16 v[24:27], a[72:75], a[32:35], v[24:27]
    ds_read_b128 a[52:55], v158 offset:2560
    ds_read_b64 a[88:89], v159 offset:512
    v_mfma_f32_16x16x32_bf16 v[28:31], a[72:75], a[36:39], 0
    ds_read_b64 a[90:91], v159 offset:520
    ds_read_b128 a[56:59], v158 offset:3072
    s_waitcnt lgkmcnt(12)
    v_mfma_f32_16x16x32_bf16 v[24:27], a[64:67], a[40:43], v[24:27]
    ds_read_b64 a[92:93], v159 offset:0
    v_mfma_f32_16x16x32_bf16 v[28:31], a[68:71], a[40:43], v[28:31]
    ds_read_b64 a[94:95], v159 offset:8
    v_mfma_f32_16x16x32_bf16 v[32:35], a[72:75], a[40:43], 0
    ds_read_b128 a[60:63], v158 offset:3584
    s_waitcnt lgkmcnt(13)
    v_mfma_f32_16x16x32_bf16 v[28:31], a[76:79], a[32:35], v[28:31]
    ds_read_b64 a[128:129], v159 offset:3648
    v_mfma_f32_16x16x32_bf16 v[32:35], a[76:79], a[36:39], v[32:35]
    ds_read_b64 a[130:131], v159 offset:3656
    v_mfma_f32_16x16x32_bf16 v[36:39], a[76:79], a[40:43], 0
    ds_read_b128 a[96:99], v158 offset:64
    s_waitcnt lgkmcnt(15)
    v_mfma_f32_16x16x32_bf16 v[28:31], a[64:67], a[44:47], v[28:31]
    ds_read_b64 a[132:133], v159 offset:3136
    v_mfma_f32_16x16x32_bf16 v[32:35], a[68:71], a[44:47], v[32:35]
    ds_read_b64 a[134:135], v159 offset:3144
    v_mfma_f32_16x16x32_bf16 v[36:39], a[72:75], a[44:47], v[36:39]
    ds_read_b128 a[100:103], v158 offset:576
    v_mfma_f32_16x16x32_bf16 v[40:43], a[76:79], a[44:47], 0
    ds_read_b64 a[136:137], v159 offset:2624
    s_waitcnt lgkmcnt(15)
    v_mfma_f32_16x16x32_bf16 v[32:35], a[80:83], a[32:35], v[32:35]
    ds_read_b64 a[138:139], v159 offset:2632
    v_mfma_f32_16x16x32_bf16 v[36:39], a[80:83], a[36:39], v[36:39]
    ds_read_b128 a[104:107], v158 offset:1088
    v_mfma_f32_16x16x32_bf16 v[40:43], a[80:83], a[40:43], v[40:43]
    ds_read_b64 a[140:141], v159 offset:2112
    v_mfma_f32_16x16x32_bf16 v[44:47], a[80:83], a[44:47], 0
    ds_read_b64 a[142:143], v159 offset:2120
    v_mfma_f32_16x16x32_bf16 v[32:35], a[64:67], a[48:51], v[32:35]
    ds_read_b128 a[108:111], v158 offset:1600
    v_mfma_f32_16x16x32_bf16 v[36:39], a[68:71], a[48:51], v[36:39]
    ds_read_b64 a[144:145], v159 offset:1600
    v_mfma_f32_16x16x32_bf16 v[40:43], a[72:75], a[48:51], v[40:43]
    ds_read_b64 a[146:147], v159 offset:1608
    v_mfma_f32_16x16x32_bf16 v[44:47], a[76:79], a[48:51], v[44:47]
    ds_read_b128 a[112:115], v158 offset:2112
    s_waitcnt lgkmcnt(15)
    v_mfma_f32_16x16x32_bf16 v[36:39], a[84:87], a[32:35], v[36:39]
    ds_read_b64 a[148:149], v159 offset:1088
    v_mfma_f32_16x16x32_bf16 v[40:43], a[84:87], a[36:39], v[40:43]
    ds_read_b64 a[150:151], v159 offset:1096
    v_mfma_f32_16x16x32_bf16 v[44:47], a[84:87], a[40:43], v[44:47]
    ds_read_b128 a[116:119], v158 offset:2624
    v_mfma_f32_16x16x32_bf16 v[36:39], a[64:67], a[52:55], v[36:39]
    ds_read_b64 a[152:153], v159 offset:576
    v_mfma_f32_16x16x32_bf16 v[40:43], a[68:71], a[52:55], v[40:43]
    ds_read_b64 a[154:155], v159 offset:584
    v_mfma_f32_16x16x32_bf16 v[44:47], a[72:75], a[52:55], v[44:47]
    ds_read_b128 a[120:123], v158 offset:3136
    v_mfma_f32_16x16x32_bf16 v[40:43], a[88:91], a[32:35], v[40:43]
    ds_read_b64 a[156:157], v159 offset:64
    v_mfma_f32_16x16x32_bf16 v[44:47], a[88:91], a[36:39], v[44:47]
    ds_read_b64 a[158:159], v159 offset:72
    v_mfma_f32_16x16x32_bf16 v[40:43], a[64:67], a[56:59], v[40:43]
    ds_read_b128 a[124:127], v158 offset:3648
    v_mfma_f32_16x16x32_bf16 v[44:47], a[68:71], a[56:59], v[44:47]
    v_mfma_f32_16x16x32_bf16 v[44:47], a[92:95], a[32:35], v[44:47]
    v_mfma_f32_16x16x32_bf16 v[44:47], a[64:67], a[60:63], v[44:47]
    s_waitcnt lgkmcnt(15)
    v_mfma_f32_16x16x32_bf16 v[16:19], a[128:131], a[96:99], v[16:19]
    v_mfma_f32_16x16x32_bf16 v[20:23], a[132:135], a[96:99], v[20:23]
    v_mfma_f32_16x16x32_bf16 v[20:23], a[128:131], a[100:103], v[20:23]
    v_mfma_f32_16x16x32_bf16 v[24:27], a[132:135], a[100:103], v[24:27]
    v_mfma_f32_16x16x32_bf16 v[24:27], a[136:139], a[96:99], v[24:27]
    v_mfma_f32_16x16x32_bf16 v[28:31], a[136:139], a[100:103], v[28:31]
    v_mfma_f32_16x16x32_bf16 v[24:27], a[128:131], a[104:107], v[24:27]
    v_mfma_f32_16x16x32_bf16 v[28:31], a[132:135], a[104:107], v[28:31]
    v_mfma_f32_16x16x32_bf16 v[32:35], a[136:139], a[104:107], v[32:35]
    s_waitcnt lgkmcnt(13)
    v_mfma_f32_16x16x32_bf16 v[28:31], a[140:143], a[96:99], v[28:31]
    v_mfma_f32_16x16x32_bf16 v[32:35], a[140:143], a[100:103], v[32:35]
    v_mfma_f32_16x16x32_bf16 v[36:39], a[140:143], a[104:107], v[36:39]
    s_waitcnt lgkmcnt(12)
    v_mfma_f32_16x16x32_bf16 v[28:31], a[128:131], a[108:111], v[28:31]
    v_mfma_f32_16x16x32_bf16 v[32:35], a[132:135], a[108:111], v[32:35]
    v_mfma_f32_16x16x32_bf16 v[36:39], a[136:139], a[108:111], v[36:39]
    v_mfma_f32_16x16x32_bf16 v[40:43], a[140:143], a[108:111], v[40:43]
    s_waitcnt lgkmcnt(10)
    v_mfma_f32_16x16x32_bf16 v[32:35], a[144:147], a[96:99], v[32:35]
    v_mfma_f32_16x16x32_bf16 v[36:39], a[144:147], a[100:103], v[36:39]
    v_mfma_f32_16x16x32_bf16 v[40:43], a[144:147], a[104:107], v[40:43]
    v_mfma_f32_16x16x32_bf16 v[44:47], a[144:147], a[108:111], v[44:47]
    s_waitcnt lgkmcnt(9)
    v_mfma_f32_16x16x32_bf16 v[32:35], a[128:131], a[112:115], v[32:35]
    v_mfma_f32_16x16x32_bf16 v[36:39], a[132:135], a[112:115], v[36:39]
    v_mfma_f32_16x16x32_bf16 v[40:43], a[136:139], a[112:115], v[40:43]
    v_mfma_f32_16x16x32_bf16 v[44:47], a[140:143], a[112:115], v[44:47]
    s_waitcnt lgkmcnt(7)
    v_mfma_f32_16x16x32_bf16 v[36:39], a[148:151], a[96:99], v[36:39]
    v_mfma_f32_16x16x32_bf16 v[40:43], a[148:151], a[100:103], v[40:43]
    v_mfma_f32_16x16x32_bf16 v[44:47], a[148:151], a[104:107], v[44:47]
    s_waitcnt lgkmcnt(6)
    v_mfma_f32_16x16x32_bf16 v[36:39], a[128:131], a[116:119], v[36:39]
    v_mfma_f32_16x16x32_bf16 v[40:43], a[132:135], a[116:119], v[40:43]
    v_mfma_f32_16x16x32_bf16 v[44:47], a[136:139], a[116:119], v[44:47]
    s_waitcnt lgkmcnt(4)
    v_mfma_f32_16x16x32_bf16 v[40:43], a[152:155], a[96:99], v[40:43]
    v_mfma_f32_16x16x32_bf16 v[44:47], a[152:155], a[100:103], v[44:47]
    s_waitcnt lgkmcnt(3)
    v_mfma_f32_16x16x32_bf16 v[40:43], a[128:131], a[120:123], v[40:43]
    v_mfma_f32_16x16x32_bf16 v[44:47], a[132:135], a[120:123], v[44:47]
    s_waitcnt lgkmcnt(1)
    v_mfma_f32_16x16x32_bf16 v[44:47], a[156:159], a[96:99], v[44:47]
    s_waitcnt lgkmcnt(0)
    v_mfma_f32_16x16x32_bf16 v[44:47], a[128:131], a[124:127], v[44:47]
    v_add_u32 v158, s46, v153
    s_lshl_b32 s40, s3, 11
    v_add_u32 v159, s40, v153
    s_barrier
    s_nop 3
    ds_write_b128 v158, v[16:19] offset:0
    ds_write_b128 v158, v[20:23] offset:1024
    ds_write_b128 v158, v[24:27] offset:2048
    ds_write_b128 v158, v[28:31] offset:3072
    ds_write_b128 v158, v[32:35] offset:4096
    ds_write_b128 v158, v[36:39] offset:5120
    ds_write_b128 v158, v[40:43] offset:6144
    ds_write_b128 v158, v[44:47] offset:7168
    s_waitcnt lgkmcnt(0)
    s_barrier
    ds_read_b128 v[64:67], v159 offset:0
    ds_read_b128 v[68:71], v159 offset:1024
    ds_read_b128 v[72:75], v159 offset:16640
    ds_read_b128 v[76:79], v159 offset:17664
    ds_read_b128 v[80:83], v159 offset:33280
    ds_read_b128 v[84:87], v159 offset:34304
    ds_read_b128 v[88:91], v159 offset:49920
    ds_read_b128 v[92:95], v159 offset:50944
    s_waitcnt lgkmcnt(4)
    v_pk_add_f32 v[64:65], v[64:65], v[72:73]
    v_pk_add_f32 v[66:67], v[66:67], v[74:75]
    v_pk_add_f32 v[68:69], v[68:69], v[76:77]
    v_pk_add_f32 v[70:71], v[70:71], v[78:79]
    s_waitcnt lgkmcnt(2)
    v_pk_add_f32 v[64:65], v[64:65], v[80:81]
    v_pk_add_f32 v[66:67], v[66:67], v[82:83]
    v_pk_add_f32 v[68:69], v[68:69], v[84:85]
    v_pk_add_f32 v[70:71], v[70:71], v[86:87]
    s_waitcnt lgkmcnt(0)
    v_pk_add_f32 v[64:65], v[64:65], v[88:89]
    v_pk_add_f32 v[66:67], v[66:67], v[90:91]
    v_pk_add_f32 v[68:69], v[68:69], v[92:93]
    v_pk_add_f32 v[70:71], v[70:71], v[94:95]
    s_lshl_b32 s40, s3, 10
    v_add_u32 v158, s40, v154
    s_lshl_b32 s55, s45, 12
    v_cvt_pk_bf16_f32 v48, v64, v65
    v_cvt_pk_bf16_f32 v49, v66, v67
    v_cvt_pk_bf16_f32 v50, v68, v69
    v_cvt_pk_bf16_f32 v51, v70, v71
    s_nop 1
    v_permlane16_swap_b32 v48, v50
    v_permlane16_swap_b32 v49, v51
    buffer_store_dwordx4 v[48:51], v158, s[32:35], s55 offen offset:0 sc1
    s_waitcnt vmcnt(0)
    s_barrier
    v_mov_b32 v252, s65
    s_mov_b64 exec, s[66:67]
    buffer_store_dword v252, off, s[72:75], s100 sc1
    s_mov_b64 exec, -1
L_main_end:
    s_endpgm
L_code_end:
.section .rodata,"a"
.p2align 6
.amdhsa_kernel parallel_sum__ssm_conv_s4d__dense_activation_relu__prompt_kernel
  .amdhsa_next_free_vgpr 512
  .amdhsa_next_free_sgpr 102
  .amdhsa_accum_offset 256
  .amdhsa_group_segment_fixed_size 0
  .amdhsa_kernarg_size 104
  .amdhsa_user_sgpr_count 2
  .amdhsa_user_sgpr_kernarg_segment_ptr 1
  .amdhsa_system_sgpr_workgroup_id_x 1
.end_amdhsa_kernel
.text
```
